```python
import torch

def _softmax(x, axis=-1):
    return torch.softmax(x, dim=axis)

def _gelu(x):
    return torch.nn.functional.gelu(x, approximate='tanh')

def _silu(x):
    return torch.nn.functional.silu(x)

def _sigmoid(x):
    return torch.sigmoid(x)

def _layernorm(x, axis=-1, eps=1e-05):
    m = x.mean(dim=axis, keepdim=True)
    v = x.var(dim=axis, keepdim=True, unbiased=False)
    return (x - m) / torch.sqrt(v + eps)

def _scatter_add(tgt, idx, src, axis=0):
    return tgt.clone().index_add_(axis, idx, src)

def _segment_sum(src, seg, n):
    out = torch.zeros((n,) + src.shape[1:], dtype=src.dtype)
    return out.index_add_(0, seg, src)

def _pad(x, pw):
    flat = tuple((v for pair in reversed(pw) for v in pair))
    return torch.nn.functional.pad(x, flat)
kernel_name = 'interleave_layers__grouped_kv_mqa__memory_aug_recurrent_mem_tr__prompt'

def setup_inputs():

    _w = lambda a: (lambda t: t.to(torch.bfloat16) if t.is_floating_point() else t)(torch.as_tensor(a))

    def _A_setup():
        B, S, D, H = (1, 2048, 640, 32)
        Dh = D // H
        return {'x': _w((lambda *s: torch.randn(*s, dtype=torch.bfloat16) * 0.05)(B, S, D)), 'wq': _w((lambda *s: torch.randn(*s, dtype=torch.bfloat16) * 0.05)(D, H * Dh)), 'wk': _w((lambda *s: torch.randn(*s, dtype=torch.bfloat16) * 0.05)(D, Dh)), 'wv': _w((lambda *s: torch.randn(*s, dtype=torch.bfloat16) * 0.05)(D, Dh)), 'wo': _w((lambda *s: torch.randn(*s, dtype=torch.bfloat16) * 0.05)(H * Dh, D))}
    _A_in = _A_setup()

    def _B_setup():
        B, S, Dm = (1, 2048, 640)
        H, Dh = (32, 128)
        M, seg = (8, 32)
        seg = min(seg, S)
        S = S // seg * seg
        return {'x': _w((lambda *s: torch.randn(*s, dtype=torch.bfloat16) * 0.05)(B, S, Dm)), 'mem0': _w((lambda *s: torch.randn(*s, dtype=torch.bfloat16) * 0.8)(B, M, Dm)), 'Wq': _w((lambda *s: torch.randn(*s, dtype=torch.bfloat16) * 1.6)(Dm, H, Dh) * Dm ** (-0.5)), 'Wk': _w((lambda *s: torch.randn(*s, dtype=torch.bfloat16) * 1.6)(Dm, H, Dh) * Dm ** (-0.5)), 'Wv': _w((lambda *s: torch.randn(*s, dtype=torch.bfloat16) * 0.8)(Dm, H, Dh) * Dm ** (-0.5)), 'Wo': _w((lambda *s: torch.randn(*s, dtype=torch.bfloat16) * 0.8)(H, Dh, Dm) * (H * Dh) ** (-0.5)), 'seg_len': seg}
    _B_in = _B_setup()
    return {'A_x': _A_in['x'], 'A_wq': _A_in['wq'], 'A_wk': _A_in['wk'], 'A_wv': _A_in['wv'], 'A_wo': _A_in['wo'], 'B_x': _B_in['x'], 'B_mem0': _B_in['mem0'], 'B_Wq': _B_in['Wq'], 'B_Wk': _B_in['Wk'], 'B_Wv': _B_in['Wv'], 'B_Wo': _B_in['Wo'], 'B_seg_len': _B_in['seg_len']}

def reference(A_x, A_wq, A_wk, A_wv, A_wo, B_x, B_mem0, B_Wq, B_Wk, B_Wv, B_Wo, B_seg_len):

    def _A_ref(x, wq, wk, wv, wo):
        B, S, D = x.shape
        H = 32
        Dh = D // H
        q = (lambda x, *d: x.permute(*d))((x @ wq).reshape(B, S, H, Dh), 0, 2, 1, 3)
        k = x @ wk
        v = x @ wv
        scores = torch.einsum('bhqd,bkd->bhqk', q, k) * Dh ** (-0.5)
        p = _softmax(scores, axis=-1)
        o = torch.einsum('bhqk,bkd->bhqd', p, v)
        return (lambda x, *d: x.permute(*d))(o, 0, 2, 1, 3).reshape(B, S, H * Dh) @ wo

    def _B_ref(x, mem0, Wq, Wk, Wv, Wo, seg_len):
        B, S, Dm = x.shape
        H, Dh = (Wq.shape[1], Wq.shape[2])
        M = mem0.shape[1]
        scale = Dh ** (-0.5)
        n_seg = S // seg_len
        L = M + seg_len
        idx = torch.arange(L)
        mask = (idx[:, None] < M) | (idx[:, None] >= idx[None, :])
        mem = mem0
        outs = []
        for s in range(n_seg):
            xs = x[:, s * seg_len:(s + 1) * seg_len, :].clone()
            h = torch.concatenate([mem, xs], axis=1)
            q = torch.einsum('btd,dhe->bhte', h, Wq)
            k = torch.einsum('btd,dhe->bhte', h, Wk)
            v = torch.einsum('btd,dhe->bhte', h, Wv)
            scores = torch.einsum('bhqe,bhke->bhqk', q, k) * scale
            scores = torch.where(mask[None, None], scores, -1000000000.0)
            p = _softmax(scores, axis=-1)
            o = torch.einsum('bhqk,bhke->bhqe', p, v)
            o = torch.einsum('bhte,hed->btd', o, Wo)
            mem = o[:, :M, :].clone()
            outs.append(o[:, M:, :])
        return torch.concatenate(outs, axis=1)
    x = A_x
    x = x + _A_ref(_layernorm(x, axis=-1), A_wq, A_wk, A_wv, A_wo)
    x = x + _B_ref(_layernorm(x, axis=-1), B_mem0, B_Wq, B_Wk, B_Wv, B_Wo, B_seg_len)
    x = x + _A_ref(_layernorm(x, axis=-1), A_wq, A_wk, A_wv, A_wo)
    x = x + _B_ref(_layernorm(x, axis=-1), B_mem0, B_Wq, B_Wk, B_Wv, B_Wo, B_seg_len)
    return x
```

```asm
; @launch kernel=init_kernel grid=(32,1,1) block=(256,1,1) lds=0
; @launch kernel=m0_kernel grid=(256,1,1) block=(256,1,1) lds=163840
.amdgcn_target "amdgcn-amd-amdhsa--gfx950"
.text
.globl init_kernel
.p2align 8
.type init_kernel,@function
init_kernel:
    s_load_dwordx2 s[4:5], s[0:1], 112
    s_waitcnt lgkmcnt(0)
    s_mov_b32 s8, s4
    s_mov_b32 s9, s5
    s_mov_b32 s10, 0x20000
    s_mov_b32 s11, 0x20000
    s_lshl_b32 s3, s2, 12
    v_lshlrev_b32 v1, 4, v0
    v_add_u32 v1, s3, v1
    v_mov_b32 v4, 0
    v_mov_b32 v5, 0
    v_mov_b32 v6, 0
    v_mov_b32 v7, 0
    buffer_store_dwordx4 v[4:7], v1, s[8:11], 0 offen
    s_endpgm
.text
.globl m0_kernel
.p2align 8
.type m0_kernel,@function
m0_kernel:
    s_mov_b32 s16, 127
    s_mov_b32 s14, 0
    s_mov_b32 s15, 2
    s_branch MAIN
MAIN:
    s_mov_b32 s99, 0
    s_cmp_ge_u32 s2, 256
    s_cbranch_scc1 EXIT
    s_load_dwordx2 s[4:5], s[0:1], 112
    s_load_dwordx2 s[6:7], s[0:1], 104
    s_getreg_b32 s18, hwreg(HW_REG_XCC_ID)
    s_and_b32 s18, s18, 7
    v_lshrrev_b32 v1, 6, v0
    v_and_b32 v0, 63, v0
    v_readfirstlane_b32 s13, v1
    s_nop 0
    s_waitcnt lgkmcnt(0)
    s_mov_b32 s8, s4
    s_mov_b32 s9, s5
    s_mov_b32 s10, 0x10000000
    s_mov_b32 s11, 0x20000
    s_mov_b32 s20, s6
    s_mov_b32 s21, s7
    s_mov_b32 s22, 0x100
    s_mov_b32 s23, 0x20000
    s_cmp_lg_u32 s13, 0
    s_cbranch_scc1 TK_DONE
    s_lshl_b32 s3, s18, 4
    v_mov_b32 v2, s3
    v_mov_b32 v3, 1
    s_mov_b64 exec, 1
    buffer_atomic_add v3, v2, s[20:23], 0 offen sc0 sc1
    s_waitcnt vmcnt(0)
    s_mov_b64 exec, -1
    v_readfirstlane_b32 s3, v3
    s_nop 0
    s_lshl_b32 s24, s18, 5
    s_add_u32 s24, s24, s3
    s_cmp_lt_u32 s3, 32
    s_cbranch_scc1 TK_HAVE
    v_mov_b32 v2, 128
    v_mov_b32 v3, 1
    s_mov_b64 exec, 1
    buffer_atomic_add v3, v2, s[20:23], 0 offen sc0 sc1
    s_waitcnt vmcnt(0)
    s_mov_b64 exec, -1
    v_readfirstlane_b32 s25, v3
    v_and_b32 v2, 7, v0
    v_lshlrev_b32 v2, 4, v2
    s_mov_b32 s27, 0
TK_W:
    buffer_load_dword v3, v2, s[20:23], 0 offen sc1
    s_waitcnt vmcnt(0)
    s_mov_b32 s26, 0
    v_readlane_b32 s30, v3, 0
    s_nop 0
    s_add_u32 s26, s26, s30
    v_readlane_b32 s31, v3, 1
    s_nop 0
    s_add_u32 s26, s26, s31
    v_readlane_b32 s32, v3, 2
    s_nop 0
    s_add_u32 s26, s26, s32
    v_readlane_b32 s33, v3, 3
    s_nop 0
    s_add_u32 s26, s26, s33
    v_readlane_b32 s34, v3, 4
    s_nop 0
    s_add_u32 s26, s26, s34
    v_readlane_b32 s35, v3, 5
    s_nop 0
    s_add_u32 s26, s26, s35
    v_readlane_b32 s36, v3, 6
    s_nop 0
    s_add_u32 s26, s26, s36
    v_readlane_b32 s37, v3, 7
    s_nop 0
    s_add_u32 s26, s26, s37
    s_add_u32 s27, s27, 1
    s_cmp_ge_u32 s27, 0x80000
    s_cbranch_scc1 TK_S
    s_cmp_lt_u32 s26, 256
    s_cbranch_scc1 TK_W
TK_S:
    s_mov_b32 s24, 0
    s_min_u32 s26, s30, 32
    s_sub_u32 s27, 32, s26
    s_cmp_ge_u32 s25, s27
    s_cbranch_scc1 TKN_1
    s_add_u32 s24, s26, s25
    s_add_u32 s24, s24, 0
    s_branch TK_HAVE
TKN_1:
    s_sub_u32 s25, s25, s27
    s_min_u32 s26, s31, 32
    s_sub_u32 s27, 32, s26
    s_cmp_ge_u32 s25, s27
    s_cbranch_scc1 TKN_2
    s_add_u32 s24, s26, s25
    s_add_u32 s24, s24, 32
    s_branch TK_HAVE
TKN_2:
    s_sub_u32 s25, s25, s27
    s_min_u32 s26, s32, 32
    s_sub_u32 s27, 32, s26
    s_cmp_ge_u32 s25, s27
    s_cbranch_scc1 TKN_3
    s_add_u32 s24, s26, s25
    s_add_u32 s24, s24, 64
    s_branch TK_HAVE
TKN_3:
    s_sub_u32 s25, s25, s27
    s_min_u32 s26, s33, 32
    s_sub_u32 s27, 32, s26
    s_cmp_ge_u32 s25, s27
    s_cbranch_scc1 TKN_4
    s_add_u32 s24, s26, s25
    s_add_u32 s24, s24, 96
    s_branch TK_HAVE
TKN_4:
    s_sub_u32 s25, s25, s27
    s_min_u32 s26, s34, 32
    s_sub_u32 s27, 32, s26
    s_cmp_ge_u32 s25, s27
    s_cbranch_scc1 TKN_5
    s_add_u32 s24, s26, s25
    s_add_u32 s24, s24, 128
    s_branch TK_HAVE
TKN_5:
    s_sub_u32 s25, s25, s27
    s_min_u32 s26, s35, 32
    s_sub_u32 s27, 32, s26
    s_cmp_ge_u32 s25, s27
    s_cbranch_scc1 TKN_6
    s_add_u32 s24, s26, s25
    s_add_u32 s24, s24, 160
    s_branch TK_HAVE
TKN_6:
    s_sub_u32 s25, s25, s27
    s_min_u32 s26, s36, 32
    s_sub_u32 s27, 32, s26
    s_cmp_ge_u32 s25, s27
    s_cbranch_scc1 TKN_7
    s_add_u32 s24, s26, s25
    s_add_u32 s24, s24, 192
    s_branch TK_HAVE
TKN_7:
    s_sub_u32 s25, s25, s27
    s_min_u32 s26, s37, 32
    s_sub_u32 s27, 32, s26
    s_cmp_ge_u32 s25, s27
    s_cbranch_scc1 TKN_8
    s_add_u32 s24, s26, s25
    s_add_u32 s24, s24, 224
    s_branch TK_HAVE
TKN_8:
    s_sub_u32 s25, s25, s27
TK_HAVE:
    v_mov_b32 v2, 0
    v_mov_b32 v3, s24
    ds_write_b32 v2, v3
    s_waitcnt lgkmcnt(0)
TK_DONE:
    s_barrier
    v_mov_b32 v2, 0
    ds_read_b32 v3, v2
    s_waitcnt lgkmcnt(0)
    v_readfirstlane_b32 s12, v3
    s_nop 0
    s_barrier
    s_cmp_ge_u32 s12, 32
    s_nop 0
    s_cbranch_scc1 RD_9
    s_and_b32 s3, s16, 16
    s_cbranch_scc0 EXIT
    s_branch ROLE_R
RD_9:
    s_sub_u32 s12, s12, 32
    s_cmp_ge_u32 s12, 64
    s_cbranch_scc1 RD_10
    s_and_b32 s3, s16, 8
    s_cbranch_scc0 EXIT
    s_branch ROLE_KV
RD_10:
    s_sub_u32 s12, s12, 64
    s_cmp_ge_u32 s12, 48
    s_cbranch_scc1 RD_11
    s_and_b32 s3, s16, 33
    s_cbranch_scc0 EXIT
    s_branch ROLE_QA
RD_11:
    s_sub_u32 s12, s12, 48
    s_cmp_ge_u32 s12, 40
    s_cbranch_scc1 RD_12
    s_and_b32 s3, s16, 64
    s_cbranch_scc0 EXIT
    s_branch ROLE_BO
RD_12:
    s_sub_u32 s12, s12, 40
    s_cmp_ge_u32 s12, 6
    s_cbranch_scc1 RD_13
    s_and_b32 s3, s16, 4
    s_cbranch_scc0 EXIT
    s_branch ROLE_AO
RD_13:
    s_sub_u32 s12, s12, 6
    s_cmp_ge_u32 s12, 6
    s_cbranch_scc1 RD_14
    s_and_b32 s3, s16, 1
    s_cbranch_scc0 EXIT
    s_branch ROLE_P1
RD_14:
    s_sub_u32 s12, s12, 6
    s_cmp_ge_u32 s12, 60
    s_cbranch_scc1 RD_15
    s_and_b32 s3, s16, 3
    s_cbranch_scc0 EXIT
    s_branch ROLE_AT
RD_15:
    s_sub_u32 s12, s12, 60
EXIT:
    s_endpgm
ROLE_P1:
    s_mov_b32 s19, s12
    s_mov_b32 s47, 0
P1_BODY:
    s_mul_i32 s42, s19, 43
    s_lshr_b32 s42, s42, 7
    s_mul_i32 s3, s42, 3
    s_sub_u32 s19, s19, s3
    v_lshlrev_b32 v1, 4, v0
    s_add_u32 s3, s13, 0
    s_and_b32 s3, s3, 3
    s_mul_i32 s3, s3, 5120
    v_add_u32 v2, s3, v1
    s_add_u32 s3, s13, 1
    s_and_b32 s3, s3, 3
    s_mul_i32 s3, s3, 5120
    v_add_u32 v3, s3, v1
    s_add_u32 s3, s13, 2
    s_and_b32 s3, s3, 3
    s_mul_i32 s3, s3, 5120
    v_add_u32 v4, s3, v1
    s_add_u32 s3, s13, 3
    s_and_b32 s3, s3, 3
    s_mul_i32 s3, s3, 5120
    v_add_u32 v5, s3, v1
    v_mov_b32 v176, 0x3f803f80
    v_mov_b32 v177, 0x3f803f80
    v_mov_b32 v178, 0x3f803f80
    v_mov_b32 v179, 0x3f803f80
    v_lshrrev_b32 v16, 4, v0
    v_lshlrev_b32 v16, 10, v16
    v_bfe_u32 v17, v0, 2, 2
    v_lshl_add_u32 v16, v17, 7, v16
    v_and_b32 v17, 3, v0
    v_lshl_add_u32 v16, v17, 4, v16
    s_mul_i32 s48, s13, 40960
    v_add_u32 v13, s48, v16
    v_and_b32 v16, 15, v0
    v_lshlrev_b32 v11, 3, v16
    v_add_u32 v11, 81920, v11
    s_lshl_b32 s3, s13, 8
    v_add_u32 v10, s3, v11
    v_and_b32 v17, 3, v0
    v_cmp_eq_u32 s[50:51], 1, v17
    v_cmp_eq_u32 s[52:53], 2, v17
    v_cmp_eq_u32 s[54:55], 3, v17
    v_lshrrev_b32 v17, 2, v16
    v_lshrrev_b32 v18, 4, v0
    v_cmp_eq_u32 s[56:57], v17, v18
    s_nop 0
    s_lshl_b32 s64, s19, 2
    s_add_u32 s64, s64, s13
    s_mov_b32 s46, 0
    s_cmp_ge_u32 s64, 10
    s_cbranch_scc1 P1_KVW
    s_load_dwordx2 s[4:5], s[0:1], 8
    s_waitcnt lgkmcnt(0)
    s_mov_b32 s28, s4
    s_mov_b32 s29, s5
    s_mov_b32 s30, 0xc8000
    s_mov_b32 s31, 0x20000
    s_lshl_b32 s65, s64, 7
    v_lshrrev_b32 v16, 3, v0
    v_mul_u32_u24 v16, 1280, v16
    v_and_b32 v17, 7, v0
    v_lshl_add_u32 v14, v17, 4, v16
    s_add_u32 s3, s13, 0
    s_and_b32 s3, s3, 3
    s_mul_i32 s3, s3, 204800
    s_add_u32 s60, s3, s65
    s_add_u32 s3, s13, 1
    s_and_b32 s3, s3, 3
    s_mul_i32 s3, s3, 204800
    s_add_u32 s61, s3, s65
    s_add_u32 s3, s13, 2
    s_and_b32 s3, s3, 3
    s_mul_i32 s3, s3, 204800
    s_add_u32 s62, s3, s65
    s_add_u32 s3, s13, 3
    s_and_b32 s3, s3, 3
    s_mul_i32 s3, s3, 204800
    s_add_u32 s63, s3, s65
    s_add_u32 m0, s48, 0
    s_add_u32 s3, s60, 0x0
    buffer_load_dwordx4 v14, s[28:31], s3 offen lds
    s_add_u32 m0, s48, 1024
    s_add_u32 s3, s60, 0x2800
    buffer_load_dwordx4 v14, s[28:31], s3 offen lds
    s_add_u32 m0, s48, 2048
    s_add_u32 s3, s60, 0x5000
    buffer_load_dwordx4 v14, s[28:31], s3 offen lds
    s_add_u32 m0, s48, 3072
    s_add_u32 s3, s60, 0x7800
    buffer_load_dwordx4 v14, s[28:31], s3 offen lds
    s_add_u32 m0, s48, 4096
    s_add_u32 s3, s60, 0xa000
    buffer_load_dwordx4 v14, s[28:31], s3 offen lds
    s_add_u32 m0, s48, 5120
    s_add_u32 s3, s60, 0xc800
    buffer_load_dwordx4 v14, s[28:31], s3 offen lds
    s_add_u32 m0, s48, 6144
    s_add_u32 s3, s60, 0xf000
    buffer_load_dwordx4 v14, s[28:31], s3 offen lds
    s_add_u32 m0, s48, 7168
    s_add_u32 s3, s60, 0x11800
    buffer_load_dwordx4 v14, s[28:31], s3 offen lds
    s_add_u32 m0, s48, 8192
    s_add_u32 s3, s60, 0x14000
    buffer_load_dwordx4 v14, s[28:31], s3 offen lds
    s_add_u32 m0, s48, 9216
    s_add_u32 s3, s60, 0x16800
    buffer_load_dwordx4 v14, s[28:31], s3 offen lds
    s_add_u32 m0, s48, 10240
    s_add_u32 s3, s60, 0x19000
    buffer_load_dwordx4 v14, s[28:31], s3 offen lds
    s_add_u32 m0, s48, 11264
    s_add_u32 s3, s60, 0x1b800
    buffer_load_dwordx4 v14, s[28:31], s3 offen lds
    s_add_u32 m0, s48, 12288
    s_add_u32 s3, s60, 0x1e000
    buffer_load_dwordx4 v14, s[28:31], s3 offen lds
    s_add_u32 m0, s48, 13312
    s_add_u32 s3, s60, 0x20800
    buffer_load_dwordx4 v14, s[28:31], s3 offen lds
    s_add_u32 m0, s48, 14336
    s_add_u32 s3, s60, 0x23000
    buffer_load_dwordx4 v14, s[28:31], s3 offen lds
    s_add_u32 m0, s48, 15360
    s_add_u32 s3, s60, 0x25800
    buffer_load_dwordx4 v14, s[28:31], s3 offen lds
    s_add_u32 m0, s48, 16384
    s_add_u32 s3, s60, 0x28000
    buffer_load_dwordx4 v14, s[28:31], s3 offen lds
    s_add_u32 m0, s48, 17408
    s_add_u32 s3, s60, 0x2a800
    buffer_load_dwordx4 v14, s[28:31], s3 offen lds
    s_add_u32 m0, s48, 18432
    s_add_u32 s3, s60, 0x2d000
    buffer_load_dwordx4 v14, s[28:31], s3 offen lds
    s_add_u32 m0, s48, 19456
    s_add_u32 s3, s60, 0x2f800
    buffer_load_dwordx4 v14, s[28:31], s3 offen lds
    s_add_u32 m0, s48, 20480
    s_add_u32 s3, s61, 0x0
    buffer_load_dwordx4 v14, s[28:31], s3 offen lds
    s_add_u32 m0, s48, 21504
    s_add_u32 s3, s61, 0x2800
    buffer_load_dwordx4 v14, s[28:31], s3 offen lds
    s_add_u32 m0, s48, 22528
    s_add_u32 s3, s61, 0x5000
    buffer_load_dwordx4 v14, s[28:31], s3 offen lds
    s_add_u32 m0, s48, 23552
    s_add_u32 s3, s61, 0x7800
    buffer_load_dwordx4 v14, s[28:31], s3 offen lds
    s_add_u32 m0, s48, 24576
    s_add_u32 s3, s61, 0xa000
    buffer_load_dwordx4 v14, s[28:31], s3 offen lds
    s_add_u32 m0, s48, 25600
    s_add_u32 s3, s61, 0xc800
    buffer_load_dwordx4 v14, s[28:31], s3 offen lds
    s_add_u32 m0, s48, 26624
    s_add_u32 s3, s61, 0xf000
    buffer_load_dwordx4 v14, s[28:31], s3 offen lds
    s_add_u32 m0, s48, 27648
    s_add_u32 s3, s61, 0x11800
    buffer_load_dwordx4 v14, s[28:31], s3 offen lds
    s_add_u32 m0, s48, 28672
    s_add_u32 s3, s61, 0x14000
    buffer_load_dwordx4 v14, s[28:31], s3 offen lds
    s_add_u32 m0, s48, 29696
    s_add_u32 s3, s61, 0x16800
    buffer_load_dwordx4 v14, s[28:31], s3 offen lds
    s_add_u32 m0, s48, 30720
    s_add_u32 s3, s61, 0x19000
    buffer_load_dwordx4 v14, s[28:31], s3 offen lds
    s_add_u32 m0, s48, 31744
    s_add_u32 s3, s61, 0x1b800
    buffer_load_dwordx4 v14, s[28:31], s3 offen lds
    s_add_u32 m0, s48, 32768
    s_add_u32 s3, s61, 0x1e000
    buffer_load_dwordx4 v14, s[28:31], s3 offen lds
    s_add_u32 m0, s48, 33792
    s_add_u32 s3, s61, 0x20800
    buffer_load_dwordx4 v14, s[28:31], s3 offen lds
    s_add_u32 m0, s48, 34816
    s_add_u32 s3, s61, 0x23000
    buffer_load_dwordx4 v14, s[28:31], s3 offen lds
    s_add_u32 m0, s48, 35840
    s_add_u32 s3, s61, 0x25800
    buffer_load_dwordx4 v14, s[28:31], s3 offen lds
    s_add_u32 m0, s48, 36864
    s_add_u32 s3, s61, 0x28000
    buffer_load_dwordx4 v14, s[28:31], s3 offen lds
    s_add_u32 m0, s48, 37888
    s_add_u32 s3, s61, 0x2a800
    buffer_load_dwordx4 v14, s[28:31], s3 offen lds
    s_add_u32 m0, s48, 38912
    s_add_u32 s3, s61, 0x2d000
    buffer_load_dwordx4 v14, s[28:31], s3 offen lds
    s_add_u32 m0, s48, 39936
    s_add_u32 s3, s61, 0x2f800
    buffer_load_dwordx4 v14, s[28:31], s3 offen lds
    s_waitcnt vmcnt(20)
    ds_read_b64_tr_b16 a[0:1], v13 offset:0
    ds_read_b64_tr_b16 a[2:3], v13 offset:512
    ds_read_b64_tr_b16 a[4:5], v13 offset:8
    ds_read_b64_tr_b16 a[6:7], v13 offset:520
    ds_read_b64_tr_b16 a[8:9], v13 offset:64
    ds_read_b64_tr_b16 a[10:11], v13 offset:576
    ds_read_b64_tr_b16 a[12:13], v13 offset:72
    ds_read_b64_tr_b16 a[14:15], v13 offset:584
    ds_read_b64_tr_b16 a[16:17], v13 offset:4096
    ds_read_b64_tr_b16 a[18:19], v13 offset:4608
    ds_read_b64_tr_b16 a[20:21], v13 offset:4104
    ds_read_b64_tr_b16 a[22:23], v13 offset:4616
    ds_read_b64_tr_b16 a[24:25], v13 offset:4160
    ds_read_b64_tr_b16 a[26:27], v13 offset:4672
    ds_read_b64_tr_b16 a[28:29], v13 offset:4168
    ds_read_b64_tr_b16 a[30:31], v13 offset:4680
    ds_read_b64_tr_b16 a[32:33], v13 offset:8192
    ds_read_b64_tr_b16 a[34:35], v13 offset:8704
    ds_read_b64_tr_b16 a[36:37], v13 offset:8200
    ds_read_b64_tr_b16 a[38:39], v13 offset:8712
    ds_read_b64_tr_b16 a[40:41], v13 offset:8256
    ds_read_b64_tr_b16 a[42:43], v13 offset:8768
    ds_read_b64_tr_b16 a[44:45], v13 offset:8264
    ds_read_b64_tr_b16 a[46:47], v13 offset:8776
    ds_read_b64_tr_b16 a[48:49], v13 offset:12288
    ds_read_b64_tr_b16 a[50:51], v13 offset:12800
    ds_read_b64_tr_b16 a[52:53], v13 offset:12296
    ds_read_b64_tr_b16 a[54:55], v13 offset:12808
    ds_read_b64_tr_b16 a[56:57], v13 offset:12352
    ds_read_b64_tr_b16 a[58:59], v13 offset:12864
    ds_read_b64_tr_b16 a[60:61], v13 offset:12360
    ds_read_b64_tr_b16 a[62:63], v13 offset:12872
    ds_read_b64_tr_b16 a[64:65], v13 offset:16384
    ds_read_b64_tr_b16 a[66:67], v13 offset:16896
    ds_read_b64_tr_b16 a[68:69], v13 offset:16392
    ds_read_b64_tr_b16 a[70:71], v13 offset:16904
    ds_read_b64_tr_b16 a[72:73], v13 offset:16448
    ds_read_b64_tr_b16 a[74:75], v13 offset:16960
    ds_read_b64_tr_b16 a[76:77], v13 offset:16456
    ds_read_b64_tr_b16 a[78:79], v13 offset:16968
    s_waitcnt lgkmcnt(0)
    s_add_u32 m0, s48, 0
    s_add_u32 s3, s62, 0x0
    buffer_load_dwordx4 v14, s[28:31], s3 offen lds
    s_add_u32 m0, s48, 1024
    s_add_u32 s3, s62, 0x2800
    buffer_load_dwordx4 v14, s[28:31], s3 offen lds
    s_add_u32 m0, s48, 2048
    s_add_u32 s3, s62, 0x5000
    buffer_load_dwordx4 v14, s[28:31], s3 offen lds
    s_add_u32 m0, s48, 3072
    s_add_u32 s3, s62, 0x7800
    buffer_load_dwordx4 v14, s[28:31], s3 offen lds
    s_add_u32 m0, s48, 4096
    s_add_u32 s3, s62, 0xa000
    buffer_load_dwordx4 v14, s[28:31], s3 offen lds
    s_add_u32 m0, s48, 5120
    s_add_u32 s3, s62, 0xc800
    buffer_load_dwordx4 v14, s[28:31], s3 offen lds
    s_add_u32 m0, s48, 6144
    s_add_u32 s3, s62, 0xf000
    buffer_load_dwordx4 v14, s[28:31], s3 offen lds
    s_add_u32 m0, s48, 7168
    s_add_u32 s3, s62, 0x11800
    buffer_load_dwordx4 v14, s[28:31], s3 offen lds
    s_add_u32 m0, s48, 8192
    s_add_u32 s3, s62, 0x14000
    buffer_load_dwordx4 v14, s[28:31], s3 offen lds
    s_add_u32 m0, s48, 9216
    s_add_u32 s3, s62, 0x16800
    buffer_load_dwordx4 v14, s[28:31], s3 offen lds
    s_add_u32 m0, s48, 10240
    s_add_u32 s3, s62, 0x19000
    buffer_load_dwordx4 v14, s[28:31], s3 offen lds
    s_add_u32 m0, s48, 11264
    s_add_u32 s3, s62, 0x1b800
    buffer_load_dwordx4 v14, s[28:31], s3 offen lds
    s_add_u32 m0, s48, 12288
    s_add_u32 s3, s62, 0x1e000
    buffer_load_dwordx4 v14, s[28:31], s3 offen lds
    s_add_u32 m0, s48, 13312
    s_add_u32 s3, s62, 0x20800
    buffer_load_dwordx4 v14, s[28:31], s3 offen lds
    s_add_u32 m0, s48, 14336
    s_add_u32 s3, s62, 0x23000
    buffer_load_dwordx4 v14, s[28:31], s3 offen lds
    s_add_u32 m0, s48, 15360
    s_add_u32 s3, s62, 0x25800
    buffer_load_dwordx4 v14, s[28:31], s3 offen lds
    s_add_u32 m0, s48, 16384
    s_add_u32 s3, s62, 0x28000
    buffer_load_dwordx4 v14, s[28:31], s3 offen lds
    s_add_u32 m0, s48, 17408
    s_add_u32 s3, s62, 0x2a800
    buffer_load_dwordx4 v14, s[28:31], s3 offen lds
    s_add_u32 m0, s48, 18432
    s_add_u32 s3, s62, 0x2d000
    buffer_load_dwordx4 v14, s[28:31], s3 offen lds
    s_add_u32 m0, s48, 19456
    s_add_u32 s3, s62, 0x2f800
    buffer_load_dwordx4 v14, s[28:31], s3 offen lds
    s_waitcnt vmcnt(20)
    ds_read_b64_tr_b16 a[80:81], v13 offset:20480
    ds_read_b64_tr_b16 a[82:83], v13 offset:20992
    ds_read_b64_tr_b16 a[84:85], v13 offset:20488
    ds_read_b64_tr_b16 a[86:87], v13 offset:21000
    ds_read_b64_tr_b16 a[88:89], v13 offset:20544
    ds_read_b64_tr_b16 a[90:91], v13 offset:21056
    ds_read_b64_tr_b16 a[92:93], v13 offset:20552
    ds_read_b64_tr_b16 a[94:95], v13 offset:21064
    ds_read_b64_tr_b16 a[96:97], v13 offset:24576
    ds_read_b64_tr_b16 a[98:99], v13 offset:25088
    ds_read_b64_tr_b16 a[100:101], v13 offset:24584
    ds_read_b64_tr_b16 a[102:103], v13 offset:25096
    ds_read_b64_tr_b16 a[104:105], v13 offset:24640
    ds_read_b64_tr_b16 a[106:107], v13 offset:25152
    ds_read_b64_tr_b16 a[108:109], v13 offset:24648
    ds_read_b64_tr_b16 a[110:111], v13 offset:25160
    ds_read_b64_tr_b16 a[112:113], v13 offset:28672
    ds_read_b64_tr_b16 a[114:115], v13 offset:29184
    ds_read_b64_tr_b16 a[116:117], v13 offset:28680
    ds_read_b64_tr_b16 a[118:119], v13 offset:29192
    ds_read_b64_tr_b16 a[120:121], v13 offset:28736
    ds_read_b64_tr_b16 a[122:123], v13 offset:29248
    ds_read_b64_tr_b16 a[124:125], v13 offset:28744
    ds_read_b64_tr_b16 a[126:127], v13 offset:29256
    ds_read_b64_tr_b16 a[128:129], v13 offset:32768
    ds_read_b64_tr_b16 a[130:131], v13 offset:33280
    ds_read_b64_tr_b16 a[132:133], v13 offset:32776
    ds_read_b64_tr_b16 a[134:135], v13 offset:33288
    ds_read_b64_tr_b16 a[136:137], v13 offset:32832
    ds_read_b64_tr_b16 a[138:139], v13 offset:33344
    ds_read_b64_tr_b16 a[140:141], v13 offset:32840
    ds_read_b64_tr_b16 a[142:143], v13 offset:33352
    ds_read_b64_tr_b16 a[144:145], v13 offset:36864
    ds_read_b64_tr_b16 a[146:147], v13 offset:37376
    ds_read_b64_tr_b16 a[148:149], v13 offset:36872
    ds_read_b64_tr_b16 a[150:151], v13 offset:37384
    ds_read_b64_tr_b16 a[152:153], v13 offset:36928
    ds_read_b64_tr_b16 a[154:155], v13 offset:37440
    ds_read_b64_tr_b16 a[156:157], v13 offset:36936
    ds_read_b64_tr_b16 a[158:159], v13 offset:37448
    s_waitcnt lgkmcnt(0)
    s_add_u32 m0, s48, 20480
    s_add_u32 s3, s63, 0x0
    buffer_load_dwordx4 v14, s[28:31], s3 offen lds
    s_add_u32 m0, s48, 21504
    s_add_u32 s3, s63, 0x2800
    buffer_load_dwordx4 v14, s[28:31], s3 offen lds
    s_add_u32 m0, s48, 22528
    s_add_u32 s3, s63, 0x5000
    buffer_load_dwordx4 v14, s[28:31], s3 offen lds
    s_add_u32 m0, s48, 23552
    s_add_u32 s3, s63, 0x7800
    buffer_load_dwordx4 v14, s[28:31], s3 offen lds
    s_add_u32 m0, s48, 24576
    s_add_u32 s3, s63, 0xa000
    buffer_load_dwordx4 v14, s[28:31], s3 offen lds
    s_add_u32 m0, s48, 25600
    s_add_u32 s3, s63, 0xc800
    buffer_load_dwordx4 v14, s[28:31], s3 offen lds
    s_add_u32 m0, s48, 26624
    s_add_u32 s3, s63, 0xf000
    buffer_load_dwordx4 v14, s[28:31], s3 offen lds
    s_add_u32 m0, s48, 27648
    s_add_u32 s3, s63, 0x11800
    buffer_load_dwordx4 v14, s[28:31], s3 offen lds
    s_add_u32 m0, s48, 28672
    s_add_u32 s3, s63, 0x14000
    buffer_load_dwordx4 v14, s[28:31], s3 offen lds
    s_add_u32 m0, s48, 29696
    s_add_u32 s3, s63, 0x16800
    buffer_load_dwordx4 v14, s[28:31], s3 offen lds
    s_add_u32 m0, s48, 30720
    s_add_u32 s3, s63, 0x19000
    buffer_load_dwordx4 v14, s[28:31], s3 offen lds
    s_add_u32 m0, s48, 31744
    s_add_u32 s3, s63, 0x1b800
    buffer_load_dwordx4 v14, s[28:31], s3 offen lds
    s_add_u32 m0, s48, 32768
    s_add_u32 s3, s63, 0x1e000
    buffer_load_dwordx4 v14, s[28:31], s3 offen lds
    s_add_u32 m0, s48, 33792
    s_add_u32 s3, s63, 0x20800
    buffer_load_dwordx4 v14, s[28:31], s3 offen lds
    s_add_u32 m0, s48, 34816
    s_add_u32 s3, s63, 0x23000
    buffer_load_dwordx4 v14, s[28:31], s3 offen lds
    s_add_u32 m0, s48, 35840
    s_add_u32 s3, s63, 0x25800
    buffer_load_dwordx4 v14, s[28:31], s3 offen lds
    s_add_u32 m0, s48, 36864
    s_add_u32 s3, s63, 0x28000
    buffer_load_dwordx4 v14, s[28:31], s3 offen lds
    s_add_u32 m0, s48, 37888
    s_add_u32 s3, s63, 0x2a800
    buffer_load_dwordx4 v14, s[28:31], s3 offen lds
    s_add_u32 m0, s48, 38912
    s_add_u32 s3, s63, 0x2d000
    buffer_load_dwordx4 v14, s[28:31], s3 offen lds
    s_add_u32 m0, s48, 39936
    s_add_u32 s3, s63, 0x2f800
    buffer_load_dwordx4 v14, s[28:31], s3 offen lds
    s_waitcnt vmcnt(20)
    ds_read_b64_tr_b16 a[160:161], v13 offset:0
    ds_read_b64_tr_b16 a[162:163], v13 offset:512
    ds_read_b64_tr_b16 a[164:165], v13 offset:8
    ds_read_b64_tr_b16 a[166:167], v13 offset:520
    ds_read_b64_tr_b16 a[168:169], v13 offset:64
    ds_read_b64_tr_b16 a[170:171], v13 offset:576
    ds_read_b64_tr_b16 a[172:173], v13 offset:72
    ds_read_b64_tr_b16 a[174:175], v13 offset:584
    ds_read_b64_tr_b16 a[176:177], v13 offset:4096
    ds_read_b64_tr_b16 a[178:179], v13 offset:4608
    ds_read_b64_tr_b16 a[180:181], v13 offset:4104
    ds_read_b64_tr_b16 a[182:183], v13 offset:4616
    ds_read_b64_tr_b16 a[184:185], v13 offset:4160
    ds_read_b64_tr_b16 a[186:187], v13 offset:4672
    ds_read_b64_tr_b16 a[188:189], v13 offset:4168
    ds_read_b64_tr_b16 a[190:191], v13 offset:4680
    ds_read_b64_tr_b16 a[192:193], v13 offset:8192
    ds_read_b64_tr_b16 a[194:195], v13 offset:8704
    ds_read_b64_tr_b16 a[196:197], v13 offset:8200
    ds_read_b64_tr_b16 a[198:199], v13 offset:8712
    ds_read_b64_tr_b16 a[200:201], v13 offset:8256
    ds_read_b64_tr_b16 a[202:203], v13 offset:8768
    ds_read_b64_tr_b16 a[204:205], v13 offset:8264
    ds_read_b64_tr_b16 a[206:207], v13 offset:8776
    ds_read_b64_tr_b16 a[208:209], v13 offset:12288
    ds_read_b64_tr_b16 a[210:211], v13 offset:12800
    ds_read_b64_tr_b16 a[212:213], v13 offset:12296
    ds_read_b64_tr_b16 a[214:215], v13 offset:12808
    ds_read_b64_tr_b16 a[216:217], v13 offset:12352
    ds_read_b64_tr_b16 a[218:219], v13 offset:12864
    ds_read_b64_tr_b16 a[220:221], v13 offset:12360
    ds_read_b64_tr_b16 a[222:223], v13 offset:12872
    ds_read_b64_tr_b16 a[224:225], v13 offset:16384
    ds_read_b64_tr_b16 a[226:227], v13 offset:16896
    ds_read_b64_tr_b16 a[228:229], v13 offset:16392
    ds_read_b64_tr_b16 a[230:231], v13 offset:16904
    ds_read_b64_tr_b16 a[232:233], v13 offset:16448
    ds_read_b64_tr_b16 a[234:235], v13 offset:16960
    ds_read_b64_tr_b16 a[236:237], v13 offset:16456
    ds_read_b64_tr_b16 a[238:239], v13 offset:16968
    s_waitcnt lgkmcnt(0)
    s_waitcnt vmcnt(0)
    ds_read_b64_tr_b16 a[240:241], v13 offset:20480
    ds_read_b64_tr_b16 a[242:243], v13 offset:20992
    ds_read_b64_tr_b16 a[244:245], v13 offset:20488
    ds_read_b64_tr_b16 a[246:247], v13 offset:21000
    ds_read_b64_tr_b16 a[248:249], v13 offset:20544
    ds_read_b64_tr_b16 a[250:251], v13 offset:21056
    ds_read_b64_tr_b16 a[252:253], v13 offset:20552
    ds_read_b64_tr_b16 a[254:255], v13 offset:21064
    ds_read_b64_tr_b16 v[192:193], v13 offset:24576
    ds_read_b64_tr_b16 v[194:195], v13 offset:25088
    ds_read_b64_tr_b16 v[196:197], v13 offset:24584
    ds_read_b64_tr_b16 v[198:199], v13 offset:25096
    ds_read_b64_tr_b16 v[200:201], v13 offset:24640
    ds_read_b64_tr_b16 v[202:203], v13 offset:25152
    ds_read_b64_tr_b16 v[204:205], v13 offset:24648
    ds_read_b64_tr_b16 v[206:207], v13 offset:25160
    ds_read_b64_tr_b16 v[208:209], v13 offset:28672
    ds_read_b64_tr_b16 v[210:211], v13 offset:29184
    ds_read_b64_tr_b16 v[212:213], v13 offset:28680
    ds_read_b64_tr_b16 v[214:215], v13 offset:29192
    ds_read_b64_tr_b16 v[216:217], v13 offset:28736
    ds_read_b64_tr_b16 v[218:219], v13 offset:29248
    ds_read_b64_tr_b16 v[220:221], v13 offset:28744
    ds_read_b64_tr_b16 v[222:223], v13 offset:29256
    ds_read_b64_tr_b16 v[224:225], v13 offset:32768
    ds_read_b64_tr_b16 v[226:227], v13 offset:33280
    ds_read_b64_tr_b16 v[228:229], v13 offset:32776
    ds_read_b64_tr_b16 v[230:231], v13 offset:33288
    ds_read_b64_tr_b16 v[232:233], v13 offset:32832
    ds_read_b64_tr_b16 v[234:235], v13 offset:33344
    ds_read_b64_tr_b16 v[236:237], v13 offset:32840
    ds_read_b64_tr_b16 v[238:239], v13 offset:33352
    ds_read_b64_tr_b16 v[240:241], v13 offset:36864
    ds_read_b64_tr_b16 v[242:243], v13 offset:37376
    ds_read_b64_tr_b16 v[244:245], v13 offset:36872
    ds_read_b64_tr_b16 v[246:247], v13 offset:37384
    ds_read_b64_tr_b16 v[248:249], v13 offset:36928
    ds_read_b64_tr_b16 v[250:251], v13 offset:37440
    ds_read_b64_tr_b16 v[252:253], v13 offset:36936
    ds_read_b64_tr_b16 v[254:255], v13 offset:37448
    s_waitcnt lgkmcnt(0)
    v_mfma_f32_16x16x32_bf16 v[96:99], a[0:3], v[176:179], 0
    v_mfma_f32_16x16x32_bf16 v[100:103], a[4:7], v[176:179], 0
    v_mfma_f32_16x16x32_bf16 v[104:107], a[8:11], v[176:179], 0
    v_mfma_f32_16x16x32_bf16 v[108:111], a[12:15], v[176:179], 0
    v_mfma_f32_16x16x32_bf16 v[96:99], a[16:19], v[176:179], v[96:99]
    v_mfma_f32_16x16x32_bf16 v[100:103], a[20:23], v[176:179], v[100:103]
    v_mfma_f32_16x16x32_bf16 v[104:107], a[24:27], v[176:179], v[104:107]
    v_mfma_f32_16x16x32_bf16 v[108:111], a[28:31], v[176:179], v[108:111]
    v_mfma_f32_16x16x32_bf16 v[96:99], a[32:35], v[176:179], v[96:99]
    v_mfma_f32_16x16x32_bf16 v[100:103], a[36:39], v[176:179], v[100:103]
    v_mfma_f32_16x16x32_bf16 v[104:107], a[40:43], v[176:179], v[104:107]
    v_mfma_f32_16x16x32_bf16 v[108:111], a[44:47], v[176:179], v[108:111]
    v_mfma_f32_16x16x32_bf16 v[96:99], a[48:51], v[176:179], v[96:99]
    v_mfma_f32_16x16x32_bf16 v[100:103], a[52:55], v[176:179], v[100:103]
    v_mfma_f32_16x16x32_bf16 v[104:107], a[56:59], v[176:179], v[104:107]
    v_mfma_f32_16x16x32_bf16 v[108:111], a[60:63], v[176:179], v[108:111]
    v_mfma_f32_16x16x32_bf16 v[96:99], a[64:67], v[176:179], v[96:99]
    v_mfma_f32_16x16x32_bf16 v[100:103], a[68:71], v[176:179], v[100:103]
    v_mfma_f32_16x16x32_bf16 v[104:107], a[72:75], v[176:179], v[104:107]
    v_mfma_f32_16x16x32_bf16 v[108:111], a[76:79], v[176:179], v[108:111]
    v_mfma_f32_16x16x32_bf16 v[96:99], a[80:83], v[176:179], v[96:99]
    v_mfma_f32_16x16x32_bf16 v[100:103], a[84:87], v[176:179], v[100:103]
    v_mfma_f32_16x16x32_bf16 v[104:107], a[88:91], v[176:179], v[104:107]
    v_mfma_f32_16x16x32_bf16 v[108:111], a[92:95], v[176:179], v[108:111]
    v_mfma_f32_16x16x32_bf16 v[96:99], a[96:99], v[176:179], v[96:99]
    v_mfma_f32_16x16x32_bf16 v[100:103], a[100:103], v[176:179], v[100:103]
    v_mfma_f32_16x16x32_bf16 v[104:107], a[104:107], v[176:179], v[104:107]
    v_mfma_f32_16x16x32_bf16 v[108:111], a[108:111], v[176:179], v[108:111]
    v_mfma_f32_16x16x32_bf16 v[96:99], a[112:115], v[176:179], v[96:99]
    v_mfma_f32_16x16x32_bf16 v[100:103], a[116:119], v[176:179], v[100:103]
    v_mfma_f32_16x16x32_bf16 v[104:107], a[120:123], v[176:179], v[104:107]
    v_mfma_f32_16x16x32_bf16 v[108:111], a[124:127], v[176:179], v[108:111]
    v_mfma_f32_16x16x32_bf16 v[96:99], a[128:131], v[176:179], v[96:99]
    v_mfma_f32_16x16x32_bf16 v[100:103], a[132:135], v[176:179], v[100:103]
    v_mfma_f32_16x16x32_bf16 v[104:107], a[136:139], v[176:179], v[104:107]
    v_mfma_f32_16x16x32_bf16 v[108:111], a[140:143], v[176:179], v[108:111]
    v_mfma_f32_16x16x32_bf16 v[96:99], a[144:147], v[176:179], v[96:99]
    v_mfma_f32_16x16x32_bf16 v[100:103], a[148:151], v[176:179], v[100:103]
    v_mfma_f32_16x16x32_bf16 v[104:107], a[152:155], v[176:179], v[104:107]
    v_mfma_f32_16x16x32_bf16 v[108:111], a[156:159], v[176:179], v[108:111]
    v_mfma_f32_16x16x32_bf16 v[96:99], a[160:163], v[176:179], v[96:99]
    v_mfma_f32_16x16x32_bf16 v[100:103], a[164:167], v[176:179], v[100:103]
    v_mfma_f32_16x16x32_bf16 v[104:107], a[168:171], v[176:179], v[104:107]
    v_mfma_f32_16x16x32_bf16 v[108:111], a[172:175], v[176:179], v[108:111]
    v_mfma_f32_16x16x32_bf16 v[96:99], a[176:179], v[176:179], v[96:99]
    v_mfma_f32_16x16x32_bf16 v[100:103], a[180:183], v[176:179], v[100:103]
    v_mfma_f32_16x16x32_bf16 v[104:107], a[184:187], v[176:179], v[104:107]
    v_mfma_f32_16x16x32_bf16 v[108:111], a[188:191], v[176:179], v[108:111]
    v_mfma_f32_16x16x32_bf16 v[96:99], a[192:195], v[176:179], v[96:99]
    v_mfma_f32_16x16x32_bf16 v[100:103], a[196:199], v[176:179], v[100:103]
    v_mfma_f32_16x16x32_bf16 v[104:107], a[200:203], v[176:179], v[104:107]
    v_mfma_f32_16x16x32_bf16 v[108:111], a[204:207], v[176:179], v[108:111]
    v_mfma_f32_16x16x32_bf16 v[96:99], a[208:211], v[176:179], v[96:99]
    v_mfma_f32_16x16x32_bf16 v[100:103], a[212:215], v[176:179], v[100:103]
    v_mfma_f32_16x16x32_bf16 v[104:107], a[216:219], v[176:179], v[104:107]
    v_mfma_f32_16x16x32_bf16 v[108:111], a[220:223], v[176:179], v[108:111]
    v_mfma_f32_16x16x32_bf16 v[96:99], a[224:227], v[176:179], v[96:99]
    v_mfma_f32_16x16x32_bf16 v[100:103], a[228:231], v[176:179], v[100:103]
    v_mfma_f32_16x16x32_bf16 v[104:107], a[232:235], v[176:179], v[104:107]
    v_mfma_f32_16x16x32_bf16 v[108:111], a[236:239], v[176:179], v[108:111]
    v_mfma_f32_16x16x32_bf16 v[96:99], a[240:243], v[176:179], v[96:99]
    v_mfma_f32_16x16x32_bf16 v[100:103], a[244:247], v[176:179], v[100:103]
    v_mfma_f32_16x16x32_bf16 v[104:107], a[248:251], v[176:179], v[104:107]
    v_mfma_f32_16x16x32_bf16 v[108:111], a[252:255], v[176:179], v[108:111]
    v_mfma_f32_16x16x32_bf16 v[96:99], v[192:195], v[176:179], v[96:99]
    v_mfma_f32_16x16x32_bf16 v[100:103], v[196:199], v[176:179], v[100:103]
    v_mfma_f32_16x16x32_bf16 v[104:107], v[200:203], v[176:179], v[104:107]
    v_mfma_f32_16x16x32_bf16 v[108:111], v[204:207], v[176:179], v[108:111]
    v_mfma_f32_16x16x32_bf16 v[96:99], v[208:211], v[176:179], v[96:99]
    v_mfma_f32_16x16x32_bf16 v[100:103], v[212:215], v[176:179], v[100:103]
    v_mfma_f32_16x16x32_bf16 v[104:107], v[216:219], v[176:179], v[104:107]
    v_mfma_f32_16x16x32_bf16 v[108:111], v[220:223], v[176:179], v[108:111]
    v_mfma_f32_16x16x32_bf16 v[96:99], v[224:227], v[176:179], v[96:99]
    v_mfma_f32_16x16x32_bf16 v[100:103], v[228:231], v[176:179], v[100:103]
    v_mfma_f32_16x16x32_bf16 v[104:107], v[232:235], v[176:179], v[104:107]
    v_mfma_f32_16x16x32_bf16 v[108:111], v[236:239], v[176:179], v[108:111]
    v_mfma_f32_16x16x32_bf16 v[96:99], v[240:243], v[176:179], v[96:99]
    v_mfma_f32_16x16x32_bf16 v[100:103], v[244:247], v[176:179], v[100:103]
    v_mfma_f32_16x16x32_bf16 v[104:107], v[248:251], v[176:179], v[104:107]
    v_mfma_f32_16x16x32_bf16 v[108:111], v[252:255], v[176:179], v[108:111]
    v_and_b32 v16, 15, v0
    v_mul_u32_u24 v16, 1280, v16
    v_lshrrev_b32 v17, 4, v0
    v_lshl_add_u32 v16, v17, 4, v16
    v_add_u32 v7, s65, v16
    s_nop 1
    s_branch P1_LOOP
P1_KVW:
    s_sub_u32 s46, s64, 9
    s_load_dwordx4 s[4:7], s[0:1], 16
    s_waitcnt lgkmcnt(0)
    s_cmp_eq_u32 s46, 1
    s_cselect_b64 s[4:5], s[4:5], s[6:7]
    s_mov_b32 s28, s4
    s_mov_b32 s29, s5
    s_mov_b32 s30, 0x6400
    s_mov_b32 s31, 0x20000
    v_lshrrev_b32 v16, 4, v0
    v_lshlrev_b32 v16, 3, v16
    v_bfe_u32 v17, v0, 2, 2
    v_add_u32 v16, v16, v17
    v_mul_u32_u24 v16, 40, v16
    v_and_b32 v17, 3, v0
    v_lshl_add_u32 v16, v17, 4, v16
    s_add_u32 s3, s13, 0
    s_and_b32 s3, s3, 3
    s_mul_i32 s3, s3, 6400
    s_add_u32 s3, s3, s48
    v_add_u32 v20, s3, v16
    s_add_u32 s3, s13, 1
    s_and_b32 s3, s3, 3
    s_mul_i32 s3, s3, 6400
    s_add_u32 s3, s3, s48
    v_add_u32 v21, s3, v16
    s_add_u32 s3, s13, 2
    s_and_b32 s3, s3, 3
    s_mul_i32 s3, s3, 6400
    s_add_u32 s3, s3, s48
    v_add_u32 v22, s3, v16
    s_add_u32 s3, s13, 3
    s_and_b32 s3, s3, 3
    s_mul_i32 s3, s3, 6400
    s_add_u32 s3, s3, s48
    v_add_u32 v23, s3, v16
    s_mov_b32 s60, 0
    s_add_u32 m0, s48, 0
    s_add_u32 s3, s60, 0x0
    buffer_load_dwordx4 v1, s[28:31], s3 offen lds
    s_add_u32 m0, s48, 1024
    s_add_u32 s3, s60, 0x400
    buffer_load_dwordx4 v1, s[28:31], s3 offen lds
    s_add_u32 m0, s48, 2048
    s_add_u32 s3, s60, 0x800
    buffer_load_dwordx4 v1, s[28:31], s3 offen lds
    s_add_u32 m0, s48, 3072
    s_add_u32 s3, s60, 0xc00
    buffer_load_dwordx4 v1, s[28:31], s3 offen lds
    s_add_u32 m0, s48, 4096
    s_add_u32 s3, s60, 0x1000
    buffer_load_dwordx4 v1, s[28:31], s3 offen lds
    s_add_u32 m0, s48, 5120
    s_add_u32 s3, s60, 0x1400
    buffer_load_dwordx4 v1, s[28:31], s3 offen lds
    s_add_u32 m0, s48, 6144
    s_add_u32 s3, s60, 0x1800
    buffer_load_dwordx4 v1, s[28:31], s3 offen lds
    s_add_u32 m0, s48, 7168
    s_add_u32 s3, s60, 0x1c00
    buffer_load_dwordx4 v1, s[28:31], s3 offen lds
    s_add_u32 m0, s48, 8192
    s_add_u32 s3, s60, 0x2000
    buffer_load_dwordx4 v1, s[28:31], s3 offen lds
    s_add_u32 m0, s48, 9216
    s_add_u32 s3, s60, 0x2400
    buffer_load_dwordx4 v1, s[28:31], s3 offen lds
    s_add_u32 m0, s48, 10240
    s_add_u32 s3, s60, 0x2800
    buffer_load_dwordx4 v1, s[28:31], s3 offen lds
    s_add_u32 m0, s48, 11264
    s_add_u32 s3, s60, 0x2c00
    buffer_load_dwordx4 v1, s[28:31], s3 offen lds
    s_add_u32 m0, s48, 12288
    s_add_u32 s3, s60, 0x3000
    buffer_load_dwordx4 v1, s[28:31], s3 offen lds
    s_add_u32 m0, s48, 13312
    s_add_u32 s3, s60, 0x3400
    buffer_load_dwordx4 v1, s[28:31], s3 offen lds
    s_add_u32 m0, s48, 14336
    s_add_u32 s3, s60, 0x3800
    buffer_load_dwordx4 v1, s[28:31], s3 offen lds
    s_add_u32 m0, s48, 15360
    s_add_u32 s3, s60, 0x3c00
    buffer_load_dwordx4 v1, s[28:31], s3 offen lds
    s_add_u32 m0, s48, 16384
    s_add_u32 s3, s60, 0x4000
    buffer_load_dwordx4 v1, s[28:31], s3 offen lds
    s_add_u32 m0, s48, 17408
    s_add_u32 s3, s60, 0x4400
    buffer_load_dwordx4 v1, s[28:31], s3 offen lds
    s_add_u32 m0, s48, 18432
    s_add_u32 s3, s60, 0x4800
    buffer_load_dwordx4 v1, s[28:31], s3 offen lds
    s_add_u32 m0, s48, 19456
    s_add_u32 s3, s60, 0x4c00
    buffer_load_dwordx4 v1, s[28:31], s3 offen lds
    s_add_u32 m0, s48, 20480
    s_add_u32 s3, s60, 0x5000
    buffer_load_dwordx4 v1, s[28:31], s3 offen lds
    s_add_u32 m0, s48, 21504
    s_add_u32 s3, s60, 0x5400
    buffer_load_dwordx4 v1, s[28:31], s3 offen lds
    s_add_u32 m0, s48, 22528
    s_add_u32 s3, s60, 0x5800
    buffer_load_dwordx4 v1, s[28:31], s3 offen lds
    s_add_u32 m0, s48, 23552
    s_add_u32 s3, s60, 0x5c00
    buffer_load_dwordx4 v1, s[28:31], s3 offen lds
    s_add_u32 m0, s48, 24576
    s_add_u32 s3, s60, 0x6000
    buffer_load_dwordx4 v1, s[28:31], s3 offen lds
    s_waitcnt vmcnt(0)
    ds_read_b64_tr_b16 a[0:1], v20 offset:0
    ds_read_b64_tr_b16 a[2:3], v20 offset:160
    ds_read_b64_tr_b16 a[4:5], v20 offset:8
    ds_read_b64_tr_b16 a[6:7], v20 offset:168
    ds_read_b64_tr_b16 a[16:17], v20 offset:1280
    ds_read_b64_tr_b16 a[18:19], v20 offset:1440
    ds_read_b64_tr_b16 a[20:21], v20 offset:1288
    ds_read_b64_tr_b16 a[22:23], v20 offset:1448
    ds_read_b64_tr_b16 a[32:33], v20 offset:2560
    ds_read_b64_tr_b16 a[34:35], v20 offset:2720
    ds_read_b64_tr_b16 a[36:37], v20 offset:2568
    ds_read_b64_tr_b16 a[38:39], v20 offset:2728
    ds_read_b64_tr_b16 a[48:49], v20 offset:3840
    ds_read_b64_tr_b16 a[50:51], v20 offset:4000
    ds_read_b64_tr_b16 a[52:53], v20 offset:3848
    ds_read_b64_tr_b16 a[54:55], v20 offset:4008
    ds_read_b64_tr_b16 a[64:65], v20 offset:5120
    ds_read_b64_tr_b16 a[66:67], v20 offset:5280
    ds_read_b64_tr_b16 a[68:69], v20 offset:5128
    ds_read_b64_tr_b16 a[70:71], v20 offset:5288
    ds_read_b64_tr_b16 a[80:81], v21 offset:0
    ds_read_b64_tr_b16 a[82:83], v21 offset:160
    ds_read_b64_tr_b16 a[84:85], v21 offset:8
    ds_read_b64_tr_b16 a[86:87], v21 offset:168
    ds_read_b64_tr_b16 a[96:97], v21 offset:1280
    ds_read_b64_tr_b16 a[98:99], v21 offset:1440
    ds_read_b64_tr_b16 a[100:101], v21 offset:1288
    ds_read_b64_tr_b16 a[102:103], v21 offset:1448
    ds_read_b64_tr_b16 a[112:113], v21 offset:2560
    ds_read_b64_tr_b16 a[114:115], v21 offset:2720
    ds_read_b64_tr_b16 a[116:117], v21 offset:2568
    ds_read_b64_tr_b16 a[118:119], v21 offset:2728
    ds_read_b64_tr_b16 a[128:129], v21 offset:3840
    ds_read_b64_tr_b16 a[130:131], v21 offset:4000
    ds_read_b64_tr_b16 a[132:133], v21 offset:3848
    ds_read_b64_tr_b16 a[134:135], v21 offset:4008
    ds_read_b64_tr_b16 a[144:145], v21 offset:5120
    ds_read_b64_tr_b16 a[146:147], v21 offset:5280
    ds_read_b64_tr_b16 a[148:149], v21 offset:5128
    ds_read_b64_tr_b16 a[150:151], v21 offset:5288
    ds_read_b64_tr_b16 a[160:161], v22 offset:0
    ds_read_b64_tr_b16 a[162:163], v22 offset:160
    ds_read_b64_tr_b16 a[164:165], v22 offset:8
    ds_read_b64_tr_b16 a[166:167], v22 offset:168
    ds_read_b64_tr_b16 a[176:177], v22 offset:1280
    ds_read_b64_tr_b16 a[178:179], v22 offset:1440
    ds_read_b64_tr_b16 a[180:181], v22 offset:1288
    ds_read_b64_tr_b16 a[182:183], v22 offset:1448
    ds_read_b64_tr_b16 a[192:193], v22 offset:2560
    ds_read_b64_tr_b16 a[194:195], v22 offset:2720
    ds_read_b64_tr_b16 a[196:197], v22 offset:2568
    ds_read_b64_tr_b16 a[198:199], v22 offset:2728
    ds_read_b64_tr_b16 a[208:209], v22 offset:3840
    ds_read_b64_tr_b16 a[210:211], v22 offset:4000
    ds_read_b64_tr_b16 a[212:213], v22 offset:3848
    ds_read_b64_tr_b16 a[214:215], v22 offset:4008
    ds_read_b64_tr_b16 a[224:225], v22 offset:5120
    ds_read_b64_tr_b16 a[226:227], v22 offset:5280
    ds_read_b64_tr_b16 a[228:229], v22 offset:5128
    ds_read_b64_tr_b16 a[230:231], v22 offset:5288
    ds_read_b64_tr_b16 a[240:241], v23 offset:0
    ds_read_b64_tr_b16 a[242:243], v23 offset:160
    ds_read_b64_tr_b16 a[244:245], v23 offset:8
    ds_read_b64_tr_b16 a[246:247], v23 offset:168
    ds_read_b64_tr_b16 v[192:193], v23 offset:1280
    ds_read_b64_tr_b16 v[194:195], v23 offset:1440
    ds_read_b64_tr_b16 v[196:197], v23 offset:1288
    ds_read_b64_tr_b16 v[198:199], v23 offset:1448
    ds_read_b64_tr_b16 v[208:209], v23 offset:2560
    ds_read_b64_tr_b16 v[210:211], v23 offset:2720
    ds_read_b64_tr_b16 v[212:213], v23 offset:2568
    ds_read_b64_tr_b16 v[214:215], v23 offset:2728
    ds_read_b64_tr_b16 v[224:225], v23 offset:3840
    ds_read_b64_tr_b16 v[226:227], v23 offset:4000
    ds_read_b64_tr_b16 v[228:229], v23 offset:3848
    ds_read_b64_tr_b16 v[230:231], v23 offset:4008
    ds_read_b64_tr_b16 v[240:241], v23 offset:5120
    ds_read_b64_tr_b16 v[242:243], v23 offset:5280
    ds_read_b64_tr_b16 v[244:245], v23 offset:5128
    ds_read_b64_tr_b16 v[246:247], v23 offset:5288
    s_waitcnt lgkmcnt(0)
    s_mov_b32 exec_lo, 0xf000f000
    s_mov_b32 exec_hi, 0xf000f000
    v_accvgpr_write_b32 a0, 0
    v_accvgpr_write_b32 a1, 0
    v_accvgpr_write_b32 a2, 0
    v_accvgpr_write_b32 a3, 0
    v_accvgpr_write_b32 a16, 0
    v_accvgpr_write_b32 a17, 0
    v_accvgpr_write_b32 a18, 0
    v_accvgpr_write_b32 a19, 0
    v_accvgpr_write_b32 a32, 0
    v_accvgpr_write_b32 a33, 0
    v_accvgpr_write_b32 a34, 0
    v_accvgpr_write_b32 a35, 0
    v_accvgpr_write_b32 a48, 0
    v_accvgpr_write_b32 a49, 0
    v_accvgpr_write_b32 a50, 0
    v_accvgpr_write_b32 a51, 0
    v_accvgpr_write_b32 a64, 0
    v_accvgpr_write_b32 a65, 0
    v_accvgpr_write_b32 a66, 0
    v_accvgpr_write_b32 a67, 0
    v_accvgpr_write_b32 a80, 0
    v_accvgpr_write_b32 a81, 0
    v_accvgpr_write_b32 a82, 0
    v_accvgpr_write_b32 a83, 0
    v_accvgpr_write_b32 a96, 0
    v_accvgpr_write_b32 a97, 0
    v_accvgpr_write_b32 a98, 0
    v_accvgpr_write_b32 a99, 0
    v_accvgpr_write_b32 a112, 0
    v_accvgpr_write_b32 a113, 0
    v_accvgpr_write_b32 a114, 0
    v_accvgpr_write_b32 a115, 0
    v_accvgpr_write_b32 a128, 0
    v_accvgpr_write_b32 a129, 0
    v_accvgpr_write_b32 a130, 0
    v_accvgpr_write_b32 a131, 0
    v_accvgpr_write_b32 a144, 0
    v_accvgpr_write_b32 a145, 0
    v_accvgpr_write_b32 a146, 0
    v_accvgpr_write_b32 a147, 0
    v_accvgpr_write_b32 a160, 0
    v_accvgpr_write_b32 a161, 0
    v_accvgpr_write_b32 a162, 0
    v_accvgpr_write_b32 a163, 0
    v_accvgpr_write_b32 a176, 0
    v_accvgpr_write_b32 a177, 0
    v_accvgpr_write_b32 a178, 0
    v_accvgpr_write_b32 a179, 0
    v_accvgpr_write_b32 a192, 0
    v_accvgpr_write_b32 a193, 0
    v_accvgpr_write_b32 a194, 0
    v_accvgpr_write_b32 a195, 0
    v_accvgpr_write_b32 a208, 0
    v_accvgpr_write_b32 a209, 0
    v_accvgpr_write_b32 a210, 0
    v_accvgpr_write_b32 a211, 0
    v_accvgpr_write_b32 a224, 0
    v_accvgpr_write_b32 a225, 0
    v_accvgpr_write_b32 a226, 0
    v_accvgpr_write_b32 a227, 0
    v_accvgpr_write_b32 a240, 0
    v_accvgpr_write_b32 a241, 0
    v_accvgpr_write_b32 a242, 0
    v_accvgpr_write_b32 a243, 0
    v_mov_b32 v192, 0
    v_mov_b32 v193, 0
    v_mov_b32 v194, 0
    v_mov_b32 v195, 0
    v_mov_b32 v208, 0
    v_mov_b32 v209, 0
    v_mov_b32 v210, 0
    v_mov_b32 v211, 0
    v_mov_b32 v224, 0
    v_mov_b32 v225, 0
    v_mov_b32 v226, 0
    v_mov_b32 v227, 0
    v_mov_b32 v240, 0
    v_mov_b32 v241, 0
    v_mov_b32 v242, 0
    v_mov_b32 v243, 0
    s_mov_b32 exec_lo, 0xff00ff00
    s_mov_b32 exec_hi, 0xff00ff00
    v_accvgpr_write_b32 a4, 0
    v_accvgpr_write_b32 a5, 0
    v_accvgpr_write_b32 a6, 0
    v_accvgpr_write_b32 a7, 0
    v_accvgpr_write_b32 a20, 0
    v_accvgpr_write_b32 a21, 0
    v_accvgpr_write_b32 a22, 0
    v_accvgpr_write_b32 a23, 0
    v_accvgpr_write_b32 a36, 0
    v_accvgpr_write_b32 a37, 0
    v_accvgpr_write_b32 a38, 0
    v_accvgpr_write_b32 a39, 0
    v_accvgpr_write_b32 a52, 0
    v_accvgpr_write_b32 a53, 0
    v_accvgpr_write_b32 a54, 0
    v_accvgpr_write_b32 a55, 0
    v_accvgpr_write_b32 a68, 0
    v_accvgpr_write_b32 a69, 0
    v_accvgpr_write_b32 a70, 0
    v_accvgpr_write_b32 a71, 0
    v_accvgpr_write_b32 a84, 0
    v_accvgpr_write_b32 a85, 0
    v_accvgpr_write_b32 a86, 0
    v_accvgpr_write_b32 a87, 0
    v_accvgpr_write_b32 a100, 0
    v_accvgpr_write_b32 a101, 0
    v_accvgpr_write_b32 a102, 0
    v_accvgpr_write_b32 a103, 0
    v_accvgpr_write_b32 a116, 0
    v_accvgpr_write_b32 a117, 0
    v_accvgpr_write_b32 a118, 0
    v_accvgpr_write_b32 a119, 0
    v_accvgpr_write_b32 a132, 0
    v_accvgpr_write_b32 a133, 0
    v_accvgpr_write_b32 a134, 0
    v_accvgpr_write_b32 a135, 0
    v_accvgpr_write_b32 a148, 0
    v_accvgpr_write_b32 a149, 0
    v_accvgpr_write_b32 a150, 0
    v_accvgpr_write_b32 a151, 0
    v_accvgpr_write_b32 a164, 0
    v_accvgpr_write_b32 a165, 0
    v_accvgpr_write_b32 a166, 0
    v_accvgpr_write_b32 a167, 0
    v_accvgpr_write_b32 a180, 0
    v_accvgpr_write_b32 a181, 0
    v_accvgpr_write_b32 a182, 0
    v_accvgpr_write_b32 a183, 0
    v_accvgpr_write_b32 a196, 0
    v_accvgpr_write_b32 a197, 0
    v_accvgpr_write_b32 a198, 0
    v_accvgpr_write_b32 a199, 0
    v_accvgpr_write_b32 a212, 0
    v_accvgpr_write_b32 a213, 0
    v_accvgpr_write_b32 a214, 0
    v_accvgpr_write_b32 a215, 0
    v_accvgpr_write_b32 a228, 0
    v_accvgpr_write_b32 a229, 0
    v_accvgpr_write_b32 a230, 0
    v_accvgpr_write_b32 a231, 0
    v_accvgpr_write_b32 a244, 0
    v_accvgpr_write_b32 a245, 0
    v_accvgpr_write_b32 a246, 0
    v_accvgpr_write_b32 a247, 0
    v_mov_b32 v196, 0
    v_mov_b32 v197, 0
    v_mov_b32 v198, 0
    v_mov_b32 v199, 0
    v_mov_b32 v212, 0
    v_mov_b32 v213, 0
    v_mov_b32 v214, 0
    v_mov_b32 v215, 0
    v_mov_b32 v228, 0
    v_mov_b32 v229, 0
    v_mov_b32 v230, 0
    v_mov_b32 v231, 0
    v_mov_b32 v244, 0
    v_mov_b32 v245, 0
    v_mov_b32 v246, 0
    v_mov_b32 v247, 0
    s_mov_b64 exec, -1
    s_cmp_eq_u32 s46, 2
    s_cbranch_scc1 P1_VW
    v_mfma_f32_16x16x32_bf16 v[96:99], a[0:3], v[176:179], 0
    v_mfma_f32_16x16x32_bf16 v[100:103], a[4:7], v[176:179], 0
    v_mfma_f32_16x16x32_bf16 v[96:99], a[16:19], v[176:179], v[96:99]
    v_mfma_f32_16x16x32_bf16 v[100:103], a[20:23], v[176:179], v[100:103]
    v_mfma_f32_16x16x32_bf16 v[96:99], a[32:35], v[176:179], v[96:99]
    v_mfma_f32_16x16x32_bf16 v[100:103], a[36:39], v[176:179], v[100:103]
    v_mfma_f32_16x16x32_bf16 v[96:99], a[48:51], v[176:179], v[96:99]
    v_mfma_f32_16x16x32_bf16 v[100:103], a[52:55], v[176:179], v[100:103]
    v_mfma_f32_16x16x32_bf16 v[96:99], a[64:67], v[176:179], v[96:99]
    v_mfma_f32_16x16x32_bf16 v[100:103], a[68:71], v[176:179], v[100:103]
    v_mfma_f32_16x16x32_bf16 v[96:99], a[80:83], v[176:179], v[96:99]
    v_mfma_f32_16x16x32_bf16 v[100:103], a[84:87], v[176:179], v[100:103]
    v_mfma_f32_16x16x32_bf16 v[96:99], a[96:99], v[176:179], v[96:99]
    v_mfma_f32_16x16x32_bf16 v[100:103], a[100:103], v[176:179], v[100:103]
    v_mfma_f32_16x16x32_bf16 v[96:99], a[112:115], v[176:179], v[96:99]
    v_mfma_f32_16x16x32_bf16 v[100:103], a[116:119], v[176:179], v[100:103]
    v_mfma_f32_16x16x32_bf16 v[96:99], a[128:131], v[176:179], v[96:99]
    v_mfma_f32_16x16x32_bf16 v[100:103], a[132:135], v[176:179], v[100:103]
    v_mfma_f32_16x16x32_bf16 v[96:99], a[144:147], v[176:179], v[96:99]
    v_mfma_f32_16x16x32_bf16 v[100:103], a[148:151], v[176:179], v[100:103]
    v_mfma_f32_16x16x32_bf16 v[96:99], a[160:163], v[176:179], v[96:99]
    v_mfma_f32_16x16x32_bf16 v[100:103], a[164:167], v[176:179], v[100:103]
    v_mfma_f32_16x16x32_bf16 v[96:99], a[176:179], v[176:179], v[96:99]
    v_mfma_f32_16x16x32_bf16 v[100:103], a[180:183], v[176:179], v[100:103]
    v_mfma_f32_16x16x32_bf16 v[96:99], a[192:195], v[176:179], v[96:99]
    v_mfma_f32_16x16x32_bf16 v[100:103], a[196:199], v[176:179], v[100:103]
    v_mfma_f32_16x16x32_bf16 v[96:99], a[208:211], v[176:179], v[96:99]
    v_mfma_f32_16x16x32_bf16 v[100:103], a[212:215], v[176:179], v[100:103]
    v_mfma_f32_16x16x32_bf16 v[96:99], a[224:227], v[176:179], v[96:99]
    v_mfma_f32_16x16x32_bf16 v[100:103], a[228:231], v[176:179], v[100:103]
    v_mfma_f32_16x16x32_bf16 v[96:99], a[240:243], v[176:179], v[96:99]
    v_mfma_f32_16x16x32_bf16 v[100:103], a[244:247], v[176:179], v[100:103]
    v_mfma_f32_16x16x32_bf16 v[96:99], v[192:195], v[176:179], v[96:99]
    v_mfma_f32_16x16x32_bf16 v[100:103], v[196:199], v[176:179], v[100:103]
    v_mfma_f32_16x16x32_bf16 v[96:99], v[208:211], v[176:179], v[96:99]
    v_mfma_f32_16x16x32_bf16 v[100:103], v[212:215], v[176:179], v[100:103]
    v_mfma_f32_16x16x32_bf16 v[96:99], v[224:227], v[176:179], v[96:99]
    v_mfma_f32_16x16x32_bf16 v[100:103], v[228:231], v[176:179], v[100:103]
    v_mfma_f32_16x16x32_bf16 v[96:99], v[240:243], v[176:179], v[96:99]
    v_mfma_f32_16x16x32_bf16 v[100:103], v[244:247], v[176:179], v[100:103]
    v_and_b32 v16, 15, v0
    v_lshlrev_b32 v16, 4, v16
    v_lshrrev_b32 v17, 4, v0
    v_lshl_add_u32 v7, v17, 9, v16
    s_nop 2
    s_branch P1_LOOP
P1_VW:
    v_mfma_f32_16x16x32_bf16 v[96:99], v[176:179], a[0:3], 0
    v_mfma_f32_16x16x32_bf16 v[100:103], v[176:179], a[4:7], 0
    v_mfma_f32_16x16x32_bf16 v[96:99], v[176:179], a[16:19], v[96:99]
    v_mfma_f32_16x16x32_bf16 v[100:103], v[176:179], a[20:23], v[100:103]
    v_mfma_f32_16x16x32_bf16 v[96:99], v[176:179], a[32:35], v[96:99]
    v_mfma_f32_16x16x32_bf16 v[100:103], v[176:179], a[36:39], v[100:103]
    v_mfma_f32_16x16x32_bf16 v[96:99], v[176:179], a[48:51], v[96:99]
    v_mfma_f32_16x16x32_bf16 v[100:103], v[176:179], a[52:55], v[100:103]
    v_mfma_f32_16x16x32_bf16 v[96:99], v[176:179], a[64:67], v[96:99]
    v_mfma_f32_16x16x32_bf16 v[100:103], v[176:179], a[68:71], v[100:103]
    v_mfma_f32_16x16x32_bf16 v[96:99], v[176:179], a[80:83], v[96:99]
    v_mfma_f32_16x16x32_bf16 v[100:103], v[176:179], a[84:87], v[100:103]
    v_mfma_f32_16x16x32_bf16 v[96:99], v[176:179], a[96:99], v[96:99]
    v_mfma_f32_16x16x32_bf16 v[100:103], v[176:179], a[100:103], v[100:103]
    v_mfma_f32_16x16x32_bf16 v[96:99], v[176:179], a[112:115], v[96:99]
    v_mfma_f32_16x16x32_bf16 v[100:103], v[176:179], a[116:119], v[100:103]
    v_mfma_f32_16x16x32_bf16 v[96:99], v[176:179], a[128:131], v[96:99]
    v_mfma_f32_16x16x32_bf16 v[100:103], v[176:179], a[132:135], v[100:103]
    v_mfma_f32_16x16x32_bf16 v[96:99], v[176:179], a[144:147], v[96:99]
    v_mfma_f32_16x16x32_bf16 v[100:103], v[176:179], a[148:151], v[100:103]
    v_mfma_f32_16x16x32_bf16 v[96:99], v[176:179], a[160:163], v[96:99]
    v_mfma_f32_16x16x32_bf16 v[100:103], v[176:179], a[164:167], v[100:103]
    v_mfma_f32_16x16x32_bf16 v[96:99], v[176:179], a[176:179], v[96:99]
    v_mfma_f32_16x16x32_bf16 v[100:103], v[176:179], a[180:183], v[100:103]
    v_mfma_f32_16x16x32_bf16 v[96:99], v[176:179], a[192:195], v[96:99]
    v_mfma_f32_16x16x32_bf16 v[100:103], v[176:179], a[196:199], v[100:103]
    v_mfma_f32_16x16x32_bf16 v[96:99], v[176:179], a[208:211], v[96:99]
    v_mfma_f32_16x16x32_bf16 v[100:103], v[176:179], a[212:215], v[100:103]
    v_mfma_f32_16x16x32_bf16 v[96:99], v[176:179], a[224:227], v[96:99]
    v_mfma_f32_16x16x32_bf16 v[100:103], v[176:179], a[228:231], v[100:103]
    v_mfma_f32_16x16x32_bf16 v[96:99], v[176:179], a[240:243], v[96:99]
    v_mfma_f32_16x16x32_bf16 v[100:103], v[176:179], a[244:247], v[100:103]
    v_mfma_f32_16x16x32_bf16 v[96:99], v[176:179], v[192:195], v[96:99]
    v_mfma_f32_16x16x32_bf16 v[100:103], v[176:179], v[196:199], v[100:103]
    v_mfma_f32_16x16x32_bf16 v[96:99], v[176:179], v[208:211], v[96:99]
    v_mfma_f32_16x16x32_bf16 v[100:103], v[176:179], v[212:215], v[100:103]
    v_mfma_f32_16x16x32_bf16 v[96:99], v[176:179], v[224:227], v[96:99]
    v_mfma_f32_16x16x32_bf16 v[100:103], v[176:179], v[228:231], v[100:103]
    v_mfma_f32_16x16x32_bf16 v[96:99], v[176:179], v[240:243], v[96:99]
    v_mfma_f32_16x16x32_bf16 v[100:103], v[176:179], v[244:247], v[100:103]
    v_bfe_u32 v16, v0, 2, 2
    v_lshlrev_b32 v16, 3, v16
    v_and_b32 v17, 3, v0
    v_add_u32 v16, v16, v17
    v_lshlrev_b32 v16, 4, v16
    v_bfe_u32 v17, v0, 4, 1
    v_lshl_add_u32 v16, v17, 9, v16
    v_lshrrev_b32 v17, 5, v0
    v_lshl_add_u32 v7, v17, 3, v16
P1_LOOP:
    s_mov_b32 s39, 0
    s_mov_b32 s40, 40960
    s_barrier
P1_PAIR:
    s_mul_i32 s17, s14, 0x6000000
    s_add_u32 s17, s17, 0x1000000
    s_lshl_b32 s38, s14, 7
    s_add_u32 s38, s38, 0
    s_mov_b32 s36, 53248
    s_cmp_lg_u32 s14, 0
    s_cbranch_scc1 P1_S1
    s_load_dwordx2 s[4:5], s[0:1], 0
    s_waitcnt lgkmcnt(0)
    s_mov_b32 s24, s4
    s_mov_b32 s25, s5
    s_mov_b32 s26, 0x280000
    s_mov_b32 s27, 0x20000
    v_and_b32 v16, 15, v0
    v_mul_u32_u24 v16, 1280, v16
    v_lshrrev_b32 v17, 4, v0
    v_lshl_add_u32 v6, v17, 4, v16
    s_mov_b32 s35, 64
    s_lshr_b32 s3, s13, 1
    s_mul_i32 s3, s3, 20480
    s_and_b32 s59, s13, 1
    s_mul_i32 s59, s59, 640
    s_add_u32 s3, s3, s59
    v_add_u32 v6, s3, v6
    s_mov_b32 s34, 0
    s_mov_b32 s37, 0
    s_mov_b32 s33, 32
    s_branch P1_S2
P1_S1:
    s_mov_b32 s24, s8
    s_mov_b32 s25, s9
    s_mov_b32 s26, s10
    s_mov_b32 s27, s11
    v_mov_b32 v6, v1
    s_mov_b32 s35, 1024
    s_mul_i32 s3, s13, 10240
    v_add_u32 v6, s3, v6
    s_mov_b32 s34, 0x1a00000
    s_mov_b32 s37, 40
    s_mov_b32 s33, 2
P1_S2:
    s_mov_b32 s32, s42
    s_mov_b32 s41, 0
P1_SEG:
    s_cmp_ge_u32 s32, 64
    s_cbranch_scc1 P1_NEXTP
    s_cmp_lg_u32 s41, 0
    s_cbranch_scc1 P1_GO
    s_lshl_b32 s49, s32, 7
    s_add_u32 s49, s49, s36
    v_mov_b32 v8, 0
POLL_16:
    buffer_load_dword v9, v8, s[8:11], s49 offen sc1
    s_waitcnt vmcnt(0)
    v_readfirstlane_b32 s58, v9
    s_nop 0
    s_cmp_ge_u32 s58, s37
    s_nop 1
    s_cbranch_scc1 POLLD_17
    s_add_u32 s99, s99, 1
    s_cmp_ge_u32 s99, 0x80000
    s_cbranch_scc1 POLLD_17
    s_sleep 1
    s_branch POLL_16
POLLD_17:
    s_mov_b32 s58, s32
    s_mul_i32 s3, s58, 40960
    s_add_u32 s3, s3, s34
    s_mul_i32 s59, s13, 10240
    s_add_u32 s59, s59, s39
    s_mov_b32 m0, s59
    s_add_u32 s59, s59, 1024
    buffer_load_dwordx4 v6, s[24:27], s3 offen sc1 lds
    s_add_u32 s3, s3, s35
    s_mov_b32 m0, s59
    s_add_u32 s59, s59, 1024
    buffer_load_dwordx4 v6, s[24:27], s3 offen sc1 lds
    s_add_u32 s3, s3, s35
    s_mov_b32 m0, s59
    s_add_u32 s59, s59, 1024
    buffer_load_dwordx4 v6, s[24:27], s3 offen sc1 lds
    s_add_u32 s3, s3, s35
    s_mov_b32 m0, s59
    s_add_u32 s59, s59, 1024
    buffer_load_dwordx4 v6, s[24:27], s3 offen sc1 lds
    s_add_u32 s3, s3, s35
    s_mov_b32 m0, s59
    s_add_u32 s59, s59, 1024
    buffer_load_dwordx4 v6, s[24:27], s3 offen sc1 lds
    s_add_u32 s3, s3, s35
    s_mov_b32 m0, s59
    s_add_u32 s59, s59, 1024
    buffer_load_dwordx4 v6, s[24:27], s3 offen sc1 lds
    s_add_u32 s3, s3, s35
    s_mov_b32 m0, s59
    s_add_u32 s59, s59, 1024
    buffer_load_dwordx4 v6, s[24:27], s3 offen sc1 lds
    s_add_u32 s3, s3, s35
    s_mov_b32 m0, s59
    s_add_u32 s59, s59, 1024
    buffer_load_dwordx4 v6, s[24:27], s3 offen sc1 lds
    s_add_u32 s3, s3, s35
    s_mov_b32 m0, s59
    s_add_u32 s59, s59, 1024
    buffer_load_dwordx4 v6, s[24:27], s3 offen sc1 lds
    s_add_u32 s3, s3, s35
    s_mov_b32 m0, s59
    s_add_u32 s59, s59, 1024
    buffer_load_dwordx4 v6, s[24:27], s3 offen sc1 lds
    s_add_u32 s3, s3, s35
    s_waitcnt vmcnt(0)
P1_GO:
    s_barrier
    s_cmp_eq_u32 s46, 1
    s_cbranch_scc1 P1_V1
    s_cmp_eq_u32 s46, 2
    s_cbranch_scc1 P1_V2
P1_V0:
    s_add_u32 s58, s32, s33
    s_min_u32 s3, s58, 63
    s_lshl_b32 s3, s3, 7
    s_add_u32 s3, s3, s36
    v_mov_b32 v8, 0
    buffer_load_dword v9, v8, s[8:11], s3 offen sc1
    ds_read_b128 v[64:67], v2 offset:0
    ds_read_b128 v[68:71], v2 offset:20480
    ds_read_b128 v[72:75], v2 offset:1024
    ds_read_b128 v[76:79], v2 offset:21504
    ds_read_b128 v[80:83], v2 offset:2048
    ds_read_b128 v[84:87], v2 offset:22528
    ds_read_b128 v[88:91], v2 offset:3072
    s_waitcnt lgkmcnt(6)
    v_mfma_f32_16x16x32_bf16 v[128:131], a[0:3], v[64:67], 0
    v_mfma_f32_16x16x32_bf16 v[132:135], a[4:7], v[64:67], 0
    v_mfma_f32_16x16x32_bf16 v[136:139], a[8:11], v[64:67], 0
    v_mfma_f32_16x16x32_bf16 v[140:143], a[12:15], v[64:67], 0
    v_mfma_f32_16x16x32_bf16 v[160:163], v[176:179], v[64:67], 0
    v_mfma_f32_16x16x32_bf16 v[168:171], v[64:67], v[64:67], 0
    ds_read_b128 v[92:95], v2 offset:23552
    s_waitcnt lgkmcnt(6)
    v_mfma_f32_16x16x32_bf16 v[144:147], a[0:3], v[68:71], 0
    v_mfma_f32_16x16x32_bf16 v[148:151], a[4:7], v[68:71], 0
    v_mfma_f32_16x16x32_bf16 v[152:155], a[8:11], v[68:71], 0
    v_mfma_f32_16x16x32_bf16 v[156:159], a[12:15], v[68:71], 0
    v_mfma_f32_16x16x32_bf16 v[164:167], v[176:179], v[68:71], 0
    v_mfma_f32_16x16x32_bf16 v[172:175], v[68:71], v[68:71], 0
    ds_read_b128 v[64:67], v2 offset:4096
    s_waitcnt lgkmcnt(6)
    v_mfma_f32_16x16x32_bf16 v[128:131], a[16:19], v[72:75], v[128:131]
    v_mfma_f32_16x16x32_bf16 v[132:135], a[20:23], v[72:75], v[132:135]
    v_mfma_f32_16x16x32_bf16 v[136:139], a[24:27], v[72:75], v[136:139]
    v_mfma_f32_16x16x32_bf16 v[140:143], a[28:31], v[72:75], v[140:143]
    v_mfma_f32_16x16x32_bf16 v[160:163], v[176:179], v[72:75], v[160:163]
    v_mfma_f32_16x16x32_bf16 v[168:171], v[72:75], v[72:75], v[168:171]
    ds_read_b128 v[68:71], v2 offset:24576
    s_waitcnt lgkmcnt(6)
    v_mfma_f32_16x16x32_bf16 v[144:147], a[16:19], v[76:79], v[144:147]
    v_mfma_f32_16x16x32_bf16 v[148:151], a[20:23], v[76:79], v[148:151]
    v_mfma_f32_16x16x32_bf16 v[152:155], a[24:27], v[76:79], v[152:155]
    v_mfma_f32_16x16x32_bf16 v[156:159], a[28:31], v[76:79], v[156:159]
    v_mfma_f32_16x16x32_bf16 v[164:167], v[176:179], v[76:79], v[164:167]
    v_mfma_f32_16x16x32_bf16 v[172:175], v[76:79], v[76:79], v[172:175]
    ds_read_b128 v[72:75], v3 offset:0
    s_waitcnt lgkmcnt(6)
    v_mfma_f32_16x16x32_bf16 v[128:131], a[32:35], v[80:83], v[128:131]
    v_mfma_f32_16x16x32_bf16 v[132:135], a[36:39], v[80:83], v[132:135]
    v_mfma_f32_16x16x32_bf16 v[136:139], a[40:43], v[80:83], v[136:139]
    v_mfma_f32_16x16x32_bf16 v[140:143], a[44:47], v[80:83], v[140:143]
    v_mfma_f32_16x16x32_bf16 v[160:163], v[176:179], v[80:83], v[160:163]
    v_mfma_f32_16x16x32_bf16 v[168:171], v[80:83], v[80:83], v[168:171]
    ds_read_b128 v[76:79], v3 offset:20480
    s_waitcnt lgkmcnt(6)
    v_mfma_f32_16x16x32_bf16 v[144:147], a[32:35], v[84:87], v[144:147]
    v_mfma_f32_16x16x32_bf16 v[148:151], a[36:39], v[84:87], v[148:151]
    v_mfma_f32_16x16x32_bf16 v[152:155], a[40:43], v[84:87], v[152:155]
    v_mfma_f32_16x16x32_bf16 v[156:159], a[44:47], v[84:87], v[156:159]
    v_mfma_f32_16x16x32_bf16 v[164:167], v[176:179], v[84:87], v[164:167]
    v_mfma_f32_16x16x32_bf16 v[172:175], v[84:87], v[84:87], v[172:175]
    ds_read_b128 v[80:83], v3 offset:1024
    s_waitcnt lgkmcnt(6)
    v_mfma_f32_16x16x32_bf16 v[128:131], a[48:51], v[88:91], v[128:131]
    v_mfma_f32_16x16x32_bf16 v[132:135], a[52:55], v[88:91], v[132:135]
    v_mfma_f32_16x16x32_bf16 v[136:139], a[56:59], v[88:91], v[136:139]
    v_mfma_f32_16x16x32_bf16 v[140:143], a[60:63], v[88:91], v[140:143]
    v_mfma_f32_16x16x32_bf16 v[160:163], v[176:179], v[88:91], v[160:163]
    v_mfma_f32_16x16x32_bf16 v[168:171], v[88:91], v[88:91], v[168:171]
    ds_read_b128 v[84:87], v3 offset:21504
    s_waitcnt lgkmcnt(6)
    v_mfma_f32_16x16x32_bf16 v[144:147], a[48:51], v[92:95], v[144:147]
    v_mfma_f32_16x16x32_bf16 v[148:151], a[52:55], v[92:95], v[148:151]
    v_mfma_f32_16x16x32_bf16 v[152:155], a[56:59], v[92:95], v[152:155]
    v_mfma_f32_16x16x32_bf16 v[156:159], a[60:63], v[92:95], v[156:159]
    v_mfma_f32_16x16x32_bf16 v[164:167], v[176:179], v[92:95], v[164:167]
    v_mfma_f32_16x16x32_bf16 v[172:175], v[92:95], v[92:95], v[172:175]
    ds_read_b128 v[88:91], v3 offset:2048
    s_waitcnt lgkmcnt(6)
    v_mfma_f32_16x16x32_bf16 v[128:131], a[64:67], v[64:67], v[128:131]
    v_mfma_f32_16x16x32_bf16 v[132:135], a[68:71], v[64:67], v[132:135]
    v_mfma_f32_16x16x32_bf16 v[136:139], a[72:75], v[64:67], v[136:139]
    v_mfma_f32_16x16x32_bf16 v[140:143], a[76:79], v[64:67], v[140:143]
    v_mfma_f32_16x16x32_bf16 v[160:163], v[176:179], v[64:67], v[160:163]
    v_mfma_f32_16x16x32_bf16 v[168:171], v[64:67], v[64:67], v[168:171]
    ds_read_b128 v[92:95], v3 offset:22528
    s_waitcnt lgkmcnt(6)
    v_mfma_f32_16x16x32_bf16 v[144:147], a[64:67], v[68:71], v[144:147]
    v_mfma_f32_16x16x32_bf16 v[148:151], a[68:71], v[68:71], v[148:151]
    v_mfma_f32_16x16x32_bf16 v[152:155], a[72:75], v[68:71], v[152:155]
    v_mfma_f32_16x16x32_bf16 v[156:159], a[76:79], v[68:71], v[156:159]
    v_mfma_f32_16x16x32_bf16 v[164:167], v[176:179], v[68:71], v[164:167]
    v_mfma_f32_16x16x32_bf16 v[172:175], v[68:71], v[68:71], v[172:175]
    ds_read_b128 v[64:67], v3 offset:3072
    s_waitcnt lgkmcnt(6)
    v_mfma_f32_16x16x32_bf16 v[128:131], a[80:83], v[72:75], v[128:131]
    v_mfma_f32_16x16x32_bf16 v[132:135], a[84:87], v[72:75], v[132:135]
    v_mfma_f32_16x16x32_bf16 v[136:139], a[88:91], v[72:75], v[136:139]
    v_mfma_f32_16x16x32_bf16 v[140:143], a[92:95], v[72:75], v[140:143]
    ds_read_b128 v[68:71], v3 offset:23552
    s_waitcnt lgkmcnt(6)
    v_mfma_f32_16x16x32_bf16 v[144:147], a[80:83], v[76:79], v[144:147]
    v_mfma_f32_16x16x32_bf16 v[148:151], a[84:87], v[76:79], v[148:151]
    v_mfma_f32_16x16x32_bf16 v[152:155], a[88:91], v[76:79], v[152:155]
    v_mfma_f32_16x16x32_bf16 v[156:159], a[92:95], v[76:79], v[156:159]
    ds_read_b128 v[72:75], v3 offset:4096
    s_waitcnt lgkmcnt(6)
    v_mfma_f32_16x16x32_bf16 v[128:131], a[96:99], v[80:83], v[128:131]
    v_mfma_f32_16x16x32_bf16 v[132:135], a[100:103], v[80:83], v[132:135]
    v_mfma_f32_16x16x32_bf16 v[136:139], a[104:107], v[80:83], v[136:139]
    v_mfma_f32_16x16x32_bf16 v[140:143], a[108:111], v[80:83], v[140:143]
    ds_read_b128 v[76:79], v3 offset:24576
    s_waitcnt lgkmcnt(6)
    v_mfma_f32_16x16x32_bf16 v[144:147], a[96:99], v[84:87], v[144:147]
    v_mfma_f32_16x16x32_bf16 v[148:151], a[100:103], v[84:87], v[148:151]
    v_mfma_f32_16x16x32_bf16 v[152:155], a[104:107], v[84:87], v[152:155]
    v_mfma_f32_16x16x32_bf16 v[156:159], a[108:111], v[84:87], v[156:159]
    ds_read_b128 v[80:83], v4 offset:0
    s_waitcnt lgkmcnt(6)
    v_mfma_f32_16x16x32_bf16 v[128:131], a[112:115], v[88:91], v[128:131]
    v_mfma_f32_16x16x32_bf16 v[132:135], a[116:119], v[88:91], v[132:135]
    v_mfma_f32_16x16x32_bf16 v[136:139], a[120:123], v[88:91], v[136:139]
    v_mfma_f32_16x16x32_bf16 v[140:143], a[124:127], v[88:91], v[140:143]
    ds_read_b128 v[84:87], v4 offset:20480
    s_waitcnt lgkmcnt(6)
    v_mfma_f32_16x16x32_bf16 v[144:147], a[112:115], v[92:95], v[144:147]
    v_mfma_f32_16x16x32_bf16 v[148:151], a[116:119], v[92:95], v[148:151]
    v_mfma_f32_16x16x32_bf16 v[152:155], a[120:123], v[92:95], v[152:155]
    v_mfma_f32_16x16x32_bf16 v[156:159], a[124:127], v[92:95], v[156:159]
    ds_read_b128 v[88:91], v4 offset:1024
    s_waitcnt lgkmcnt(6)
    v_mfma_f32_16x16x32_bf16 v[128:131], a[128:131], v[64:67], v[128:131]
    v_mfma_f32_16x16x32_bf16 v[132:135], a[132:135], v[64:67], v[132:135]
    v_mfma_f32_16x16x32_bf16 v[136:139], a[136:139], v[64:67], v[136:139]
    v_mfma_f32_16x16x32_bf16 v[140:143], a[140:143], v[64:67], v[140:143]
    ds_read_b128 v[92:95], v4 offset:21504
    s_waitcnt lgkmcnt(6)
    v_mfma_f32_16x16x32_bf16 v[144:147], a[128:131], v[68:71], v[144:147]
    v_mfma_f32_16x16x32_bf16 v[148:151], a[132:135], v[68:71], v[148:151]
    v_mfma_f32_16x16x32_bf16 v[152:155], a[136:139], v[68:71], v[152:155]
    v_mfma_f32_16x16x32_bf16 v[156:159], a[140:143], v[68:71], v[156:159]
    ds_read_b128 v[64:67], v4 offset:2048
    s_waitcnt lgkmcnt(6)
    v_mfma_f32_16x16x32_bf16 v[128:131], a[144:147], v[72:75], v[128:131]
    v_mfma_f32_16x16x32_bf16 v[132:135], a[148:151], v[72:75], v[132:135]
    v_mfma_f32_16x16x32_bf16 v[136:139], a[152:155], v[72:75], v[136:139]
    v_mfma_f32_16x16x32_bf16 v[140:143], a[156:159], v[72:75], v[140:143]
    ds_read_b128 v[68:71], v4 offset:22528
    s_waitcnt lgkmcnt(6)
    v_mfma_f32_16x16x32_bf16 v[144:147], a[144:147], v[76:79], v[144:147]
    v_mfma_f32_16x16x32_bf16 v[148:151], a[148:151], v[76:79], v[148:151]
    v_mfma_f32_16x16x32_bf16 v[152:155], a[152:155], v[76:79], v[152:155]
    v_mfma_f32_16x16x32_bf16 v[156:159], a[156:159], v[76:79], v[156:159]
    s_waitcnt vmcnt(0)
    v_readfirstlane_b32 s3, v9
    s_nop 0
    s_mov_b32 s41, 0
    s_cmp_ge_u32 s58, 64
    s_cbranch_scc1 NPF_18
    s_cmp_lt_u32 s3, s37
    s_cbranch_scc1 NPF_18
    s_add_u32 s49, s39, s40
    s_mov_b32 s41, 1
    s_mul_i32 s3, s58, 40960
    s_add_u32 s3, s3, s34
    s_mul_i32 s59, s13, 10240
    s_add_u32 s59, s59, s49
    s_mov_b32 m0, s59
    s_add_u32 s59, s59, 1024
    buffer_load_dwordx4 v6, s[24:27], s3 offen sc1 lds
    s_add_u32 s3, s3, s35
    s_mov_b32 m0, s59
    s_add_u32 s59, s59, 1024
    buffer_load_dwordx4 v6, s[24:27], s3 offen sc1 lds
    s_add_u32 s3, s3, s35
    s_mov_b32 m0, s59
    s_add_u32 s59, s59, 1024
    buffer_load_dwordx4 v6, s[24:27], s3 offen sc1 lds
    s_add_u32 s3, s3, s35
    s_mov_b32 m0, s59
    s_add_u32 s59, s59, 1024
    buffer_load_dwordx4 v6, s[24:27], s3 offen sc1 lds
    s_add_u32 s3, s3, s35
    s_mov_b32 m0, s59
    s_add_u32 s59, s59, 1024
    buffer_load_dwordx4 v6, s[24:27], s3 offen sc1 lds
    s_add_u32 s3, s3, s35
    s_mov_b32 m0, s59
    s_add_u32 s59, s59, 1024
    buffer_load_dwordx4 v6, s[24:27], s3 offen sc1 lds
    s_add_u32 s3, s3, s35
    s_mov_b32 m0, s59
    s_add_u32 s59, s59, 1024
    buffer_load_dwordx4 v6, s[24:27], s3 offen sc1 lds
    s_add_u32 s3, s3, s35
    s_mov_b32 m0, s59
    s_add_u32 s59, s59, 1024
    buffer_load_dwordx4 v6, s[24:27], s3 offen sc1 lds
    s_add_u32 s3, s3, s35
    s_mov_b32 m0, s59
    s_add_u32 s59, s59, 1024
    buffer_load_dwordx4 v6, s[24:27], s3 offen sc1 lds
    s_add_u32 s3, s3, s35
    s_mov_b32 m0, s59
    s_add_u32 s59, s59, 1024
    buffer_load_dwordx4 v6, s[24:27], s3 offen sc1 lds
    s_add_u32 s3, s3, s35
NPF_18:
    ds_read_b128 v[72:75], v4 offset:3072
    s_waitcnt lgkmcnt(6)
    v_mfma_f32_16x16x32_bf16 v[128:131], a[160:163], v[80:83], v[128:131]
    v_mfma_f32_16x16x32_bf16 v[132:135], a[164:167], v[80:83], v[132:135]
    v_mfma_f32_16x16x32_bf16 v[136:139], a[168:171], v[80:83], v[136:139]
    v_mfma_f32_16x16x32_bf16 v[140:143], a[172:175], v[80:83], v[140:143]
    ds_read_b128 v[76:79], v4 offset:23552
    s_waitcnt lgkmcnt(6)
    v_mfma_f32_16x16x32_bf16 v[144:147], a[160:163], v[84:87], v[144:147]
    v_mfma_f32_16x16x32_bf16 v[148:151], a[164:167], v[84:87], v[148:151]
    v_mfma_f32_16x16x32_bf16 v[152:155], a[168:171], v[84:87], v[152:155]
    v_mfma_f32_16x16x32_bf16 v[156:159], a[172:175], v[84:87], v[156:159]
    ds_read_b128 v[80:83], v4 offset:4096
    s_waitcnt lgkmcnt(6)
    v_mfma_f32_16x16x32_bf16 v[128:131], a[176:179], v[88:91], v[128:131]
    v_mfma_f32_16x16x32_bf16 v[132:135], a[180:183], v[88:91], v[132:135]
    v_mfma_f32_16x16x32_bf16 v[136:139], a[184:187], v[88:91], v[136:139]
    v_mfma_f32_16x16x32_bf16 v[140:143], a[188:191], v[88:91], v[140:143]
    ds_read_b128 v[84:87], v4 offset:24576
    s_waitcnt lgkmcnt(6)
    v_mfma_f32_16x16x32_bf16 v[144:147], a[176:179], v[92:95], v[144:147]
    v_mfma_f32_16x16x32_bf16 v[148:151], a[180:183], v[92:95], v[148:151]
    v_mfma_f32_16x16x32_bf16 v[152:155], a[184:187], v[92:95], v[152:155]
    v_mfma_f32_16x16x32_bf16 v[156:159], a[188:191], v[92:95], v[156:159]
    ds_read_b128 v[88:91], v5 offset:0
    s_waitcnt lgkmcnt(6)
    v_mfma_f32_16x16x32_bf16 v[128:131], a[192:195], v[64:67], v[128:131]
    v_mfma_f32_16x16x32_bf16 v[132:135], a[196:199], v[64:67], v[132:135]
    v_mfma_f32_16x16x32_bf16 v[136:139], a[200:203], v[64:67], v[136:139]
    v_mfma_f32_16x16x32_bf16 v[140:143], a[204:207], v[64:67], v[140:143]
    ds_read_b128 v[92:95], v5 offset:20480
    s_waitcnt lgkmcnt(6)
    v_mfma_f32_16x16x32_bf16 v[144:147], a[192:195], v[68:71], v[144:147]
    v_mfma_f32_16x16x32_bf16 v[148:151], a[196:199], v[68:71], v[148:151]
    v_mfma_f32_16x16x32_bf16 v[152:155], a[200:203], v[68:71], v[152:155]
    v_mfma_f32_16x16x32_bf16 v[156:159], a[204:207], v[68:71], v[156:159]
    ds_read_b128 v[64:67], v5 offset:1024
    s_waitcnt lgkmcnt(6)
    v_mfma_f32_16x16x32_bf16 v[128:131], a[208:211], v[72:75], v[128:131]
    v_mfma_f32_16x16x32_bf16 v[132:135], a[212:215], v[72:75], v[132:135]
    v_mfma_f32_16x16x32_bf16 v[136:139], a[216:219], v[72:75], v[136:139]
    v_mfma_f32_16x16x32_bf16 v[140:143], a[220:223], v[72:75], v[140:143]
    ds_read_b128 v[68:71], v5 offset:21504
    s_waitcnt lgkmcnt(6)
    v_mfma_f32_16x16x32_bf16 v[144:147], a[208:211], v[76:79], v[144:147]
    v_mfma_f32_16x16x32_bf16 v[148:151], a[212:215], v[76:79], v[148:151]
    v_mfma_f32_16x16x32_bf16 v[152:155], a[216:219], v[76:79], v[152:155]
    v_mfma_f32_16x16x32_bf16 v[156:159], a[220:223], v[76:79], v[156:159]
    ds_read_b128 v[72:75], v5 offset:2048
    s_waitcnt lgkmcnt(6)
    v_mfma_f32_16x16x32_bf16 v[128:131], a[224:227], v[80:83], v[128:131]
    v_mfma_f32_16x16x32_bf16 v[132:135], a[228:231], v[80:83], v[132:135]
    v_mfma_f32_16x16x32_bf16 v[136:139], a[232:235], v[80:83], v[136:139]
    v_mfma_f32_16x16x32_bf16 v[140:143], a[236:239], v[80:83], v[140:143]
    ds_read_b128 v[76:79], v5 offset:22528
    s_waitcnt lgkmcnt(6)
    v_mfma_f32_16x16x32_bf16 v[144:147], a[224:227], v[84:87], v[144:147]
    v_mfma_f32_16x16x32_bf16 v[148:151], a[228:231], v[84:87], v[148:151]
    v_mfma_f32_16x16x32_bf16 v[152:155], a[232:235], v[84:87], v[152:155]
    v_mfma_f32_16x16x32_bf16 v[156:159], a[236:239], v[84:87], v[156:159]
    ds_read_b128 v[80:83], v5 offset:3072
    s_waitcnt lgkmcnt(6)
    v_mfma_f32_16x16x32_bf16 v[128:131], a[240:243], v[88:91], v[128:131]
    v_mfma_f32_16x16x32_bf16 v[132:135], a[244:247], v[88:91], v[132:135]
    v_mfma_f32_16x16x32_bf16 v[136:139], a[248:251], v[88:91], v[136:139]
    v_mfma_f32_16x16x32_bf16 v[140:143], a[252:255], v[88:91], v[140:143]
    ds_read_b128 v[84:87], v5 offset:23552
    s_waitcnt lgkmcnt(6)
    v_mfma_f32_16x16x32_bf16 v[144:147], a[240:243], v[92:95], v[144:147]
    v_mfma_f32_16x16x32_bf16 v[148:151], a[244:247], v[92:95], v[148:151]
    v_mfma_f32_16x16x32_bf16 v[152:155], a[248:251], v[92:95], v[152:155]
    v_mfma_f32_16x16x32_bf16 v[156:159], a[252:255], v[92:95], v[156:159]
    ds_read_b128 v[88:91], v5 offset:4096
    s_waitcnt lgkmcnt(6)
    v_mfma_f32_16x16x32_bf16 v[128:131], v[192:195], v[64:67], v[128:131]
    v_mfma_f32_16x16x32_bf16 v[132:135], v[196:199], v[64:67], v[132:135]
    v_mfma_f32_16x16x32_bf16 v[136:139], v[200:203], v[64:67], v[136:139]
    v_mfma_f32_16x16x32_bf16 v[140:143], v[204:207], v[64:67], v[140:143]
    ds_read_b128 v[92:95], v5 offset:24576
    s_waitcnt lgkmcnt(6)
    v_mfma_f32_16x16x32_bf16 v[144:147], v[192:195], v[68:71], v[144:147]
    v_mfma_f32_16x16x32_bf16 v[148:151], v[196:199], v[68:71], v[148:151]
    v_mfma_f32_16x16x32_bf16 v[152:155], v[200:203], v[68:71], v[152:155]
    v_mfma_f32_16x16x32_bf16 v[156:159], v[204:207], v[68:71], v[156:159]
    s_waitcnt lgkmcnt(5)
    v_mfma_f32_16x16x32_bf16 v[128:131], v[208:211], v[72:75], v[128:131]
    v_mfma_f32_16x16x32_bf16 v[132:135], v[212:215], v[72:75], v[132:135]
    v_mfma_f32_16x16x32_bf16 v[136:139], v[216:219], v[72:75], v[136:139]
    v_mfma_f32_16x16x32_bf16 v[140:143], v[220:223], v[72:75], v[140:143]
    s_waitcnt lgkmcnt(4)
    v_mfma_f32_16x16x32_bf16 v[144:147], v[208:211], v[76:79], v[144:147]
    v_mfma_f32_16x16x32_bf16 v[148:151], v[212:215], v[76:79], v[148:151]
    v_mfma_f32_16x16x32_bf16 v[152:155], v[216:219], v[76:79], v[152:155]
    v_mfma_f32_16x16x32_bf16 v[156:159], v[220:223], v[76:79], v[156:159]
    s_waitcnt lgkmcnt(3)
    v_mfma_f32_16x16x32_bf16 v[128:131], v[224:227], v[80:83], v[128:131]
    v_mfma_f32_16x16x32_bf16 v[132:135], v[228:231], v[80:83], v[132:135]
    v_mfma_f32_16x16x32_bf16 v[136:139], v[232:235], v[80:83], v[136:139]
    v_mfma_f32_16x16x32_bf16 v[140:143], v[236:239], v[80:83], v[140:143]
    s_waitcnt lgkmcnt(2)
    v_mfma_f32_16x16x32_bf16 v[144:147], v[224:227], v[84:87], v[144:147]
    v_mfma_f32_16x16x32_bf16 v[148:151], v[228:231], v[84:87], v[148:151]
    v_mfma_f32_16x16x32_bf16 v[152:155], v[232:235], v[84:87], v[152:155]
    v_mfma_f32_16x16x32_bf16 v[156:159], v[236:239], v[84:87], v[156:159]
    s_waitcnt lgkmcnt(1)
    v_mfma_f32_16x16x32_bf16 v[128:131], v[240:243], v[88:91], v[128:131]
    v_mfma_f32_16x16x32_bf16 v[132:135], v[244:247], v[88:91], v[132:135]
    v_mfma_f32_16x16x32_bf16 v[136:139], v[248:251], v[88:91], v[136:139]
    v_mfma_f32_16x16x32_bf16 v[140:143], v[252:255], v[88:91], v[140:143]
    s_waitcnt lgkmcnt(0)
    v_mfma_f32_16x16x32_bf16 v[144:147], v[240:243], v[92:95], v[144:147]
    v_mfma_f32_16x16x32_bf16 v[148:151], v[244:247], v[92:95], v[148:151]
    v_mfma_f32_16x16x32_bf16 v[152:155], v[248:251], v[92:95], v[152:155]
    v_mfma_f32_16x16x32_bf16 v[156:159], v[252:255], v[92:95], v[156:159]
    v_cndmask_b32 v168, v168, v169, s[50:51]
    v_cndmask_b32 v168, v168, v170, s[52:53]
    v_cndmask_b32 v168, v168, v171, s[54:55]
    v_mov_b32 v161, v168
    v_cndmask_b32 v172, v172, v173, s[50:51]
    v_cndmask_b32 v172, v172, v174, s[52:53]
    v_cndmask_b32 v172, v172, v175, s[54:55]
    v_mov_b32 v165, v172
    s_mov_b64 exec, s[56:57]
    ds_write_b64 v10, v[160:161] offset:0
    ds_write_b64 v10, v[164:165] offset:128
    s_mov_b64 exec, -1
    s_waitcnt lgkmcnt(0)
    s_barrier
    ds_read_b64 v[20:21], v11 offset:0
    ds_read_b64 v[22:23], v11 offset:256
    ds_read_b64 v[24:25], v11 offset:512
    ds_read_b64 v[26:27], v11 offset:768
    ds_read_b64 v[28:29], v11 offset:128
    ds_read_b64 v[30:31], v11 offset:384
    ds_read_b64 v[32:33], v11 offset:640
    ds_read_b64 v[34:35], v11 offset:896
    s_waitcnt lgkmcnt(0)
    v_pk_add_f32 v[20:21], v[20:21], v[22:23]
    v_pk_add_f32 v[24:25], v[24:25], v[26:27]
    v_pk_add_f32 v[20:21], v[20:21], v[24:25]
    v_mul_f32 v20, 0x3acccccd, v20
    v_mul_f32 v21, 0x3acccccd, v21
    v_fma_f32 v21, -v20, v20, v21
    v_max_f32 v21, 0, v21
    v_cvt_pk_bf16_f32 v16, v20, v20
    v_lshlrev_b32 v16, 16, v16
    v_cvt_pk_bf16_f32 v21, v21, v21
    v_lshlrev_b32 v21, 16, v21
    v_add_f32 v21, 0x3727c5ac, v21
    v_cvt_pk_bf16_f32 v21, v21, v21
    v_lshlrev_b32 v21, 16, v21
    v_sqrt_f32 v21, v21
    s_nop 0
    v_cvt_pk_bf16_f32 v21, v21, v21
    v_lshlrev_b32 v21, 16, v21
    v_rcp_f32 v18, v21
    s_nop 0
    v_mul_f32 v18, 0x3ea52b5c, v18
    v_pk_add_f32 v[28:29], v[28:29], v[30:31]
    v_pk_add_f32 v[32:33], v[32:33], v[34:35]
    v_pk_add_f32 v[28:29], v[28:29], v[32:33]
    v_mul_f32 v28, 0x3acccccd, v28
    v_mul_f32 v29, 0x3acccccd, v29
    v_fma_f32 v29, -v28, v28, v29
    v_max_f32 v29, 0, v29
    v_cvt_pk_bf16_f32 v17, v28, v28
    v_lshlrev_b32 v17, 16, v17
    v_cvt_pk_bf16_f32 v29, v29, v29
    v_lshlrev_b32 v29, 16, v29
    v_add_f32 v29, 0x3727c5ac, v29
    v_cvt_pk_bf16_f32 v29, v29, v29
    v_lshlrev_b32 v29, 16, v29
    v_sqrt_f32 v29, v29
    s_nop 0
    v_cvt_pk_bf16_f32 v29, v29, v29
    v_lshlrev_b32 v29, 16, v29
    v_rcp_f32 v19, v29
    s_nop 0
    v_mul_f32 v19, 0x3ea52b5c, v19
    v_fma_f32 v128, -v16, v96, v128
    v_mul_f32 v128, v128, v18
    v_fma_f32 v129, -v16, v97, v129
    v_mul_f32 v129, v129, v18
    v_fma_f32 v130, -v16, v98, v130
    v_mul_f32 v130, v130, v18
    v_fma_f32 v131, -v16, v99, v131
    v_mul_f32 v131, v131, v18
    v_fma_f32 v132, -v16, v100, v132
    v_mul_f32 v132, v132, v18
    v_fma_f32 v133, -v16, v101, v133
    v_mul_f32 v133, v133, v18
    v_fma_f32 v134, -v16, v102, v134
    v_mul_f32 v134, v134, v18
    v_fma_f32 v135, -v16, v103, v135
    v_mul_f32 v135, v135, v18
    v_fma_f32 v136, -v16, v104, v136
    v_mul_f32 v136, v136, v18
    v_fma_f32 v137, -v16, v105, v137
    v_mul_f32 v137, v137, v18
    v_fma_f32 v138, -v16, v106, v138
    v_mul_f32 v138, v138, v18
    v_fma_f32 v139, -v16, v107, v139
    v_mul_f32 v139, v139, v18
    v_fma_f32 v140, -v16, v108, v140
    v_mul_f32 v140, v140, v18
    v_fma_f32 v141, -v16, v109, v141
    v_mul_f32 v141, v141, v18
    v_fma_f32 v142, -v16, v110, v142
    v_mul_f32 v142, v142, v18
    v_fma_f32 v143, -v16, v111, v143
    v_mul_f32 v143, v143, v18
    v_fma_f32 v144, -v17, v96, v144
    v_mul_f32 v144, v144, v19
    v_fma_f32 v145, -v17, v97, v145
    v_mul_f32 v145, v145, v19
    v_fma_f32 v146, -v17, v98, v146
    v_mul_f32 v146, v146, v19
    v_fma_f32 v147, -v17, v99, v147
    v_mul_f32 v147, v147, v19
    v_fma_f32 v148, -v17, v100, v148
    v_mul_f32 v148, v148, v19
    v_fma_f32 v149, -v17, v101, v149
    v_mul_f32 v149, v149, v19
    v_fma_f32 v150, -v17, v102, v150
    v_mul_f32 v150, v150, v19
    v_fma_f32 v151, -v17, v103, v151
    v_mul_f32 v151, v151, v19
    v_fma_f32 v152, -v17, v104, v152
    v_mul_f32 v152, v152, v19
    v_fma_f32 v153, -v17, v105, v153
    v_mul_f32 v153, v153, v19
    v_fma_f32 v154, -v17, v106, v154
    v_mul_f32 v154, v154, v19
    v_fma_f32 v155, -v17, v107, v155
    v_mul_f32 v155, v155, v19
    v_fma_f32 v156, -v17, v108, v156
    v_mul_f32 v156, v156, v19
    v_fma_f32 v157, -v17, v109, v157
    v_mul_f32 v157, v157, v19
    v_fma_f32 v158, -v17, v110, v158
    v_mul_f32 v158, v158, v19
    v_fma_f32 v159, -v17, v111, v159
    v_mul_f32 v159, v159, v19
    s_mul_i32 s49, s32, 40960
    s_add_u32 s49, s49, s17
    s_add_u32 s59, s49, 20480
    v_cvt_pk_bf16_f32 v20, v128, v129
    v_cvt_pk_bf16_f32 v21, v130, v131
    v_cvt_pk_bf16_f32 v22, v132, v133
    v_cvt_pk_bf16_f32 v23, v134, v135
    buffer_store_dwordx4 v[20:23], v7, s[8:11], s49 offen offset:0 sc1
    v_cvt_pk_bf16_f32 v24, v136, v137
    v_cvt_pk_bf16_f32 v25, v138, v139
    v_cvt_pk_bf16_f32 v26, v140, v141
    v_cvt_pk_bf16_f32 v27, v142, v143
    buffer_store_dwordx4 v[24:27], v7, s[8:11], s49 offen offset:64 sc1
    v_cvt_pk_bf16_f32 v28, v144, v145
    v_cvt_pk_bf16_f32 v29, v146, v147
    v_cvt_pk_bf16_f32 v30, v148, v149
    v_cvt_pk_bf16_f32 v31, v150, v151
    buffer_store_dwordx4 v[28:31], v7, s[8:11], s59 offen offset:0 sc1
    v_cvt_pk_bf16_f32 v32, v152, v153
    v_cvt_pk_bf16_f32 v33, v154, v155
    v_cvt_pk_bf16_f32 v34, v156, v157
    v_cvt_pk_bf16_f32 v35, v158, v159
    buffer_store_dwordx4 v[32:35], v7, s[8:11], s59 offen offset:64 sc1
    s_nop 0
    s_branch P1_END
P1_V1:
    s_add_u32 s58, s32, s33
    s_min_u32 s3, s58, 63
    s_lshl_b32 s3, s3, 7
    s_add_u32 s3, s3, s36
    v_mov_b32 v8, 0
    buffer_load_dword v9, v8, s[8:11], s3 offen sc1
    ds_read_b128 v[64:67], v2 offset:0
    ds_read_b128 v[68:71], v2 offset:20480
    ds_read_b128 v[72:75], v2 offset:1024
    ds_read_b128 v[76:79], v2 offset:21504
    ds_read_b128 v[80:83], v2 offset:2048
    ds_read_b128 v[84:87], v2 offset:22528
    ds_read_b128 v[88:91], v2 offset:3072
    s_waitcnt lgkmcnt(6)
    v_mfma_f32_16x16x32_bf16 v[128:131], a[0:3], v[64:67], 0
    v_mfma_f32_16x16x32_bf16 v[132:135], a[4:7], v[64:67], 0
    v_mfma_f32_16x16x32_bf16 v[160:163], v[176:179], v[64:67], 0
    v_mfma_f32_16x16x32_bf16 v[168:171], v[64:67], v[64:67], 0
    ds_read_b128 v[92:95], v2 offset:23552
    s_waitcnt lgkmcnt(6)
    v_mfma_f32_16x16x32_bf16 v[144:147], a[0:3], v[68:71], 0
    v_mfma_f32_16x16x32_bf16 v[148:151], a[4:7], v[68:71], 0
    v_mfma_f32_16x16x32_bf16 v[164:167], v[176:179], v[68:71], 0
    v_mfma_f32_16x16x32_bf16 v[172:175], v[68:71], v[68:71], 0
    ds_read_b128 v[64:67], v2 offset:4096
    s_waitcnt lgkmcnt(6)
    v_mfma_f32_16x16x32_bf16 v[128:131], a[16:19], v[72:75], v[128:131]
    v_mfma_f32_16x16x32_bf16 v[132:135], a[20:23], v[72:75], v[132:135]
    v_mfma_f32_16x16x32_bf16 v[160:163], v[176:179], v[72:75], v[160:163]
    v_mfma_f32_16x16x32_bf16 v[168:171], v[72:75], v[72:75], v[168:171]
    ds_read_b128 v[68:71], v2 offset:24576
    s_waitcnt lgkmcnt(6)
    v_mfma_f32_16x16x32_bf16 v[144:147], a[16:19], v[76:79], v[144:147]
    v_mfma_f32_16x16x32_bf16 v[148:151], a[20:23], v[76:79], v[148:151]
    v_mfma_f32_16x16x32_bf16 v[164:167], v[176:179], v[76:79], v[164:167]
    v_mfma_f32_16x16x32_bf16 v[172:175], v[76:79], v[76:79], v[172:175]
    ds_read_b128 v[72:75], v3 offset:0
    s_waitcnt lgkmcnt(6)
    v_mfma_f32_16x16x32_bf16 v[128:131], a[32:35], v[80:83], v[128:131]
    v_mfma_f32_16x16x32_bf16 v[132:135], a[36:39], v[80:83], v[132:135]
    v_mfma_f32_16x16x32_bf16 v[160:163], v[176:179], v[80:83], v[160:163]
    v_mfma_f32_16x16x32_bf16 v[168:171], v[80:83], v[80:83], v[168:171]
    ds_read_b128 v[76:79], v3 offset:20480
    s_waitcnt lgkmcnt(6)
    v_mfma_f32_16x16x32_bf16 v[144:147], a[32:35], v[84:87], v[144:147]
    v_mfma_f32_16x16x32_bf16 v[148:151], a[36:39], v[84:87], v[148:151]
    v_mfma_f32_16x16x32_bf16 v[164:167], v[176:179], v[84:87], v[164:167]
    v_mfma_f32_16x16x32_bf16 v[172:175], v[84:87], v[84:87], v[172:175]
    ds_read_b128 v[80:83], v3 offset:1024
    s_waitcnt lgkmcnt(6)
    v_mfma_f32_16x16x32_bf16 v[128:131], a[48:51], v[88:91], v[128:131]
    v_mfma_f32_16x16x32_bf16 v[132:135], a[52:55], v[88:91], v[132:135]
    v_mfma_f32_16x16x32_bf16 v[160:163], v[176:179], v[88:91], v[160:163]
    v_mfma_f32_16x16x32_bf16 v[168:171], v[88:91], v[88:91], v[168:171]
    ds_read_b128 v[84:87], v3 offset:21504
    s_waitcnt lgkmcnt(6)
    v_mfma_f32_16x16x32_bf16 v[144:147], a[48:51], v[92:95], v[144:147]
    v_mfma_f32_16x16x32_bf16 v[148:151], a[52:55], v[92:95], v[148:151]
    v_mfma_f32_16x16x32_bf16 v[164:167], v[176:179], v[92:95], v[164:167]
    v_mfma_f32_16x16x32_bf16 v[172:175], v[92:95], v[92:95], v[172:175]
    ds_read_b128 v[88:91], v3 offset:2048
    s_waitcnt lgkmcnt(6)
    v_mfma_f32_16x16x32_bf16 v[128:131], a[64:67], v[64:67], v[128:131]
    v_mfma_f32_16x16x32_bf16 v[132:135], a[68:71], v[64:67], v[132:135]
    v_mfma_f32_16x16x32_bf16 v[160:163], v[176:179], v[64:67], v[160:163]
    v_mfma_f32_16x16x32_bf16 v[168:171], v[64:67], v[64:67], v[168:171]
    ds_read_b128 v[92:95], v3 offset:22528
    s_waitcnt lgkmcnt(6)
    v_mfma_f32_16x16x32_bf16 v[144:147], a[64:67], v[68:71], v[144:147]
    v_mfma_f32_16x16x32_bf16 v[148:151], a[68:71], v[68:71], v[148:151]
    v_mfma_f32_16x16x32_bf16 v[164:167], v[176:179], v[68:71], v[164:167]
    v_mfma_f32_16x16x32_bf16 v[172:175], v[68:71], v[68:71], v[172:175]
    ds_read_b128 v[64:67], v3 offset:3072
    s_waitcnt lgkmcnt(6)
    v_mfma_f32_16x16x32_bf16 v[128:131], a[80:83], v[72:75], v[128:131]
    v_mfma_f32_16x16x32_bf16 v[132:135], a[84:87], v[72:75], v[132:135]
    ds_read_b128 v[68:71], v3 offset:23552
    s_waitcnt lgkmcnt(6)
    v_mfma_f32_16x16x32_bf16 v[144:147], a[80:83], v[76:79], v[144:147]
    v_mfma_f32_16x16x32_bf16 v[148:151], a[84:87], v[76:79], v[148:151]
    ds_read_b128 v[72:75], v3 offset:4096
    s_waitcnt lgkmcnt(6)
    v_mfma_f32_16x16x32_bf16 v[128:131], a[96:99], v[80:83], v[128:131]
    v_mfma_f32_16x16x32_bf16 v[132:135], a[100:103], v[80:83], v[132:135]
    ds_read_b128 v[76:79], v3 offset:24576
    s_waitcnt lgkmcnt(6)
    v_mfma_f32_16x16x32_bf16 v[144:147], a[96:99], v[84:87], v[144:147]
    v_mfma_f32_16x16x32_bf16 v[148:151], a[100:103], v[84:87], v[148:151]
    ds_read_b128 v[80:83], v4 offset:0
    s_waitcnt lgkmcnt(6)
    v_mfma_f32_16x16x32_bf16 v[128:131], a[112:115], v[88:91], v[128:131]
    v_mfma_f32_16x16x32_bf16 v[132:135], a[116:119], v[88:91], v[132:135]
    ds_read_b128 v[84:87], v4 offset:20480
    s_waitcnt lgkmcnt(6)
    v_mfma_f32_16x16x32_bf16 v[144:147], a[112:115], v[92:95], v[144:147]
    v_mfma_f32_16x16x32_bf16 v[148:151], a[116:119], v[92:95], v[148:151]
    ds_read_b128 v[88:91], v4 offset:1024
    s_waitcnt lgkmcnt(6)
    v_mfma_f32_16x16x32_bf16 v[128:131], a[128:131], v[64:67], v[128:131]
    v_mfma_f32_16x16x32_bf16 v[132:135], a[132:135], v[64:67], v[132:135]
    ds_read_b128 v[92:95], v4 offset:21504
    s_waitcnt lgkmcnt(6)
    v_mfma_f32_16x16x32_bf16 v[144:147], a[128:131], v[68:71], v[144:147]
    v_mfma_f32_16x16x32_bf16 v[148:151], a[132:135], v[68:71], v[148:151]
    ds_read_b128 v[64:67], v4 offset:2048
    s_waitcnt lgkmcnt(6)
    v_mfma_f32_16x16x32_bf16 v[128:131], a[144:147], v[72:75], v[128:131]
    v_mfma_f32_16x16x32_bf16 v[132:135], a[148:151], v[72:75], v[132:135]
    ds_read_b128 v[68:71], v4 offset:22528
    s_waitcnt lgkmcnt(6)
    v_mfma_f32_16x16x32_bf16 v[144:147], a[144:147], v[76:79], v[144:147]
    v_mfma_f32_16x16x32_bf16 v[148:151], a[148:151], v[76:79], v[148:151]
    ds_read_b128 v[72:75], v4 offset:3072
    s_waitcnt lgkmcnt(6)
    v_mfma_f32_16x16x32_bf16 v[128:131], a[160:163], v[80:83], v[128:131]
    v_mfma_f32_16x16x32_bf16 v[132:135], a[164:167], v[80:83], v[132:135]
    ds_read_b128 v[76:79], v4 offset:23552
    s_waitcnt lgkmcnt(6)
    v_mfma_f32_16x16x32_bf16 v[144:147], a[160:163], v[84:87], v[144:147]
    v_mfma_f32_16x16x32_bf16 v[148:151], a[164:167], v[84:87], v[148:151]
    ds_read_b128 v[80:83], v4 offset:4096
    s_waitcnt lgkmcnt(6)
    v_mfma_f32_16x16x32_bf16 v[128:131], a[176:179], v[88:91], v[128:131]
    v_mfma_f32_16x16x32_bf16 v[132:135], a[180:183], v[88:91], v[132:135]
    ds_read_b128 v[84:87], v4 offset:24576
    s_waitcnt lgkmcnt(6)
    v_mfma_f32_16x16x32_bf16 v[144:147], a[176:179], v[92:95], v[144:147]
    v_mfma_f32_16x16x32_bf16 v[148:151], a[180:183], v[92:95], v[148:151]
    ds_read_b128 v[88:91], v5 offset:0
    s_waitcnt lgkmcnt(6)
    v_mfma_f32_16x16x32_bf16 v[128:131], a[192:195], v[64:67], v[128:131]
    v_mfma_f32_16x16x32_bf16 v[132:135], a[196:199], v[64:67], v[132:135]
    ds_read_b128 v[92:95], v5 offset:20480
    s_waitcnt lgkmcnt(6)
    v_mfma_f32_16x16x32_bf16 v[144:147], a[192:195], v[68:71], v[144:147]
    v_mfma_f32_16x16x32_bf16 v[148:151], a[196:199], v[68:71], v[148:151]
    ds_read_b128 v[64:67], v5 offset:1024
    s_waitcnt lgkmcnt(6)
    v_mfma_f32_16x16x32_bf16 v[128:131], a[208:211], v[72:75], v[128:131]
    v_mfma_f32_16x16x32_bf16 v[132:135], a[212:215], v[72:75], v[132:135]
    ds_read_b128 v[68:71], v5 offset:21504
    s_waitcnt lgkmcnt(6)
    v_mfma_f32_16x16x32_bf16 v[144:147], a[208:211], v[76:79], v[144:147]
    v_mfma_f32_16x16x32_bf16 v[148:151], a[212:215], v[76:79], v[148:151]
    ds_read_b128 v[72:75], v5 offset:2048
    s_waitcnt lgkmcnt(6)
    v_mfma_f32_16x16x32_bf16 v[128:131], a[224:227], v[80:83], v[128:131]
    v_mfma_f32_16x16x32_bf16 v[132:135], a[228:231], v[80:83], v[132:135]
    ds_read_b128 v[76:79], v5 offset:22528
    s_waitcnt lgkmcnt(6)
    v_mfma_f32_16x16x32_bf16 v[144:147], a[224:227], v[84:87], v[144:147]
    v_mfma_f32_16x16x32_bf16 v[148:151], a[228:231], v[84:87], v[148:151]
    ds_read_b128 v[80:83], v5 offset:3072
    s_waitcnt lgkmcnt(6)
    v_mfma_f32_16x16x32_bf16 v[128:131], a[240:243], v[88:91], v[128:131]
    v_mfma_f32_16x16x32_bf16 v[132:135], a[244:247], v[88:91], v[132:135]
    ds_read_b128 v[84:87], v5 offset:23552
    s_waitcnt lgkmcnt(6)
    v_mfma_f32_16x16x32_bf16 v[144:147], a[240:243], v[92:95], v[144:147]
    v_mfma_f32_16x16x32_bf16 v[148:151], a[244:247], v[92:95], v[148:151]
    ds_read_b128 v[88:91], v5 offset:4096
    s_waitcnt lgkmcnt(6)
    v_mfma_f32_16x16x32_bf16 v[128:131], v[192:195], v[64:67], v[128:131]
    v_mfma_f32_16x16x32_bf16 v[132:135], v[196:199], v[64:67], v[132:135]
    ds_read_b128 v[92:95], v5 offset:24576
    s_waitcnt lgkmcnt(6)
    v_mfma_f32_16x16x32_bf16 v[144:147], v[192:195], v[68:71], v[144:147]
    v_mfma_f32_16x16x32_bf16 v[148:151], v[196:199], v[68:71], v[148:151]
    s_waitcnt lgkmcnt(5)
    v_mfma_f32_16x16x32_bf16 v[128:131], v[208:211], v[72:75], v[128:131]
    v_mfma_f32_16x16x32_bf16 v[132:135], v[212:215], v[72:75], v[132:135]
    s_waitcnt lgkmcnt(4)
    v_mfma_f32_16x16x32_bf16 v[144:147], v[208:211], v[76:79], v[144:147]
    v_mfma_f32_16x16x32_bf16 v[148:151], v[212:215], v[76:79], v[148:151]
    s_waitcnt lgkmcnt(3)
    v_mfma_f32_16x16x32_bf16 v[128:131], v[224:227], v[80:83], v[128:131]
    v_mfma_f32_16x16x32_bf16 v[132:135], v[228:231], v[80:83], v[132:135]
    s_waitcnt lgkmcnt(2)
    v_mfma_f32_16x16x32_bf16 v[144:147], v[224:227], v[84:87], v[144:147]
    v_mfma_f32_16x16x32_bf16 v[148:151], v[228:231], v[84:87], v[148:151]
    s_waitcnt lgkmcnt(1)
    v_mfma_f32_16x16x32_bf16 v[128:131], v[240:243], v[88:91], v[128:131]
    v_mfma_f32_16x16x32_bf16 v[132:135], v[244:247], v[88:91], v[132:135]
    s_waitcnt lgkmcnt(0)
    v_mfma_f32_16x16x32_bf16 v[144:147], v[240:243], v[92:95], v[144:147]
    v_mfma_f32_16x16x32_bf16 v[148:151], v[244:247], v[92:95], v[148:151]
    s_waitcnt vmcnt(0)
    v_readfirstlane_b32 s3, v9
    s_nop 0
    s_mov_b32 s41, 0
    s_cmp_ge_u32 s58, 64
    s_cbranch_scc1 NPF_19
    s_cmp_lt_u32 s3, s37
    s_cbranch_scc1 NPF_19
    s_add_u32 s49, s39, s40
    s_mov_b32 s41, 1
    s_mul_i32 s3, s58, 40960
    s_add_u32 s3, s3, s34
    s_mul_i32 s59, s13, 10240
    s_add_u32 s59, s59, s49
    s_mov_b32 m0, s59
    s_add_u32 s59, s59, 1024
    buffer_load_dwordx4 v6, s[24:27], s3 offen sc1 lds
    s_add_u32 s3, s3, s35
    s_mov_b32 m0, s59
    s_add_u32 s59, s59, 1024
    buffer_load_dwordx4 v6, s[24:27], s3 offen sc1 lds
    s_add_u32 s3, s3, s35
    s_mov_b32 m0, s59
    s_add_u32 s59, s59, 1024
    buffer_load_dwordx4 v6, s[24:27], s3 offen sc1 lds
    s_add_u32 s3, s3, s35
    s_mov_b32 m0, s59
    s_add_u32 s59, s59, 1024
    buffer_load_dwordx4 v6, s[24:27], s3 offen sc1 lds
    s_add_u32 s3, s3, s35
    s_mov_b32 m0, s59
    s_add_u32 s59, s59, 1024
    buffer_load_dwordx4 v6, s[24:27], s3 offen sc1 lds
    s_add_u32 s3, s3, s35
    s_mov_b32 m0, s59
    s_add_u32 s59, s59, 1024
    buffer_load_dwordx4 v6, s[24:27], s3 offen sc1 lds
    s_add_u32 s3, s3, s35
    s_mov_b32 m0, s59
    s_add_u32 s59, s59, 1024
    buffer_load_dwordx4 v6, s[24:27], s3 offen sc1 lds
    s_add_u32 s3, s3, s35
    s_mov_b32 m0, s59
    s_add_u32 s59, s59, 1024
    buffer_load_dwordx4 v6, s[24:27], s3 offen sc1 lds
    s_add_u32 s3, s3, s35
    s_mov_b32 m0, s59
    s_add_u32 s59, s59, 1024
    buffer_load_dwordx4 v6, s[24:27], s3 offen sc1 lds
    s_add_u32 s3, s3, s35
    s_mov_b32 m0, s59
    s_add_u32 s59, s59, 1024
    buffer_load_dwordx4 v6, s[24:27], s3 offen sc1 lds
    s_add_u32 s3, s3, s35
NPF_19:
    v_cndmask_b32 v168, v168, v169, s[50:51]
    v_cndmask_b32 v168, v168, v170, s[52:53]
    v_cndmask_b32 v168, v168, v171, s[54:55]
    v_mov_b32 v161, v168
    v_cndmask_b32 v172, v172, v173, s[50:51]
    v_cndmask_b32 v172, v172, v174, s[52:53]
    v_cndmask_b32 v172, v172, v175, s[54:55]
    v_mov_b32 v165, v172
    s_mov_b64 exec, s[56:57]
    ds_write_b64 v10, v[160:161] offset:0
    ds_write_b64 v10, v[164:165] offset:128
    s_mov_b64 exec, -1
    s_waitcnt lgkmcnt(0)
    s_barrier
    ds_read_b64 v[20:21], v11 offset:0
    ds_read_b64 v[22:23], v11 offset:256
    ds_read_b64 v[24:25], v11 offset:512
    ds_read_b64 v[26:27], v11 offset:768
    ds_read_b64 v[28:29], v11 offset:128
    ds_read_b64 v[30:31], v11 offset:384
    ds_read_b64 v[32:33], v11 offset:640
    ds_read_b64 v[34:35], v11 offset:896
    s_waitcnt lgkmcnt(0)
    v_pk_add_f32 v[20:21], v[20:21], v[22:23]
    v_pk_add_f32 v[24:25], v[24:25], v[26:27]
    v_pk_add_f32 v[20:21], v[20:21], v[24:25]
    v_mul_f32 v20, 0x3acccccd, v20
    v_mul_f32 v21, 0x3acccccd, v21
    v_fma_f32 v21, -v20, v20, v21
    v_max_f32 v21, 0, v21
    v_cvt_pk_bf16_f32 v16, v20, v20
    v_lshlrev_b32 v16, 16, v16
    v_cvt_pk_bf16_f32 v21, v21, v21
    v_lshlrev_b32 v21, 16, v21
    v_add_f32 v21, 0x3727c5ac, v21
    v_cvt_pk_bf16_f32 v21, v21, v21
    v_lshlrev_b32 v21, 16, v21
    v_sqrt_f32 v21, v21
    s_nop 0
    v_cvt_pk_bf16_f32 v21, v21, v21
    v_lshlrev_b32 v21, 16, v21
    v_rcp_f32 v18, v21
    v_pk_add_f32 v[28:29], v[28:29], v[30:31]
    v_pk_add_f32 v[32:33], v[32:33], v[34:35]
    v_pk_add_f32 v[28:29], v[28:29], v[32:33]
    v_mul_f32 v28, 0x3acccccd, v28
    v_mul_f32 v29, 0x3acccccd, v29
    v_fma_f32 v29, -v28, v28, v29
    v_max_f32 v29, 0, v29
    v_cvt_pk_bf16_f32 v17, v28, v28
    v_lshlrev_b32 v17, 16, v17
    v_cvt_pk_bf16_f32 v29, v29, v29
    v_lshlrev_b32 v29, 16, v29
    v_add_f32 v29, 0x3727c5ac, v29
    v_cvt_pk_bf16_f32 v29, v29, v29
    v_lshlrev_b32 v29, 16, v29
    v_sqrt_f32 v29, v29
    s_nop 0
    v_cvt_pk_bf16_f32 v29, v29, v29
    v_lshlrev_b32 v29, 16, v29
    v_rcp_f32 v19, v29
    v_fma_f32 v128, -v16, v96, v128
    v_mul_f32 v128, v128, v18
    v_fma_f32 v129, -v16, v97, v129
    v_mul_f32 v129, v129, v18
    v_fma_f32 v130, -v16, v98, v130
    v_mul_f32 v130, v130, v18
    v_fma_f32 v131, -v16, v99, v131
    v_mul_f32 v131, v131, v18
    v_fma_f32 v132, -v16, v100, v132
    v_mul_f32 v132, v132, v18
    v_fma_f32 v133, -v16, v101, v133
    v_mul_f32 v133, v133, v18
    v_fma_f32 v134, -v16, v102, v134
    v_mul_f32 v134, v134, v18
    v_fma_f32 v135, -v16, v103, v135
    v_mul_f32 v135, v135, v18
    v_fma_f32 v144, -v17, v96, v144
    v_mul_f32 v144, v144, v19
    v_fma_f32 v145, -v17, v97, v145
    v_mul_f32 v145, v145, v19
    v_fma_f32 v146, -v17, v98, v146
    v_mul_f32 v146, v146, v19
    v_fma_f32 v147, -v17, v99, v147
    v_mul_f32 v147, v147, v19
    v_fma_f32 v148, -v17, v100, v148
    v_mul_f32 v148, v148, v19
    v_fma_f32 v149, -v17, v101, v149
    v_mul_f32 v149, v149, v19
    v_fma_f32 v150, -v17, v102, v150
    v_mul_f32 v150, v150, v19
    v_fma_f32 v151, -v17, v103, v151
    v_mul_f32 v151, v151, v19
    s_lshl_b32 s49, s32, 12
    s_add_u32 s49, s49, s17
    s_add_u32 s49, s49, 0x300000
    v_cvt_pk_bf16_f32 v20, v128, v129
    v_cvt_pk_bf16_f32 v21, v130, v131
    v_cvt_pk_bf16_f32 v22, v132, v133
    v_cvt_pk_bf16_f32 v23, v134, v135
    buffer_store_dwordx4 v[20:23], v7, s[8:11], s49 offen offset:0 sc1
    v_cvt_pk_bf16_f32 v24, v144, v145
    v_cvt_pk_bf16_f32 v25, v146, v147
    v_cvt_pk_bf16_f32 v26, v148, v149
    v_cvt_pk_bf16_f32 v27, v150, v151
    buffer_store_dwordx4 v[24:27], v7, s[8:11], s49 offen offset:256 sc1
    s_nop 0
    s_branch P1_END
P1_V2:
    s_add_u32 s58, s32, s33
    s_min_u32 s3, s58, 63
    s_lshl_b32 s3, s3, 7
    s_add_u32 s3, s3, s36
    v_mov_b32 v8, 0
    buffer_load_dword v9, v8, s[8:11], s3 offen sc1
    ds_read_b128 v[64:67], v2 offset:0
    ds_read_b128 v[68:71], v2 offset:20480
    ds_read_b128 v[72:75], v2 offset:1024
    ds_read_b128 v[76:79], v2 offset:21504
    ds_read_b128 v[80:83], v2 offset:2048
    ds_read_b128 v[84:87], v2 offset:22528
    ds_read_b128 v[88:91], v2 offset:3072
    s_waitcnt lgkmcnt(6)
    v_mfma_f32_16x16x32_bf16 v[128:131], v[64:67], a[0:3], 0
    v_mfma_f32_16x16x32_bf16 v[132:135], v[64:67], a[4:7], 0
    v_mfma_f32_16x16x32_bf16 v[160:163], v[176:179], v[64:67], 0
    v_mfma_f32_16x16x32_bf16 v[168:171], v[64:67], v[64:67], 0
    ds_read_b128 v[92:95], v2 offset:23552
    s_waitcnt lgkmcnt(6)
    v_mfma_f32_16x16x32_bf16 v[144:147], v[68:71], a[0:3], 0
    v_mfma_f32_16x16x32_bf16 v[148:151], v[68:71], a[4:7], 0
    v_mfma_f32_16x16x32_bf16 v[164:167], v[176:179], v[68:71], 0
    v_mfma_f32_16x16x32_bf16 v[172:175], v[68:71], v[68:71], 0
    ds_read_b128 v[64:67], v2 offset:4096
    s_waitcnt lgkmcnt(6)
    v_mfma_f32_16x16x32_bf16 v[128:131], v[72:75], a[16:19], v[128:131]
    v_mfma_f32_16x16x32_bf16 v[132:135], v[72:75], a[20:23], v[132:135]
    v_mfma_f32_16x16x32_bf16 v[160:163], v[176:179], v[72:75], v[160:163]
    v_mfma_f32_16x16x32_bf16 v[168:171], v[72:75], v[72:75], v[168:171]
    ds_read_b128 v[68:71], v2 offset:24576
    s_waitcnt lgkmcnt(6)
    v_mfma_f32_16x16x32_bf16 v[144:147], v[76:79], a[16:19], v[144:147]
    v_mfma_f32_16x16x32_bf16 v[148:151], v[76:79], a[20:23], v[148:151]
    v_mfma_f32_16x16x32_bf16 v[164:167], v[176:179], v[76:79], v[164:167]
    v_mfma_f32_16x16x32_bf16 v[172:175], v[76:79], v[76:79], v[172:175]
    ds_read_b128 v[72:75], v3 offset:0
    s_waitcnt lgkmcnt(6)
    v_mfma_f32_16x16x32_bf16 v[128:131], v[80:83], a[32:35], v[128:131]
    v_mfma_f32_16x16x32_bf16 v[132:135], v[80:83], a[36:39], v[132:135]
    v_mfma_f32_16x16x32_bf16 v[160:163], v[176:179], v[80:83], v[160:163]
    v_mfma_f32_16x16x32_bf16 v[168:171], v[80:83], v[80:83], v[168:171]
    ds_read_b128 v[76:79], v3 offset:20480
    s_waitcnt lgkmcnt(6)
    v_mfma_f32_16x16x32_bf16 v[144:147], v[84:87], a[32:35], v[144:147]
    v_mfma_f32_16x16x32_bf16 v[148:151], v[84:87], a[36:39], v[148:151]
    v_mfma_f32_16x16x32_bf16 v[164:167], v[176:179], v[84:87], v[164:167]
    v_mfma_f32_16x16x32_bf16 v[172:175], v[84:87], v[84:87], v[172:175]
    ds_read_b128 v[80:83], v3 offset:1024
    s_waitcnt lgkmcnt(6)
    v_mfma_f32_16x16x32_bf16 v[128:131], v[88:91], a[48:51], v[128:131]
    v_mfma_f32_16x16x32_bf16 v[132:135], v[88:91], a[52:55], v[132:135]
    v_mfma_f32_16x16x32_bf16 v[160:163], v[176:179], v[88:91], v[160:163]
    v_mfma_f32_16x16x32_bf16 v[168:171], v[88:91], v[88:91], v[168:171]
    ds_read_b128 v[84:87], v3 offset:21504
    s_waitcnt lgkmcnt(6)
    v_mfma_f32_16x16x32_bf16 v[144:147], v[92:95], a[48:51], v[144:147]
    v_mfma_f32_16x16x32_bf16 v[148:151], v[92:95], a[52:55], v[148:151]
    v_mfma_f32_16x16x32_bf16 v[164:167], v[176:179], v[92:95], v[164:167]
    v_mfma_f32_16x16x32_bf16 v[172:175], v[92:95], v[92:95], v[172:175]
    ds_read_b128 v[88:91], v3 offset:2048
    s_waitcnt lgkmcnt(6)
    v_mfma_f32_16x16x32_bf16 v[128:131], v[64:67], a[64:67], v[128:131]
    v_mfma_f32_16x16x32_bf16 v[132:135], v[64:67], a[68:71], v[132:135]
    v_mfma_f32_16x16x32_bf16 v[160:163], v[176:179], v[64:67], v[160:163]
    v_mfma_f32_16x16x32_bf16 v[168:171], v[64:67], v[64:67], v[168:171]
    ds_read_b128 v[92:95], v3 offset:22528
    s_waitcnt lgkmcnt(6)
    v_mfma_f32_16x16x32_bf16 v[144:147], v[68:71], a[64:67], v[144:147]
    v_mfma_f32_16x16x32_bf16 v[148:151], v[68:71], a[68:71], v[148:151]
    v_mfma_f32_16x16x32_bf16 v[164:167], v[176:179], v[68:71], v[164:167]
    v_mfma_f32_16x16x32_bf16 v[172:175], v[68:71], v[68:71], v[172:175]
    ds_read_b128 v[64:67], v3 offset:3072
    s_waitcnt lgkmcnt(6)
    v_mfma_f32_16x16x32_bf16 v[128:131], v[72:75], a[80:83], v[128:131]
    v_mfma_f32_16x16x32_bf16 v[132:135], v[72:75], a[84:87], v[132:135]
    ds_read_b128 v[68:71], v3 offset:23552
    s_waitcnt lgkmcnt(6)
    v_mfma_f32_16x16x32_bf16 v[144:147], v[76:79], a[80:83], v[144:147]
    v_mfma_f32_16x16x32_bf16 v[148:151], v[76:79], a[84:87], v[148:151]
    ds_read_b128 v[72:75], v3 offset:4096
    s_waitcnt lgkmcnt(6)
    v_mfma_f32_16x16x32_bf16 v[128:131], v[80:83], a[96:99], v[128:131]
    v_mfma_f32_16x16x32_bf16 v[132:135], v[80:83], a[100:103], v[132:135]
    ds_read_b128 v[76:79], v3 offset:24576
    s_waitcnt lgkmcnt(6)
    v_mfma_f32_16x16x32_bf16 v[144:147], v[84:87], a[96:99], v[144:147]
    v_mfma_f32_16x16x32_bf16 v[148:151], v[84:87], a[100:103], v[148:151]
    ds_read_b128 v[80:83], v4 offset:0
    s_waitcnt lgkmcnt(6)
    v_mfma_f32_16x16x32_bf16 v[128:131], v[88:91], a[112:115], v[128:131]
    v_mfma_f32_16x16x32_bf16 v[132:135], v[88:91], a[116:119], v[132:135]
    ds_read_b128 v[84:87], v4 offset:20480
    s_waitcnt lgkmcnt(6)
    v_mfma_f32_16x16x32_bf16 v[144:147], v[92:95], a[112:115], v[144:147]
    v_mfma_f32_16x16x32_bf16 v[148:151], v[92:95], a[116:119], v[148:151]
    ds_read_b128 v[88:91], v4 offset:1024
    s_waitcnt lgkmcnt(6)
    v_mfma_f32_16x16x32_bf16 v[128:131], v[64:67], a[128:131], v[128:131]
    v_mfma_f32_16x16x32_bf16 v[132:135], v[64:67], a[132:135], v[132:135]
    ds_read_b128 v[92:95], v4 offset:21504
    s_waitcnt lgkmcnt(6)
    v_mfma_f32_16x16x32_bf16 v[144:147], v[68:71], a[128:131], v[144:147]
    v_mfma_f32_16x16x32_bf16 v[148:151], v[68:71], a[132:135], v[148:151]
    ds_read_b128 v[64:67], v4 offset:2048
    s_waitcnt lgkmcnt(6)
    v_mfma_f32_16x16x32_bf16 v[128:131], v[72:75], a[144:147], v[128:131]
    v_mfma_f32_16x16x32_bf16 v[132:135], v[72:75], a[148:151], v[132:135]
    ds_read_b128 v[68:71], v4 offset:22528
    s_waitcnt lgkmcnt(6)
    v_mfma_f32_16x16x32_bf16 v[144:147], v[76:79], a[144:147], v[144:147]
    v_mfma_f32_16x16x32_bf16 v[148:151], v[76:79], a[148:151], v[148:151]
    ds_read_b128 v[72:75], v4 offset:3072
    s_waitcnt lgkmcnt(6)
    v_mfma_f32_16x16x32_bf16 v[128:131], v[80:83], a[160:163], v[128:131]
    v_mfma_f32_16x16x32_bf16 v[132:135], v[80:83], a[164:167], v[132:135]
    ds_read_b128 v[76:79], v4 offset:23552
    s_waitcnt lgkmcnt(6)
    v_mfma_f32_16x16x32_bf16 v[144:147], v[84:87], a[160:163], v[144:147]
    v_mfma_f32_16x16x32_bf16 v[148:151], v[84:87], a[164:167], v[148:151]
    ds_read_b128 v[80:83], v4 offset:4096
    s_waitcnt lgkmcnt(6)
    v_mfma_f32_16x16x32_bf16 v[128:131], v[88:91], a[176:179], v[128:131]
    v_mfma_f32_16x16x32_bf16 v[132:135], v[88:91], a[180:183], v[132:135]
    ds_read_b128 v[84:87], v4 offset:24576
    s_waitcnt lgkmcnt(6)
    v_mfma_f32_16x16x32_bf16 v[144:147], v[92:95], a[176:179], v[144:147]
    v_mfma_f32_16x16x32_bf16 v[148:151], v[92:95], a[180:183], v[148:151]
    ds_read_b128 v[88:91], v5 offset:0
    s_waitcnt lgkmcnt(6)
    v_mfma_f32_16x16x32_bf16 v[128:131], v[64:67], a[192:195], v[128:131]
    v_mfma_f32_16x16x32_bf16 v[132:135], v[64:67], a[196:199], v[132:135]
    ds_read_b128 v[92:95], v5 offset:20480
    s_waitcnt lgkmcnt(6)
    v_mfma_f32_16x16x32_bf16 v[144:147], v[68:71], a[192:195], v[144:147]
    v_mfma_f32_16x16x32_bf16 v[148:151], v[68:71], a[196:199], v[148:151]
    ds_read_b128 v[64:67], v5 offset:1024
    s_waitcnt lgkmcnt(6)
    v_mfma_f32_16x16x32_bf16 v[128:131], v[72:75], a[208:211], v[128:131]
    v_mfma_f32_16x16x32_bf16 v[132:135], v[72:75], a[212:215], v[132:135]
    ds_read_b128 v[68:71], v5 offset:21504
    s_waitcnt lgkmcnt(6)
    v_mfma_f32_16x16x32_bf16 v[144:147], v[76:79], a[208:211], v[144:147]
    v_mfma_f32_16x16x32_bf16 v[148:151], v[76:79], a[212:215], v[148:151]
    ds_read_b128 v[72:75], v5 offset:2048
    s_waitcnt lgkmcnt(6)
    v_mfma_f32_16x16x32_bf16 v[128:131], v[80:83], a[224:227], v[128:131]
    v_mfma_f32_16x16x32_bf16 v[132:135], v[80:83], a[228:231], v[132:135]
    ds_read_b128 v[76:79], v5 offset:22528
    s_waitcnt lgkmcnt(6)
    v_mfma_f32_16x16x32_bf16 v[144:147], v[84:87], a[224:227], v[144:147]
    v_mfma_f32_16x16x32_bf16 v[148:151], v[84:87], a[228:231], v[148:151]
    ds_read_b128 v[80:83], v5 offset:3072
    s_waitcnt lgkmcnt(6)
    v_mfma_f32_16x16x32_bf16 v[128:131], v[88:91], a[240:243], v[128:131]
    v_mfma_f32_16x16x32_bf16 v[132:135], v[88:91], a[244:247], v[132:135]
    ds_read_b128 v[84:87], v5 offset:23552
    s_waitcnt lgkmcnt(6)
    v_mfma_f32_16x16x32_bf16 v[144:147], v[92:95], a[240:243], v[144:147]
    v_mfma_f32_16x16x32_bf16 v[148:151], v[92:95], a[244:247], v[148:151]
    ds_read_b128 v[88:91], v5 offset:4096
    s_waitcnt lgkmcnt(6)
    v_mfma_f32_16x16x32_bf16 v[128:131], v[64:67], v[192:195], v[128:131]
    v_mfma_f32_16x16x32_bf16 v[132:135], v[64:67], v[196:199], v[132:135]
    ds_read_b128 v[92:95], v5 offset:24576
    s_waitcnt lgkmcnt(6)
    v_mfma_f32_16x16x32_bf16 v[144:147], v[68:71], v[192:195], v[144:147]
    v_mfma_f32_16x16x32_bf16 v[148:151], v[68:71], v[196:199], v[148:151]
    s_waitcnt lgkmcnt(5)
    v_mfma_f32_16x16x32_bf16 v[128:131], v[72:75], v[208:211], v[128:131]
    v_mfma_f32_16x16x32_bf16 v[132:135], v[72:75], v[212:215], v[132:135]
    s_waitcnt lgkmcnt(4)
    v_mfma_f32_16x16x32_bf16 v[144:147], v[76:79], v[208:211], v[144:147]
    v_mfma_f32_16x16x32_bf16 v[148:151], v[76:79], v[212:215], v[148:151]
    s_waitcnt lgkmcnt(3)
    v_mfma_f32_16x16x32_bf16 v[128:131], v[80:83], v[224:227], v[128:131]
    v_mfma_f32_16x16x32_bf16 v[132:135], v[80:83], v[228:231], v[132:135]
    s_waitcnt lgkmcnt(2)
    v_mfma_f32_16x16x32_bf16 v[144:147], v[84:87], v[224:227], v[144:147]
    v_mfma_f32_16x16x32_bf16 v[148:151], v[84:87], v[228:231], v[148:151]
    s_waitcnt lgkmcnt(1)
    v_mfma_f32_16x16x32_bf16 v[128:131], v[88:91], v[240:243], v[128:131]
    v_mfma_f32_16x16x32_bf16 v[132:135], v[88:91], v[244:247], v[132:135]
    s_waitcnt lgkmcnt(0)
    v_mfma_f32_16x16x32_bf16 v[144:147], v[92:95], v[240:243], v[144:147]
    v_mfma_f32_16x16x32_bf16 v[148:151], v[92:95], v[244:247], v[148:151]
    s_waitcnt vmcnt(0)
    v_readfirstlane_b32 s3, v9
    s_nop 0
    s_mov_b32 s41, 0
    s_cmp_ge_u32 s58, 64
    s_cbranch_scc1 NPF_20
    s_cmp_lt_u32 s3, s37
    s_cbranch_scc1 NPF_20
    s_add_u32 s49, s39, s40
    s_mov_b32 s41, 1
    s_mul_i32 s3, s58, 40960
    s_add_u32 s3, s3, s34
    s_mul_i32 s59, s13, 10240
    s_add_u32 s59, s59, s49
    s_mov_b32 m0, s59
    s_add_u32 s59, s59, 1024
    buffer_load_dwordx4 v6, s[24:27], s3 offen sc1 lds
    s_add_u32 s3, s3, s35
    s_mov_b32 m0, s59
    s_add_u32 s59, s59, 1024
    buffer_load_dwordx4 v6, s[24:27], s3 offen sc1 lds
    s_add_u32 s3, s3, s35
    s_mov_b32 m0, s59
    s_add_u32 s59, s59, 1024
    buffer_load_dwordx4 v6, s[24:27], s3 offen sc1 lds
    s_add_u32 s3, s3, s35
    s_mov_b32 m0, s59
    s_add_u32 s59, s59, 1024
    buffer_load_dwordx4 v6, s[24:27], s3 offen sc1 lds
    s_add_u32 s3, s3, s35
    s_mov_b32 m0, s59
    s_add_u32 s59, s59, 1024
    buffer_load_dwordx4 v6, s[24:27], s3 offen sc1 lds
    s_add_u32 s3, s3, s35
    s_mov_b32 m0, s59
    s_add_u32 s59, s59, 1024
    buffer_load_dwordx4 v6, s[24:27], s3 offen sc1 lds
    s_add_u32 s3, s3, s35
    s_mov_b32 m0, s59
    s_add_u32 s59, s59, 1024
    buffer_load_dwordx4 v6, s[24:27], s3 offen sc1 lds
    s_add_u32 s3, s3, s35
    s_mov_b32 m0, s59
    s_add_u32 s59, s59, 1024
    buffer_load_dwordx4 v6, s[24:27], s3 offen sc1 lds
    s_add_u32 s3, s3, s35
    s_mov_b32 m0, s59
    s_add_u32 s59, s59, 1024
    buffer_load_dwordx4 v6, s[24:27], s3 offen sc1 lds
    s_add_u32 s3, s3, s35
    s_mov_b32 m0, s59
    s_add_u32 s59, s59, 1024
    buffer_load_dwordx4 v6, s[24:27], s3 offen sc1 lds
    s_add_u32 s3, s3, s35
NPF_20:
    v_cndmask_b32 v168, v168, v169, s[50:51]
    v_cndmask_b32 v168, v168, v170, s[52:53]
    v_cndmask_b32 v168, v168, v171, s[54:55]
    v_mov_b32 v161, v168
    v_cndmask_b32 v172, v172, v173, s[50:51]
    v_cndmask_b32 v172, v172, v174, s[52:53]
    v_cndmask_b32 v172, v172, v175, s[54:55]
    v_mov_b32 v165, v172
    s_mov_b64 exec, s[56:57]
    ds_write_b64 v10, v[160:161] offset:0
    ds_write_b64 v10, v[164:165] offset:128
    s_mov_b64 exec, -1
    s_waitcnt lgkmcnt(0)
    s_barrier
    ds_read_b64 v[20:21], v11 offset:0
    ds_read_b64 v[22:23], v11 offset:256
    ds_read_b64 v[24:25], v11 offset:512
    ds_read_b64 v[26:27], v11 offset:768
    ds_read_b64 v[28:29], v11 offset:128
    ds_read_b64 v[30:31], v11 offset:384
    ds_read_b64 v[32:33], v11 offset:640
    ds_read_b64 v[34:35], v11 offset:896
    s_waitcnt lgkmcnt(0)
    v_pk_add_f32 v[20:21], v[20:21], v[22:23]
    v_pk_add_f32 v[24:25], v[24:25], v[26:27]
    v_pk_add_f32 v[20:21], v[20:21], v[24:25]
    v_mul_f32 v20, 0x3acccccd, v20
    v_mul_f32 v21, 0x3acccccd, v21
    v_fma_f32 v21, -v20, v20, v21
    v_max_f32 v21, 0, v21
    v_cvt_pk_bf16_f32 v16, v20, v20
    v_lshlrev_b32 v16, 16, v16
    v_cvt_pk_bf16_f32 v21, v21, v21
    v_lshlrev_b32 v21, 16, v21
    v_add_f32 v21, 0x3727c5ac, v21
    v_cvt_pk_bf16_f32 v21, v21, v21
    v_lshlrev_b32 v21, 16, v21
    v_sqrt_f32 v21, v21
    s_nop 0
    v_cvt_pk_bf16_f32 v21, v21, v21
    v_lshlrev_b32 v21, 16, v21
    v_rcp_f32 v18, v21
    v_pk_add_f32 v[28:29], v[28:29], v[30:31]
    v_pk_add_f32 v[32:33], v[32:33], v[34:35]
    v_pk_add_f32 v[28:29], v[28:29], v[32:33]
    v_mul_f32 v28, 0x3acccccd, v28
    v_mul_f32 v29, 0x3acccccd, v29
    v_fma_f32 v29, -v28, v28, v29
    v_max_f32 v29, 0, v29
    v_cvt_pk_bf16_f32 v17, v28, v28
    v_lshlrev_b32 v17, 16, v17
    v_cvt_pk_bf16_f32 v29, v29, v29
    v_lshlrev_b32 v29, 16, v29
    v_add_f32 v29, 0x3727c5ac, v29
    v_cvt_pk_bf16_f32 v29, v29, v29
    v_lshlrev_b32 v29, 16, v29
    v_sqrt_f32 v29, v29
    s_nop 0
    v_cvt_pk_bf16_f32 v29, v29, v29
    v_lshlrev_b32 v29, 16, v29
    v_rcp_f32 v19, v29
    v_and_b32 v36, 15, v0
    v_lshlrev_b32 v36, 2, v36
    s_lshl_b32 s3, s13, 8
    s_add_u32 s3, s3, 82944
    v_add_u32 v36, s3, v36
    v_and_b32 v37, 48, v0
    v_add_u32 v37, s3, v37
    ds_write_b32 v36, v16 offset:0
    ds_write_b32 v36, v17 offset:64
    ds_write_b32 v36, v18 offset:128
    ds_write_b32 v36, v19 offset:192
    s_waitcnt lgkmcnt(0)
    ds_read_b128 v[20:23], v37 offset:0
    ds_read_b128 v[24:27], v37 offset:64
    ds_read_b128 v[28:31], v37 offset:128
    ds_read_b128 v[32:35], v37 offset:192
    s_waitcnt lgkmcnt(0)
    v_fma_f32 v128, -v20, v96, v128
    v_mul_f32 v128, v128, v28
    v_fma_f32 v129, -v21, v97, v129
    v_mul_f32 v129, v129, v29
    v_fma_f32 v130, -v22, v98, v130
    v_mul_f32 v130, v130, v30
    v_fma_f32 v131, -v23, v99, v131
    v_mul_f32 v131, v131, v31
    v_fma_f32 v132, -v20, v100, v132
    v_mul_f32 v132, v132, v28
    v_fma_f32 v133, -v21, v101, v133
    v_mul_f32 v133, v133, v29
    v_fma_f32 v134, -v22, v102, v134
    v_mul_f32 v134, v134, v30
    v_fma_f32 v135, -v23, v103, v135
    v_mul_f32 v135, v135, v31
    v_fma_f32 v144, -v24, v96, v144
    v_mul_f32 v144, v144, v32
    v_fma_f32 v145, -v25, v97, v145
    v_mul_f32 v145, v145, v33
    v_fma_f32 v146, -v26, v98, v146
    v_mul_f32 v146, v146, v34
    v_fma_f32 v147, -v27, v99, v147
    v_mul_f32 v147, v147, v35
    v_fma_f32 v148, -v24, v100, v148
    v_mul_f32 v148, v148, v32
    v_fma_f32 v149, -v25, v101, v149
    v_mul_f32 v149, v149, v33
    v_fma_f32 v150, -v26, v102, v150
    v_mul_f32 v150, v150, v34
    v_fma_f32 v151, -v27, v103, v151
    v_mul_f32 v151, v151, v35
    s_lshl_b32 s49, s32, 12
    s_add_u32 s49, s49, s17
    s_add_u32 s49, s49, 0x300000
    v_cvt_pk_bf16_f32 v40, v128, v129
    v_cvt_pk_bf16_f32 v41, v130, v131
    v_cvt_pk_bf16_f32 v42, v144, v145
    v_cvt_pk_bf16_f32 v43, v146, v147
    buffer_store_dwordx2 v[40:41], v7, s[8:11], s49 offen offset:2048 sc1
    buffer_store_dwordx2 v[42:43], v7, s[8:11], s49 offen offset:3072 sc1
    v_cvt_pk_bf16_f32 v44, v132, v133
    v_cvt_pk_bf16_f32 v45, v134, v135
    v_cvt_pk_bf16_f32 v46, v148, v149
    v_cvt_pk_bf16_f32 v47, v150, v151
    s_mov_b32 exec_lo, 0x01000100
    s_mov_b32 exec_hi, 0x01000100
    v_mov_b32 v44, 0x3f803f80
    v_mov_b32 v45, 0x3f803f80
    v_mov_b32 v46, 0x3f803f80
    v_mov_b32 v47, 0x3f803f80
    s_mov_b64 exec, -1
    buffer_store_dwordx2 v[44:45], v7, s[8:11], s49 offen offset:2112 sc1
    buffer_store_dwordx2 v[46:47], v7, s[8:11], s49 offen offset:3136 sc1
P1_END:
    s_waitcnt vmcnt(0)
    s_barrier
    s_mov_b32 s49, s38
    s_cmp_lg_u32 s13, 0
    s_cbranch_scc1 SIG_21
    v_mov_b32 v8, 0
    v_mov_b32 v9, 1
    s_mov_b64 exec, 1
    buffer_atomic_add v9, v8, s[8:11], s49 offen sc1
    s_mov_b64 exec, -1
SIG_21:
    v_add_u32 v2, s40, v2
    v_add_u32 v3, s40, v3
    v_add_u32 v4, s40, v4
    v_add_u32 v5, s40, v5
    s_add_u32 s39, s39, s40
    s_sub_u32 s40, 0, s40
    s_add_u32 s32, s32, s33
    s_branch P1_SEG
P1_NEXTP:
    s_cmp_eq_u32 s47, 1
    s_cbranch_scc1 AT_BODY
    s_cmp_eq_u32 s47, 2
    s_cbranch_scc1 QA_BODY
    s_add_u32 s14, s14, 1
    s_cmp_lt_u32 s14, s15
    s_cbranch_scc1 P1_PAIR
    s_endpgm
ROLE_AT:
    s_and_b32 s3, s16, 1
    s_cbranch_scc0 AT_BODY
    s_cmp_lg_u32 s14, 0
    s_cbranch_scc1 AT_BODY
    s_cmp_ge_u32 s12, 60
    s_cbranch_scc1 AT_BODY
    s_add_u32 s19, s12, 6
    s_mov_b32 s47, 1
    s_branch P1_BODY
AT_BODY:
    s_and_b32 s3, s16, 2
    s_cbranch_scc0 EXIT2
    v_and_b32 v16, 31, v0
    v_lshrrev_b32 v17, 5, v0
    v_mul_u32_u24 v18, 40, v16
    v_lshl_add_u32 v1, v17, 4, v18
    v_add_u32 v2, 32, v18
    v_lshl_add_u32 v2, v17, 30, v2
    v_lshlrev_b32 v3, 4, v0
    s_lshl_b32 s3, s13, 16
    v_add_u32 v3, s3, v3
    v_mul_u32_u24 v5, 112, v16
    v_lshl_add_u32 v5, v17, 4, v5
    s_mul_i32 s3, s13, 3584
    v_add_u32 v5, s3, v5
    v_add_u32 v18, 0, v0
    v_min_u32 v18, 159, v18
    v_mul_u32_u24 v19, 205, v18
    v_lshrrev_b32 v19, 10, v19
    v_mul_u32_u24 v20, 5, v19
    v_sub_u32 v20, v18, v20
    v_mul_u32_u24 v10, 112, v19
    v_lshl_add_u32 v6, v20, 4, v10
    v_add_u32 v18, 64, v0
    v_min_u32 v18, 159, v18
    v_mul_u32_u24 v19, 205, v18
    v_lshrrev_b32 v19, 10, v19
    v_mul_u32_u24 v20, 5, v19
    v_sub_u32 v20, v18, v20
    v_mul_u32_u24 v11, 112, v19
    v_lshl_add_u32 v7, v20, 4, v11
    v_add_u32 v18, 128, v0
    v_min_u32 v18, 159, v18
    v_mul_u32_u24 v19, 205, v18
    v_lshrrev_b32 v19, 10, v19
    v_mul_u32_u24 v20, 5, v19
    v_sub_u32 v20, v18, v20
    v_mul_u32_u24 v12, 112, v19
    v_lshl_add_u32 v8, v20, 4, v12
    v_lshlrev_b32 v9, 3, v0
    v_mov_b32 v110, 0
    v_mov_b32 v111, 0
    v_cmp_eq_u32 s[50:51], 20, v16
    s_nop 0
    s_mov_b32 s33, 0
    s_mov_b32 s35, 14336
AT_PAIR:
    s_mul_i32 s17, s14, 0x6000000
    s_add_u32 s17, s17, 0x1000000
    s_lshl_b32 s49, s14, 7
    s_add_u32 s49, s49, 0
    s_cmp_lt_u32 s13, 3
    s_cselect_b32 s3, s14, 0
    s_lshl_b32 s3, s3, 3
    s_sub_u32 s37, 192, s3
    v_mov_b32 v14, 0
POLL_22:
    buffer_load_dword v15, v14, s[8:11], s49 offen sc1
    s_waitcnt vmcnt(0)
    v_readfirstlane_b32 s58, v15
    s_nop 0
    s_cmp_ge_u32 s58, s37
    s_nop 1
    s_cbranch_scc1 POLLD_23
    s_add_u32 s99, s99, 1
    s_cmp_ge_u32 s99, 0x80000
    s_cbranch_scc1 POLLD_23
    s_sleep 1
    s_branch POLL_22
POLLD_23:
    s_mov_b32 s32, s12
    s_mul_i32 s3, s32, 1280
    s_add_u32 s3, s3, s17
    buffer_load_dwordx4 v[112:115], v1, s[8:11], s3 offen sc1
    buffer_load_dwordx2 v[116:117], v2, s[8:11], s3 offen sc1
    s_add_u32 s36, s17, 0x300000
    buffer_load_dwordx4 a[0:3], v3, s[8:11], s36 offen offset:0 sc1
    buffer_load_dwordx4 a[4:7], v3, s[8:11], s36 offen offset:1024 sc1
    buffer_load_dwordx4 a[128:131], v3, s[8:11], s36 offen offset:2048 sc1
    buffer_load_dwordx4 a[132:135], v3, s[8:11], s36 offen offset:3072 sc1
    s_add_u32 s36, s36, 4096
    buffer_load_dwordx4 a[8:11], v3, s[8:11], s36 offen offset:0 sc1
    buffer_load_dwordx4 a[12:15], v3, s[8:11], s36 offen offset:1024 sc1
    buffer_load_dwordx4 a[136:139], v3, s[8:11], s36 offen offset:2048 sc1
    buffer_load_dwordx4 a[140:143], v3, s[8:11], s36 offen offset:3072 sc1
    s_add_u32 s36, s36, 4096
    buffer_load_dwordx4 a[16:19], v3, s[8:11], s36 offen offset:0 sc1
    buffer_load_dwordx4 a[20:23], v3, s[8:11], s36 offen offset:1024 sc1
    buffer_load_dwordx4 a[144:147], v3, s[8:11], s36 offen offset:2048 sc1
    buffer_load_dwordx4 a[148:151], v3, s[8:11], s36 offen offset:3072 sc1
    s_add_u32 s36, s36, 4096
    buffer_load_dwordx4 a[24:27], v3, s[8:11], s36 offen offset:0 sc1
    buffer_load_dwordx4 a[28:31], v3, s[8:11], s36 offen offset:1024 sc1
    buffer_load_dwordx4 a[152:155], v3, s[8:11], s36 offen offset:2048 sc1
    buffer_load_dwordx4 a[156:159], v3, s[8:11], s36 offen offset:3072 sc1
    s_add_u32 s36, s36, 4096
    buffer_load_dwordx4 a[32:35], v3, s[8:11], s36 offen offset:0 sc1
    buffer_load_dwordx4 a[36:39], v3, s[8:11], s36 offen offset:1024 sc1
    buffer_load_dwordx4 a[160:163], v3, s[8:11], s36 offen offset:2048 sc1
    buffer_load_dwordx4 a[164:167], v3, s[8:11], s36 offen offset:3072 sc1
    s_add_u32 s36, s36, 4096
    buffer_load_dwordx4 a[40:43], v3, s[8:11], s36 offen offset:0 sc1
    buffer_load_dwordx4 a[44:47], v3, s[8:11], s36 offen offset:1024 sc1
    buffer_load_dwordx4 a[168:171], v3, s[8:11], s36 offen offset:2048 sc1
    buffer_load_dwordx4 a[172:175], v3, s[8:11], s36 offen offset:3072 sc1
    s_add_u32 s36, s36, 4096
    buffer_load_dwordx4 a[48:51], v3, s[8:11], s36 offen offset:0 sc1
    buffer_load_dwordx4 a[52:55], v3, s[8:11], s36 offen offset:1024 sc1
    buffer_load_dwordx4 a[176:179], v3, s[8:11], s36 offen offset:2048 sc1
    buffer_load_dwordx4 a[180:183], v3, s[8:11], s36 offen offset:3072 sc1
    s_add_u32 s36, s36, 4096
    buffer_load_dwordx4 a[56:59], v3, s[8:11], s36 offen offset:0 sc1
    buffer_load_dwordx4 a[60:63], v3, s[8:11], s36 offen offset:1024 sc1
    buffer_load_dwordx4 a[184:187], v3, s[8:11], s36 offen offset:2048 sc1
    buffer_load_dwordx4 a[188:191], v3, s[8:11], s36 offen offset:3072 sc1
    s_add_u32 s36, s36, 4096
    buffer_load_dwordx4 a[64:67], v3, s[8:11], s36 offen offset:0 sc1
    buffer_load_dwordx4 a[68:71], v3, s[8:11], s36 offen offset:1024 sc1
    buffer_load_dwordx4 a[192:195], v3, s[8:11], s36 offen offset:2048 sc1
    buffer_load_dwordx4 a[196:199], v3, s[8:11], s36 offen offset:3072 sc1
    s_add_u32 s36, s36, 4096
    buffer_load_dwordx4 a[72:75], v3, s[8:11], s36 offen offset:0 sc1
    buffer_load_dwordx4 a[76:79], v3, s[8:11], s36 offen offset:1024 sc1
    buffer_load_dwordx4 a[200:203], v3, s[8:11], s36 offen offset:2048 sc1
    buffer_load_dwordx4 a[204:207], v3, s[8:11], s36 offen offset:3072 sc1
    s_add_u32 s36, s36, 4096
    buffer_load_dwordx4 a[80:83], v3, s[8:11], s36 offen offset:0 sc1
    buffer_load_dwordx4 a[84:87], v3, s[8:11], s36 offen offset:1024 sc1
    buffer_load_dwordx4 a[208:211], v3, s[8:11], s36 offen offset:2048 sc1
    buffer_load_dwordx4 a[212:215], v3, s[8:11], s36 offen offset:3072 sc1
    s_add_u32 s36, s36, 4096
    buffer_load_dwordx4 a[88:91], v3, s[8:11], s36 offen offset:0 sc1
    buffer_load_dwordx4 a[92:95], v3, s[8:11], s36 offen offset:1024 sc1
    buffer_load_dwordx4 a[216:219], v3, s[8:11], s36 offen offset:2048 sc1
    buffer_load_dwordx4 a[220:223], v3, s[8:11], s36 offen offset:3072 sc1
    s_add_u32 s36, s36, 4096
    s_waitcnt vmcnt(10)
    buffer_load_dwordx4 a[96:99], v3, s[8:11], s36 offen offset:0 sc1
    buffer_load_dwordx4 a[100:103], v3, s[8:11], s36 offen offset:1024 sc1
    buffer_load_dwordx4 a[224:227], v3, s[8:11], s36 offen offset:2048 sc1
    buffer_load_dwordx4 a[228:231], v3, s[8:11], s36 offen offset:3072 sc1
    s_add_u32 s36, s36, 4096
    buffer_load_dwordx4 a[104:107], v3, s[8:11], s36 offen offset:0 sc1
    buffer_load_dwordx4 a[108:111], v3, s[8:11], s36 offen offset:1024 sc1
    buffer_load_dwordx4 a[232:235], v3, s[8:11], s36 offen offset:2048 sc1
    buffer_load_dwordx4 a[236:239], v3, s[8:11], s36 offen offset:3072 sc1
    s_add_u32 s36, s36, 4096
    buffer_load_dwordx4 a[112:115], v3, s[8:11], s36 offen offset:0 sc1
    buffer_load_dwordx4 a[116:119], v3, s[8:11], s36 offen offset:1024 sc1
    buffer_load_dwordx4 a[240:243], v3, s[8:11], s36 offen offset:2048 sc1
    buffer_load_dwordx4 a[244:247], v3, s[8:11], s36 offen offset:3072 sc1
    s_add_u32 s36, s36, 4096
    buffer_load_dwordx4 a[120:123], v3, s[8:11], s36 offen offset:0 sc1
    buffer_load_dwordx4 a[124:127], v3, s[8:11], s36 offen offset:1024 sc1
    buffer_load_dwordx4 a[248:251], v3, s[8:11], s36 offen offset:2048 sc1
    buffer_load_dwordx4 a[252:255], v3, s[8:11], s36 offen offset:3072 sc1
    s_add_u32 s36, s36, 4096
    s_waitcnt vmcnt(0)
    v_mov_b32 v104, v112
    v_mov_b32 v105, v113
    v_mov_b32 v106, v114
    v_mov_b32 v107, v115
    v_mov_b32 v108, v116
    v_mov_b32 v109, v117
    s_add_u32 s3, s32, 60
    s_min_u32 s3, s3, 2047
    s_mul_i32 s3, s3, 1280
    s_add_u32 s3, s3, s17
    buffer_load_dwordx4 v[112:115], v1, s[8:11], s3 offen sc1
    buffer_load_dwordx2 v[116:117], v2, s[8:11], s3 offen sc1
    s_mov_b32 s38, 0
AT_TOK:
    s_mov_b32 s34, 0
    v_mfma_f32_32x32x16_bf16 v[32:47], a[0:3], v[104:107], 0
    v_mfma_f32_32x32x16_bf16 v[32:47], a[4:7], v[108:111], v[32:47]
    s_nop 11
    v_max3_f32 v16, v32, v33, v47
    v_max3_f32 v16, v16, v34, v35
    v_max3_f32 v16, v16, v36, v37
    v_max3_f32 v16, v16, v38, v39
    v_max3_f32 v16, v16, v40, v41
    v_max3_f32 v16, v16, v42, v43
    v_max3_f32 v16, v16, v44, v45
    v_max_f32 v16, v16, v46
AT_HAVEM:
    v_mov_b32 v17, v16
    s_nop 1
    v_permlane32_swap_b32 v16, v17
    v_max_f32 v16, v16, v17
    v_sub_f32 v64, 0, v16
    v_sub_f32 v65, 0, v16
    v_sub_f32 v66, 0, v16
    v_sub_f32 v67, 0, v16
    v_sub_f32 v68, 0, v16
    v_sub_f32 v69, 0, v16
    v_sub_f32 v70, 0, v16
    v_sub_f32 v71, 0, v16
    v_sub_f32 v72, 0, v16
    v_sub_f32 v73, 0, v16
    v_sub_f32 v74, 0, v16
    v_sub_f32 v75, 0, v16
    v_sub_f32 v76, 0, v16
    v_sub_f32 v77, 0, v16
    v_sub_f32 v78, 0, v16
    v_sub_f32 v79, 0, v16
    s_nop 1
    v_mfma_f32_32x32x16_bf16 v[32:47], a[0:3], v[104:107], v[64:79]
    v_mfma_f32_32x32x16_bf16 v[32:47], a[4:7], v[108:111], v[32:47]
    v_mfma_f32_32x32x16_bf16 v[48:63], a[8:11], v[104:107], v[64:79]
    s_nop 10
    v_exp_f32 v32, v32
    v_exp_f32 v33, v33
    v_exp_f32 v34, v34
    v_exp_f32 v35, v35
    v_mfma_f32_32x32x16_bf16 v[48:63], a[12:15], v[108:111], v[48:63]
    v_exp_f32 v36, v36
    v_exp_f32 v37, v37
    v_exp_f32 v38, v38
    v_exp_f32 v39, v39
    v_cvt_pk_bf16_f32 v96, v32, v33
    v_cvt_pk_bf16_f32 v97, v34, v35
    v_cvt_pk_bf16_f32 v98, v36, v37
    v_cvt_pk_bf16_f32 v99, v38, v39
    v_exp_f32 v40, v40
    v_exp_f32 v41, v41
    v_mfma_f32_32x32x16_bf16 v[80:95], a[128:131], v[96:99], 0
    v_exp_f32 v42, v42
    v_exp_f32 v43, v43
    v_exp_f32 v44, v44
    v_exp_f32 v45, v45
    v_exp_f32 v46, v46
    v_exp_f32 v47, v47
    v_cvt_pk_bf16_f32 v100, v40, v41
    v_cvt_pk_bf16_f32 v101, v42, v43
    v_cvt_pk_bf16_f32 v102, v44, v45
    v_cvt_pk_bf16_f32 v103, v46, v47
    s_nop 1
    v_mfma_f32_32x32x16_bf16 v[80:95], a[132:135], v[100:103], v[80:95]
    v_mfma_f32_32x32x16_bf16 v[32:47], a[16:19], v[104:107], v[64:79]
    v_exp_f32 v48, v48
    v_exp_f32 v49, v49
    v_exp_f32 v50, v50
    v_exp_f32 v51, v51
    v_mfma_f32_32x32x16_bf16 v[32:47], a[20:23], v[108:111], v[32:47]
    v_exp_f32 v52, v52
    v_exp_f32 v53, v53
    v_exp_f32 v54, v54
    v_exp_f32 v55, v55
    v_cvt_pk_bf16_f32 v96, v48, v49
    v_cvt_pk_bf16_f32 v97, v50, v51
    v_cvt_pk_bf16_f32 v98, v52, v53
    v_cvt_pk_bf16_f32 v99, v54, v55
    v_exp_f32 v56, v56
    v_exp_f32 v57, v57
    v_mfma_f32_32x32x16_bf16 v[80:95], a[136:139], v[96:99], v[80:95]
    v_exp_f32 v58, v58
    v_exp_f32 v59, v59
    v_exp_f32 v60, v60
    v_exp_f32 v61, v61
    v_exp_f32 v62, v62
    v_exp_f32 v63, v63
    v_cvt_pk_bf16_f32 v100, v56, v57
    v_cvt_pk_bf16_f32 v101, v58, v59
    v_cvt_pk_bf16_f32 v102, v60, v61
    v_cvt_pk_bf16_f32 v103, v62, v63
    s_nop 1
    v_mfma_f32_32x32x16_bf16 v[80:95], a[140:143], v[100:103], v[80:95]
    v_mfma_f32_32x32x16_bf16 v[48:63], a[24:27], v[104:107], v[64:79]
    v_exp_f32 v32, v32
    v_exp_f32 v33, v33
    v_exp_f32 v34, v34
    v_exp_f32 v35, v35
    v_mfma_f32_32x32x16_bf16 v[48:63], a[28:31], v[108:111], v[48:63]
    v_exp_f32 v36, v36
    v_exp_f32 v37, v37
    v_exp_f32 v38, v38
    v_exp_f32 v39, v39
    v_cvt_pk_bf16_f32 v96, v32, v33
    v_cvt_pk_bf16_f32 v97, v34, v35
    v_cvt_pk_bf16_f32 v98, v36, v37
    v_cvt_pk_bf16_f32 v99, v38, v39
    v_exp_f32 v40, v40
    v_exp_f32 v41, v41
    v_mfma_f32_32x32x16_bf16 v[80:95], a[144:147], v[96:99], v[80:95]
    v_exp_f32 v42, v42
    v_exp_f32 v43, v43
    v_exp_f32 v44, v44
    v_exp_f32 v45, v45
    v_exp_f32 v46, v46
    v_exp_f32 v47, v47
    v_cvt_pk_bf16_f32 v100, v40, v41
    v_cvt_pk_bf16_f32 v101, v42, v43
    v_cvt_pk_bf16_f32 v102, v44, v45
    v_cvt_pk_bf16_f32 v103, v46, v47
    s_nop 1
    v_mfma_f32_32x32x16_bf16 v[80:95], a[148:151], v[100:103], v[80:95]
    s_cmp_eq_u32 s38, 0
    s_cbranch_scc1 ATF_24
    s_mov_b64 exec, 1
    v_mov_b32 v14, 0
    v_mov_b32 v15, 1
    s_waitcnt vmcnt(0)
    buffer_atomic_add v15, v14, s[8:11], s38 offen sc1
    s_mov_b64 exec, -1
    s_mov_b32 s38, 0
ATF_24:
    v_mfma_f32_32x32x16_bf16 v[32:47], a[32:35], v[104:107], v[64:79]
    v_exp_f32 v48, v48
    v_exp_f32 v49, v49
    v_exp_f32 v50, v50
    v_exp_f32 v51, v51
    v_mfma_f32_32x32x16_bf16 v[32:47], a[36:39], v[108:111], v[32:47]
    v_exp_f32 v52, v52
    v_exp_f32 v53, v53
    v_exp_f32 v54, v54
    v_exp_f32 v55, v55
    v_cvt_pk_bf16_f32 v96, v48, v49
    v_cvt_pk_bf16_f32 v97, v50, v51
    v_cvt_pk_bf16_f32 v98, v52, v53
    v_cvt_pk_bf16_f32 v99, v54, v55
    v_exp_f32 v56, v56
    v_exp_f32 v57, v57
    v_mfma_f32_32x32x16_bf16 v[80:95], a[152:155], v[96:99], v[80:95]
    v_exp_f32 v58, v58
    v_exp_f32 v59, v59
    v_exp_f32 v60, v60
    v_exp_f32 v61, v61
    v_exp_f32 v62, v62
    v_exp_f32 v63, v63
    v_cvt_pk_bf16_f32 v100, v56, v57
    v_cvt_pk_bf16_f32 v101, v58, v59
    v_cvt_pk_bf16_f32 v102, v60, v61
    v_cvt_pk_bf16_f32 v103, v62, v63
    s_nop 1
    v_mfma_f32_32x32x16_bf16 v[80:95], a[156:159], v[100:103], v[80:95]
    v_mfma_f32_32x32x16_bf16 v[48:63], a[40:43], v[104:107], v[64:79]
    v_exp_f32 v32, v32
    v_exp_f32 v33, v33
    v_exp_f32 v34, v34
    v_exp_f32 v35, v35
    v_mfma_f32_32x32x16_bf16 v[48:63], a[44:47], v[108:111], v[48:63]
    v_exp_f32 v36, v36
    v_exp_f32 v37, v37
    v_exp_f32 v38, v38
    v_exp_f32 v39, v39
    v_cvt_pk_bf16_f32 v96, v32, v33
    v_cvt_pk_bf16_f32 v97, v34, v35
    v_cvt_pk_bf16_f32 v98, v36, v37
    v_cvt_pk_bf16_f32 v99, v38, v39
    v_exp_f32 v40, v40
    v_exp_f32 v41, v41
    v_mfma_f32_32x32x16_bf16 v[80:95], a[160:163], v[96:99], v[80:95]
    v_exp_f32 v42, v42
    v_exp_f32 v43, v43
    v_exp_f32 v44, v44
    v_exp_f32 v45, v45
    v_exp_f32 v46, v46
    v_exp_f32 v47, v47
    v_cvt_pk_bf16_f32 v100, v40, v41
    v_cvt_pk_bf16_f32 v101, v42, v43
    v_cvt_pk_bf16_f32 v102, v44, v45
    v_cvt_pk_bf16_f32 v103, v46, v47
    s_nop 1
    v_mfma_f32_32x32x16_bf16 v[80:95], a[164:167], v[100:103], v[80:95]
    v_mfma_f32_32x32x16_bf16 v[32:47], a[48:51], v[104:107], v[64:79]
    v_exp_f32 v48, v48
    v_exp_f32 v49, v49
    v_exp_f32 v50, v50
    v_exp_f32 v51, v51
    v_mfma_f32_32x32x16_bf16 v[32:47], a[52:55], v[108:111], v[32:47]
    v_exp_f32 v52, v52
    v_exp_f32 v53, v53
    v_exp_f32 v54, v54
    v_exp_f32 v55, v55
    v_cvt_pk_bf16_f32 v96, v48, v49
    v_cvt_pk_bf16_f32 v97, v50, v51
    v_cvt_pk_bf16_f32 v98, v52, v53
    v_cvt_pk_bf16_f32 v99, v54, v55
    v_exp_f32 v56, v56
    v_exp_f32 v57, v57
    v_mfma_f32_32x32x16_bf16 v[80:95], a[168:171], v[96:99], v[80:95]
    v_exp_f32 v58, v58
    v_exp_f32 v59, v59
    v_exp_f32 v60, v60
    v_exp_f32 v61, v61
    v_exp_f32 v62, v62
    v_exp_f32 v63, v63
    v_cvt_pk_bf16_f32 v100, v56, v57
    v_cvt_pk_bf16_f32 v101, v58, v59
    v_cvt_pk_bf16_f32 v102, v60, v61
    v_cvt_pk_bf16_f32 v103, v62, v63
    s_nop 1
    v_mfma_f32_32x32x16_bf16 v[80:95], a[172:175], v[100:103], v[80:95]
    v_mfma_f32_32x32x16_bf16 v[48:63], a[56:59], v[104:107], v[64:79]
    v_exp_f32 v32, v32
    v_exp_f32 v33, v33
    v_exp_f32 v34, v34
    v_exp_f32 v35, v35
    v_mfma_f32_32x32x16_bf16 v[48:63], a[60:63], v[108:111], v[48:63]
    v_exp_f32 v36, v36
    v_exp_f32 v37, v37
    v_exp_f32 v38, v38
    v_exp_f32 v39, v39
    v_cvt_pk_bf16_f32 v96, v32, v33
    v_cvt_pk_bf16_f32 v97, v34, v35
    v_cvt_pk_bf16_f32 v98, v36, v37
    v_cvt_pk_bf16_f32 v99, v38, v39
    v_exp_f32 v40, v40
    v_exp_f32 v41, v41
    v_mfma_f32_32x32x16_bf16 v[80:95], a[176:179], v[96:99], v[80:95]
    v_exp_f32 v42, v42
    v_exp_f32 v43, v43
    v_exp_f32 v44, v44
    v_exp_f32 v45, v45
    v_exp_f32 v46, v46
    v_exp_f32 v47, v47
    v_cvt_pk_bf16_f32 v100, v40, v41
    v_cvt_pk_bf16_f32 v101, v42, v43
    v_cvt_pk_bf16_f32 v102, v44, v45
    v_cvt_pk_bf16_f32 v103, v46, v47
    s_nop 1
    v_mfma_f32_32x32x16_bf16 v[80:95], a[180:183], v[100:103], v[80:95]
    v_mfma_f32_32x32x16_bf16 v[32:47], a[64:67], v[104:107], v[64:79]
    v_exp_f32 v48, v48
    v_exp_f32 v49, v49
    v_exp_f32 v50, v50
    v_exp_f32 v51, v51
    v_mfma_f32_32x32x16_bf16 v[32:47], a[68:71], v[108:111], v[32:47]
    v_exp_f32 v52, v52
    v_exp_f32 v53, v53
    v_exp_f32 v54, v54
    v_exp_f32 v55, v55
    v_cvt_pk_bf16_f32 v96, v48, v49
    v_cvt_pk_bf16_f32 v97, v50, v51
    v_cvt_pk_bf16_f32 v98, v52, v53
    v_cvt_pk_bf16_f32 v99, v54, v55
    v_exp_f32 v56, v56
    v_exp_f32 v57, v57
    v_mfma_f32_32x32x16_bf16 v[80:95], a[184:187], v[96:99], v[80:95]
    v_exp_f32 v58, v58
    v_exp_f32 v59, v59
    v_exp_f32 v60, v60
    v_exp_f32 v61, v61
    v_exp_f32 v62, v62
    v_exp_f32 v63, v63
    v_cvt_pk_bf16_f32 v100, v56, v57
    v_cvt_pk_bf16_f32 v101, v58, v59
    v_cvt_pk_bf16_f32 v102, v60, v61
    v_cvt_pk_bf16_f32 v103, v62, v63
    s_nop 1
    v_mfma_f32_32x32x16_bf16 v[80:95], a[188:191], v[100:103], v[80:95]
    v_mfma_f32_32x32x16_bf16 v[48:63], a[72:75], v[104:107], v[64:79]
    v_exp_f32 v32, v32
    v_exp_f32 v33, v33
    v_exp_f32 v34, v34
    v_exp_f32 v35, v35
    v_mfma_f32_32x32x16_bf16 v[48:63], a[76:79], v[108:111], v[48:63]
    v_exp_f32 v36, v36
    v_exp_f32 v37, v37
    v_exp_f32 v38, v38
    v_exp_f32 v39, v39
    v_cvt_pk_bf16_f32 v96, v32, v33
    v_cvt_pk_bf16_f32 v97, v34, v35
    v_cvt_pk_bf16_f32 v98, v36, v37
    v_cvt_pk_bf16_f32 v99, v38, v39
    v_exp_f32 v40, v40
    v_exp_f32 v41, v41
    v_mfma_f32_32x32x16_bf16 v[80:95], a[192:195], v[96:99], v[80:95]
    v_exp_f32 v42, v42
    v_exp_f32 v43, v43
    v_exp_f32 v44, v44
    v_exp_f32 v45, v45
    v_exp_f32 v46, v46
    v_exp_f32 v47, v47
    v_cvt_pk_bf16_f32 v100, v40, v41
    v_cvt_pk_bf16_f32 v101, v42, v43
    v_cvt_pk_bf16_f32 v102, v44, v45
    v_cvt_pk_bf16_f32 v103, v46, v47
    s_nop 1
    v_mfma_f32_32x32x16_bf16 v[80:95], a[196:199], v[100:103], v[80:95]
    v_mfma_f32_32x32x16_bf16 v[32:47], a[80:83], v[104:107], v[64:79]
    v_exp_f32 v48, v48
    v_exp_f32 v49, v49
    v_exp_f32 v50, v50
    v_exp_f32 v51, v51
    v_mfma_f32_32x32x16_bf16 v[32:47], a[84:87], v[108:111], v[32:47]
    v_exp_f32 v52, v52
    v_exp_f32 v53, v53
    v_exp_f32 v54, v54
    v_exp_f32 v55, v55
    v_cvt_pk_bf16_f32 v96, v48, v49
    v_cvt_pk_bf16_f32 v97, v50, v51
    v_cvt_pk_bf16_f32 v98, v52, v53
    v_cvt_pk_bf16_f32 v99, v54, v55
    v_exp_f32 v56, v56
    v_exp_f32 v57, v57
    v_mfma_f32_32x32x16_bf16 v[80:95], a[200:203], v[96:99], v[80:95]
    v_exp_f32 v58, v58
    v_exp_f32 v59, v59
    v_exp_f32 v60, v60
    v_exp_f32 v61, v61
    v_exp_f32 v62, v62
    v_exp_f32 v63, v63
    v_cvt_pk_bf16_f32 v100, v56, v57
    v_cvt_pk_bf16_f32 v101, v58, v59
    v_cvt_pk_bf16_f32 v102, v60, v61
    v_cvt_pk_bf16_f32 v103, v62, v63
    s_nop 1
    v_mfma_f32_32x32x16_bf16 v[80:95], a[204:207], v[100:103], v[80:95]
    v_mfma_f32_32x32x16_bf16 v[48:63], a[88:91], v[104:107], v[64:79]
    v_exp_f32 v32, v32
    v_exp_f32 v33, v33
    v_exp_f32 v34, v34
    v_exp_f32 v35, v35
    v_mfma_f32_32x32x16_bf16 v[48:63], a[92:95], v[108:111], v[48:63]
    v_exp_f32 v36, v36
    v_exp_f32 v37, v37
    v_exp_f32 v38, v38
    v_exp_f32 v39, v39
    v_cvt_pk_bf16_f32 v96, v32, v33
    v_cvt_pk_bf16_f32 v97, v34, v35
    v_cvt_pk_bf16_f32 v98, v36, v37
    v_cvt_pk_bf16_f32 v99, v38, v39
    v_exp_f32 v40, v40
    v_exp_f32 v41, v41
    v_mfma_f32_32x32x16_bf16 v[80:95], a[208:211], v[96:99], v[80:95]
    v_exp_f32 v42, v42
    v_exp_f32 v43, v43
    v_exp_f32 v44, v44
    v_exp_f32 v45, v45
    v_exp_f32 v46, v46
    v_exp_f32 v47, v47
    v_cvt_pk_bf16_f32 v100, v40, v41
    v_cvt_pk_bf16_f32 v101, v42, v43
    v_cvt_pk_bf16_f32 v102, v44, v45
    v_cvt_pk_bf16_f32 v103, v46, v47
    s_nop 1
    v_mfma_f32_32x32x16_bf16 v[80:95], a[212:215], v[100:103], v[80:95]
    v_mfma_f32_32x32x16_bf16 v[32:47], a[96:99], v[104:107], v[64:79]
    v_exp_f32 v48, v48
    v_exp_f32 v49, v49
    v_exp_f32 v50, v50
    v_exp_f32 v51, v51
    v_mfma_f32_32x32x16_bf16 v[32:47], a[100:103], v[108:111], v[32:47]
    v_exp_f32 v52, v52
    v_exp_f32 v53, v53
    v_exp_f32 v54, v54
    v_exp_f32 v55, v55
    v_cvt_pk_bf16_f32 v96, v48, v49
    v_cvt_pk_bf16_f32 v97, v50, v51
    v_cvt_pk_bf16_f32 v98, v52, v53
    v_cvt_pk_bf16_f32 v99, v54, v55
    v_exp_f32 v56, v56
    v_exp_f32 v57, v57
    v_mfma_f32_32x32x16_bf16 v[80:95], a[216:219], v[96:99], v[80:95]
    v_exp_f32 v58, v58
    v_exp_f32 v59, v59
    v_exp_f32 v60, v60
    v_exp_f32 v61, v61
    v_exp_f32 v62, v62
    v_exp_f32 v63, v63
    v_cvt_pk_bf16_f32 v100, v56, v57
    v_cvt_pk_bf16_f32 v101, v58, v59
    v_cvt_pk_bf16_f32 v102, v60, v61
    v_cvt_pk_bf16_f32 v103, v62, v63
    s_nop 1
    v_mfma_f32_32x32x16_bf16 v[80:95], a[220:223], v[100:103], v[80:95]
    v_mfma_f32_32x32x16_bf16 v[48:63], a[104:107], v[104:107], v[64:79]
    v_exp_f32 v32, v32
    v_exp_f32 v33, v33
    v_exp_f32 v34, v34
    v_exp_f32 v35, v35
    v_mfma_f32_32x32x16_bf16 v[48:63], a[108:111], v[108:111], v[48:63]
    v_exp_f32 v36, v36
    v_exp_f32 v37, v37
    v_exp_f32 v38, v38
    v_exp_f32 v39, v39
    v_cvt_pk_bf16_f32 v96, v32, v33
    v_cvt_pk_bf16_f32 v97, v34, v35
    v_cvt_pk_bf16_f32 v98, v36, v37
    v_cvt_pk_bf16_f32 v99, v38, v39
    v_exp_f32 v40, v40
    v_exp_f32 v41, v41
    v_mfma_f32_32x32x16_bf16 v[80:95], a[224:227], v[96:99], v[80:95]
    v_exp_f32 v42, v42
    v_exp_f32 v43, v43
    v_exp_f32 v44, v44
    v_exp_f32 v45, v45
    v_exp_f32 v46, v46
    v_exp_f32 v47, v47
    v_cvt_pk_bf16_f32 v100, v40, v41
    v_cvt_pk_bf16_f32 v101, v42, v43
    v_cvt_pk_bf16_f32 v102, v44, v45
    v_cvt_pk_bf16_f32 v103, v46, v47
    s_nop 1
    v_mfma_f32_32x32x16_bf16 v[80:95], a[228:231], v[100:103], v[80:95]
    v_mfma_f32_32x32x16_bf16 v[32:47], a[112:115], v[104:107], v[64:79]
    v_exp_f32 v48, v48
    v_exp_f32 v49, v49
    v_exp_f32 v50, v50
    v_exp_f32 v51, v51
    v_mfma_f32_32x32x16_bf16 v[32:47], a[116:119], v[108:111], v[32:47]
    v_exp_f32 v52, v52
    v_exp_f32 v53, v53
    v_exp_f32 v54, v54
    v_exp_f32 v55, v55
    v_cvt_pk_bf16_f32 v96, v48, v49
    v_cvt_pk_bf16_f32 v97, v50, v51
    v_cvt_pk_bf16_f32 v98, v52, v53
    v_cvt_pk_bf16_f32 v99, v54, v55
    v_exp_f32 v56, v56
    v_exp_f32 v57, v57
    v_mfma_f32_32x32x16_bf16 v[80:95], a[232:235], v[96:99], v[80:95]
    v_exp_f32 v58, v58
    v_exp_f32 v59, v59
    v_exp_f32 v60, v60
    v_exp_f32 v61, v61
    v_exp_f32 v62, v62
    v_exp_f32 v63, v63
    v_cvt_pk_bf16_f32 v100, v56, v57
    v_cvt_pk_bf16_f32 v101, v58, v59
    v_cvt_pk_bf16_f32 v102, v60, v61
    v_cvt_pk_bf16_f32 v103, v62, v63
    s_nop 1
    v_mfma_f32_32x32x16_bf16 v[80:95], a[236:239], v[100:103], v[80:95]
    v_mfma_f32_32x32x16_bf16 v[48:63], a[120:123], v[104:107], v[64:79]
    v_exp_f32 v32, v32
    v_exp_f32 v33, v33
    v_exp_f32 v34, v34
    v_exp_f32 v35, v35
    v_mfma_f32_32x32x16_bf16 v[48:63], a[124:127], v[108:111], v[48:63]
    v_exp_f32 v36, v36
    v_exp_f32 v37, v37
    v_exp_f32 v38, v38
    v_exp_f32 v39, v39
    v_cvt_pk_bf16_f32 v96, v32, v33
    v_cvt_pk_bf16_f32 v97, v34, v35
    v_cvt_pk_bf16_f32 v98, v36, v37
    v_cvt_pk_bf16_f32 v99, v38, v39
    v_exp_f32 v40, v40
    v_exp_f32 v41, v41
    v_mfma_f32_32x32x16_bf16 v[80:95], a[240:243], v[96:99], v[80:95]
    v_exp_f32 v42, v42
    v_exp_f32 v43, v43
    v_exp_f32 v44, v44
    v_exp_f32 v45, v45
    v_exp_f32 v46, v46
    v_exp_f32 v47, v47
    v_cvt_pk_bf16_f32 v100, v40, v41
    v_cvt_pk_bf16_f32 v101, v42, v43
    v_cvt_pk_bf16_f32 v102, v44, v45
    v_cvt_pk_bf16_f32 v103, v46, v47
    s_nop 1
    v_mfma_f32_32x32x16_bf16 v[80:95], a[244:247], v[100:103], v[80:95]
    v_exp_f32 v48, v48
    v_exp_f32 v49, v49
    v_exp_f32 v50, v50
    v_exp_f32 v51, v51
    v_exp_f32 v52, v52
    v_exp_f32 v53, v53
    v_exp_f32 v54, v54
    v_exp_f32 v55, v55
    v_cvt_pk_bf16_f32 v96, v48, v49
    v_cvt_pk_bf16_f32 v97, v50, v51
    v_cvt_pk_bf16_f32 v98, v52, v53
    v_cvt_pk_bf16_f32 v99, v54, v55
    v_exp_f32 v56, v56
    v_exp_f32 v57, v57
    v_mfma_f32_32x32x16_bf16 v[80:95], a[248:251], v[96:99], v[80:95]
    v_exp_f32 v58, v58
    v_exp_f32 v59, v59
    v_exp_f32 v60, v60
    v_exp_f32 v61, v61
    v_exp_f32 v62, v62
    v_exp_f32 v63, v63
    v_cvt_pk_bf16_f32 v100, v56, v57
    v_cvt_pk_bf16_f32 v101, v58, v59
    v_cvt_pk_bf16_f32 v102, v60, v61
    v_cvt_pk_bf16_f32 v103, v62, v63
    s_nop 1
    v_mfma_f32_32x32x16_bf16 v[80:95], a[252:255], v[100:103], v[80:95]
    v_mov_b32 v18, 0x71800000
    s_nop 10
    v_cmp_nlt_f32 vcc, v88, v18
    s_nop 0
    s_cmp_lg_u32 s34, 0
    s_cbranch_scc1 AT_OK
    s_cmp_eq_u32 vcc_hi, 0
    s_cbranch_scc1 AT_OK
    v_mfma_f32_32x32x16_bf16 v[32:47], a[0:3], v[104:107], 0
    v_mfma_f32_32x32x16_bf16 v[32:47], a[4:7], v[108:111], v[32:47]
    s_nop 11
    v_max3_f32 v16, v32, v33, v47
    v_max3_f32 v16, v16, v34, v35
    v_max3_f32 v16, v16, v36, v37
    v_max3_f32 v16, v16, v38, v39
    v_max3_f32 v16, v16, v40, v41
    v_max3_f32 v16, v16, v42, v43
    v_max3_f32 v16, v16, v44, v45
    v_max_f32 v16, v16, v46
    v_mfma_f32_32x32x16_bf16 v[32:47], a[8:11], v[104:107], 0
    v_mfma_f32_32x32x16_bf16 v[32:47], a[12:15], v[108:111], v[32:47]
    s_nop 11
    v_max3_f32 v16, v16, v32, v33
    v_max_f32 v16, v16, v47
    v_max3_f32 v16, v16, v34, v35
    v_max3_f32 v16, v16, v36, v37
    v_max3_f32 v16, v16, v38, v39
    v_max3_f32 v16, v16, v40, v41
    v_max3_f32 v16, v16, v42, v43
    v_max3_f32 v16, v16, v44, v45
    v_max_f32 v16, v16, v46
    v_mfma_f32_32x32x16_bf16 v[32:47], a[16:19], v[104:107], 0
    v_mfma_f32_32x32x16_bf16 v[32:47], a[20:23], v[108:111], v[32:47]
    s_nop 11
    v_max3_f32 v16, v16, v32, v33
    v_max_f32 v16, v16, v47
    v_max3_f32 v16, v16, v34, v35
    v_max3_f32 v16, v16, v36, v37
    v_max3_f32 v16, v16, v38, v39
    v_max3_f32 v16, v16, v40, v41
    v_max3_f32 v16, v16, v42, v43
    v_max3_f32 v16, v16, v44, v45
    v_max_f32 v16, v16, v46
    v_mfma_f32_32x32x16_bf16 v[32:47], a[24:27], v[104:107], 0
    v_mfma_f32_32x32x16_bf16 v[32:47], a[28:31], v[108:111], v[32:47]
    s_nop 11
    v_max3_f32 v16, v16, v32, v33
    v_max_f32 v16, v16, v47
    v_max3_f32 v16, v16, v34, v35
    v_max3_f32 v16, v16, v36, v37
    v_max3_f32 v16, v16, v38, v39
    v_max3_f32 v16, v16, v40, v41
    v_max3_f32 v16, v16, v42, v43
    v_max3_f32 v16, v16, v44, v45
    v_max_f32 v16, v16, v46
    v_mfma_f32_32x32x16_bf16 v[32:47], a[32:35], v[104:107], 0
    v_mfma_f32_32x32x16_bf16 v[32:47], a[36:39], v[108:111], v[32:47]
    s_nop 11
    v_max3_f32 v16, v16, v32, v33
    v_max_f32 v16, v16, v47
    v_max3_f32 v16, v16, v34, v35
    v_max3_f32 v16, v16, v36, v37
    v_max3_f32 v16, v16, v38, v39
    v_max3_f32 v16, v16, v40, v41
    v_max3_f32 v16, v16, v42, v43
    v_max3_f32 v16, v16, v44, v45
    v_max_f32 v16, v16, v46
    v_mfma_f32_32x32x16_bf16 v[32:47], a[40:43], v[104:107], 0
    v_mfma_f32_32x32x16_bf16 v[32:47], a[44:47], v[108:111], v[32:47]
    s_nop 11
    v_max3_f32 v16, v16, v32, v33
    v_max_f32 v16, v16, v47
    v_max3_f32 v16, v16, v34, v35
    v_max3_f32 v16, v16, v36, v37
    v_max3_f32 v16, v16, v38, v39
    v_max3_f32 v16, v16, v40, v41
    v_max3_f32 v16, v16, v42, v43
    v_max3_f32 v16, v16, v44, v45
    v_max_f32 v16, v16, v46
    v_mfma_f32_32x32x16_bf16 v[32:47], a[48:51], v[104:107], 0
    v_mfma_f32_32x32x16_bf16 v[32:47], a[52:55], v[108:111], v[32:47]
    s_nop 11
    v_max3_f32 v16, v16, v32, v33
    v_max_f32 v16, v16, v47
    v_max3_f32 v16, v16, v34, v35
    v_max3_f32 v16, v16, v36, v37
    v_max3_f32 v16, v16, v38, v39
    v_max3_f32 v16, v16, v40, v41
    v_max3_f32 v16, v16, v42, v43
    v_max3_f32 v16, v16, v44, v45
    v_max_f32 v16, v16, v46
    v_mfma_f32_32x32x16_bf16 v[32:47], a[56:59], v[104:107], 0
    v_mfma_f32_32x32x16_bf16 v[32:47], a[60:63], v[108:111], v[32:47]
    s_nop 11
    v_max3_f32 v16, v16, v32, v33
    v_max_f32 v16, v16, v47
    v_max3_f32 v16, v16, v34, v35
    v_max3_f32 v16, v16, v36, v37
    v_max3_f32 v16, v16, v38, v39
    v_max3_f32 v16, v16, v40, v41
    v_max3_f32 v16, v16, v42, v43
    v_max3_f32 v16, v16, v44, v45
    v_max_f32 v16, v16, v46
    v_mfma_f32_32x32x16_bf16 v[32:47], a[64:67], v[104:107], 0
    v_mfma_f32_32x32x16_bf16 v[32:47], a[68:71], v[108:111], v[32:47]
    s_nop 11
    v_max3_f32 v16, v16, v32, v33
    v_max_f32 v16, v16, v47
    v_max3_f32 v16, v16, v34, v35
    v_max3_f32 v16, v16, v36, v37
    v_max3_f32 v16, v16, v38, v39
    v_max3_f32 v16, v16, v40, v41
    v_max3_f32 v16, v16, v42, v43
    v_max3_f32 v16, v16, v44, v45
    v_max_f32 v16, v16, v46
    v_mfma_f32_32x32x16_bf16 v[32:47], a[72:75], v[104:107], 0
    v_mfma_f32_32x32x16_bf16 v[32:47], a[76:79], v[108:111], v[32:47]
    s_nop 11
    v_max3_f32 v16, v16, v32, v33
    v_max_f32 v16, v16, v47
    v_max3_f32 v16, v16, v34, v35
    v_max3_f32 v16, v16, v36, v37
    v_max3_f32 v16, v16, v38, v39
    v_max3_f32 v16, v16, v40, v41
    v_max3_f32 v16, v16, v42, v43
    v_max3_f32 v16, v16, v44, v45
    v_max_f32 v16, v16, v46
    v_mfma_f32_32x32x16_bf16 v[32:47], a[80:83], v[104:107], 0
    v_mfma_f32_32x32x16_bf16 v[32:47], a[84:87], v[108:111], v[32:47]
    s_nop 11
    v_max3_f32 v16, v16, v32, v33
    v_max_f32 v16, v16, v47
    v_max3_f32 v16, v16, v34, v35
    v_max3_f32 v16, v16, v36, v37
    v_max3_f32 v16, v16, v38, v39
    v_max3_f32 v16, v16, v40, v41
    v_max3_f32 v16, v16, v42, v43
    v_max3_f32 v16, v16, v44, v45
    v_max_f32 v16, v16, v46
    v_mfma_f32_32x32x16_bf16 v[32:47], a[88:91], v[104:107], 0
    v_mfma_f32_32x32x16_bf16 v[32:47], a[92:95], v[108:111], v[32:47]
    s_nop 11
    v_max3_f32 v16, v16, v32, v33
    v_max_f32 v16, v16, v47
    v_max3_f32 v16, v16, v34, v35
    v_max3_f32 v16, v16, v36, v37
    v_max3_f32 v16, v16, v38, v39
    v_max3_f32 v16, v16, v40, v41
    v_max3_f32 v16, v16, v42, v43
    v_max3_f32 v16, v16, v44, v45
    v_max_f32 v16, v16, v46
    v_mfma_f32_32x32x16_bf16 v[32:47], a[96:99], v[104:107], 0
    v_mfma_f32_32x32x16_bf16 v[32:47], a[100:103], v[108:111], v[32:47]
    s_nop 11
    v_max3_f32 v16, v16, v32, v33
    v_max_f32 v16, v16, v47
    v_max3_f32 v16, v16, v34, v35
    v_max3_f32 v16, v16, v36, v37
    v_max3_f32 v16, v16, v38, v39
    v_max3_f32 v16, v16, v40, v41
    v_max3_f32 v16, v16, v42, v43
    v_max3_f32 v16, v16, v44, v45
    v_max_f32 v16, v16, v46
    v_mfma_f32_32x32x16_bf16 v[32:47], a[104:107], v[104:107], 0
    v_mfma_f32_32x32x16_bf16 v[32:47], a[108:111], v[108:111], v[32:47]
    s_nop 11
    v_max3_f32 v16, v16, v32, v33
    v_max_f32 v16, v16, v47
    v_max3_f32 v16, v16, v34, v35
    v_max3_f32 v16, v16, v36, v37
    v_max3_f32 v16, v16, v38, v39
    v_max3_f32 v16, v16, v40, v41
    v_max3_f32 v16, v16, v42, v43
    v_max3_f32 v16, v16, v44, v45
    v_max_f32 v16, v16, v46
    v_mfma_f32_32x32x16_bf16 v[32:47], a[112:115], v[104:107], 0
    v_mfma_f32_32x32x16_bf16 v[32:47], a[116:119], v[108:111], v[32:47]
    s_nop 11
    v_max3_f32 v16, v16, v32, v33
    v_max_f32 v16, v16, v47
    v_max3_f32 v16, v16, v34, v35
    v_max3_f32 v16, v16, v36, v37
    v_max3_f32 v16, v16, v38, v39
    v_max3_f32 v16, v16, v40, v41
    v_max3_f32 v16, v16, v42, v43
    v_max3_f32 v16, v16, v44, v45
    v_max_f32 v16, v16, v46
    v_mfma_f32_32x32x16_bf16 v[32:47], a[120:123], v[104:107], 0
    v_mfma_f32_32x32x16_bf16 v[32:47], a[124:127], v[108:111], v[32:47]
    s_nop 11
    v_max3_f32 v16, v16, v32, v33
    v_max_f32 v16, v16, v47
    v_max3_f32 v16, v16, v34, v35
    v_max3_f32 v16, v16, v36, v37
    v_max3_f32 v16, v16, v38, v39
    v_max3_f32 v16, v16, v40, v41
    v_max3_f32 v16, v16, v42, v43
    v_max3_f32 v16, v16, v44, v45
    v_max_f32 v16, v16, v46
    s_mov_b32 s34, 1
    s_branch AT_HAVEM
AT_OK:
    ds_write_b128 v5, v[80:83] offset:0
    ds_write_b128 v5, v[84:87] offset:32
    ds_write_b128 v5, v[88:91] offset:64
    s_mov_b64 exec, 0xffffffff
    ds_write_b32 v5, v16 offset:96
    s_mov_b64 exec, -1
    s_waitcnt vmcnt(0)
    v_mov_b32 v104, v112
    v_mov_b32 v105, v113
    v_mov_b32 v106, v114
    v_mov_b32 v107, v115
    v_mov_b32 v108, v116
    v_mov_b32 v109, v117
    s_add_u32 s3, s32, 120
    s_min_u32 s3, s3, 2047
    s_mul_i32 s3, s3, 1280
    s_add_u32 s3, s3, s17
    buffer_load_dwordx4 v[112:115], v1, s[8:11], s3 offen sc1
    buffer_load_dwordx2 v[116:117], v2, s[8:11], s3 offen sc1
    s_waitcnt lgkmcnt(0)
    s_barrier
    s_and_b32 s3, s33, 3
    s_cmp_lg_u32 s3, s13
    s_cbranch_scc1 AT_NEXT
    s_mul_i32 s36, s32, 1280
    s_add_u32 s36, s36, s17
    s_add_u32 s36, s36, 0x400000
    ds_read_b128 v[32:35], v6 offset:0
    ds_read_b32 v48, v10 offset:80
    ds_read_b32 v52, v10 offset:96
    ds_read_b128 v[36:39], v6 offset:3584
    ds_read_b32 v49, v10 offset:3664
    ds_read_b32 v53, v10 offset:3680
    ds_read_b128 v[40:43], v6 offset:7168
    ds_read_b32 v50, v10 offset:7248
    ds_read_b32 v54, v10 offset:7264
    ds_read_b128 v[44:47], v6 offset:10752
    ds_read_b32 v51, v10 offset:10832
    ds_read_b32 v55, v10 offset:10848
    s_waitcnt lgkmcnt(0)
    ds_read_b128 v[56:59], v7 offset:0
    ds_read_b32 v72, v11 offset:80
    ds_read_b32 v76, v11 offset:96
    ds_read_b128 v[60:63], v7 offset:3584
    ds_read_b32 v73, v11 offset:3664
    ds_read_b32 v77, v11 offset:3680
    ds_read_b128 v[64:67], v7 offset:7168
    ds_read_b32 v74, v11 offset:7248
    ds_read_b32 v78, v11 offset:7264
    ds_read_b128 v[68:71], v7 offset:10752
    ds_read_b32 v75, v11 offset:10832
    ds_read_b32 v79, v11 offset:10848
    s_waitcnt lgkmcnt(0)
    ds_read_b128 v[80:83], v8 offset:0
    ds_read_b32 v96, v12 offset:80
    ds_read_b32 v100, v12 offset:96
    ds_read_b128 v[84:87], v8 offset:3584
    ds_read_b32 v97, v12 offset:3664
    ds_read_b32 v101, v12 offset:3680
    ds_read_b128 v[88:91], v8 offset:7168
    ds_read_b32 v98, v12 offset:7248
    ds_read_b32 v102, v12 offset:7264
    ds_read_b128 v[92:95], v8 offset:10752
    ds_read_b32 v99, v12 offset:10832
    ds_read_b32 v103, v12 offset:10848
    s_waitcnt lgkmcnt(0)
    v_max3_f32 v18, v52, v53, v54
    v_max_f32 v18, v18, v55
    v_sub_f32 v52, v52, v18
    v_exp_f32 v52, v52
    v_sub_f32 v53, v53, v18
    v_exp_f32 v53, v53
    v_sub_f32 v54, v54, v18
    v_exp_f32 v54, v54
    v_sub_f32 v55, v55, v18
    v_exp_f32 v55, v55
    v_mul_f32 v19, v48, v52
    v_fmac_f32 v19, v49, v53
    v_fmac_f32 v19, v50, v54
    v_fmac_f32 v19, v51, v55
    v_rcp_f32 v19, v19
    v_mul_f32 v32, v32, v52
    v_fmac_f32 v32, v36, v53
    v_fmac_f32 v32, v40, v54
    v_fmac_f32 v32, v44, v55
    v_mul_f32 v32, v32, v19
    v_mul_f32 v33, v33, v52
    v_fmac_f32 v33, v37, v53
    v_fmac_f32 v33, v41, v54
    v_fmac_f32 v33, v45, v55
    v_mul_f32 v33, v33, v19
    v_mul_f32 v34, v34, v52
    v_fmac_f32 v34, v38, v53
    v_fmac_f32 v34, v42, v54
    v_fmac_f32 v34, v46, v55
    v_mul_f32 v34, v34, v19
    v_mul_f32 v35, v35, v52
    v_fmac_f32 v35, v39, v53
    v_fmac_f32 v35, v43, v54
    v_fmac_f32 v35, v47, v55
    v_mul_f32 v35, v35, v19
    v_cvt_pk_bf16_f32 v20, v32, v33
    v_cvt_pk_bf16_f32 v21, v34, v35
    buffer_store_dwordx2 v[20:21], v9, s[8:11], s36 offen offset:0 sc1
    v_max3_f32 v18, v76, v77, v78
    v_max_f32 v18, v18, v79
    v_sub_f32 v76, v76, v18
    v_exp_f32 v76, v76
    v_sub_f32 v77, v77, v18
    v_exp_f32 v77, v77
    v_sub_f32 v78, v78, v18
    v_exp_f32 v78, v78
    v_sub_f32 v79, v79, v18
    v_exp_f32 v79, v79
    v_mul_f32 v19, v72, v76
    v_fmac_f32 v19, v73, v77
    v_fmac_f32 v19, v74, v78
    v_fmac_f32 v19, v75, v79
    v_rcp_f32 v19, v19
    v_mul_f32 v56, v56, v76
    v_fmac_f32 v56, v60, v77
    v_fmac_f32 v56, v64, v78
    v_fmac_f32 v56, v68, v79
    v_mul_f32 v56, v56, v19
    v_mul_f32 v57, v57, v76
    v_fmac_f32 v57, v61, v77
    v_fmac_f32 v57, v65, v78
    v_fmac_f32 v57, v69, v79
    v_mul_f32 v57, v57, v19
    v_mul_f32 v58, v58, v76
    v_fmac_f32 v58, v62, v77
    v_fmac_f32 v58, v66, v78
    v_fmac_f32 v58, v70, v79
    v_mul_f32 v58, v58, v19
    v_mul_f32 v59, v59, v76
    v_fmac_f32 v59, v63, v77
    v_fmac_f32 v59, v67, v78
    v_fmac_f32 v59, v71, v79
    v_mul_f32 v59, v59, v19
    v_cvt_pk_bf16_f32 v22, v56, v57
    v_cvt_pk_bf16_f32 v23, v58, v59
    buffer_store_dwordx2 v[22:23], v9, s[8:11], s36 offen offset:512 sc1
    v_max3_f32 v18, v100, v101, v102
    v_max_f32 v18, v18, v103
    v_sub_f32 v100, v100, v18
    v_exp_f32 v100, v100
    v_sub_f32 v101, v101, v18
    v_exp_f32 v101, v101
    v_sub_f32 v102, v102, v18
    v_exp_f32 v102, v102
    v_sub_f32 v103, v103, v18
    v_exp_f32 v103, v103
    v_mul_f32 v19, v96, v100
    v_fmac_f32 v19, v97, v101
    v_fmac_f32 v19, v98, v102
    v_fmac_f32 v19, v99, v103
    v_rcp_f32 v19, v19
    v_mul_f32 v80, v80, v100
    v_fmac_f32 v80, v84, v101
    v_fmac_f32 v80, v88, v102
    v_fmac_f32 v80, v92, v103
    v_mul_f32 v80, v80, v19
    v_mul_f32 v81, v81, v100
    v_fmac_f32 v81, v85, v101
    v_fmac_f32 v81, v89, v102
    v_fmac_f32 v81, v93, v103
    v_mul_f32 v81, v81, v19
    v_mul_f32 v82, v82, v100
    v_fmac_f32 v82, v86, v101
    v_fmac_f32 v82, v90, v102
    v_fmac_f32 v82, v94, v103
    v_mul_f32 v82, v82, v19
    v_mul_f32 v83, v83, v100
    v_fmac_f32 v83, v87, v101
    v_fmac_f32 v83, v91, v102
    v_fmac_f32 v83, v95, v103
    v_mul_f32 v83, v83, v19
    v_cvt_pk_bf16_f32 v24, v80, v81
    v_cvt_pk_bf16_f32 v25, v82, v83
    s_mov_b64 exec, 0xffffffff
    buffer_store_dwordx2 v[24:25], v9, s[8:11], s36 offen offset:1024 sc1
    s_lshr_b32 s3, s32, 5
    s_lshl_b32 s3, s3, 7
    s_lshl_b32 s49, s14, 13
    s_add_u32 s49, s49, s3
    s_add_u32 s49, s49, 4096
    s_mov_b64 exec, -1
    s_mov_b32 s38, s49
AT_NEXT:
    v_add_u32 v5, s35, v5
    v_add_u32 v6, s35, v6
    v_add_u32 v7, s35, v7
    v_add_u32 v8, s35, v8
    v_add_u32 v10, s35, v10
    v_add_u32 v11, s35, v11
    v_add_u32 v12, s35, v12
    s_sub_u32 s35, 0, s35
    s_add_u32 s33, s33, 1
    s_add_u32 s32, s32, 60
    s_cmp_lt_u32 s32, 2048
    s_cbranch_scc1 AT_TOK
    s_cmp_eq_u32 s38, 0
    s_cbranch_scc1 ATF_25
    s_mov_b64 exec, 1
    v_mov_b32 v14, 0
    v_mov_b32 v15, 1
    s_waitcnt vmcnt(0)
    buffer_atomic_add v15, v14, s[8:11], s38 offen sc1
    s_mov_b64 exec, -1
    s_mov_b32 s38, 0
ATF_25:
    s_waitcnt vmcnt(0)
    s_add_u32 s14, s14, 1
    s_cmp_lt_u32 s14, s15
    s_cbranch_scc1 AT_PAIR
EXIT2:
    s_endpgm
ROLE_AO:
    s_mul_i32 s42, s12, 43
    s_lshr_b32 s42, s42, 7
    s_mul_i32 s3, s42, 3
    s_sub_u32 s19, s12, s3
    v_lshlrev_b32 v1, 4, v0
    s_add_u32 s3, s13, 0
    s_and_b32 s3, s3, 3
    s_mul_i32 s3, s3, 5120
    v_add_u32 v2, s3, v1
    s_add_u32 s3, s13, 1
    s_and_b32 s3, s3, 3
    s_mul_i32 s3, s3, 5120
    v_add_u32 v3, s3, v1
    s_add_u32 s3, s13, 2
    s_and_b32 s3, s3, 3
    s_mul_i32 s3, s3, 5120
    v_add_u32 v4, s3, v1
    s_add_u32 s3, s13, 3
    s_and_b32 s3, s3, 3
    s_mul_i32 s3, s3, 5120
    v_add_u32 v5, s3, v1
    v_mov_b32 v176, 0x3f803f80
    v_mov_b32 v177, 0x3f803f80
    v_mov_b32 v178, 0x3f803f80
    v_mov_b32 v179, 0x3f803f80
    v_lshrrev_b32 v16, 4, v0
    v_lshlrev_b32 v16, 10, v16
    v_bfe_u32 v17, v0, 2, 2
    v_lshl_add_u32 v16, v17, 7, v16
    v_and_b32 v17, 3, v0
    v_lshl_add_u32 v16, v17, 4, v16
    s_mul_i32 s48, s13, 40960
    v_add_u32 v13, s48, v16
    v_and_b32 v16, 15, v0
    v_lshlrev_b32 v11, 3, v16
    v_add_u32 v11, 81920, v11
    s_lshl_b32 s3, s13, 8
    v_add_u32 v10, s3, v11
    v_and_b32 v17, 3, v0
    v_cmp_eq_u32 s[50:51], 1, v17
    v_cmp_eq_u32 s[52:53], 2, v17
    v_cmp_eq_u32 s[54:55], 3, v17
    v_lshrrev_b32 v17, 2, v16
    v_lshrrev_b32 v18, 4, v0
    v_cmp_eq_u32 s[56:57], v17, v18
    s_nop 0
    s_lshl_b32 s64, s19, 2
    s_add_u32 s64, s64, s13
    s_mov_b32 s46, 1
    s_mov_b32 s33, 2
    s_cmp_ge_u32 s64, 10
    s_cbranch_scc1 AO_LOOP
    s_mov_b32 s46, 0
    s_load_dwordx2 s[4:5], s[0:1], 32
    s_waitcnt lgkmcnt(0)
    s_mov_b32 s28, s4
    s_mov_b32 s29, s5
    s_mov_b32 s30, 0xc8000
    s_mov_b32 s31, 0x20000
    s_lshl_b32 s65, s64, 7
    v_lshrrev_b32 v16, 3, v0
    v_mul_u32_u24 v16, 1280, v16
    v_and_b32 v17, 7, v0
    v_lshl_add_u32 v14, v17, 4, v16
    s_add_u32 s3, s13, 0
    s_and_b32 s3, s3, 3
    s_mul_i32 s3, s3, 204800
    s_add_u32 s60, s3, s65
    s_add_u32 s3, s13, 1
    s_and_b32 s3, s3, 3
    s_mul_i32 s3, s3, 204800
    s_add_u32 s61, s3, s65
    s_add_u32 s3, s13, 2
    s_and_b32 s3, s3, 3
    s_mul_i32 s3, s3, 204800
    s_add_u32 s62, s3, s65
    s_add_u32 s3, s13, 3
    s_and_b32 s3, s3, 3
    s_mul_i32 s3, s3, 204800
    s_add_u32 s63, s3, s65
    s_add_u32 m0, s48, 0
    s_add_u32 s3, s60, 0x0
    buffer_load_dwordx4 v14, s[28:31], s3 offen lds
    s_add_u32 m0, s48, 1024
    s_add_u32 s3, s60, 0x2800
    buffer_load_dwordx4 v14, s[28:31], s3 offen lds
    s_add_u32 m0, s48, 2048
    s_add_u32 s3, s60, 0x5000
    buffer_load_dwordx4 v14, s[28:31], s3 offen lds
    s_add_u32 m0, s48, 3072
    s_add_u32 s3, s60, 0x7800
    buffer_load_dwordx4 v14, s[28:31], s3 offen lds
    s_add_u32 m0, s48, 4096
    s_add_u32 s3, s60, 0xa000
    buffer_load_dwordx4 v14, s[28:31], s3 offen lds
    s_add_u32 m0, s48, 5120
    s_add_u32 s3, s60, 0xc800
    buffer_load_dwordx4 v14, s[28:31], s3 offen lds
    s_add_u32 m0, s48, 6144
    s_add_u32 s3, s60, 0xf000
    buffer_load_dwordx4 v14, s[28:31], s3 offen lds
    s_add_u32 m0, s48, 7168
    s_add_u32 s3, s60, 0x11800
    buffer_load_dwordx4 v14, s[28:31], s3 offen lds
    s_add_u32 m0, s48, 8192
    s_add_u32 s3, s60, 0x14000
    buffer_load_dwordx4 v14, s[28:31], s3 offen lds
    s_add_u32 m0, s48, 9216
    s_add_u32 s3, s60, 0x16800
    buffer_load_dwordx4 v14, s[28:31], s3 offen lds
    s_add_u32 m0, s48, 10240
    s_add_u32 s3, s60, 0x19000
    buffer_load_dwordx4 v14, s[28:31], s3 offen lds
    s_add_u32 m0, s48, 11264
    s_add_u32 s3, s60, 0x1b800
    buffer_load_dwordx4 v14, s[28:31], s3 offen lds
    s_add_u32 m0, s48, 12288
    s_add_u32 s3, s60, 0x1e000
    buffer_load_dwordx4 v14, s[28:31], s3 offen lds
    s_add_u32 m0, s48, 13312
    s_add_u32 s3, s60, 0x20800
    buffer_load_dwordx4 v14, s[28:31], s3 offen lds
    s_add_u32 m0, s48, 14336
    s_add_u32 s3, s60, 0x23000
    buffer_load_dwordx4 v14, s[28:31], s3 offen lds
    s_add_u32 m0, s48, 15360
    s_add_u32 s3, s60, 0x25800
    buffer_load_dwordx4 v14, s[28:31], s3 offen lds
    s_add_u32 m0, s48, 16384
    s_add_u32 s3, s60, 0x28000
    buffer_load_dwordx4 v14, s[28:31], s3 offen lds
    s_add_u32 m0, s48, 17408
    s_add_u32 s3, s60, 0x2a800
    buffer_load_dwordx4 v14, s[28:31], s3 offen lds
    s_add_u32 m0, s48, 18432
    s_add_u32 s3, s60, 0x2d000
    buffer_load_dwordx4 v14, s[28:31], s3 offen lds
    s_add_u32 m0, s48, 19456
    s_add_u32 s3, s60, 0x2f800
    buffer_load_dwordx4 v14, s[28:31], s3 offen lds
    s_add_u32 m0, s48, 20480
    s_add_u32 s3, s61, 0x0
    buffer_load_dwordx4 v14, s[28:31], s3 offen lds
    s_add_u32 m0, s48, 21504
    s_add_u32 s3, s61, 0x2800
    buffer_load_dwordx4 v14, s[28:31], s3 offen lds
    s_add_u32 m0, s48, 22528
    s_add_u32 s3, s61, 0x5000
    buffer_load_dwordx4 v14, s[28:31], s3 offen lds
    s_add_u32 m0, s48, 23552
    s_add_u32 s3, s61, 0x7800
    buffer_load_dwordx4 v14, s[28:31], s3 offen lds
    s_add_u32 m0, s48, 24576
    s_add_u32 s3, s61, 0xa000
    buffer_load_dwordx4 v14, s[28:31], s3 offen lds
    s_add_u32 m0, s48, 25600
    s_add_u32 s3, s61, 0xc800
    buffer_load_dwordx4 v14, s[28:31], s3 offen lds
    s_add_u32 m0, s48, 26624
    s_add_u32 s3, s61, 0xf000
    buffer_load_dwordx4 v14, s[28:31], s3 offen lds
    s_add_u32 m0, s48, 27648
    s_add_u32 s3, s61, 0x11800
    buffer_load_dwordx4 v14, s[28:31], s3 offen lds
    s_add_u32 m0, s48, 28672
    s_add_u32 s3, s61, 0x14000
    buffer_load_dwordx4 v14, s[28:31], s3 offen lds
    s_add_u32 m0, s48, 29696
    s_add_u32 s3, s61, 0x16800
    buffer_load_dwordx4 v14, s[28:31], s3 offen lds
    s_add_u32 m0, s48, 30720
    s_add_u32 s3, s61, 0x19000
    buffer_load_dwordx4 v14, s[28:31], s3 offen lds
    s_add_u32 m0, s48, 31744
    s_add_u32 s3, s61, 0x1b800
    buffer_load_dwordx4 v14, s[28:31], s3 offen lds
    s_add_u32 m0, s48, 32768
    s_add_u32 s3, s61, 0x1e000
    buffer_load_dwordx4 v14, s[28:31], s3 offen lds
    s_add_u32 m0, s48, 33792
    s_add_u32 s3, s61, 0x20800
    buffer_load_dwordx4 v14, s[28:31], s3 offen lds
    s_add_u32 m0, s48, 34816
    s_add_u32 s3, s61, 0x23000
    buffer_load_dwordx4 v14, s[28:31], s3 offen lds
    s_add_u32 m0, s48, 35840
    s_add_u32 s3, s61, 0x25800
    buffer_load_dwordx4 v14, s[28:31], s3 offen lds
    s_add_u32 m0, s48, 36864
    s_add_u32 s3, s61, 0x28000
    buffer_load_dwordx4 v14, s[28:31], s3 offen lds
    s_add_u32 m0, s48, 37888
    s_add_u32 s3, s61, 0x2a800
    buffer_load_dwordx4 v14, s[28:31], s3 offen lds
    s_add_u32 m0, s48, 38912
    s_add_u32 s3, s61, 0x2d000
    buffer_load_dwordx4 v14, s[28:31], s3 offen lds
    s_add_u32 m0, s48, 39936
    s_add_u32 s3, s61, 0x2f800
    buffer_load_dwordx4 v14, s[28:31], s3 offen lds
    s_waitcnt vmcnt(20)
    ds_read_b64_tr_b16 a[0:1], v13 offset:0
    ds_read_b64_tr_b16 a[2:3], v13 offset:512
    ds_read_b64_tr_b16 a[4:5], v13 offset:8
    ds_read_b64_tr_b16 a[6:7], v13 offset:520
    ds_read_b64_tr_b16 a[8:9], v13 offset:64
    ds_read_b64_tr_b16 a[10:11], v13 offset:576
    ds_read_b64_tr_b16 a[12:13], v13 offset:72
    ds_read_b64_tr_b16 a[14:15], v13 offset:584
    ds_read_b64_tr_b16 a[16:17], v13 offset:4096
    ds_read_b64_tr_b16 a[18:19], v13 offset:4608
    ds_read_b64_tr_b16 a[20:21], v13 offset:4104
    ds_read_b64_tr_b16 a[22:23], v13 offset:4616
    ds_read_b64_tr_b16 a[24:25], v13 offset:4160
    ds_read_b64_tr_b16 a[26:27], v13 offset:4672
    ds_read_b64_tr_b16 a[28:29], v13 offset:4168
    ds_read_b64_tr_b16 a[30:31], v13 offset:4680
    ds_read_b64_tr_b16 a[32:33], v13 offset:8192
    ds_read_b64_tr_b16 a[34:35], v13 offset:8704
    ds_read_b64_tr_b16 a[36:37], v13 offset:8200
    ds_read_b64_tr_b16 a[38:39], v13 offset:8712
    ds_read_b64_tr_b16 a[40:41], v13 offset:8256
    ds_read_b64_tr_b16 a[42:43], v13 offset:8768
    ds_read_b64_tr_b16 a[44:45], v13 offset:8264
    ds_read_b64_tr_b16 a[46:47], v13 offset:8776
    ds_read_b64_tr_b16 a[48:49], v13 offset:12288
    ds_read_b64_tr_b16 a[50:51], v13 offset:12800
    ds_read_b64_tr_b16 a[52:53], v13 offset:12296
    ds_read_b64_tr_b16 a[54:55], v13 offset:12808
    ds_read_b64_tr_b16 a[56:57], v13 offset:12352
    ds_read_b64_tr_b16 a[58:59], v13 offset:12864
    ds_read_b64_tr_b16 a[60:61], v13 offset:12360
    ds_read_b64_tr_b16 a[62:63], v13 offset:12872
    ds_read_b64_tr_b16 a[64:65], v13 offset:16384
    ds_read_b64_tr_b16 a[66:67], v13 offset:16896
    ds_read_b64_tr_b16 a[68:69], v13 offset:16392
    ds_read_b64_tr_b16 a[70:71], v13 offset:16904
    ds_read_b64_tr_b16 a[72:73], v13 offset:16448
    ds_read_b64_tr_b16 a[74:75], v13 offset:16960
    ds_read_b64_tr_b16 a[76:77], v13 offset:16456
    ds_read_b64_tr_b16 a[78:79], v13 offset:16968
    s_waitcnt lgkmcnt(0)
    s_add_u32 m0, s48, 0
    s_add_u32 s3, s62, 0x0
    buffer_load_dwordx4 v14, s[28:31], s3 offen lds
    s_add_u32 m0, s48, 1024
    s_add_u32 s3, s62, 0x2800
    buffer_load_dwordx4 v14, s[28:31], s3 offen lds
    s_add_u32 m0, s48, 2048
    s_add_u32 s3, s62, 0x5000
    buffer_load_dwordx4 v14, s[28:31], s3 offen lds
    s_add_u32 m0, s48, 3072
    s_add_u32 s3, s62, 0x7800
    buffer_load_dwordx4 v14, s[28:31], s3 offen lds
    s_add_u32 m0, s48, 4096
    s_add_u32 s3, s62, 0xa000
    buffer_load_dwordx4 v14, s[28:31], s3 offen lds
    s_add_u32 m0, s48, 5120
    s_add_u32 s3, s62, 0xc800
    buffer_load_dwordx4 v14, s[28:31], s3 offen lds
    s_add_u32 m0, s48, 6144
    s_add_u32 s3, s62, 0xf000
    buffer_load_dwordx4 v14, s[28:31], s3 offen lds
    s_add_u32 m0, s48, 7168
    s_add_u32 s3, s62, 0x11800
    buffer_load_dwordx4 v14, s[28:31], s3 offen lds
    s_add_u32 m0, s48, 8192
    s_add_u32 s3, s62, 0x14000
    buffer_load_dwordx4 v14, s[28:31], s3 offen lds
    s_add_u32 m0, s48, 9216
    s_add_u32 s3, s62, 0x16800
    buffer_load_dwordx4 v14, s[28:31], s3 offen lds
    s_add_u32 m0, s48, 10240
    s_add_u32 s3, s62, 0x19000
    buffer_load_dwordx4 v14, s[28:31], s3 offen lds
    s_add_u32 m0, s48, 11264
    s_add_u32 s3, s62, 0x1b800
    buffer_load_dwordx4 v14, s[28:31], s3 offen lds
    s_add_u32 m0, s48, 12288
    s_add_u32 s3, s62, 0x1e000
    buffer_load_dwordx4 v14, s[28:31], s3 offen lds
    s_add_u32 m0, s48, 13312
    s_add_u32 s3, s62, 0x20800
    buffer_load_dwordx4 v14, s[28:31], s3 offen lds
    s_add_u32 m0, s48, 14336
    s_add_u32 s3, s62, 0x23000
    buffer_load_dwordx4 v14, s[28:31], s3 offen lds
    s_add_u32 m0, s48, 15360
    s_add_u32 s3, s62, 0x25800
    buffer_load_dwordx4 v14, s[28:31], s3 offen lds
    s_add_u32 m0, s48, 16384
    s_add_u32 s3, s62, 0x28000
    buffer_load_dwordx4 v14, s[28:31], s3 offen lds
    s_add_u32 m0, s48, 17408
    s_add_u32 s3, s62, 0x2a800
    buffer_load_dwordx4 v14, s[28:31], s3 offen lds
    s_add_u32 m0, s48, 18432
    s_add_u32 s3, s62, 0x2d000
    buffer_load_dwordx4 v14, s[28:31], s3 offen lds
    s_add_u32 m0, s48, 19456
    s_add_u32 s3, s62, 0x2f800
    buffer_load_dwordx4 v14, s[28:31], s3 offen lds
    s_waitcnt vmcnt(20)
    ds_read_b64_tr_b16 a[80:81], v13 offset:20480
    ds_read_b64_tr_b16 a[82:83], v13 offset:20992
    ds_read_b64_tr_b16 a[84:85], v13 offset:20488
    ds_read_b64_tr_b16 a[86:87], v13 offset:21000
    ds_read_b64_tr_b16 a[88:89], v13 offset:20544
    ds_read_b64_tr_b16 a[90:91], v13 offset:21056
    ds_read_b64_tr_b16 a[92:93], v13 offset:20552
    ds_read_b64_tr_b16 a[94:95], v13 offset:21064
    ds_read_b64_tr_b16 a[96:97], v13 offset:24576
    ds_read_b64_tr_b16 a[98:99], v13 offset:25088
    ds_read_b64_tr_b16 a[100:101], v13 offset:24584
    ds_read_b64_tr_b16 a[102:103], v13 offset:25096
    ds_read_b64_tr_b16 a[104:105], v13 offset:24640
    ds_read_b64_tr_b16 a[106:107], v13 offset:25152
    ds_read_b64_tr_b16 a[108:109], v13 offset:24648
    ds_read_b64_tr_b16 a[110:111], v13 offset:25160
    ds_read_b64_tr_b16 a[112:113], v13 offset:28672
    ds_read_b64_tr_b16 a[114:115], v13 offset:29184
    ds_read_b64_tr_b16 a[116:117], v13 offset:28680
    ds_read_b64_tr_b16 a[118:119], v13 offset:29192
    ds_read_b64_tr_b16 a[120:121], v13 offset:28736
    ds_read_b64_tr_b16 a[122:123], v13 offset:29248
    ds_read_b64_tr_b16 a[124:125], v13 offset:28744
    ds_read_b64_tr_b16 a[126:127], v13 offset:29256
    ds_read_b64_tr_b16 a[128:129], v13 offset:32768
    ds_read_b64_tr_b16 a[130:131], v13 offset:33280
    ds_read_b64_tr_b16 a[132:133], v13 offset:32776
    ds_read_b64_tr_b16 a[134:135], v13 offset:33288
    ds_read_b64_tr_b16 a[136:137], v13 offset:32832
    ds_read_b64_tr_b16 a[138:139], v13 offset:33344
    ds_read_b64_tr_b16 a[140:141], v13 offset:32840
    ds_read_b64_tr_b16 a[142:143], v13 offset:33352
    ds_read_b64_tr_b16 a[144:145], v13 offset:36864
    ds_read_b64_tr_b16 a[146:147], v13 offset:37376
    ds_read_b64_tr_b16 a[148:149], v13 offset:36872
    ds_read_b64_tr_b16 a[150:151], v13 offset:37384
    ds_read_b64_tr_b16 a[152:153], v13 offset:36928
    ds_read_b64_tr_b16 a[154:155], v13 offset:37440
    ds_read_b64_tr_b16 a[156:157], v13 offset:36936
    ds_read_b64_tr_b16 a[158:159], v13 offset:37448
    s_waitcnt lgkmcnt(0)
    s_add_u32 m0, s48, 20480
    s_add_u32 s3, s63, 0x0
    buffer_load_dwordx4 v14, s[28:31], s3 offen lds
    s_add_u32 m0, s48, 21504
    s_add_u32 s3, s63, 0x2800
    buffer_load_dwordx4 v14, s[28:31], s3 offen lds
    s_add_u32 m0, s48, 22528
    s_add_u32 s3, s63, 0x5000
    buffer_load_dwordx4 v14, s[28:31], s3 offen lds
    s_add_u32 m0, s48, 23552
    s_add_u32 s3, s63, 0x7800
    buffer_load_dwordx4 v14, s[28:31], s3 offen lds
    s_add_u32 m0, s48, 24576
    s_add_u32 s3, s63, 0xa000
    buffer_load_dwordx4 v14, s[28:31], s3 offen lds
    s_add_u32 m0, s48, 25600
    s_add_u32 s3, s63, 0xc800
    buffer_load_dwordx4 v14, s[28:31], s3 offen lds
    s_add_u32 m0, s48, 26624
    s_add_u32 s3, s63, 0xf000
    buffer_load_dwordx4 v14, s[28:31], s3 offen lds
    s_add_u32 m0, s48, 27648
    s_add_u32 s3, s63, 0x11800
    buffer_load_dwordx4 v14, s[28:31], s3 offen lds
    s_add_u32 m0, s48, 28672
    s_add_u32 s3, s63, 0x14000
    buffer_load_dwordx4 v14, s[28:31], s3 offen lds
    s_add_u32 m0, s48, 29696
    s_add_u32 s3, s63, 0x16800
    buffer_load_dwordx4 v14, s[28:31], s3 offen lds
    s_add_u32 m0, s48, 30720
    s_add_u32 s3, s63, 0x19000
    buffer_load_dwordx4 v14, s[28:31], s3 offen lds
    s_add_u32 m0, s48, 31744
    s_add_u32 s3, s63, 0x1b800
    buffer_load_dwordx4 v14, s[28:31], s3 offen lds
    s_add_u32 m0, s48, 32768
    s_add_u32 s3, s63, 0x1e000
    buffer_load_dwordx4 v14, s[28:31], s3 offen lds
    s_add_u32 m0, s48, 33792
    s_add_u32 s3, s63, 0x20800
    buffer_load_dwordx4 v14, s[28:31], s3 offen lds
    s_add_u32 m0, s48, 34816
    s_add_u32 s3, s63, 0x23000
    buffer_load_dwordx4 v14, s[28:31], s3 offen lds
    s_add_u32 m0, s48, 35840
    s_add_u32 s3, s63, 0x25800
    buffer_load_dwordx4 v14, s[28:31], s3 offen lds
    s_add_u32 m0, s48, 36864
    s_add_u32 s3, s63, 0x28000
    buffer_load_dwordx4 v14, s[28:31], s3 offen lds
    s_add_u32 m0, s48, 37888
    s_add_u32 s3, s63, 0x2a800
    buffer_load_dwordx4 v14, s[28:31], s3 offen lds
    s_add_u32 m0, s48, 38912
    s_add_u32 s3, s63, 0x2d000
    buffer_load_dwordx4 v14, s[28:31], s3 offen lds
    s_add_u32 m0, s48, 39936
    s_add_u32 s3, s63, 0x2f800
    buffer_load_dwordx4 v14, s[28:31], s3 offen lds
    s_waitcnt vmcnt(20)
    ds_read_b64_tr_b16 a[160:161], v13 offset:0
    ds_read_b64_tr_b16 a[162:163], v13 offset:512
    ds_read_b64_tr_b16 a[164:165], v13 offset:8
    ds_read_b64_tr_b16 a[166:167], v13 offset:520
    ds_read_b64_tr_b16 a[168:169], v13 offset:64
    ds_read_b64_tr_b16 a[170:171], v13 offset:576
    ds_read_b64_tr_b16 a[172:173], v13 offset:72
    ds_read_b64_tr_b16 a[174:175], v13 offset:584
    ds_read_b64_tr_b16 a[176:177], v13 offset:4096
    ds_read_b64_tr_b16 a[178:179], v13 offset:4608
    ds_read_b64_tr_b16 a[180:181], v13 offset:4104
    ds_read_b64_tr_b16 a[182:183], v13 offset:4616
    ds_read_b64_tr_b16 a[184:185], v13 offset:4160
    ds_read_b64_tr_b16 a[186:187], v13 offset:4672
    ds_read_b64_tr_b16 a[188:189], v13 offset:4168
    ds_read_b64_tr_b16 a[190:191], v13 offset:4680
    ds_read_b64_tr_b16 a[192:193], v13 offset:8192
    ds_read_b64_tr_b16 a[194:195], v13 offset:8704
    ds_read_b64_tr_b16 a[196:197], v13 offset:8200
    ds_read_b64_tr_b16 a[198:199], v13 offset:8712
    ds_read_b64_tr_b16 a[200:201], v13 offset:8256
    ds_read_b64_tr_b16 a[202:203], v13 offset:8768
    ds_read_b64_tr_b16 a[204:205], v13 offset:8264
    ds_read_b64_tr_b16 a[206:207], v13 offset:8776
    ds_read_b64_tr_b16 a[208:209], v13 offset:12288
    ds_read_b64_tr_b16 a[210:211], v13 offset:12800
    ds_read_b64_tr_b16 a[212:213], v13 offset:12296
    ds_read_b64_tr_b16 a[214:215], v13 offset:12808
    ds_read_b64_tr_b16 a[216:217], v13 offset:12352
    ds_read_b64_tr_b16 a[218:219], v13 offset:12864
    ds_read_b64_tr_b16 a[220:221], v13 offset:12360
    ds_read_b64_tr_b16 a[222:223], v13 offset:12872
    ds_read_b64_tr_b16 a[224:225], v13 offset:16384
    ds_read_b64_tr_b16 a[226:227], v13 offset:16896
    ds_read_b64_tr_b16 a[228:229], v13 offset:16392
    ds_read_b64_tr_b16 a[230:231], v13 offset:16904
    ds_read_b64_tr_b16 a[232:233], v13 offset:16448
    ds_read_b64_tr_b16 a[234:235], v13 offset:16960
    ds_read_b64_tr_b16 a[236:237], v13 offset:16456
    ds_read_b64_tr_b16 a[238:239], v13 offset:16968
    s_waitcnt lgkmcnt(0)
    s_waitcnt vmcnt(0)
    ds_read_b64_tr_b16 a[240:241], v13 offset:20480
    ds_read_b64_tr_b16 a[242:243], v13 offset:20992
    ds_read_b64_tr_b16 a[244:245], v13 offset:20488
    ds_read_b64_tr_b16 a[246:247], v13 offset:21000
    ds_read_b64_tr_b16 a[248:249], v13 offset:20544
    ds_read_b64_tr_b16 a[250:251], v13 offset:21056
    ds_read_b64_tr_b16 a[252:253], v13 offset:20552
    ds_read_b64_tr_b16 a[254:255], v13 offset:21064
    ds_read_b64_tr_b16 v[192:193], v13 offset:24576
    ds_read_b64_tr_b16 v[194:195], v13 offset:25088
    ds_read_b64_tr_b16 v[196:197], v13 offset:24584
    ds_read_b64_tr_b16 v[198:199], v13 offset:25096
    ds_read_b64_tr_b16 v[200:201], v13 offset:24640
    ds_read_b64_tr_b16 v[202:203], v13 offset:25152
    ds_read_b64_tr_b16 v[204:205], v13 offset:24648
    ds_read_b64_tr_b16 v[206:207], v13 offset:25160
    ds_read_b64_tr_b16 v[208:209], v13 offset:28672
    ds_read_b64_tr_b16 v[210:211], v13 offset:29184
    ds_read_b64_tr_b16 v[212:213], v13 offset:28680
    ds_read_b64_tr_b16 v[214:215], v13 offset:29192
    ds_read_b64_tr_b16 v[216:217], v13 offset:28736
    ds_read_b64_tr_b16 v[218:219], v13 offset:29248
    ds_read_b64_tr_b16 v[220:221], v13 offset:28744
    ds_read_b64_tr_b16 v[222:223], v13 offset:29256
    ds_read_b64_tr_b16 v[224:225], v13 offset:32768
    ds_read_b64_tr_b16 v[226:227], v13 offset:33280
    ds_read_b64_tr_b16 v[228:229], v13 offset:32776
    ds_read_b64_tr_b16 v[230:231], v13 offset:33288
    ds_read_b64_tr_b16 v[232:233], v13 offset:32832
    ds_read_b64_tr_b16 v[234:235], v13 offset:33344
    ds_read_b64_tr_b16 v[236:237], v13 offset:32840
    ds_read_b64_tr_b16 v[238:239], v13 offset:33352
    ds_read_b64_tr_b16 v[240:241], v13 offset:36864
    ds_read_b64_tr_b16 v[242:243], v13 offset:37376
    ds_read_b64_tr_b16 v[244:245], v13 offset:36872
    ds_read_b64_tr_b16 v[246:247], v13 offset:37384
    ds_read_b64_tr_b16 v[248:249], v13 offset:36928
    ds_read_b64_tr_b16 v[250:251], v13 offset:37440
    ds_read_b64_tr_b16 v[252:253], v13 offset:36936
    ds_read_b64_tr_b16 v[254:255], v13 offset:37448
    s_waitcnt lgkmcnt(0)
AO_LOOP:
    s_mov_b32 s24, s8
    s_mov_b32 s25, s9
    s_mov_b32 s26, s10
    s_mov_b32 s27, s11
    v_and_b32 v16, 15, v0
    v_mul_u32_u24 v16, 1280, v16
    v_lshrrev_b32 v17, 4, v0
    v_lshl_add_u32 v6, v17, 4, v16
    s_mov_b32 s35, 64
    s_lshr_b32 s3, s13, 1
    s_mul_i32 s3, s3, 20480
    s_and_b32 s59, s13, 1
    s_mul_i32 s59, s59, 640
    s_add_u32 s3, s3, s59
    v_add_u32 v6, s3, v6
    s_mov_b32 s39, 0
    s_mov_b32 s40, 40960
    s_barrier
AO_PAIR:
    s_mul_i32 s17, s14, 0x6000000
    s_add_u32 s17, s17, 0x1000000
    s_lshl_b32 s3, s14, 13
    s_add_u32 s36, s3, 4096
    s_add_u32 s38, s3, 20480
    s_mov_b32 s37, 32
    s_add_u32 s34, s17, 0x400000
    s_cmp_lg_u32 s14, 0
    s_cbranch_scc1 AO_S1
    s_load_dwordx2 s[4:5], s[0:1], 0
    s_waitcnt lgkmcnt(0)
    s_mov_b32 s28, s4
    s_mov_b32 s29, s5
    s_mov_b32 s30, 0x280000
    s_mov_b32 s31, 0x20000
    v_and_b32 v16, 15, v0
    v_mul_u32_u24 v16, 1280, v16
    v_lshrrev_b32 v17, 4, v0
    v_lshl_add_u32 v12, v17, 4, v16
    s_mov_b32 s44, 64
    s_mov_b32 s43, 0
    s_branch AO_S2
AO_S1:
    s_mov_b32 s28, s8
    s_mov_b32 s29, s9
    s_mov_b32 s30, s10
    s_mov_b32 s31, s11
    v_mov_b32 v12, v1
    s_mov_b32 s44, 1024
    s_mov_b32 s43, 0x1a00000
AO_S2:
    s_lshl_b32 s3, s64, 1
    s_mul_i32 s59, s3, s44
    s_add_u32 s43, s43, s59
    s_lshl_b32 s3, s3, 10
    s_add_u32 s45, s3, s17
    s_add_u32 s45, s45, 0x700000
    s_mov_b32 s32, s42
    s_mov_b32 s41, 0
AO_SEG:
    s_cmp_ge_u32 s32, 64
    s_cbranch_scc1 AO_NEXTP
    s_cmp_lg_u32 s41, 0
    s_cbranch_scc1 AO_GO
    s_lshl_b32 s49, s32, 7
    s_add_u32 s49, s49, s36
    v_mov_b32 v8, 0
POLL_26:
    buffer_load_dword v9, v8, s[8:11], s49 offen sc1
    s_waitcnt vmcnt(0)
    v_readfirstlane_b32 s58, v9
    s_nop 0
    s_cmp_ge_u32 s58, s37
    s_nop 1
    s_cbranch_scc1 POLLD_27
    s_add_u32 s99, s99, 1
    s_cmp_ge_u32 s99, 0x80000
    s_cbranch_scc1 POLLD_27
    s_sleep 1
    s_branch POLL_26
POLLD_27:
    s_mov_b32 s58, s32
    s_mul_i32 s3, s58, 40960
    s_add_u32 s3, s3, s34
    s_mul_i32 s59, s13, 10240
    s_add_u32 s59, s59, s39
    s_mov_b32 m0, s59
    s_add_u32 s59, s59, 1024
    buffer_load_dwordx4 v6, s[24:27], s3 offen sc1 lds
    s_add_u32 s3, s3, s35
    s_mov_b32 m0, s59
    s_add_u32 s59, s59, 1024
    buffer_load_dwordx4 v6, s[24:27], s3 offen sc1 lds
    s_add_u32 s3, s3, s35
    s_mov_b32 m0, s59
    s_add_u32 s59, s59, 1024
    buffer_load_dwordx4 v6, s[24:27], s3 offen sc1 lds
    s_add_u32 s3, s3, s35
    s_mov_b32 m0, s59
    s_add_u32 s59, s59, 1024
    buffer_load_dwordx4 v6, s[24:27], s3 offen sc1 lds
    s_add_u32 s3, s3, s35
    s_mov_b32 m0, s59
    s_add_u32 s59, s59, 1024
    buffer_load_dwordx4 v6, s[24:27], s3 offen sc1 lds
    s_add_u32 s3, s3, s35
    s_mov_b32 m0, s59
    s_add_u32 s59, s59, 1024
    buffer_load_dwordx4 v6, s[24:27], s3 offen sc1 lds
    s_add_u32 s3, s3, s35
    s_mov_b32 m0, s59
    s_add_u32 s59, s59, 1024
    buffer_load_dwordx4 v6, s[24:27], s3 offen sc1 lds
    s_add_u32 s3, s3, s35
    s_mov_b32 m0, s59
    s_add_u32 s59, s59, 1024
    buffer_load_dwordx4 v6, s[24:27], s3 offen sc1 lds
    s_add_u32 s3, s3, s35
    s_mov_b32 m0, s59
    s_add_u32 s59, s59, 1024
    buffer_load_dwordx4 v6, s[24:27], s3 offen sc1 lds
    s_add_u32 s3, s3, s35
    s_mov_b32 m0, s59
    s_add_u32 s59, s59, 1024
    buffer_load_dwordx4 v6, s[24:27], s3 offen sc1 lds
    s_add_u32 s3, s3, s35
    s_waitcnt vmcnt(0)
AO_GO:
    s_barrier
    s_cmp_eq_u32 s46, 1
    s_cbranch_scc1 AO_V1
AO_V0:
    s_mul_i32 s49, s32, 40960
    s_add_u32 s3, s49, s43
    s_add_u32 s59, s3, s44
    buffer_load_dwordx4 v[20:23], v12, s[28:31], s3 offen sc1
    buffer_load_dwordx4 v[24:27], v12, s[28:31], s59 offen sc1
    s_add_u32 s3, s3, 20480
    s_add_u32 s59, s3, s44
    buffer_load_dwordx4 v[28:31], v12, s[28:31], s3 offen sc1
    buffer_load_dwordx4 v[32:35], v12, s[28:31], s59 offen sc1
    s_add_u32 s3, s3, 20480
    s_add_u32 s58, s32, s33
    s_min_u32 s3, s58, 63
    s_lshl_b32 s3, s3, 7
    s_add_u32 s3, s3, s36
    v_mov_b32 v8, 0
    buffer_load_dword v9, v8, s[8:11], s3 offen sc1
    ds_read_b128 v[64:67], v2 offset:0
    ds_read_b128 v[68:71], v2 offset:20480
    ds_read_b128 v[72:75], v2 offset:1024
    ds_read_b128 v[76:79], v2 offset:21504
    ds_read_b128 v[80:83], v2 offset:2048
    ds_read_b128 v[84:87], v2 offset:22528
    ds_read_b128 v[88:91], v2 offset:3072
    s_waitcnt lgkmcnt(6)
    v_mfma_f32_16x16x32_bf16 v[128:131], a[0:3], v[64:67], 0
    v_mfma_f32_16x16x32_bf16 v[132:135], a[4:7], v[64:67], 0
    v_mfma_f32_16x16x32_bf16 v[136:139], a[8:11], v[64:67], 0
    v_mfma_f32_16x16x32_bf16 v[140:143], a[12:15], v[64:67], 0
    ds_read_b128 v[92:95], v2 offset:23552
    s_waitcnt lgkmcnt(6)
    v_mfma_f32_16x16x32_bf16 v[144:147], a[0:3], v[68:71], 0
    v_mfma_f32_16x16x32_bf16 v[148:151], a[4:7], v[68:71], 0
    v_mfma_f32_16x16x32_bf16 v[152:155], a[8:11], v[68:71], 0
    v_mfma_f32_16x16x32_bf16 v[156:159], a[12:15], v[68:71], 0
    ds_read_b128 v[64:67], v2 offset:4096
    s_waitcnt lgkmcnt(6)
    v_mfma_f32_16x16x32_bf16 v[128:131], a[16:19], v[72:75], v[128:131]
    v_mfma_f32_16x16x32_bf16 v[132:135], a[20:23], v[72:75], v[132:135]
    v_mfma_f32_16x16x32_bf16 v[136:139], a[24:27], v[72:75], v[136:139]
    v_mfma_f32_16x16x32_bf16 v[140:143], a[28:31], v[72:75], v[140:143]
    ds_read_b128 v[68:71], v2 offset:24576
    s_waitcnt lgkmcnt(6)
    v_mfma_f32_16x16x32_bf16 v[144:147], a[16:19], v[76:79], v[144:147]
    v_mfma_f32_16x16x32_bf16 v[148:151], a[20:23], v[76:79], v[148:151]
    v_mfma_f32_16x16x32_bf16 v[152:155], a[24:27], v[76:79], v[152:155]
    v_mfma_f32_16x16x32_bf16 v[156:159], a[28:31], v[76:79], v[156:159]
    ds_read_b128 v[72:75], v3 offset:0
    s_waitcnt lgkmcnt(6)
    v_mfma_f32_16x16x32_bf16 v[128:131], a[32:35], v[80:83], v[128:131]
    v_mfma_f32_16x16x32_bf16 v[132:135], a[36:39], v[80:83], v[132:135]
    v_mfma_f32_16x16x32_bf16 v[136:139], a[40:43], v[80:83], v[136:139]
    v_mfma_f32_16x16x32_bf16 v[140:143], a[44:47], v[80:83], v[140:143]
    ds_read_b128 v[76:79], v3 offset:20480
    s_waitcnt lgkmcnt(6)
    v_mfma_f32_16x16x32_bf16 v[144:147], a[32:35], v[84:87], v[144:147]
    v_mfma_f32_16x16x32_bf16 v[148:151], a[36:39], v[84:87], v[148:151]
    v_mfma_f32_16x16x32_bf16 v[152:155], a[40:43], v[84:87], v[152:155]
    v_mfma_f32_16x16x32_bf16 v[156:159], a[44:47], v[84:87], v[156:159]
    ds_read_b128 v[80:83], v3 offset:1024
    s_waitcnt lgkmcnt(6)
    v_mfma_f32_16x16x32_bf16 v[128:131], a[48:51], v[88:91], v[128:131]
    v_mfma_f32_16x16x32_bf16 v[132:135], a[52:55], v[88:91], v[132:135]
    v_mfma_f32_16x16x32_bf16 v[136:139], a[56:59], v[88:91], v[136:139]
    v_mfma_f32_16x16x32_bf16 v[140:143], a[60:63], v[88:91], v[140:143]
    ds_read_b128 v[84:87], v3 offset:21504
    s_waitcnt lgkmcnt(6)
    v_mfma_f32_16x16x32_bf16 v[144:147], a[48:51], v[92:95], v[144:147]
    v_mfma_f32_16x16x32_bf16 v[148:151], a[52:55], v[92:95], v[148:151]
    v_mfma_f32_16x16x32_bf16 v[152:155], a[56:59], v[92:95], v[152:155]
    v_mfma_f32_16x16x32_bf16 v[156:159], a[60:63], v[92:95], v[156:159]
    ds_read_b128 v[88:91], v3 offset:2048
    s_waitcnt lgkmcnt(6)
    v_mfma_f32_16x16x32_bf16 v[128:131], a[64:67], v[64:67], v[128:131]
    v_mfma_f32_16x16x32_bf16 v[132:135], a[68:71], v[64:67], v[132:135]
    v_mfma_f32_16x16x32_bf16 v[136:139], a[72:75], v[64:67], v[136:139]
    v_mfma_f32_16x16x32_bf16 v[140:143], a[76:79], v[64:67], v[140:143]
    ds_read_b128 v[92:95], v3 offset:22528
    s_waitcnt lgkmcnt(6)
    v_mfma_f32_16x16x32_bf16 v[144:147], a[64:67], v[68:71], v[144:147]
    v_mfma_f32_16x16x32_bf16 v[148:151], a[68:71], v[68:71], v[148:151]
    v_mfma_f32_16x16x32_bf16 v[152:155], a[72:75], v[68:71], v[152:155]
    v_mfma_f32_16x16x32_bf16 v[156:159], a[76:79], v[68:71], v[156:159]
    ds_read_b128 v[64:67], v3 offset:3072
    s_waitcnt lgkmcnt(6)
    v_mfma_f32_16x16x32_bf16 v[128:131], a[80:83], v[72:75], v[128:131]
    v_mfma_f32_16x16x32_bf16 v[132:135], a[84:87], v[72:75], v[132:135]
    v_mfma_f32_16x16x32_bf16 v[136:139], a[88:91], v[72:75], v[136:139]
    v_mfma_f32_16x16x32_bf16 v[140:143], a[92:95], v[72:75], v[140:143]
    ds_read_b128 v[68:71], v3 offset:23552
    s_waitcnt lgkmcnt(6)
    v_mfma_f32_16x16x32_bf16 v[144:147], a[80:83], v[76:79], v[144:147]
    v_mfma_f32_16x16x32_bf16 v[148:151], a[84:87], v[76:79], v[148:151]
    v_mfma_f32_16x16x32_bf16 v[152:155], a[88:91], v[76:79], v[152:155]
    v_mfma_f32_16x16x32_bf16 v[156:159], a[92:95], v[76:79], v[156:159]
    ds_read_b128 v[72:75], v3 offset:4096
    s_waitcnt lgkmcnt(6)
    v_mfma_f32_16x16x32_bf16 v[128:131], a[96:99], v[80:83], v[128:131]
    v_mfma_f32_16x16x32_bf16 v[132:135], a[100:103], v[80:83], v[132:135]
    v_mfma_f32_16x16x32_bf16 v[136:139], a[104:107], v[80:83], v[136:139]
    v_mfma_f32_16x16x32_bf16 v[140:143], a[108:111], v[80:83], v[140:143]
    ds_read_b128 v[76:79], v3 offset:24576
    s_waitcnt lgkmcnt(6)
    v_mfma_f32_16x16x32_bf16 v[144:147], a[96:99], v[84:87], v[144:147]
    v_mfma_f32_16x16x32_bf16 v[148:151], a[100:103], v[84:87], v[148:151]
    v_mfma_f32_16x16x32_bf16 v[152:155], a[104:107], v[84:87], v[152:155]
    v_mfma_f32_16x16x32_bf16 v[156:159], a[108:111], v[84:87], v[156:159]
    ds_read_b128 v[80:83], v4 offset:0
    s_waitcnt lgkmcnt(6)
    v_mfma_f32_16x16x32_bf16 v[128:131], a[112:115], v[88:91], v[128:131]
    v_mfma_f32_16x16x32_bf16 v[132:135], a[116:119], v[88:91], v[132:135]
    v_mfma_f32_16x16x32_bf16 v[136:139], a[120:123], v[88:91], v[136:139]
    v_mfma_f32_16x16x32_bf16 v[140:143], a[124:127], v[88:91], v[140:143]
    ds_read_b128 v[84:87], v4 offset:20480
    s_waitcnt lgkmcnt(6)
    v_mfma_f32_16x16x32_bf16 v[144:147], a[112:115], v[92:95], v[144:147]
    v_mfma_f32_16x16x32_bf16 v[148:151], a[116:119], v[92:95], v[148:151]
    v_mfma_f32_16x16x32_bf16 v[152:155], a[120:123], v[92:95], v[152:155]
    v_mfma_f32_16x16x32_bf16 v[156:159], a[124:127], v[92:95], v[156:159]
    ds_read_b128 v[88:91], v4 offset:1024
    s_waitcnt lgkmcnt(6)
    v_mfma_f32_16x16x32_bf16 v[128:131], a[128:131], v[64:67], v[128:131]
    v_mfma_f32_16x16x32_bf16 v[132:135], a[132:135], v[64:67], v[132:135]
    v_mfma_f32_16x16x32_bf16 v[136:139], a[136:139], v[64:67], v[136:139]
    v_mfma_f32_16x16x32_bf16 v[140:143], a[140:143], v[64:67], v[140:143]
    ds_read_b128 v[92:95], v4 offset:21504
    s_waitcnt lgkmcnt(6)
    v_mfma_f32_16x16x32_bf16 v[144:147], a[128:131], v[68:71], v[144:147]
    v_mfma_f32_16x16x32_bf16 v[148:151], a[132:135], v[68:71], v[148:151]
    v_mfma_f32_16x16x32_bf16 v[152:155], a[136:139], v[68:71], v[152:155]
    v_mfma_f32_16x16x32_bf16 v[156:159], a[140:143], v[68:71], v[156:159]
    ds_read_b128 v[64:67], v4 offset:2048
    s_waitcnt lgkmcnt(6)
    v_mfma_f32_16x16x32_bf16 v[128:131], a[144:147], v[72:75], v[128:131]
    v_mfma_f32_16x16x32_bf16 v[132:135], a[148:151], v[72:75], v[132:135]
    v_mfma_f32_16x16x32_bf16 v[136:139], a[152:155], v[72:75], v[136:139]
    v_mfma_f32_16x16x32_bf16 v[140:143], a[156:159], v[72:75], v[140:143]
    ds_read_b128 v[68:71], v4 offset:22528
    s_waitcnt lgkmcnt(6)
    v_mfma_f32_16x16x32_bf16 v[144:147], a[144:147], v[76:79], v[144:147]
    v_mfma_f32_16x16x32_bf16 v[148:151], a[148:151], v[76:79], v[148:151]
    v_mfma_f32_16x16x32_bf16 v[152:155], a[152:155], v[76:79], v[152:155]
    v_mfma_f32_16x16x32_bf16 v[156:159], a[156:159], v[76:79], v[156:159]
    s_waitcnt vmcnt(0)
    v_readfirstlane_b32 s3, v9
    s_nop 0
    s_mov_b32 s41, 0
    s_cmp_ge_u32 s58, 64
    s_cbranch_scc1 NPF_28
    s_cmp_lt_u32 s3, s37
    s_cbranch_scc1 NPF_28
    s_add_u32 s49, s39, s40
    s_mov_b32 s41, 1
    s_mul_i32 s3, s58, 40960
    s_add_u32 s3, s3, s34
    s_mul_i32 s59, s13, 10240
    s_add_u32 s59, s59, s49
    s_mov_b32 m0, s59
    s_add_u32 s59, s59, 1024
    buffer_load_dwordx4 v6, s[24:27], s3 offen sc1 lds
    s_add_u32 s3, s3, s35
    s_mov_b32 m0, s59
    s_add_u32 s59, s59, 1024
    buffer_load_dwordx4 v6, s[24:27], s3 offen sc1 lds
    s_add_u32 s3, s3, s35
    s_mov_b32 m0, s59
    s_add_u32 s59, s59, 1024
    buffer_load_dwordx4 v6, s[24:27], s3 offen sc1 lds
    s_add_u32 s3, s3, s35
    s_mov_b32 m0, s59
    s_add_u32 s59, s59, 1024
    buffer_load_dwordx4 v6, s[24:27], s3 offen sc1 lds
    s_add_u32 s3, s3, s35
    s_mov_b32 m0, s59
    s_add_u32 s59, s59, 1024
    buffer_load_dwordx4 v6, s[24:27], s3 offen sc1 lds
    s_add_u32 s3, s3, s35
    s_mov_b32 m0, s59
    s_add_u32 s59, s59, 1024
    buffer_load_dwordx4 v6, s[24:27], s3 offen sc1 lds
    s_add_u32 s3, s3, s35
    s_mov_b32 m0, s59
    s_add_u32 s59, s59, 1024
    buffer_load_dwordx4 v6, s[24:27], s3 offen sc1 lds
    s_add_u32 s3, s3, s35
    s_mov_b32 m0, s59
    s_add_u32 s59, s59, 1024
    buffer_load_dwordx4 v6, s[24:27], s3 offen sc1 lds
    s_add_u32 s3, s3, s35
    s_mov_b32 m0, s59
    s_add_u32 s59, s59, 1024
    buffer_load_dwordx4 v6, s[24:27], s3 offen sc1 lds
    s_add_u32 s3, s3, s35
    s_mov_b32 m0, s59
    s_add_u32 s59, s59, 1024
    buffer_load_dwordx4 v6, s[24:27], s3 offen sc1 lds
    s_add_u32 s3, s3, s35
NPF_28:
    ds_read_b128 v[72:75], v4 offset:3072
    s_waitcnt lgkmcnt(6)
    v_mfma_f32_16x16x32_bf16 v[128:131], a[160:163], v[80:83], v[128:131]
    v_mfma_f32_16x16x32_bf16 v[132:135], a[164:167], v[80:83], v[132:135]
    v_mfma_f32_16x16x32_bf16 v[136:139], a[168:171], v[80:83], v[136:139]
    v_mfma_f32_16x16x32_bf16 v[140:143], a[172:175], v[80:83], v[140:143]
    ds_read_b128 v[76:79], v4 offset:23552
    s_waitcnt lgkmcnt(6)
    v_mfma_f32_16x16x32_bf16 v[144:147], a[160:163], v[84:87], v[144:147]
    v_mfma_f32_16x16x32_bf16 v[148:151], a[164:167], v[84:87], v[148:151]
    v_mfma_f32_16x16x32_bf16 v[152:155], a[168:171], v[84:87], v[152:155]
    v_mfma_f32_16x16x32_bf16 v[156:159], a[172:175], v[84:87], v[156:159]
    ds_read_b128 v[80:83], v4 offset:4096
    s_waitcnt lgkmcnt(6)
    v_mfma_f32_16x16x32_bf16 v[128:131], a[176:179], v[88:91], v[128:131]
    v_mfma_f32_16x16x32_bf16 v[132:135], a[180:183], v[88:91], v[132:135]
    v_mfma_f32_16x16x32_bf16 v[136:139], a[184:187], v[88:91], v[136:139]
    v_mfma_f32_16x16x32_bf16 v[140:143], a[188:191], v[88:91], v[140:143]
    ds_read_b128 v[84:87], v4 offset:24576
    s_waitcnt lgkmcnt(6)
    v_mfma_f32_16x16x32_bf16 v[144:147], a[176:179], v[92:95], v[144:147]
    v_mfma_f32_16x16x32_bf16 v[148:151], a[180:183], v[92:95], v[148:151]
    v_mfma_f32_16x16x32_bf16 v[152:155], a[184:187], v[92:95], v[152:155]
    v_mfma_f32_16x16x32_bf16 v[156:159], a[188:191], v[92:95], v[156:159]
    ds_read_b128 v[88:91], v5 offset:0
    s_waitcnt lgkmcnt(6)
    v_mfma_f32_16x16x32_bf16 v[128:131], a[192:195], v[64:67], v[128:131]
    v_mfma_f32_16x16x32_bf16 v[132:135], a[196:199], v[64:67], v[132:135]
    v_mfma_f32_16x16x32_bf16 v[136:139], a[200:203], v[64:67], v[136:139]
    v_mfma_f32_16x16x32_bf16 v[140:143], a[204:207], v[64:67], v[140:143]
    ds_read_b128 v[92:95], v5 offset:20480
    s_waitcnt lgkmcnt(6)
    v_mfma_f32_16x16x32_bf16 v[144:147], a[192:195], v[68:71], v[144:147]
    v_mfma_f32_16x16x32_bf16 v[148:151], a[196:199], v[68:71], v[148:151]
    v_mfma_f32_16x16x32_bf16 v[152:155], a[200:203], v[68:71], v[152:155]
    v_mfma_f32_16x16x32_bf16 v[156:159], a[204:207], v[68:71], v[156:159]
    ds_read_b128 v[64:67], v5 offset:1024
    s_waitcnt lgkmcnt(6)
    v_mfma_f32_16x16x32_bf16 v[128:131], a[208:211], v[72:75], v[128:131]
    v_mfma_f32_16x16x32_bf16 v[132:135], a[212:215], v[72:75], v[132:135]
    v_mfma_f32_16x16x32_bf16 v[136:139], a[216:219], v[72:75], v[136:139]
    v_mfma_f32_16x16x32_bf16 v[140:143], a[220:223], v[72:75], v[140:143]
    ds_read_b128 v[68:71], v5 offset:21504
    s_waitcnt lgkmcnt(6)
    v_mfma_f32_16x16x32_bf16 v[144:147], a[208:211], v[76:79], v[144:147]
    v_mfma_f32_16x16x32_bf16 v[148:151], a[212:215], v[76:79], v[148:151]
    v_mfma_f32_16x16x32_bf16 v[152:155], a[216:219], v[76:79], v[152:155]
    v_mfma_f32_16x16x32_bf16 v[156:159], a[220:223], v[76:79], v[156:159]
    ds_read_b128 v[72:75], v5 offset:2048
    s_waitcnt lgkmcnt(6)
    v_mfma_f32_16x16x32_bf16 v[128:131], a[224:227], v[80:83], v[128:131]
    v_mfma_f32_16x16x32_bf16 v[132:135], a[228:231], v[80:83], v[132:135]
    v_mfma_f32_16x16x32_bf16 v[136:139], a[232:235], v[80:83], v[136:139]
    v_mfma_f32_16x16x32_bf16 v[140:143], a[236:239], v[80:83], v[140:143]
    ds_read_b128 v[76:79], v5 offset:22528
    s_waitcnt lgkmcnt(6)
    v_mfma_f32_16x16x32_bf16 v[144:147], a[224:227], v[84:87], v[144:147]
    v_mfma_f32_16x16x32_bf16 v[148:151], a[228:231], v[84:87], v[148:151]
    v_mfma_f32_16x16x32_bf16 v[152:155], a[232:235], v[84:87], v[152:155]
    v_mfma_f32_16x16x32_bf16 v[156:159], a[236:239], v[84:87], v[156:159]
    ds_read_b128 v[80:83], v5 offset:3072
    s_waitcnt lgkmcnt(6)
    v_mfma_f32_16x16x32_bf16 v[128:131], a[240:243], v[88:91], v[128:131]
    v_mfma_f32_16x16x32_bf16 v[132:135], a[244:247], v[88:91], v[132:135]
    v_mfma_f32_16x16x32_bf16 v[136:139], a[248:251], v[88:91], v[136:139]
    v_mfma_f32_16x16x32_bf16 v[140:143], a[252:255], v[88:91], v[140:143]
    ds_read_b128 v[84:87], v5 offset:23552
    s_waitcnt lgkmcnt(6)
    v_mfma_f32_16x16x32_bf16 v[144:147], a[240:243], v[92:95], v[144:147]
    v_mfma_f32_16x16x32_bf16 v[148:151], a[244:247], v[92:95], v[148:151]
    v_mfma_f32_16x16x32_bf16 v[152:155], a[248:251], v[92:95], v[152:155]
    v_mfma_f32_16x16x32_bf16 v[156:159], a[252:255], v[92:95], v[156:159]
    ds_read_b128 v[88:91], v5 offset:4096
    s_waitcnt lgkmcnt(6)
    v_mfma_f32_16x16x32_bf16 v[128:131], v[192:195], v[64:67], v[128:131]
    v_mfma_f32_16x16x32_bf16 v[132:135], v[196:199], v[64:67], v[132:135]
    v_mfma_f32_16x16x32_bf16 v[136:139], v[200:203], v[64:67], v[136:139]
    v_mfma_f32_16x16x32_bf16 v[140:143], v[204:207], v[64:67], v[140:143]
    ds_read_b128 v[92:95], v5 offset:24576
    s_waitcnt lgkmcnt(6)
    v_mfma_f32_16x16x32_bf16 v[144:147], v[192:195], v[68:71], v[144:147]
    v_mfma_f32_16x16x32_bf16 v[148:151], v[196:199], v[68:71], v[148:151]
    v_mfma_f32_16x16x32_bf16 v[152:155], v[200:203], v[68:71], v[152:155]
    v_mfma_f32_16x16x32_bf16 v[156:159], v[204:207], v[68:71], v[156:159]
    s_waitcnt lgkmcnt(5)
    v_mfma_f32_16x16x32_bf16 v[128:131], v[208:211], v[72:75], v[128:131]
    v_mfma_f32_16x16x32_bf16 v[132:135], v[212:215], v[72:75], v[132:135]
    v_mfma_f32_16x16x32_bf16 v[136:139], v[216:219], v[72:75], v[136:139]
    v_mfma_f32_16x16x32_bf16 v[140:143], v[220:223], v[72:75], v[140:143]
    s_waitcnt lgkmcnt(4)
    v_mfma_f32_16x16x32_bf16 v[144:147], v[208:211], v[76:79], v[144:147]
    v_mfma_f32_16x16x32_bf16 v[148:151], v[212:215], v[76:79], v[148:151]
    v_mfma_f32_16x16x32_bf16 v[152:155], v[216:219], v[76:79], v[152:155]
    v_mfma_f32_16x16x32_bf16 v[156:159], v[220:223], v[76:79], v[156:159]
    s_waitcnt lgkmcnt(3)
    v_mfma_f32_16x16x32_bf16 v[128:131], v[224:227], v[80:83], v[128:131]
    v_mfma_f32_16x16x32_bf16 v[132:135], v[228:231], v[80:83], v[132:135]
    v_mfma_f32_16x16x32_bf16 v[136:139], v[232:235], v[80:83], v[136:139]
    v_mfma_f32_16x16x32_bf16 v[140:143], v[236:239], v[80:83], v[140:143]
    s_waitcnt lgkmcnt(2)
    v_mfma_f32_16x16x32_bf16 v[144:147], v[224:227], v[84:87], v[144:147]
    v_mfma_f32_16x16x32_bf16 v[148:151], v[228:231], v[84:87], v[148:151]
    v_mfma_f32_16x16x32_bf16 v[152:155], v[232:235], v[84:87], v[152:155]
    v_mfma_f32_16x16x32_bf16 v[156:159], v[236:239], v[84:87], v[156:159]
    s_waitcnt lgkmcnt(1)
    v_mfma_f32_16x16x32_bf16 v[128:131], v[240:243], v[88:91], v[128:131]
    v_mfma_f32_16x16x32_bf16 v[132:135], v[244:247], v[88:91], v[132:135]
    v_mfma_f32_16x16x32_bf16 v[136:139], v[248:251], v[88:91], v[136:139]
    v_mfma_f32_16x16x32_bf16 v[140:143], v[252:255], v[88:91], v[140:143]
    s_waitcnt lgkmcnt(0)
    v_mfma_f32_16x16x32_bf16 v[144:147], v[240:243], v[92:95], v[144:147]
    v_mfma_f32_16x16x32_bf16 v[148:151], v[244:247], v[92:95], v[148:151]
    v_mfma_f32_16x16x32_bf16 v[152:155], v[248:251], v[92:95], v[152:155]
    v_mfma_f32_16x16x32_bf16 v[156:159], v[252:255], v[92:95], v[156:159]
    s_mul_i32 s49, s32, 40960
    s_add_u32 s49, s49, s45
    s_add_u32 s59, s49, 20480
    v_cvt_pk_bf16_f32 v56, v128, v129
    v_lshlrev_b32 v57, 16, v20
    v_and_b32 v58, 0xffff0000, v20
    v_lshlrev_b32 v59, 16, v56
    v_and_b32 v56, 0xffff0000, v56
    v_add_f32 v57, v57, v59
    v_add_f32 v58, v58, v56
    v_cvt_pk_bf16_f32 v36, v57, v58
    v_cvt_pk_bf16_f32 v56, v130, v131
    v_lshlrev_b32 v57, 16, v21
    v_and_b32 v58, 0xffff0000, v21
    v_lshlrev_b32 v59, 16, v56
    v_and_b32 v56, 0xffff0000, v56
    v_add_f32 v57, v57, v59
    v_add_f32 v58, v58, v56
    v_cvt_pk_bf16_f32 v37, v57, v58
    v_cvt_pk_bf16_f32 v56, v132, v133
    v_lshlrev_b32 v57, 16, v22
    v_and_b32 v58, 0xffff0000, v22
    v_lshlrev_b32 v59, 16, v56
    v_and_b32 v56, 0xffff0000, v56
    v_add_f32 v57, v57, v59
    v_add_f32 v58, v58, v56
    v_cvt_pk_bf16_f32 v38, v57, v58
    v_cvt_pk_bf16_f32 v56, v134, v135
    v_lshlrev_b32 v57, 16, v23
    v_and_b32 v58, 0xffff0000, v23
    v_lshlrev_b32 v59, 16, v56
    v_and_b32 v56, 0xffff0000, v56
    v_add_f32 v57, v57, v59
    v_add_f32 v58, v58, v56
    v_cvt_pk_bf16_f32 v39, v57, v58
    buffer_store_dwordx4 v[36:39], v1, s[8:11], s49 offen offset:0 sc1
    v_cvt_pk_bf16_f32 v56, v136, v137
    v_lshlrev_b32 v57, 16, v24
    v_and_b32 v58, 0xffff0000, v24
    v_lshlrev_b32 v59, 16, v56
    v_and_b32 v56, 0xffff0000, v56
    v_add_f32 v57, v57, v59
    v_add_f32 v58, v58, v56
    v_cvt_pk_bf16_f32 v40, v57, v58
    v_cvt_pk_bf16_f32 v56, v138, v139
    v_lshlrev_b32 v57, 16, v25
    v_and_b32 v58, 0xffff0000, v25
    v_lshlrev_b32 v59, 16, v56
    v_and_b32 v56, 0xffff0000, v56
    v_add_f32 v57, v57, v59
    v_add_f32 v58, v58, v56
    v_cvt_pk_bf16_f32 v41, v57, v58
    v_cvt_pk_bf16_f32 v56, v140, v141
    v_lshlrev_b32 v57, 16, v26
    v_and_b32 v58, 0xffff0000, v26
    v_lshlrev_b32 v59, 16, v56
    v_and_b32 v56, 0xffff0000, v56
    v_add_f32 v57, v57, v59
    v_add_f32 v58, v58, v56
    v_cvt_pk_bf16_f32 v42, v57, v58
    v_cvt_pk_bf16_f32 v56, v142, v143
    v_lshlrev_b32 v57, 16, v27
    v_and_b32 v58, 0xffff0000, v27
    v_lshlrev_b32 v59, 16, v56
    v_and_b32 v56, 0xffff0000, v56
    v_add_f32 v57, v57, v59
    v_add_f32 v58, v58, v56
    v_cvt_pk_bf16_f32 v43, v57, v58
    buffer_store_dwordx4 v[40:43], v1, s[8:11], s49 offen offset:1024 sc1
    v_cvt_pk_bf16_f32 v56, v144, v145
    v_lshlrev_b32 v57, 16, v28
    v_and_b32 v58, 0xffff0000, v28
    v_lshlrev_b32 v59, 16, v56
    v_and_b32 v56, 0xffff0000, v56
    v_add_f32 v57, v57, v59
    v_add_f32 v58, v58, v56
    v_cvt_pk_bf16_f32 v44, v57, v58
    v_cvt_pk_bf16_f32 v56, v146, v147
    v_lshlrev_b32 v57, 16, v29
    v_and_b32 v58, 0xffff0000, v29
    v_lshlrev_b32 v59, 16, v56
    v_and_b32 v56, 0xffff0000, v56
    v_add_f32 v57, v57, v59
    v_add_f32 v58, v58, v56
    v_cvt_pk_bf16_f32 v45, v57, v58
    v_cvt_pk_bf16_f32 v56, v148, v149
    v_lshlrev_b32 v57, 16, v30
    v_and_b32 v58, 0xffff0000, v30
    v_lshlrev_b32 v59, 16, v56
    v_and_b32 v56, 0xffff0000, v56
    v_add_f32 v57, v57, v59
    v_add_f32 v58, v58, v56
    v_cvt_pk_bf16_f32 v46, v57, v58
    v_cvt_pk_bf16_f32 v56, v150, v151
    v_lshlrev_b32 v57, 16, v31
    v_and_b32 v58, 0xffff0000, v31
    v_lshlrev_b32 v59, 16, v56
    v_and_b32 v56, 0xffff0000, v56
    v_add_f32 v57, v57, v59
    v_add_f32 v58, v58, v56
    v_cvt_pk_bf16_f32 v47, v57, v58
    buffer_store_dwordx4 v[44:47], v1, s[8:11], s59 offen offset:0 sc1
    v_cvt_pk_bf16_f32 v56, v152, v153
    v_lshlrev_b32 v57, 16, v32
    v_and_b32 v58, 0xffff0000, v32
    v_lshlrev_b32 v59, 16, v56
    v_and_b32 v56, 0xffff0000, v56
    v_add_f32 v57, v57, v59
    v_add_f32 v58, v58, v56
    v_cvt_pk_bf16_f32 v48, v57, v58
    v_cvt_pk_bf16_f32 v56, v154, v155
    v_lshlrev_b32 v57, 16, v33
    v_and_b32 v58, 0xffff0000, v33
    v_lshlrev_b32 v59, 16, v56
    v_and_b32 v56, 0xffff0000, v56
    v_add_f32 v57, v57, v59
    v_add_f32 v58, v58, v56
    v_cvt_pk_bf16_f32 v49, v57, v58
    v_cvt_pk_bf16_f32 v56, v156, v157
    v_lshlrev_b32 v57, 16, v34
    v_and_b32 v58, 0xffff0000, v34
    v_lshlrev_b32 v59, 16, v56
    v_and_b32 v56, 0xffff0000, v56
    v_add_f32 v57, v57, v59
    v_add_f32 v58, v58, v56
    v_cvt_pk_bf16_f32 v50, v57, v58
    v_cvt_pk_bf16_f32 v56, v158, v159
    v_lshlrev_b32 v57, 16, v35
    v_and_b32 v58, 0xffff0000, v35
    v_lshlrev_b32 v59, 16, v56
    v_and_b32 v56, 0xffff0000, v56
    v_add_f32 v57, v57, v59
    v_add_f32 v58, v58, v56
    v_cvt_pk_bf16_f32 v51, v57, v58
    buffer_store_dwordx4 v[48:51], v1, s[8:11], s59 offen offset:1024 sc1
    s_nop 0
    s_branch AO_END
AO_V1:
    s_add_u32 s58, s32, s33
    s_min_u32 s3, s58, 63
    s_lshl_b32 s3, s3, 7
    s_add_u32 s3, s3, s36
    v_mov_b32 v8, 0
    buffer_load_dword v9, v8, s[8:11], s3 offen sc1
    s_waitcnt vmcnt(0)
    v_readfirstlane_b32 s3, v9
    s_nop 0
    s_mov_b32 s41, 0
    s_cmp_ge_u32 s58, 64
    s_cbranch_scc1 NPF_29
    s_cmp_lt_u32 s3, s37
    s_cbranch_scc1 NPF_29
    s_add_u32 s49, s39, s40
    s_mov_b32 s41, 1
    s_mul_i32 s3, s58, 40960
    s_add_u32 s3, s3, s34
    s_mul_i32 s59, s13, 10240
    s_add_u32 s59, s59, s49
    s_mov_b32 m0, s59
    s_add_u32 s59, s59, 1024
    buffer_load_dwordx4 v6, s[24:27], s3 offen sc1 lds
    s_add_u32 s3, s3, s35
    s_mov_b32 m0, s59
    s_add_u32 s59, s59, 1024
    buffer_load_dwordx4 v6, s[24:27], s3 offen sc1 lds
    s_add_u32 s3, s3, s35
    s_mov_b32 m0, s59
    s_add_u32 s59, s59, 1024
    buffer_load_dwordx4 v6, s[24:27], s3 offen sc1 lds
    s_add_u32 s3, s3, s35
    s_mov_b32 m0, s59
    s_add_u32 s59, s59, 1024
    buffer_load_dwordx4 v6, s[24:27], s3 offen sc1 lds
    s_add_u32 s3, s3, s35
    s_mov_b32 m0, s59
    s_add_u32 s59, s59, 1024
    buffer_load_dwordx4 v6, s[24:27], s3 offen sc1 lds
    s_add_u32 s3, s3, s35
    s_mov_b32 m0, s59
    s_add_u32 s59, s59, 1024
    buffer_load_dwordx4 v6, s[24:27], s3 offen sc1 lds
    s_add_u32 s3, s3, s35
    s_mov_b32 m0, s59
    s_add_u32 s59, s59, 1024
    buffer_load_dwordx4 v6, s[24:27], s3 offen sc1 lds
    s_add_u32 s3, s3, s35
    s_mov_b32 m0, s59
    s_add_u32 s59, s59, 1024
    buffer_load_dwordx4 v6, s[24:27], s3 offen sc1 lds
    s_add_u32 s3, s3, s35
    s_mov_b32 m0, s59
    s_add_u32 s59, s59, 1024
    buffer_load_dwordx4 v6, s[24:27], s3 offen sc1 lds
    s_add_u32 s3, s3, s35
    s_mov_b32 m0, s59
    s_add_u32 s59, s59, 1024
    buffer_load_dwordx4 v6, s[24:27], s3 offen sc1 lds
    s_add_u32 s3, s3, s35
NPF_29:
AO_END:
    s_waitcnt vmcnt(0)
    s_barrier
    s_lshl_b32 s49, s32, 7
    s_add_u32 s49, s49, s38
    s_cmp_lg_u32 s13, 0
    s_cbranch_scc1 SIG_30
    v_mov_b32 v8, 0
    v_mov_b32 v9, 1
    s_mov_b64 exec, 1
    buffer_atomic_add v9, v8, s[8:11], s49 offen sc1
    s_mov_b64 exec, -1
SIG_30:
    v_add_u32 v2, s40, v2
    v_add_u32 v3, s40, v3
    v_add_u32 v4, s40, v4
    v_add_u32 v5, s40, v5
    s_add_u32 s39, s39, s40
    s_sub_u32 s40, 0, s40
    s_add_u32 s32, s32, s33
    s_branch AO_SEG
AO_NEXTP:
    s_add_u32 s14, s14, 1
    s_cmp_lt_u32 s14, s15
    s_cbranch_scc1 AO_PAIR
    s_endpgm
ROLE_KV:
    s_and_b32 s19, s12, 31
    s_lshr_b32 s42, s12, 5
    s_mov_b32 s33, 2
    v_lshlrev_b32 v1, 4, v0
    s_add_u32 s3, s13, 0
    s_and_b32 s3, s3, 3
    s_mul_i32 s3, s3, 5120
    v_add_u32 v2, s3, v1
    s_add_u32 s3, s13, 1
    s_and_b32 s3, s3, 3
    s_mul_i32 s3, s3, 5120
    v_add_u32 v3, s3, v1
    s_add_u32 s3, s13, 2
    s_and_b32 s3, s3, 3
    s_mul_i32 s3, s3, 5120
    v_add_u32 v4, s3, v1
    s_add_u32 s3, s13, 3
    s_and_b32 s3, s3, 3
    s_mul_i32 s3, s3, 5120
    v_add_u32 v5, s3, v1
    v_mov_b32 v176, 0x3f803f80
    v_mov_b32 v177, 0x3f803f80
    v_mov_b32 v178, 0x3f803f80
    v_mov_b32 v179, 0x3f803f80
    v_lshrrev_b32 v16, 4, v0
    v_lshlrev_b32 v16, 10, v16
    v_bfe_u32 v17, v0, 2, 2
    v_lshl_add_u32 v16, v17, 7, v16
    v_and_b32 v17, 3, v0
    v_lshl_add_u32 v16, v17, 4, v16
    s_mul_i32 s48, s13, 40960
    v_add_u32 v13, s48, v16
    v_and_b32 v16, 15, v0
    v_lshlrev_b32 v11, 3, v16
    v_add_u32 v11, 81920, v11
    s_lshl_b32 s3, s13, 8
    v_add_u32 v10, s3, v11
    v_and_b32 v17, 3, v0
    v_cmp_eq_u32 s[50:51], 1, v17
    v_cmp_eq_u32 s[52:53], 2, v17
    v_cmp_eq_u32 s[54:55], 3, v17
    v_lshrrev_b32 v17, 2, v16
    v_lshrrev_b32 v18, 4, v0
    v_cmp_eq_u32 s[56:57], v17, v18
    s_nop 0
    s_lshr_b32 s46, s13, 1
    s_load_dwordx4 s[4:7], s[0:1], 64
    s_waitcnt lgkmcnt(0)
    s_cmp_eq_u32 s46, 0
    s_cselect_b64 s[4:5], s[4:5], s[6:7]
    s_mov_b32 s28, s4
    s_mov_b32 s29, s5
    s_mov_b32 s30, 0x500000
    s_mov_b32 s31, 0x20000
    s_and_b32 s64, s13, 1
    s_lshl_b32 s65, s19, 8
    s_lshl_b32 s3, s64, 7
    s_add_u32 s65, s65, s3
    v_lshrrev_b32 v16, 3, v0
    v_mul_u32_u24 v16, 8192, v16
    v_and_b32 v17, 7, v0
    v_lshl_add_u32 v14, v17, 4, v16
    s_add_u32 s3, s13, 0
    s_and_b32 s3, s3, 3
    s_mul_i32 s3, s3, 1310720
    s_add_u32 s60, s3, s65
    s_add_u32 s3, s13, 1
    s_and_b32 s3, s3, 3
    s_mul_i32 s3, s3, 1310720
    s_add_u32 s61, s3, s65
    s_add_u32 s3, s13, 2
    s_and_b32 s3, s3, 3
    s_mul_i32 s3, s3, 1310720
    s_add_u32 s62, s3, s65
    s_add_u32 s3, s13, 3
    s_and_b32 s3, s3, 3
    s_mul_i32 s3, s3, 1310720
    s_add_u32 s63, s3, s65
    s_add_u32 m0, s48, 0
    s_add_u32 s3, s60, 0x0
    buffer_load_dwordx4 v14, s[28:31], s3 offen lds
    s_add_u32 m0, s48, 1024
    s_add_u32 s3, s60, 0x10000
    buffer_load_dwordx4 v14, s[28:31], s3 offen lds
    s_add_u32 m0, s48, 2048
    s_add_u32 s3, s60, 0x20000
    buffer_load_dwordx4 v14, s[28:31], s3 offen lds
    s_add_u32 m0, s48, 3072
    s_add_u32 s3, s60, 0x30000
    buffer_load_dwordx4 v14, s[28:31], s3 offen lds
    s_add_u32 m0, s48, 4096
    s_add_u32 s3, s60, 0x40000
    buffer_load_dwordx4 v14, s[28:31], s3 offen lds
    s_add_u32 m0, s48, 5120
    s_add_u32 s3, s60, 0x50000
    buffer_load_dwordx4 v14, s[28:31], s3 offen lds
    s_add_u32 m0, s48, 6144
    s_add_u32 s3, s60, 0x60000
    buffer_load_dwordx4 v14, s[28:31], s3 offen lds
    s_add_u32 m0, s48, 7168
    s_add_u32 s3, s60, 0x70000
    buffer_load_dwordx4 v14, s[28:31], s3 offen lds
    s_add_u32 m0, s48, 8192
    s_add_u32 s3, s60, 0x80000
    buffer_load_dwordx4 v14, s[28:31], s3 offen lds
    s_add_u32 m0, s48, 9216
    s_add_u32 s3, s60, 0x90000
    buffer_load_dwordx4 v14, s[28:31], s3 offen lds
    s_add_u32 m0, s48, 10240
    s_add_u32 s3, s60, 0xa0000
    buffer_load_dwordx4 v14, s[28:31], s3 offen lds
    s_add_u32 m0, s48, 11264
    s_add_u32 s3, s60, 0xb0000
    buffer_load_dwordx4 v14, s[28:31], s3 offen lds
    s_add_u32 m0, s48, 12288
    s_add_u32 s3, s60, 0xc0000
    buffer_load_dwordx4 v14, s[28:31], s3 offen lds
    s_add_u32 m0, s48, 13312
    s_add_u32 s3, s60, 0xd0000
    buffer_load_dwordx4 v14, s[28:31], s3 offen lds
    s_add_u32 m0, s48, 14336
    s_add_u32 s3, s60, 0xe0000
    buffer_load_dwordx4 v14, s[28:31], s3 offen lds
    s_add_u32 m0, s48, 15360
    s_add_u32 s3, s60, 0xf0000
    buffer_load_dwordx4 v14, s[28:31], s3 offen lds
    s_add_u32 m0, s48, 16384
    s_add_u32 s3, s60, 0x100000
    buffer_load_dwordx4 v14, s[28:31], s3 offen lds
    s_add_u32 m0, s48, 17408
    s_add_u32 s3, s60, 0x110000
    buffer_load_dwordx4 v14, s[28:31], s3 offen lds
    s_add_u32 m0, s48, 18432
    s_add_u32 s3, s60, 0x120000
    buffer_load_dwordx4 v14, s[28:31], s3 offen lds
    s_add_u32 m0, s48, 19456
    s_add_u32 s3, s60, 0x130000
    buffer_load_dwordx4 v14, s[28:31], s3 offen lds
    s_add_u32 m0, s48, 20480
    s_add_u32 s3, s61, 0x0
    buffer_load_dwordx4 v14, s[28:31], s3 offen lds
    s_add_u32 m0, s48, 21504
    s_add_u32 s3, s61, 0x10000
    buffer_load_dwordx4 v14, s[28:31], s3 offen lds
    s_add_u32 m0, s48, 22528
    s_add_u32 s3, s61, 0x20000
    buffer_load_dwordx4 v14, s[28:31], s3 offen lds
    s_add_u32 m0, s48, 23552
    s_add_u32 s3, s61, 0x30000
    buffer_load_dwordx4 v14, s[28:31], s3 offen lds
    s_add_u32 m0, s48, 24576
    s_add_u32 s3, s61, 0x40000
    buffer_load_dwordx4 v14, s[28:31], s3 offen lds
    s_add_u32 m0, s48, 25600
    s_add_u32 s3, s61, 0x50000
    buffer_load_dwordx4 v14, s[28:31], s3 offen lds
    s_add_u32 m0, s48, 26624
    s_add_u32 s3, s61, 0x60000
    buffer_load_dwordx4 v14, s[28:31], s3 offen lds
    s_add_u32 m0, s48, 27648
    s_add_u32 s3, s61, 0x70000
    buffer_load_dwordx4 v14, s[28:31], s3 offen lds
    s_add_u32 m0, s48, 28672
    s_add_u32 s3, s61, 0x80000
    buffer_load_dwordx4 v14, s[28:31], s3 offen lds
    s_add_u32 m0, s48, 29696
    s_add_u32 s3, s61, 0x90000
    buffer_load_dwordx4 v14, s[28:31], s3 offen lds
    s_add_u32 m0, s48, 30720
    s_add_u32 s3, s61, 0xa0000
    buffer_load_dwordx4 v14, s[28:31], s3 offen lds
    s_add_u32 m0, s48, 31744
    s_add_u32 s3, s61, 0xb0000
    buffer_load_dwordx4 v14, s[28:31], s3 offen lds
    s_add_u32 m0, s48, 32768
    s_add_u32 s3, s61, 0xc0000
    buffer_load_dwordx4 v14, s[28:31], s3 offen lds
    s_add_u32 m0, s48, 33792
    s_add_u32 s3, s61, 0xd0000
    buffer_load_dwordx4 v14, s[28:31], s3 offen lds
    s_add_u32 m0, s48, 34816
    s_add_u32 s3, s61, 0xe0000
    buffer_load_dwordx4 v14, s[28:31], s3 offen lds
    s_add_u32 m0, s48, 35840
    s_add_u32 s3, s61, 0xf0000
    buffer_load_dwordx4 v14, s[28:31], s3 offen lds
    s_add_u32 m0, s48, 36864
    s_add_u32 s3, s61, 0x100000
    buffer_load_dwordx4 v14, s[28:31], s3 offen lds
    s_add_u32 m0, s48, 37888
    s_add_u32 s3, s61, 0x110000
    buffer_load_dwordx4 v14, s[28:31], s3 offen lds
    s_add_u32 m0, s48, 38912
    s_add_u32 s3, s61, 0x120000
    buffer_load_dwordx4 v14, s[28:31], s3 offen lds
    s_add_u32 m0, s48, 39936
    s_add_u32 s3, s61, 0x130000
    buffer_load_dwordx4 v14, s[28:31], s3 offen lds
    s_waitcnt vmcnt(20)
    ds_read_b64_tr_b16 a[0:1], v13 offset:0
    ds_read_b64_tr_b16 a[2:3], v13 offset:512
    ds_read_b64_tr_b16 a[4:5], v13 offset:8
    ds_read_b64_tr_b16 a[6:7], v13 offset:520
    ds_read_b64_tr_b16 a[8:9], v13 offset:64
    ds_read_b64_tr_b16 a[10:11], v13 offset:576
    ds_read_b64_tr_b16 a[12:13], v13 offset:72
    ds_read_b64_tr_b16 a[14:15], v13 offset:584
    ds_read_b64_tr_b16 a[16:17], v13 offset:4096
    ds_read_b64_tr_b16 a[18:19], v13 offset:4608
    ds_read_b64_tr_b16 a[20:21], v13 offset:4104
    ds_read_b64_tr_b16 a[22:23], v13 offset:4616
    ds_read_b64_tr_b16 a[24:25], v13 offset:4160
    ds_read_b64_tr_b16 a[26:27], v13 offset:4672
    ds_read_b64_tr_b16 a[28:29], v13 offset:4168
    ds_read_b64_tr_b16 a[30:31], v13 offset:4680
    ds_read_b64_tr_b16 a[32:33], v13 offset:8192
    ds_read_b64_tr_b16 a[34:35], v13 offset:8704
    ds_read_b64_tr_b16 a[36:37], v13 offset:8200
    ds_read_b64_tr_b16 a[38:39], v13 offset:8712
    ds_read_b64_tr_b16 a[40:41], v13 offset:8256
    ds_read_b64_tr_b16 a[42:43], v13 offset:8768
    ds_read_b64_tr_b16 a[44:45], v13 offset:8264
    ds_read_b64_tr_b16 a[46:47], v13 offset:8776
    ds_read_b64_tr_b16 a[48:49], v13 offset:12288
    ds_read_b64_tr_b16 a[50:51], v13 offset:12800
    ds_read_b64_tr_b16 a[52:53], v13 offset:12296
    ds_read_b64_tr_b16 a[54:55], v13 offset:12808
    ds_read_b64_tr_b16 a[56:57], v13 offset:12352
    ds_read_b64_tr_b16 a[58:59], v13 offset:12864
    ds_read_b64_tr_b16 a[60:61], v13 offset:12360
    ds_read_b64_tr_b16 a[62:63], v13 offset:12872
    ds_read_b64_tr_b16 a[64:65], v13 offset:16384
    ds_read_b64_tr_b16 a[66:67], v13 offset:16896
    ds_read_b64_tr_b16 a[68:69], v13 offset:16392
    ds_read_b64_tr_b16 a[70:71], v13 offset:16904
    ds_read_b64_tr_b16 a[72:73], v13 offset:16448
    ds_read_b64_tr_b16 a[74:75], v13 offset:16960
    ds_read_b64_tr_b16 a[76:77], v13 offset:16456
    ds_read_b64_tr_b16 a[78:79], v13 offset:16968
    s_waitcnt lgkmcnt(0)
    s_add_u32 m0, s48, 0
    s_add_u32 s3, s62, 0x0
    buffer_load_dwordx4 v14, s[28:31], s3 offen lds
    s_add_u32 m0, s48, 1024
    s_add_u32 s3, s62, 0x10000
    buffer_load_dwordx4 v14, s[28:31], s3 offen lds
    s_add_u32 m0, s48, 2048
    s_add_u32 s3, s62, 0x20000
    buffer_load_dwordx4 v14, s[28:31], s3 offen lds
    s_add_u32 m0, s48, 3072
    s_add_u32 s3, s62, 0x30000
    buffer_load_dwordx4 v14, s[28:31], s3 offen lds
    s_add_u32 m0, s48, 4096
    s_add_u32 s3, s62, 0x40000
    buffer_load_dwordx4 v14, s[28:31], s3 offen lds
    s_add_u32 m0, s48, 5120
    s_add_u32 s3, s62, 0x50000
    buffer_load_dwordx4 v14, s[28:31], s3 offen lds
    s_add_u32 m0, s48, 6144
    s_add_u32 s3, s62, 0x60000
    buffer_load_dwordx4 v14, s[28:31], s3 offen lds
    s_add_u32 m0, s48, 7168
    s_add_u32 s3, s62, 0x70000
    buffer_load_dwordx4 v14, s[28:31], s3 offen lds
    s_add_u32 m0, s48, 8192
    s_add_u32 s3, s62, 0x80000
    buffer_load_dwordx4 v14, s[28:31], s3 offen lds
    s_add_u32 m0, s48, 9216
    s_add_u32 s3, s62, 0x90000
    buffer_load_dwordx4 v14, s[28:31], s3 offen lds
    s_add_u32 m0, s48, 10240
    s_add_u32 s3, s62, 0xa0000
    buffer_load_dwordx4 v14, s[28:31], s3 offen lds
    s_add_u32 m0, s48, 11264
    s_add_u32 s3, s62, 0xb0000
    buffer_load_dwordx4 v14, s[28:31], s3 offen lds
    s_add_u32 m0, s48, 12288
    s_add_u32 s3, s62, 0xc0000
    buffer_load_dwordx4 v14, s[28:31], s3 offen lds
    s_add_u32 m0, s48, 13312
    s_add_u32 s3, s62, 0xd0000
    buffer_load_dwordx4 v14, s[28:31], s3 offen lds
    s_add_u32 m0, s48, 14336
    s_add_u32 s3, s62, 0xe0000
    buffer_load_dwordx4 v14, s[28:31], s3 offen lds
    s_add_u32 m0, s48, 15360
    s_add_u32 s3, s62, 0xf0000
    buffer_load_dwordx4 v14, s[28:31], s3 offen lds
    s_add_u32 m0, s48, 16384
    s_add_u32 s3, s62, 0x100000
    buffer_load_dwordx4 v14, s[28:31], s3 offen lds
    s_add_u32 m0, s48, 17408
    s_add_u32 s3, s62, 0x110000
    buffer_load_dwordx4 v14, s[28:31], s3 offen lds
    s_add_u32 m0, s48, 18432
    s_add_u32 s3, s62, 0x120000
    buffer_load_dwordx4 v14, s[28:31], s3 offen lds
    s_add_u32 m0, s48, 19456
    s_add_u32 s3, s62, 0x130000
    buffer_load_dwordx4 v14, s[28:31], s3 offen lds
    s_waitcnt vmcnt(20)
    ds_read_b64_tr_b16 a[80:81], v13 offset:20480
    ds_read_b64_tr_b16 a[82:83], v13 offset:20992
    ds_read_b64_tr_b16 a[84:85], v13 offset:20488
    ds_read_b64_tr_b16 a[86:87], v13 offset:21000
    ds_read_b64_tr_b16 a[88:89], v13 offset:20544
    ds_read_b64_tr_b16 a[90:91], v13 offset:21056
    ds_read_b64_tr_b16 a[92:93], v13 offset:20552
    ds_read_b64_tr_b16 a[94:95], v13 offset:21064
    ds_read_b64_tr_b16 a[96:97], v13 offset:24576
    ds_read_b64_tr_b16 a[98:99], v13 offset:25088
    ds_read_b64_tr_b16 a[100:101], v13 offset:24584
    ds_read_b64_tr_b16 a[102:103], v13 offset:25096
    ds_read_b64_tr_b16 a[104:105], v13 offset:24640
    ds_read_b64_tr_b16 a[106:107], v13 offset:25152
    ds_read_b64_tr_b16 a[108:109], v13 offset:24648
    ds_read_b64_tr_b16 a[110:111], v13 offset:25160
    ds_read_b64_tr_b16 a[112:113], v13 offset:28672
    ds_read_b64_tr_b16 a[114:115], v13 offset:29184
    ds_read_b64_tr_b16 a[116:117], v13 offset:28680
    ds_read_b64_tr_b16 a[118:119], v13 offset:29192
    ds_read_b64_tr_b16 a[120:121], v13 offset:28736
    ds_read_b64_tr_b16 a[122:123], v13 offset:29248
    ds_read_b64_tr_b16 a[124:125], v13 offset:28744
    ds_read_b64_tr_b16 a[126:127], v13 offset:29256
    ds_read_b64_tr_b16 a[128:129], v13 offset:32768
    ds_read_b64_tr_b16 a[130:131], v13 offset:33280
    ds_read_b64_tr_b16 a[132:133], v13 offset:32776
    ds_read_b64_tr_b16 a[134:135], v13 offset:33288
    ds_read_b64_tr_b16 a[136:137], v13 offset:32832
    ds_read_b64_tr_b16 a[138:139], v13 offset:33344
    ds_read_b64_tr_b16 a[140:141], v13 offset:32840
    ds_read_b64_tr_b16 a[142:143], v13 offset:33352
    ds_read_b64_tr_b16 a[144:145], v13 offset:36864
    ds_read_b64_tr_b16 a[146:147], v13 offset:37376
    ds_read_b64_tr_b16 a[148:149], v13 offset:36872
    ds_read_b64_tr_b16 a[150:151], v13 offset:37384
    ds_read_b64_tr_b16 a[152:153], v13 offset:36928
    ds_read_b64_tr_b16 a[154:155], v13 offset:37440
    ds_read_b64_tr_b16 a[156:157], v13 offset:36936
    ds_read_b64_tr_b16 a[158:159], v13 offset:37448
    s_waitcnt lgkmcnt(0)
    s_add_u32 m0, s48, 20480
    s_add_u32 s3, s63, 0x0
    buffer_load_dwordx4 v14, s[28:31], s3 offen lds
    s_add_u32 m0, s48, 21504
    s_add_u32 s3, s63, 0x10000
    buffer_load_dwordx4 v14, s[28:31], s3 offen lds
    s_add_u32 m0, s48, 22528
    s_add_u32 s3, s63, 0x20000
    buffer_load_dwordx4 v14, s[28:31], s3 offen lds
    s_add_u32 m0, s48, 23552
    s_add_u32 s3, s63, 0x30000
    buffer_load_dwordx4 v14, s[28:31], s3 offen lds
    s_add_u32 m0, s48, 24576
    s_add_u32 s3, s63, 0x40000
    buffer_load_dwordx4 v14, s[28:31], s3 offen lds
    s_add_u32 m0, s48, 25600
    s_add_u32 s3, s63, 0x50000
    buffer_load_dwordx4 v14, s[28:31], s3 offen lds
    s_add_u32 m0, s48, 26624
    s_add_u32 s3, s63, 0x60000
    buffer_load_dwordx4 v14, s[28:31], s3 offen lds
    s_add_u32 m0, s48, 27648
    s_add_u32 s3, s63, 0x70000
    buffer_load_dwordx4 v14, s[28:31], s3 offen lds
    s_add_u32 m0, s48, 28672
    s_add_u32 s3, s63, 0x80000
    buffer_load_dwordx4 v14, s[28:31], s3 offen lds
    s_add_u32 m0, s48, 29696
    s_add_u32 s3, s63, 0x90000
    buffer_load_dwordx4 v14, s[28:31], s3 offen lds
    s_add_u32 m0, s48, 30720
    s_add_u32 s3, s63, 0xa0000
    buffer_load_dwordx4 v14, s[28:31], s3 offen lds
    s_add_u32 m0, s48, 31744
    s_add_u32 s3, s63, 0xb0000
    buffer_load_dwordx4 v14, s[28:31], s3 offen lds
    s_add_u32 m0, s48, 32768
    s_add_u32 s3, s63, 0xc0000
    buffer_load_dwordx4 v14, s[28:31], s3 offen lds
    s_add_u32 m0, s48, 33792
    s_add_u32 s3, s63, 0xd0000
    buffer_load_dwordx4 v14, s[28:31], s3 offen lds
    s_add_u32 m0, s48, 34816
    s_add_u32 s3, s63, 0xe0000
    buffer_load_dwordx4 v14, s[28:31], s3 offen lds
    s_add_u32 m0, s48, 35840
    s_add_u32 s3, s63, 0xf0000
    buffer_load_dwordx4 v14, s[28:31], s3 offen lds
    s_add_u32 m0, s48, 36864
    s_add_u32 s3, s63, 0x100000
    buffer_load_dwordx4 v14, s[28:31], s3 offen lds
    s_add_u32 m0, s48, 37888
    s_add_u32 s3, s63, 0x110000
    buffer_load_dwordx4 v14, s[28:31], s3 offen lds
    s_add_u32 m0, s48, 38912
    s_add_u32 s3, s63, 0x120000
    buffer_load_dwordx4 v14, s[28:31], s3 offen lds
    s_add_u32 m0, s48, 39936
    s_add_u32 s3, s63, 0x130000
    buffer_load_dwordx4 v14, s[28:31], s3 offen lds
    s_waitcnt vmcnt(20)
    ds_read_b64_tr_b16 a[160:161], v13 offset:0
    ds_read_b64_tr_b16 a[162:163], v13 offset:512
    ds_read_b64_tr_b16 a[164:165], v13 offset:8
    ds_read_b64_tr_b16 a[166:167], v13 offset:520
    ds_read_b64_tr_b16 a[168:169], v13 offset:64
    ds_read_b64_tr_b16 a[170:171], v13 offset:576
    ds_read_b64_tr_b16 a[172:173], v13 offset:72
    ds_read_b64_tr_b16 a[174:175], v13 offset:584
    ds_read_b64_tr_b16 a[176:177], v13 offset:4096
    ds_read_b64_tr_b16 a[178:179], v13 offset:4608
    ds_read_b64_tr_b16 a[180:181], v13 offset:4104
    ds_read_b64_tr_b16 a[182:183], v13 offset:4616
    ds_read_b64_tr_b16 a[184:185], v13 offset:4160
    ds_read_b64_tr_b16 a[186:187], v13 offset:4672
    ds_read_b64_tr_b16 a[188:189], v13 offset:4168
    ds_read_b64_tr_b16 a[190:191], v13 offset:4680
    ds_read_b64_tr_b16 a[192:193], v13 offset:8192
    ds_read_b64_tr_b16 a[194:195], v13 offset:8704
    ds_read_b64_tr_b16 a[196:197], v13 offset:8200
    ds_read_b64_tr_b16 a[198:199], v13 offset:8712
    ds_read_b64_tr_b16 a[200:201], v13 offset:8256
    ds_read_b64_tr_b16 a[202:203], v13 offset:8768
    ds_read_b64_tr_b16 a[204:205], v13 offset:8264
    ds_read_b64_tr_b16 a[206:207], v13 offset:8776
    ds_read_b64_tr_b16 a[208:209], v13 offset:12288
    ds_read_b64_tr_b16 a[210:211], v13 offset:12800
    ds_read_b64_tr_b16 a[212:213], v13 offset:12296
    ds_read_b64_tr_b16 a[214:215], v13 offset:12808
    ds_read_b64_tr_b16 a[216:217], v13 offset:12352
    ds_read_b64_tr_b16 a[218:219], v13 offset:12864
    ds_read_b64_tr_b16 a[220:221], v13 offset:12360
    ds_read_b64_tr_b16 a[222:223], v13 offset:12872
    ds_read_b64_tr_b16 a[224:225], v13 offset:16384
    ds_read_b64_tr_b16 a[226:227], v13 offset:16896
    ds_read_b64_tr_b16 a[228:229], v13 offset:16392
    ds_read_b64_tr_b16 a[230:231], v13 offset:16904
    ds_read_b64_tr_b16 a[232:233], v13 offset:16448
    ds_read_b64_tr_b16 a[234:235], v13 offset:16960
    ds_read_b64_tr_b16 a[236:237], v13 offset:16456
    ds_read_b64_tr_b16 a[238:239], v13 offset:16968
    s_waitcnt lgkmcnt(0)
    s_waitcnt vmcnt(0)
    ds_read_b64_tr_b16 a[240:241], v13 offset:20480
    ds_read_b64_tr_b16 a[242:243], v13 offset:20992
    ds_read_b64_tr_b16 a[244:245], v13 offset:20488
    ds_read_b64_tr_b16 a[246:247], v13 offset:21000
    ds_read_b64_tr_b16 a[248:249], v13 offset:20544
    ds_read_b64_tr_b16 a[250:251], v13 offset:21056
    ds_read_b64_tr_b16 a[252:253], v13 offset:20552
    ds_read_b64_tr_b16 a[254:255], v13 offset:21064
    ds_read_b64_tr_b16 v[192:193], v13 offset:24576
    ds_read_b64_tr_b16 v[194:195], v13 offset:25088
    ds_read_b64_tr_b16 v[196:197], v13 offset:24584
    ds_read_b64_tr_b16 v[198:199], v13 offset:25096
    ds_read_b64_tr_b16 v[200:201], v13 offset:24640
    ds_read_b64_tr_b16 v[202:203], v13 offset:25152
    ds_read_b64_tr_b16 v[204:205], v13 offset:24648
    ds_read_b64_tr_b16 v[206:207], v13 offset:25160
    ds_read_b64_tr_b16 v[208:209], v13 offset:28672
    ds_read_b64_tr_b16 v[210:211], v13 offset:29184
    ds_read_b64_tr_b16 v[212:213], v13 offset:28680
    ds_read_b64_tr_b16 v[214:215], v13 offset:29192
    ds_read_b64_tr_b16 v[216:217], v13 offset:28736
    ds_read_b64_tr_b16 v[218:219], v13 offset:29248
    ds_read_b64_tr_b16 v[220:221], v13 offset:28744
    ds_read_b64_tr_b16 v[222:223], v13 offset:29256
    ds_read_b64_tr_b16 v[224:225], v13 offset:32768
    ds_read_b64_tr_b16 v[226:227], v13 offset:33280
    ds_read_b64_tr_b16 v[228:229], v13 offset:32776
    ds_read_b64_tr_b16 v[230:231], v13 offset:33288
    ds_read_b64_tr_b16 v[232:233], v13 offset:32832
    ds_read_b64_tr_b16 v[234:235], v13 offset:33344
    ds_read_b64_tr_b16 v[236:237], v13 offset:32840
    ds_read_b64_tr_b16 v[238:239], v13 offset:33352
    ds_read_b64_tr_b16 v[240:241], v13 offset:36864
    ds_read_b64_tr_b16 v[242:243], v13 offset:37376
    ds_read_b64_tr_b16 v[244:245], v13 offset:36872
    ds_read_b64_tr_b16 v[246:247], v13 offset:37384
    ds_read_b64_tr_b16 v[248:249], v13 offset:36928
    ds_read_b64_tr_b16 v[250:251], v13 offset:37440
    ds_read_b64_tr_b16 v[252:253], v13 offset:36936
    ds_read_b64_tr_b16 v[254:255], v13 offset:37448
    s_waitcnt lgkmcnt(0)
    s_cmp_eq_u32 s46, 1
    s_cbranch_scc1 KV_C1
    v_mfma_f32_16x16x32_bf16 v[96:99], a[0:3], v[176:179], 0
    v_mfma_f32_16x16x32_bf16 v[100:103], a[4:7], v[176:179], 0
    v_mfma_f32_16x16x32_bf16 v[104:107], a[8:11], v[176:179], 0
    v_mfma_f32_16x16x32_bf16 v[108:111], a[12:15], v[176:179], 0
    v_mfma_f32_16x16x32_bf16 v[96:99], a[16:19], v[176:179], v[96:99]
    v_mfma_f32_16x16x32_bf16 v[100:103], a[20:23], v[176:179], v[100:103]
    v_mfma_f32_16x16x32_bf16 v[104:107], a[24:27], v[176:179], v[104:107]
    v_mfma_f32_16x16x32_bf16 v[108:111], a[28:31], v[176:179], v[108:111]
    v_mfma_f32_16x16x32_bf16 v[96:99], a[32:35], v[176:179], v[96:99]
    v_mfma_f32_16x16x32_bf16 v[100:103], a[36:39], v[176:179], v[100:103]
    v_mfma_f32_16x16x32_bf16 v[104:107], a[40:43], v[176:179], v[104:107]
    v_mfma_f32_16x16x32_bf16 v[108:111], a[44:47], v[176:179], v[108:111]
    v_mfma_f32_16x16x32_bf16 v[96:99], a[48:51], v[176:179], v[96:99]
    v_mfma_f32_16x16x32_bf16 v[100:103], a[52:55], v[176:179], v[100:103]
    v_mfma_f32_16x16x32_bf16 v[104:107], a[56:59], v[176:179], v[104:107]
    v_mfma_f32_16x16x32_bf16 v[108:111], a[60:63], v[176:179], v[108:111]
    v_mfma_f32_16x16x32_bf16 v[96:99], a[64:67], v[176:179], v[96:99]
    v_mfma_f32_16x16x32_bf16 v[100:103], a[68:71], v[176:179], v[100:103]
    v_mfma_f32_16x16x32_bf16 v[104:107], a[72:75], v[176:179], v[104:107]
    v_mfma_f32_16x16x32_bf16 v[108:111], a[76:79], v[176:179], v[108:111]
    v_mfma_f32_16x16x32_bf16 v[96:99], a[80:83], v[176:179], v[96:99]
    v_mfma_f32_16x16x32_bf16 v[100:103], a[84:87], v[176:179], v[100:103]
    v_mfma_f32_16x16x32_bf16 v[104:107], a[88:91], v[176:179], v[104:107]
    v_mfma_f32_16x16x32_bf16 v[108:111], a[92:95], v[176:179], v[108:111]
    v_mfma_f32_16x16x32_bf16 v[96:99], a[96:99], v[176:179], v[96:99]
    v_mfma_f32_16x16x32_bf16 v[100:103], a[100:103], v[176:179], v[100:103]
    v_mfma_f32_16x16x32_bf16 v[104:107], a[104:107], v[176:179], v[104:107]
    v_mfma_f32_16x16x32_bf16 v[108:111], a[108:111], v[176:179], v[108:111]
    v_mfma_f32_16x16x32_bf16 v[96:99], a[112:115], v[176:179], v[96:99]
    v_mfma_f32_16x16x32_bf16 v[100:103], a[116:119], v[176:179], v[100:103]
    v_mfma_f32_16x16x32_bf16 v[104:107], a[120:123], v[176:179], v[104:107]
    v_mfma_f32_16x16x32_bf16 v[108:111], a[124:127], v[176:179], v[108:111]
    v_mfma_f32_16x16x32_bf16 v[96:99], a[128:131], v[176:179], v[96:99]
    v_mfma_f32_16x16x32_bf16 v[100:103], a[132:135], v[176:179], v[100:103]
    v_mfma_f32_16x16x32_bf16 v[104:107], a[136:139], v[176:179], v[104:107]
    v_mfma_f32_16x16x32_bf16 v[108:111], a[140:143], v[176:179], v[108:111]
    v_mfma_f32_16x16x32_bf16 v[96:99], a[144:147], v[176:179], v[96:99]
    v_mfma_f32_16x16x32_bf16 v[100:103], a[148:151], v[176:179], v[100:103]
    v_mfma_f32_16x16x32_bf16 v[104:107], a[152:155], v[176:179], v[104:107]
    v_mfma_f32_16x16x32_bf16 v[108:111], a[156:159], v[176:179], v[108:111]
    v_mfma_f32_16x16x32_bf16 v[96:99], a[160:163], v[176:179], v[96:99]
    v_mfma_f32_16x16x32_bf16 v[100:103], a[164:167], v[176:179], v[100:103]
    v_mfma_f32_16x16x32_bf16 v[104:107], a[168:171], v[176:179], v[104:107]
    v_mfma_f32_16x16x32_bf16 v[108:111], a[172:175], v[176:179], v[108:111]
    v_mfma_f32_16x16x32_bf16 v[96:99], a[176:179], v[176:179], v[96:99]
    v_mfma_f32_16x16x32_bf16 v[100:103], a[180:183], v[176:179], v[100:103]
    v_mfma_f32_16x16x32_bf16 v[104:107], a[184:187], v[176:179], v[104:107]
    v_mfma_f32_16x16x32_bf16 v[108:111], a[188:191], v[176:179], v[108:111]
    v_mfma_f32_16x16x32_bf16 v[96:99], a[192:195], v[176:179], v[96:99]
    v_mfma_f32_16x16x32_bf16 v[100:103], a[196:199], v[176:179], v[100:103]
    v_mfma_f32_16x16x32_bf16 v[104:107], a[200:203], v[176:179], v[104:107]
    v_mfma_f32_16x16x32_bf16 v[108:111], a[204:207], v[176:179], v[108:111]
    v_mfma_f32_16x16x32_bf16 v[96:99], a[208:211], v[176:179], v[96:99]
    v_mfma_f32_16x16x32_bf16 v[100:103], a[212:215], v[176:179], v[100:103]
    v_mfma_f32_16x16x32_bf16 v[104:107], a[216:219], v[176:179], v[104:107]
    v_mfma_f32_16x16x32_bf16 v[108:111], a[220:223], v[176:179], v[108:111]
    v_mfma_f32_16x16x32_bf16 v[96:99], a[224:227], v[176:179], v[96:99]
    v_mfma_f32_16x16x32_bf16 v[100:103], a[228:231], v[176:179], v[100:103]
    v_mfma_f32_16x16x32_bf16 v[104:107], a[232:235], v[176:179], v[104:107]
    v_mfma_f32_16x16x32_bf16 v[108:111], a[236:239], v[176:179], v[108:111]
    v_mfma_f32_16x16x32_bf16 v[96:99], a[240:243], v[176:179], v[96:99]
    v_mfma_f32_16x16x32_bf16 v[100:103], a[244:247], v[176:179], v[100:103]
    v_mfma_f32_16x16x32_bf16 v[104:107], a[248:251], v[176:179], v[104:107]
    v_mfma_f32_16x16x32_bf16 v[108:111], a[252:255], v[176:179], v[108:111]
    v_mfma_f32_16x16x32_bf16 v[96:99], v[192:195], v[176:179], v[96:99]
    v_mfma_f32_16x16x32_bf16 v[100:103], v[196:199], v[176:179], v[100:103]
    v_mfma_f32_16x16x32_bf16 v[104:107], v[200:203], v[176:179], v[104:107]
    v_mfma_f32_16x16x32_bf16 v[108:111], v[204:207], v[176:179], v[108:111]
    v_mfma_f32_16x16x32_bf16 v[96:99], v[208:211], v[176:179], v[96:99]
    v_mfma_f32_16x16x32_bf16 v[100:103], v[212:215], v[176:179], v[100:103]
    v_mfma_f32_16x16x32_bf16 v[104:107], v[216:219], v[176:179], v[104:107]
    v_mfma_f32_16x16x32_bf16 v[108:111], v[220:223], v[176:179], v[108:111]
    v_mfma_f32_16x16x32_bf16 v[96:99], v[224:227], v[176:179], v[96:99]
    v_mfma_f32_16x16x32_bf16 v[100:103], v[228:231], v[176:179], v[100:103]
    v_mfma_f32_16x16x32_bf16 v[104:107], v[232:235], v[176:179], v[104:107]
    v_mfma_f32_16x16x32_bf16 v[108:111], v[236:239], v[176:179], v[108:111]
    v_mfma_f32_16x16x32_bf16 v[96:99], v[240:243], v[176:179], v[96:99]
    v_mfma_f32_16x16x32_bf16 v[100:103], v[244:247], v[176:179], v[100:103]
    v_mfma_f32_16x16x32_bf16 v[104:107], v[248:251], v[176:179], v[104:107]
    v_mfma_f32_16x16x32_bf16 v[108:111], v[252:255], v[176:179], v[108:111]
    s_nop 6
    s_branch KV_C2
KV_C1:
    v_mfma_f32_16x16x32_bf16 v[96:99], v[176:179], a[0:3], 0
    v_mfma_f32_16x16x32_bf16 v[100:103], v[176:179], a[4:7], 0
    v_mfma_f32_16x16x32_bf16 v[104:107], v[176:179], a[8:11], 0
    v_mfma_f32_16x16x32_bf16 v[108:111], v[176:179], a[12:15], 0
    v_mfma_f32_16x16x32_bf16 v[96:99], v[176:179], a[16:19], v[96:99]
    v_mfma_f32_16x16x32_bf16 v[100:103], v[176:179], a[20:23], v[100:103]
    v_mfma_f32_16x16x32_bf16 v[104:107], v[176:179], a[24:27], v[104:107]
    v_mfma_f32_16x16x32_bf16 v[108:111], v[176:179], a[28:31], v[108:111]
    v_mfma_f32_16x16x32_bf16 v[96:99], v[176:179], a[32:35], v[96:99]
    v_mfma_f32_16x16x32_bf16 v[100:103], v[176:179], a[36:39], v[100:103]
    v_mfma_f32_16x16x32_bf16 v[104:107], v[176:179], a[40:43], v[104:107]
    v_mfma_f32_16x16x32_bf16 v[108:111], v[176:179], a[44:47], v[108:111]
    v_mfma_f32_16x16x32_bf16 v[96:99], v[176:179], a[48:51], v[96:99]
    v_mfma_f32_16x16x32_bf16 v[100:103], v[176:179], a[52:55], v[100:103]
    v_mfma_f32_16x16x32_bf16 v[104:107], v[176:179], a[56:59], v[104:107]
    v_mfma_f32_16x16x32_bf16 v[108:111], v[176:179], a[60:63], v[108:111]
    v_mfma_f32_16x16x32_bf16 v[96:99], v[176:179], a[64:67], v[96:99]
    v_mfma_f32_16x16x32_bf16 v[100:103], v[176:179], a[68:71], v[100:103]
    v_mfma_f32_16x16x32_bf16 v[104:107], v[176:179], a[72:75], v[104:107]
    v_mfma_f32_16x16x32_bf16 v[108:111], v[176:179], a[76:79], v[108:111]
    v_mfma_f32_16x16x32_bf16 v[96:99], v[176:179], a[80:83], v[96:99]
    v_mfma_f32_16x16x32_bf16 v[100:103], v[176:179], a[84:87], v[100:103]
    v_mfma_f32_16x16x32_bf16 v[104:107], v[176:179], a[88:91], v[104:107]
    v_mfma_f32_16x16x32_bf16 v[108:111], v[176:179], a[92:95], v[108:111]
    v_mfma_f32_16x16x32_bf16 v[96:99], v[176:179], a[96:99], v[96:99]
    v_mfma_f32_16x16x32_bf16 v[100:103], v[176:179], a[100:103], v[100:103]
    v_mfma_f32_16x16x32_bf16 v[104:107], v[176:179], a[104:107], v[104:107]
    v_mfma_f32_16x16x32_bf16 v[108:111], v[176:179], a[108:111], v[108:111]
    v_mfma_f32_16x16x32_bf16 v[96:99], v[176:179], a[112:115], v[96:99]
    v_mfma_f32_16x16x32_bf16 v[100:103], v[176:179], a[116:119], v[100:103]
    v_mfma_f32_16x16x32_bf16 v[104:107], v[176:179], a[120:123], v[104:107]
    v_mfma_f32_16x16x32_bf16 v[108:111], v[176:179], a[124:127], v[108:111]
    v_mfma_f32_16x16x32_bf16 v[96:99], v[176:179], a[128:131], v[96:99]
    v_mfma_f32_16x16x32_bf16 v[100:103], v[176:179], a[132:135], v[100:103]
    v_mfma_f32_16x16x32_bf16 v[104:107], v[176:179], a[136:139], v[104:107]
    v_mfma_f32_16x16x32_bf16 v[108:111], v[176:179], a[140:143], v[108:111]
    v_mfma_f32_16x16x32_bf16 v[96:99], v[176:179], a[144:147], v[96:99]
    v_mfma_f32_16x16x32_bf16 v[100:103], v[176:179], a[148:151], v[100:103]
    v_mfma_f32_16x16x32_bf16 v[104:107], v[176:179], a[152:155], v[104:107]
    v_mfma_f32_16x16x32_bf16 v[108:111], v[176:179], a[156:159], v[108:111]
    v_mfma_f32_16x16x32_bf16 v[96:99], v[176:179], a[160:163], v[96:99]
    v_mfma_f32_16x16x32_bf16 v[100:103], v[176:179], a[164:167], v[100:103]
    v_mfma_f32_16x16x32_bf16 v[104:107], v[176:179], a[168:171], v[104:107]
    v_mfma_f32_16x16x32_bf16 v[108:111], v[176:179], a[172:175], v[108:111]
    v_mfma_f32_16x16x32_bf16 v[96:99], v[176:179], a[176:179], v[96:99]
    v_mfma_f32_16x16x32_bf16 v[100:103], v[176:179], a[180:183], v[100:103]
    v_mfma_f32_16x16x32_bf16 v[104:107], v[176:179], a[184:187], v[104:107]
    v_mfma_f32_16x16x32_bf16 v[108:111], v[176:179], a[188:191], v[108:111]
    v_mfma_f32_16x16x32_bf16 v[96:99], v[176:179], a[192:195], v[96:99]
    v_mfma_f32_16x16x32_bf16 v[100:103], v[176:179], a[196:199], v[100:103]
    v_mfma_f32_16x16x32_bf16 v[104:107], v[176:179], a[200:203], v[104:107]
    v_mfma_f32_16x16x32_bf16 v[108:111], v[176:179], a[204:207], v[108:111]
    v_mfma_f32_16x16x32_bf16 v[96:99], v[176:179], a[208:211], v[96:99]
    v_mfma_f32_16x16x32_bf16 v[100:103], v[176:179], a[212:215], v[100:103]
    v_mfma_f32_16x16x32_bf16 v[104:107], v[176:179], a[216:219], v[104:107]
    v_mfma_f32_16x16x32_bf16 v[108:111], v[176:179], a[220:223], v[108:111]
    v_mfma_f32_16x16x32_bf16 v[96:99], v[176:179], a[224:227], v[96:99]
    v_mfma_f32_16x16x32_bf16 v[100:103], v[176:179], a[228:231], v[100:103]
    v_mfma_f32_16x16x32_bf16 v[104:107], v[176:179], a[232:235], v[104:107]
    v_mfma_f32_16x16x32_bf16 v[108:111], v[176:179], a[236:239], v[108:111]
    v_mfma_f32_16x16x32_bf16 v[96:99], v[176:179], a[240:243], v[96:99]
    v_mfma_f32_16x16x32_bf16 v[100:103], v[176:179], a[244:247], v[100:103]
    v_mfma_f32_16x16x32_bf16 v[104:107], v[176:179], a[248:251], v[104:107]
    v_mfma_f32_16x16x32_bf16 v[108:111], v[176:179], a[252:255], v[108:111]
    v_mfma_f32_16x16x32_bf16 v[96:99], v[176:179], v[192:195], v[96:99]
    v_mfma_f32_16x16x32_bf16 v[100:103], v[176:179], v[196:199], v[100:103]
    v_mfma_f32_16x16x32_bf16 v[104:107], v[176:179], v[200:203], v[104:107]
    v_mfma_f32_16x16x32_bf16 v[108:111], v[176:179], v[204:207], v[108:111]
    v_mfma_f32_16x16x32_bf16 v[96:99], v[176:179], v[208:211], v[96:99]
    v_mfma_f32_16x16x32_bf16 v[100:103], v[176:179], v[212:215], v[100:103]
    v_mfma_f32_16x16x32_bf16 v[104:107], v[176:179], v[216:219], v[104:107]
    v_mfma_f32_16x16x32_bf16 v[108:111], v[176:179], v[220:223], v[108:111]
    v_mfma_f32_16x16x32_bf16 v[96:99], v[176:179], v[224:227], v[96:99]
    v_mfma_f32_16x16x32_bf16 v[100:103], v[176:179], v[228:231], v[100:103]
    v_mfma_f32_16x16x32_bf16 v[104:107], v[176:179], v[232:235], v[104:107]
    v_mfma_f32_16x16x32_bf16 v[108:111], v[176:179], v[236:239], v[108:111]
    v_mfma_f32_16x16x32_bf16 v[96:99], v[176:179], v[240:243], v[96:99]
    v_mfma_f32_16x16x32_bf16 v[100:103], v[176:179], v[244:247], v[100:103]
    v_mfma_f32_16x16x32_bf16 v[104:107], v[176:179], v[248:251], v[104:107]
    v_mfma_f32_16x16x32_bf16 v[108:111], v[176:179], v[252:255], v[108:111]
KV_C2:
    s_mov_b32 s24, s8
    s_mov_b32 s25, s9
    s_mov_b32 s26, s10
    s_mov_b32 s27, s11
    v_mov_b32 v6, v1
    s_mov_b32 s35, 1024
    s_mul_i32 s3, s13, 10240
    v_add_u32 v6, s3, v6
    s_mov_b32 s39, 0
    s_mov_b32 s40, 40960
    s_barrier
KV_PAIR:
    s_mul_i32 s17, s14, 0x6000000
    s_add_u32 s17, s17, 0x1000000
    s_lshl_b32 s3, s14, 13
    s_add_u32 s36, s3, 20480
    s_lshl_b32 s59, s19, 8
    s_add_u32 s3, s3, s59
    s_add_u32 s38, s3, 69632
    s_mov_b32 s37, 3
    s_add_u32 s34, s17, 0x700000
    s_lshl_b32 s3, s19, 14
    s_lshl_b32 s59, s64, 13
    s_add_u32 s3, s3, s59
    s_add_u32 s3, s3, s17
    s_add_u32 s45, s3, 0x1000000
    s_mov_b32 s32, s42
    s_mov_b32 s41, 0
KV_SEG:
    s_cmp_ge_u32 s32, 64
    s_cbranch_scc1 KV_NEXTP
    s_cmp_lg_u32 s41, 0
    s_cbranch_scc1 KV_GO
    s_lshl_b32 s49, s32, 7
    s_add_u32 s49, s49, s36
    v_mov_b32 v8, 0
POLL_31:
    buffer_load_dword v9, v8, s[8:11], s49 offen sc1
    s_waitcnt vmcnt(0)
    v_readfirstlane_b32 s58, v9
    s_nop 0
    s_cmp_ge_u32 s58, s37
    s_nop 1
    s_cbranch_scc1 POLLD_32
    s_add_u32 s99, s99, 1
    s_cmp_ge_u32 s99, 0x80000
    s_cbranch_scc1 POLLD_32
    s_sleep 1
    s_branch POLL_31
POLLD_32:
    s_mov_b32 s58, s32
    s_mul_i32 s3, s58, 40960
    s_add_u32 s3, s3, s34
    s_mul_i32 s59, s13, 10240
    s_add_u32 s59, s59, s39
    s_mov_b32 m0, s59
    s_add_u32 s59, s59, 1024
    buffer_load_dwordx4 v6, s[24:27], s3 offen sc1 lds
    s_add_u32 s3, s3, s35
    s_mov_b32 m0, s59
    s_add_u32 s59, s59, 1024
    buffer_load_dwordx4 v6, s[24:27], s3 offen sc1 lds
    s_add_u32 s3, s3, s35
    s_mov_b32 m0, s59
    s_add_u32 s59, s59, 1024
    buffer_load_dwordx4 v6, s[24:27], s3 offen sc1 lds
    s_add_u32 s3, s3, s35
    s_mov_b32 m0, s59
    s_add_u32 s59, s59, 1024
    buffer_load_dwordx4 v6, s[24:27], s3 offen sc1 lds
    s_add_u32 s3, s3, s35
    s_mov_b32 m0, s59
    s_add_u32 s59, s59, 1024
    buffer_load_dwordx4 v6, s[24:27], s3 offen sc1 lds
    s_add_u32 s3, s3, s35
    s_mov_b32 m0, s59
    s_add_u32 s59, s59, 1024
    buffer_load_dwordx4 v6, s[24:27], s3 offen sc1 lds
    s_add_u32 s3, s3, s35
    s_mov_b32 m0, s59
    s_add_u32 s59, s59, 1024
    buffer_load_dwordx4 v6, s[24:27], s3 offen sc1 lds
    s_add_u32 s3, s3, s35
    s_mov_b32 m0, s59
    s_add_u32 s59, s59, 1024
    buffer_load_dwordx4 v6, s[24:27], s3 offen sc1 lds
    s_add_u32 s3, s3, s35
    s_mov_b32 m0, s59
    s_add_u32 s59, s59, 1024
    buffer_load_dwordx4 v6, s[24:27], s3 offen sc1 lds
    s_add_u32 s3, s3, s35
    s_mov_b32 m0, s59
    s_add_u32 s59, s59, 1024
    buffer_load_dwordx4 v6, s[24:27], s3 offen sc1 lds
    s_add_u32 s3, s3, s35
    s_waitcnt vmcnt(0)
KV_GO:
    s_barrier
    s_cmp_eq_u32 s46, 1
    s_cbranch_scc1 KV_V1
KV_V0:
    s_add_u32 s58, s32, s33
    s_min_u32 s3, s58, 63
    s_lshl_b32 s3, s3, 7
    s_add_u32 s3, s3, s36
    v_mov_b32 v8, 0
    buffer_load_dword v9, v8, s[8:11], s3 offen sc1
    ds_read_b128 v[64:67], v2 offset:0
    ds_read_b128 v[68:71], v2 offset:20480
    ds_read_b128 v[72:75], v2 offset:1024
    ds_read_b128 v[76:79], v2 offset:21504
    ds_read_b128 v[80:83], v2 offset:2048
    ds_read_b128 v[84:87], v2 offset:22528
    ds_read_b128 v[88:91], v2 offset:3072
    s_waitcnt lgkmcnt(6)
    v_mfma_f32_16x16x32_bf16 v[128:131], a[0:3], v[64:67], 0
    v_mfma_f32_16x16x32_bf16 v[132:135], a[4:7], v[64:67], 0
    v_mfma_f32_16x16x32_bf16 v[136:139], a[8:11], v[64:67], 0
    v_mfma_f32_16x16x32_bf16 v[140:143], a[12:15], v[64:67], 0
    v_mfma_f32_16x16x32_bf16 v[160:163], v[176:179], v[64:67], 0
    v_mfma_f32_16x16x32_bf16 v[168:171], v[64:67], v[64:67], 0
    ds_read_b128 v[92:95], v2 offset:23552
    s_waitcnt lgkmcnt(6)
    v_mfma_f32_16x16x32_bf16 v[144:147], a[0:3], v[68:71], 0
    v_mfma_f32_16x16x32_bf16 v[148:151], a[4:7], v[68:71], 0
    v_mfma_f32_16x16x32_bf16 v[152:155], a[8:11], v[68:71], 0
    v_mfma_f32_16x16x32_bf16 v[156:159], a[12:15], v[68:71], 0
    v_mfma_f32_16x16x32_bf16 v[164:167], v[176:179], v[68:71], 0
    v_mfma_f32_16x16x32_bf16 v[172:175], v[68:71], v[68:71], 0
    ds_read_b128 v[64:67], v2 offset:4096
    s_waitcnt lgkmcnt(6)
    v_mfma_f32_16x16x32_bf16 v[128:131], a[16:19], v[72:75], v[128:131]
    v_mfma_f32_16x16x32_bf16 v[132:135], a[20:23], v[72:75], v[132:135]
    v_mfma_f32_16x16x32_bf16 v[136:139], a[24:27], v[72:75], v[136:139]
    v_mfma_f32_16x16x32_bf16 v[140:143], a[28:31], v[72:75], v[140:143]
    v_mfma_f32_16x16x32_bf16 v[160:163], v[176:179], v[72:75], v[160:163]
    v_mfma_f32_16x16x32_bf16 v[168:171], v[72:75], v[72:75], v[168:171]
    ds_read_b128 v[68:71], v2 offset:24576
    s_waitcnt lgkmcnt(6)
    v_mfma_f32_16x16x32_bf16 v[144:147], a[16:19], v[76:79], v[144:147]
    v_mfma_f32_16x16x32_bf16 v[148:151], a[20:23], v[76:79], v[148:151]
    v_mfma_f32_16x16x32_bf16 v[152:155], a[24:27], v[76:79], v[152:155]
    v_mfma_f32_16x16x32_bf16 v[156:159], a[28:31], v[76:79], v[156:159]
    v_mfma_f32_16x16x32_bf16 v[164:167], v[176:179], v[76:79], v[164:167]
    v_mfma_f32_16x16x32_bf16 v[172:175], v[76:79], v[76:79], v[172:175]
    ds_read_b128 v[72:75], v3 offset:0
    s_waitcnt lgkmcnt(6)
    v_mfma_f32_16x16x32_bf16 v[128:131], a[32:35], v[80:83], v[128:131]
    v_mfma_f32_16x16x32_bf16 v[132:135], a[36:39], v[80:83], v[132:135]
    v_mfma_f32_16x16x32_bf16 v[136:139], a[40:43], v[80:83], v[136:139]
    v_mfma_f32_16x16x32_bf16 v[140:143], a[44:47], v[80:83], v[140:143]
    v_mfma_f32_16x16x32_bf16 v[160:163], v[176:179], v[80:83], v[160:163]
    v_mfma_f32_16x16x32_bf16 v[168:171], v[80:83], v[80:83], v[168:171]
    ds_read_b128 v[76:79], v3 offset:20480
    s_waitcnt lgkmcnt(6)
    v_mfma_f32_16x16x32_bf16 v[144:147], a[32:35], v[84:87], v[144:147]
    v_mfma_f32_16x16x32_bf16 v[148:151], a[36:39], v[84:87], v[148:151]
    v_mfma_f32_16x16x32_bf16 v[152:155], a[40:43], v[84:87], v[152:155]
    v_mfma_f32_16x16x32_bf16 v[156:159], a[44:47], v[84:87], v[156:159]
    v_mfma_f32_16x16x32_bf16 v[164:167], v[176:179], v[84:87], v[164:167]
    v_mfma_f32_16x16x32_bf16 v[172:175], v[84:87], v[84:87], v[172:175]
    ds_read_b128 v[80:83], v3 offset:1024
    s_waitcnt lgkmcnt(6)
    v_mfma_f32_16x16x32_bf16 v[128:131], a[48:51], v[88:91], v[128:131]
    v_mfma_f32_16x16x32_bf16 v[132:135], a[52:55], v[88:91], v[132:135]
    v_mfma_f32_16x16x32_bf16 v[136:139], a[56:59], v[88:91], v[136:139]
    v_mfma_f32_16x16x32_bf16 v[140:143], a[60:63], v[88:91], v[140:143]
    v_mfma_f32_16x16x32_bf16 v[160:163], v[176:179], v[88:91], v[160:163]
    v_mfma_f32_16x16x32_bf16 v[168:171], v[88:91], v[88:91], v[168:171]
    ds_read_b128 v[84:87], v3 offset:21504
    s_waitcnt lgkmcnt(6)
    v_mfma_f32_16x16x32_bf16 v[144:147], a[48:51], v[92:95], v[144:147]
    v_mfma_f32_16x16x32_bf16 v[148:151], a[52:55], v[92:95], v[148:151]
    v_mfma_f32_16x16x32_bf16 v[152:155], a[56:59], v[92:95], v[152:155]
    v_mfma_f32_16x16x32_bf16 v[156:159], a[60:63], v[92:95], v[156:159]
    v_mfma_f32_16x16x32_bf16 v[164:167], v[176:179], v[92:95], v[164:167]
    v_mfma_f32_16x16x32_bf16 v[172:175], v[92:95], v[92:95], v[172:175]
    ds_read_b128 v[88:91], v3 offset:2048
    s_waitcnt lgkmcnt(6)
    v_mfma_f32_16x16x32_bf16 v[128:131], a[64:67], v[64:67], v[128:131]
    v_mfma_f32_16x16x32_bf16 v[132:135], a[68:71], v[64:67], v[132:135]
    v_mfma_f32_16x16x32_bf16 v[136:139], a[72:75], v[64:67], v[136:139]
    v_mfma_f32_16x16x32_bf16 v[140:143], a[76:79], v[64:67], v[140:143]
    v_mfma_f32_16x16x32_bf16 v[160:163], v[176:179], v[64:67], v[160:163]
    v_mfma_f32_16x16x32_bf16 v[168:171], v[64:67], v[64:67], v[168:171]
    ds_read_b128 v[92:95], v3 offset:22528
    s_waitcnt lgkmcnt(6)
    v_mfma_f32_16x16x32_bf16 v[144:147], a[64:67], v[68:71], v[144:147]
    v_mfma_f32_16x16x32_bf16 v[148:151], a[68:71], v[68:71], v[148:151]
    v_mfma_f32_16x16x32_bf16 v[152:155], a[72:75], v[68:71], v[152:155]
    v_mfma_f32_16x16x32_bf16 v[156:159], a[76:79], v[68:71], v[156:159]
    v_mfma_f32_16x16x32_bf16 v[164:167], v[176:179], v[68:71], v[164:167]
    v_mfma_f32_16x16x32_bf16 v[172:175], v[68:71], v[68:71], v[172:175]
    ds_read_b128 v[64:67], v3 offset:3072
    s_waitcnt lgkmcnt(6)
    v_mfma_f32_16x16x32_bf16 v[128:131], a[80:83], v[72:75], v[128:131]
    v_mfma_f32_16x16x32_bf16 v[132:135], a[84:87], v[72:75], v[132:135]
    v_mfma_f32_16x16x32_bf16 v[136:139], a[88:91], v[72:75], v[136:139]
    v_mfma_f32_16x16x32_bf16 v[140:143], a[92:95], v[72:75], v[140:143]
    ds_read_b128 v[68:71], v3 offset:23552
    s_waitcnt lgkmcnt(6)
    v_mfma_f32_16x16x32_bf16 v[144:147], a[80:83], v[76:79], v[144:147]
    v_mfma_f32_16x16x32_bf16 v[148:151], a[84:87], v[76:79], v[148:151]
    v_mfma_f32_16x16x32_bf16 v[152:155], a[88:91], v[76:79], v[152:155]
    v_mfma_f32_16x16x32_bf16 v[156:159], a[92:95], v[76:79], v[156:159]
    ds_read_b128 v[72:75], v3 offset:4096
    s_waitcnt lgkmcnt(6)
    v_mfma_f32_16x16x32_bf16 v[128:131], a[96:99], v[80:83], v[128:131]
    v_mfma_f32_16x16x32_bf16 v[132:135], a[100:103], v[80:83], v[132:135]
    v_mfma_f32_16x16x32_bf16 v[136:139], a[104:107], v[80:83], v[136:139]
    v_mfma_f32_16x16x32_bf16 v[140:143], a[108:111], v[80:83], v[140:143]
    ds_read_b128 v[76:79], v3 offset:24576
    s_waitcnt lgkmcnt(6)
    v_mfma_f32_16x16x32_bf16 v[144:147], a[96:99], v[84:87], v[144:147]
    v_mfma_f32_16x16x32_bf16 v[148:151], a[100:103], v[84:87], v[148:151]
    v_mfma_f32_16x16x32_bf16 v[152:155], a[104:107], v[84:87], v[152:155]
    v_mfma_f32_16x16x32_bf16 v[156:159], a[108:111], v[84:87], v[156:159]
    ds_read_b128 v[80:83], v4 offset:0
    s_waitcnt lgkmcnt(6)
    v_mfma_f32_16x16x32_bf16 v[128:131], a[112:115], v[88:91], v[128:131]
    v_mfma_f32_16x16x32_bf16 v[132:135], a[116:119], v[88:91], v[132:135]
    v_mfma_f32_16x16x32_bf16 v[136:139], a[120:123], v[88:91], v[136:139]
    v_mfma_f32_16x16x32_bf16 v[140:143], a[124:127], v[88:91], v[140:143]
    ds_read_b128 v[84:87], v4 offset:20480
    s_waitcnt lgkmcnt(6)
    v_mfma_f32_16x16x32_bf16 v[144:147], a[112:115], v[92:95], v[144:147]
    v_mfma_f32_16x16x32_bf16 v[148:151], a[116:119], v[92:95], v[148:151]
    v_mfma_f32_16x16x32_bf16 v[152:155], a[120:123], v[92:95], v[152:155]
    v_mfma_f32_16x16x32_bf16 v[156:159], a[124:127], v[92:95], v[156:159]
    ds_read_b128 v[88:91], v4 offset:1024
    s_waitcnt lgkmcnt(6)
    v_mfma_f32_16x16x32_bf16 v[128:131], a[128:131], v[64:67], v[128:131]
    v_mfma_f32_16x16x32_bf16 v[132:135], a[132:135], v[64:67], v[132:135]
    v_mfma_f32_16x16x32_bf16 v[136:139], a[136:139], v[64:67], v[136:139]
    v_mfma_f32_16x16x32_bf16 v[140:143], a[140:143], v[64:67], v[140:143]
    ds_read_b128 v[92:95], v4 offset:21504
    s_waitcnt lgkmcnt(6)
    v_mfma_f32_16x16x32_bf16 v[144:147], a[128:131], v[68:71], v[144:147]
    v_mfma_f32_16x16x32_bf16 v[148:151], a[132:135], v[68:71], v[148:151]
    v_mfma_f32_16x16x32_bf16 v[152:155], a[136:139], v[68:71], v[152:155]
    v_mfma_f32_16x16x32_bf16 v[156:159], a[140:143], v[68:71], v[156:159]
    ds_read_b128 v[64:67], v4 offset:2048
    s_waitcnt lgkmcnt(6)
    v_mfma_f32_16x16x32_bf16 v[128:131], a[144:147], v[72:75], v[128:131]
    v_mfma_f32_16x16x32_bf16 v[132:135], a[148:151], v[72:75], v[132:135]
    v_mfma_f32_16x16x32_bf16 v[136:139], a[152:155], v[72:75], v[136:139]
    v_mfma_f32_16x16x32_bf16 v[140:143], a[156:159], v[72:75], v[140:143]
    ds_read_b128 v[68:71], v4 offset:22528
    s_waitcnt lgkmcnt(6)
    v_mfma_f32_16x16x32_bf16 v[144:147], a[144:147], v[76:79], v[144:147]
    v_mfma_f32_16x16x32_bf16 v[148:151], a[148:151], v[76:79], v[148:151]
    v_mfma_f32_16x16x32_bf16 v[152:155], a[152:155], v[76:79], v[152:155]
    v_mfma_f32_16x16x32_bf16 v[156:159], a[156:159], v[76:79], v[156:159]
    s_waitcnt vmcnt(0)
    v_readfirstlane_b32 s3, v9
    s_nop 0
    s_mov_b32 s41, 0
    s_cmp_ge_u32 s58, 64
    s_cbranch_scc1 NPF_33
    s_cmp_lt_u32 s3, s37
    s_cbranch_scc1 NPF_33
    s_add_u32 s49, s39, s40
    s_mov_b32 s41, 1
    s_mul_i32 s3, s58, 40960
    s_add_u32 s3, s3, s34
    s_mul_i32 s59, s13, 10240
    s_add_u32 s59, s59, s49
    s_mov_b32 m0, s59
    s_add_u32 s59, s59, 1024
    buffer_load_dwordx4 v6, s[24:27], s3 offen sc1 lds
    s_add_u32 s3, s3, s35
    s_mov_b32 m0, s59
    s_add_u32 s59, s59, 1024
    buffer_load_dwordx4 v6, s[24:27], s3 offen sc1 lds
    s_add_u32 s3, s3, s35
    s_mov_b32 m0, s59
    s_add_u32 s59, s59, 1024
    buffer_load_dwordx4 v6, s[24:27], s3 offen sc1 lds
    s_add_u32 s3, s3, s35
    s_mov_b32 m0, s59
    s_add_u32 s59, s59, 1024
    buffer_load_dwordx4 v6, s[24:27], s3 offen sc1 lds
    s_add_u32 s3, s3, s35
    s_mov_b32 m0, s59
    s_add_u32 s59, s59, 1024
    buffer_load_dwordx4 v6, s[24:27], s3 offen sc1 lds
    s_add_u32 s3, s3, s35
    s_mov_b32 m0, s59
    s_add_u32 s59, s59, 1024
    buffer_load_dwordx4 v6, s[24:27], s3 offen sc1 lds
    s_add_u32 s3, s3, s35
    s_mov_b32 m0, s59
    s_add_u32 s59, s59, 1024
    buffer_load_dwordx4 v6, s[24:27], s3 offen sc1 lds
    s_add_u32 s3, s3, s35
    s_mov_b32 m0, s59
    s_add_u32 s59, s59, 1024
    buffer_load_dwordx4 v6, s[24:27], s3 offen sc1 lds
    s_add_u32 s3, s3, s35
    s_mov_b32 m0, s59
    s_add_u32 s59, s59, 1024
    buffer_load_dwordx4 v6, s[24:27], s3 offen sc1 lds
    s_add_u32 s3, s3, s35
    s_mov_b32 m0, s59
    s_add_u32 s59, s59, 1024
    buffer_load_dwordx4 v6, s[24:27], s3 offen sc1 lds
    s_add_u32 s3, s3, s35
NPF_33:
    ds_read_b128 v[72:75], v4 offset:3072
    s_waitcnt lgkmcnt(6)
    v_mfma_f32_16x16x32_bf16 v[128:131], a[160:163], v[80:83], v[128:131]
    v_mfma_f32_16x16x32_bf16 v[132:135], a[164:167], v[80:83], v[132:135]
    v_mfma_f32_16x16x32_bf16 v[136:139], a[168:171], v[80:83], v[136:139]
    v_mfma_f32_16x16x32_bf16 v[140:143], a[172:175], v[80:83], v[140:143]
    ds_read_b128 v[76:79], v4 offset:23552
    s_waitcnt lgkmcnt(6)
    v_mfma_f32_16x16x32_bf16 v[144:147], a[160:163], v[84:87], v[144:147]
    v_mfma_f32_16x16x32_bf16 v[148:151], a[164:167], v[84:87], v[148:151]
    v_mfma_f32_16x16x32_bf16 v[152:155], a[168:171], v[84:87], v[152:155]
    v_mfma_f32_16x16x32_bf16 v[156:159], a[172:175], v[84:87], v[156:159]
    ds_read_b128 v[80:83], v4 offset:4096
    s_waitcnt lgkmcnt(6)
    v_mfma_f32_16x16x32_bf16 v[128:131], a[176:179], v[88:91], v[128:131]
    v_mfma_f32_16x16x32_bf16 v[132:135], a[180:183], v[88:91], v[132:135]
    v_mfma_f32_16x16x32_bf16 v[136:139], a[184:187], v[88:91], v[136:139]
    v_mfma_f32_16x16x32_bf16 v[140:143], a[188:191], v[88:91], v[140:143]
    ds_read_b128 v[84:87], v4 offset:24576
    s_waitcnt lgkmcnt(6)
    v_mfma_f32_16x16x32_bf16 v[144:147], a[176:179], v[92:95], v[144:147]
    v_mfma_f32_16x16x32_bf16 v[148:151], a[180:183], v[92:95], v[148:151]
    v_mfma_f32_16x16x32_bf16 v[152:155], a[184:187], v[92:95], v[152:155]
    v_mfma_f32_16x16x32_bf16 v[156:159], a[188:191], v[92:95], v[156:159]
    ds_read_b128 v[88:91], v5 offset:0
    s_waitcnt lgkmcnt(6)
    v_mfma_f32_16x16x32_bf16 v[128:131], a[192:195], v[64:67], v[128:131]
    v_mfma_f32_16x16x32_bf16 v[132:135], a[196:199], v[64:67], v[132:135]
    v_mfma_f32_16x16x32_bf16 v[136:139], a[200:203], v[64:67], v[136:139]
    v_mfma_f32_16x16x32_bf16 v[140:143], a[204:207], v[64:67], v[140:143]
    ds_read_b128 v[92:95], v5 offset:20480
    s_waitcnt lgkmcnt(6)
    v_mfma_f32_16x16x32_bf16 v[144:147], a[192:195], v[68:71], v[144:147]
    v_mfma_f32_16x16x32_bf16 v[148:151], a[196:199], v[68:71], v[148:151]
    v_mfma_f32_16x16x32_bf16 v[152:155], a[200:203], v[68:71], v[152:155]
    v_mfma_f32_16x16x32_bf16 v[156:159], a[204:207], v[68:71], v[156:159]
    ds_read_b128 v[64:67], v5 offset:1024
    s_waitcnt lgkmcnt(6)
    v_mfma_f32_16x16x32_bf16 v[128:131], a[208:211], v[72:75], v[128:131]
    v_mfma_f32_16x16x32_bf16 v[132:135], a[212:215], v[72:75], v[132:135]
    v_mfma_f32_16x16x32_bf16 v[136:139], a[216:219], v[72:75], v[136:139]
    v_mfma_f32_16x16x32_bf16 v[140:143], a[220:223], v[72:75], v[140:143]
    ds_read_b128 v[68:71], v5 offset:21504
    s_waitcnt lgkmcnt(6)
    v_mfma_f32_16x16x32_bf16 v[144:147], a[208:211], v[76:79], v[144:147]
    v_mfma_f32_16x16x32_bf16 v[148:151], a[212:215], v[76:79], v[148:151]
    v_mfma_f32_16x16x32_bf16 v[152:155], a[216:219], v[76:79], v[152:155]
    v_mfma_f32_16x16x32_bf16 v[156:159], a[220:223], v[76:79], v[156:159]
    ds_read_b128 v[72:75], v5 offset:2048
    s_waitcnt lgkmcnt(6)
    v_mfma_f32_16x16x32_bf16 v[128:131], a[224:227], v[80:83], v[128:131]
    v_mfma_f32_16x16x32_bf16 v[132:135], a[228:231], v[80:83], v[132:135]
    v_mfma_f32_16x16x32_bf16 v[136:139], a[232:235], v[80:83], v[136:139]
    v_mfma_f32_16x16x32_bf16 v[140:143], a[236:239], v[80:83], v[140:143]
    ds_read_b128 v[76:79], v5 offset:22528
    s_waitcnt lgkmcnt(6)
    v_mfma_f32_16x16x32_bf16 v[144:147], a[224:227], v[84:87], v[144:147]
    v_mfma_f32_16x16x32_bf16 v[148:151], a[228:231], v[84:87], v[148:151]
    v_mfma_f32_16x16x32_bf16 v[152:155], a[232:235], v[84:87], v[152:155]
    v_mfma_f32_16x16x32_bf16 v[156:159], a[236:239], v[84:87], v[156:159]
    ds_read_b128 v[80:83], v5 offset:3072
    s_waitcnt lgkmcnt(6)
    v_mfma_f32_16x16x32_bf16 v[128:131], a[240:243], v[88:91], v[128:131]
    v_mfma_f32_16x16x32_bf16 v[132:135], a[244:247], v[88:91], v[132:135]
    v_mfma_f32_16x16x32_bf16 v[136:139], a[248:251], v[88:91], v[136:139]
    v_mfma_f32_16x16x32_bf16 v[140:143], a[252:255], v[88:91], v[140:143]
    ds_read_b128 v[84:87], v5 offset:23552
    s_waitcnt lgkmcnt(6)
    v_mfma_f32_16x16x32_bf16 v[144:147], a[240:243], v[92:95], v[144:147]
    v_mfma_f32_16x16x32_bf16 v[148:151], a[244:247], v[92:95], v[148:151]
    v_mfma_f32_16x16x32_bf16 v[152:155], a[248:251], v[92:95], v[152:155]
    v_mfma_f32_16x16x32_bf16 v[156:159], a[252:255], v[92:95], v[156:159]
    ds_read_b128 v[88:91], v5 offset:4096
    s_waitcnt lgkmcnt(6)
    v_mfma_f32_16x16x32_bf16 v[128:131], v[192:195], v[64:67], v[128:131]
    v_mfma_f32_16x16x32_bf16 v[132:135], v[196:199], v[64:67], v[132:135]
    v_mfma_f32_16x16x32_bf16 v[136:139], v[200:203], v[64:67], v[136:139]
    v_mfma_f32_16x16x32_bf16 v[140:143], v[204:207], v[64:67], v[140:143]
    ds_read_b128 v[92:95], v5 offset:24576
    s_waitcnt lgkmcnt(6)
    v_mfma_f32_16x16x32_bf16 v[144:147], v[192:195], v[68:71], v[144:147]
    v_mfma_f32_16x16x32_bf16 v[148:151], v[196:199], v[68:71], v[148:151]
    v_mfma_f32_16x16x32_bf16 v[152:155], v[200:203], v[68:71], v[152:155]
    v_mfma_f32_16x16x32_bf16 v[156:159], v[204:207], v[68:71], v[156:159]
    s_waitcnt lgkmcnt(5)
    v_mfma_f32_16x16x32_bf16 v[128:131], v[208:211], v[72:75], v[128:131]
    v_mfma_f32_16x16x32_bf16 v[132:135], v[212:215], v[72:75], v[132:135]
    v_mfma_f32_16x16x32_bf16 v[136:139], v[216:219], v[72:75], v[136:139]
    v_mfma_f32_16x16x32_bf16 v[140:143], v[220:223], v[72:75], v[140:143]
    s_waitcnt lgkmcnt(4)
    v_mfma_f32_16x16x32_bf16 v[144:147], v[208:211], v[76:79], v[144:147]
    v_mfma_f32_16x16x32_bf16 v[148:151], v[212:215], v[76:79], v[148:151]
    v_mfma_f32_16x16x32_bf16 v[152:155], v[216:219], v[76:79], v[152:155]
    v_mfma_f32_16x16x32_bf16 v[156:159], v[220:223], v[76:79], v[156:159]
    s_waitcnt lgkmcnt(3)
    v_mfma_f32_16x16x32_bf16 v[128:131], v[224:227], v[80:83], v[128:131]
    v_mfma_f32_16x16x32_bf16 v[132:135], v[228:231], v[80:83], v[132:135]
    v_mfma_f32_16x16x32_bf16 v[136:139], v[232:235], v[80:83], v[136:139]
    v_mfma_f32_16x16x32_bf16 v[140:143], v[236:239], v[80:83], v[140:143]
    s_waitcnt lgkmcnt(2)
    v_mfma_f32_16x16x32_bf16 v[144:147], v[224:227], v[84:87], v[144:147]
    v_mfma_f32_16x16x32_bf16 v[148:151], v[228:231], v[84:87], v[148:151]
    v_mfma_f32_16x16x32_bf16 v[152:155], v[232:235], v[84:87], v[152:155]
    v_mfma_f32_16x16x32_bf16 v[156:159], v[236:239], v[84:87], v[156:159]
    s_waitcnt lgkmcnt(1)
    v_mfma_f32_16x16x32_bf16 v[128:131], v[240:243], v[88:91], v[128:131]
    v_mfma_f32_16x16x32_bf16 v[132:135], v[244:247], v[88:91], v[132:135]
    v_mfma_f32_16x16x32_bf16 v[136:139], v[248:251], v[88:91], v[136:139]
    v_mfma_f32_16x16x32_bf16 v[140:143], v[252:255], v[88:91], v[140:143]
    s_waitcnt lgkmcnt(0)
    v_mfma_f32_16x16x32_bf16 v[144:147], v[240:243], v[92:95], v[144:147]
    v_mfma_f32_16x16x32_bf16 v[148:151], v[244:247], v[92:95], v[148:151]
    v_mfma_f32_16x16x32_bf16 v[152:155], v[248:251], v[92:95], v[152:155]
    v_mfma_f32_16x16x32_bf16 v[156:159], v[252:255], v[92:95], v[156:159]
    v_cndmask_b32 v168, v168, v169, s[50:51]
    v_cndmask_b32 v168, v168, v170, s[52:53]
    v_cndmask_b32 v168, v168, v171, s[54:55]
    v_mov_b32 v161, v168
    v_cndmask_b32 v172, v172, v173, s[50:51]
    v_cndmask_b32 v172, v172, v174, s[52:53]
    v_cndmask_b32 v172, v172, v175, s[54:55]
    v_mov_b32 v165, v172
    s_mov_b64 exec, s[56:57]
    ds_write_b64 v10, v[160:161] offset:0
    ds_write_b64 v10, v[164:165] offset:128
    s_mov_b64 exec, -1
    s_waitcnt lgkmcnt(0)
    s_barrier
    ds_read_b64 v[20:21], v11 offset:0
    ds_read_b64 v[22:23], v11 offset:256
    ds_read_b64 v[24:25], v11 offset:512
    ds_read_b64 v[26:27], v11 offset:768
    ds_read_b64 v[28:29], v11 offset:128
    ds_read_b64 v[30:31], v11 offset:384
    ds_read_b64 v[32:33], v11 offset:640
    ds_read_b64 v[34:35], v11 offset:896
    s_waitcnt lgkmcnt(0)
    v_pk_add_f32 v[20:21], v[20:21], v[22:23]
    v_pk_add_f32 v[24:25], v[24:25], v[26:27]
    v_pk_add_f32 v[20:21], v[20:21], v[24:25]
    v_mul_f32 v20, 0x3acccccd, v20
    v_mul_f32 v21, 0x3acccccd, v21
    v_fma_f32 v21, -v20, v20, v21
    v_max_f32 v21, 0, v21
    v_cvt_pk_bf16_f32 v16, v20, v20
    v_lshlrev_b32 v16, 16, v16
    v_cvt_pk_bf16_f32 v21, v21, v21
    v_lshlrev_b32 v21, 16, v21
    v_add_f32 v21, 0x3727c5ac, v21
    v_cvt_pk_bf16_f32 v21, v21, v21
    v_lshlrev_b32 v21, 16, v21
    v_sqrt_f32 v21, v21
    s_nop 0
    v_cvt_pk_bf16_f32 v21, v21, v21
    v_lshlrev_b32 v21, 16, v21
    v_rcp_f32 v18, v21
    s_nop 0
    v_mul_f32 v18, 0x3e0293ee, v18
    v_pk_add_f32 v[28:29], v[28:29], v[30:31]
    v_pk_add_f32 v[32:33], v[32:33], v[34:35]
    v_pk_add_f32 v[28:29], v[28:29], v[32:33]
    v_mul_f32 v28, 0x3acccccd, v28
    v_mul_f32 v29, 0x3acccccd, v29
    v_fma_f32 v29, -v28, v28, v29
    v_max_f32 v29, 0, v29
    v_cvt_pk_bf16_f32 v17, v28, v28
    v_lshlrev_b32 v17, 16, v17
    v_cvt_pk_bf16_f32 v29, v29, v29
    v_lshlrev_b32 v29, 16, v29
    v_add_f32 v29, 0x3727c5ac, v29
    v_cvt_pk_bf16_f32 v29, v29, v29
    v_lshlrev_b32 v29, 16, v29
    v_sqrt_f32 v29, v29
    s_nop 0
    v_cvt_pk_bf16_f32 v29, v29, v29
    v_lshlrev_b32 v29, 16, v29
    v_rcp_f32 v19, v29
    s_nop 0
    v_mul_f32 v19, 0x3e0293ee, v19
    v_fma_f32 v128, -v16, v96, v128
    v_mul_f32 v128, v128, v18
    v_fma_f32 v129, -v16, v97, v129
    v_mul_f32 v129, v129, v18
    v_fma_f32 v130, -v16, v98, v130
    v_mul_f32 v130, v130, v18
    v_fma_f32 v131, -v16, v99, v131
    v_mul_f32 v131, v131, v18
    v_fma_f32 v132, -v16, v100, v132
    v_mul_f32 v132, v132, v18
    v_fma_f32 v133, -v16, v101, v133
    v_mul_f32 v133, v133, v18
    v_fma_f32 v134, -v16, v102, v134
    v_mul_f32 v134, v134, v18
    v_fma_f32 v135, -v16, v103, v135
    v_mul_f32 v135, v135, v18
    v_fma_f32 v136, -v16, v104, v136
    v_mul_f32 v136, v136, v18
    v_fma_f32 v137, -v16, v105, v137
    v_mul_f32 v137, v137, v18
    v_fma_f32 v138, -v16, v106, v138
    v_mul_f32 v138, v138, v18
    v_fma_f32 v139, -v16, v107, v139
    v_mul_f32 v139, v139, v18
    v_fma_f32 v140, -v16, v108, v140
    v_mul_f32 v140, v140, v18
    v_fma_f32 v141, -v16, v109, v141
    v_mul_f32 v141, v141, v18
    v_fma_f32 v142, -v16, v110, v142
    v_mul_f32 v142, v142, v18
    v_fma_f32 v143, -v16, v111, v143
    v_mul_f32 v143, v143, v18
    v_fma_f32 v144, -v17, v96, v144
    v_mul_f32 v144, v144, v19
    v_fma_f32 v145, -v17, v97, v145
    v_mul_f32 v145, v145, v19
    v_fma_f32 v146, -v17, v98, v146
    v_mul_f32 v146, v146, v19
    v_fma_f32 v147, -v17, v99, v147
    v_mul_f32 v147, v147, v19
    v_fma_f32 v148, -v17, v100, v148
    v_mul_f32 v148, v148, v19
    v_fma_f32 v149, -v17, v101, v149
    v_mul_f32 v149, v149, v19
    v_fma_f32 v150, -v17, v102, v150
    v_mul_f32 v150, v150, v19
    v_fma_f32 v151, -v17, v103, v151
    v_mul_f32 v151, v151, v19
    v_fma_f32 v152, -v17, v104, v152
    v_mul_f32 v152, v152, v19
    v_fma_f32 v153, -v17, v105, v153
    v_mul_f32 v153, v153, v19
    v_fma_f32 v154, -v17, v106, v154
    v_mul_f32 v154, v154, v19
    v_fma_f32 v155, -v17, v107, v155
    v_mul_f32 v155, v155, v19
    v_fma_f32 v156, -v17, v108, v156
    v_mul_f32 v156, v156, v19
    v_fma_f32 v157, -v17, v109, v157
    v_mul_f32 v157, v157, v19
    v_fma_f32 v158, -v17, v110, v158
    v_mul_f32 v158, v158, v19
    v_fma_f32 v159, -v17, v111, v159
    v_mul_f32 v159, v159, v19
    s_lshl_b32 s49, s32, 19
    s_add_u32 s49, s49, s45
    s_add_u32 s59, s49, 4096
    v_cvt_pk_bf16_f32 v20, v128, v129
    v_cvt_pk_bf16_f32 v21, v130, v131
    v_cvt_pk_bf16_f32 v22, v132, v133
    v_cvt_pk_bf16_f32 v23, v134, v135
    buffer_store_dwordx4 v[20:23], v1, s[8:11], s49 offen offset:0 sc1
    v_cvt_pk_bf16_f32 v24, v136, v137
    v_cvt_pk_bf16_f32 v25, v138, v139
    v_cvt_pk_bf16_f32 v26, v140, v141
    v_cvt_pk_bf16_f32 v27, v142, v143
    buffer_store_dwordx4 v[24:27], v1, s[8:11], s59 offen offset:0 sc1
    v_cvt_pk_bf16_f32 v28, v144, v145
    v_cvt_pk_bf16_f32 v29, v146, v147
    v_cvt_pk_bf16_f32 v30, v148, v149
    v_cvt_pk_bf16_f32 v31, v150, v151
    buffer_store_dwordx4 v[28:31], v1, s[8:11], s49 offen offset:1024 sc1
    v_cvt_pk_bf16_f32 v32, v152, v153
    v_cvt_pk_bf16_f32 v33, v154, v155
    v_cvt_pk_bf16_f32 v34, v156, v157
    v_cvt_pk_bf16_f32 v35, v158, v159
    buffer_store_dwordx4 v[32:35], v1, s[8:11], s59 offen offset:1024 sc1
    s_nop 0
    s_branch KV_END
KV_V1:
    s_add_u32 s58, s32, s33
    s_min_u32 s3, s58, 63
    s_lshl_b32 s3, s3, 7
    s_add_u32 s3, s3, s36
    v_mov_b32 v8, 0
    buffer_load_dword v9, v8, s[8:11], s3 offen sc1
    ds_read_b128 v[64:67], v2 offset:0
    ds_read_b128 v[68:71], v2 offset:20480
    ds_read_b128 v[72:75], v2 offset:1024
    ds_read_b128 v[76:79], v2 offset:21504
    ds_read_b128 v[80:83], v2 offset:2048
    ds_read_b128 v[84:87], v2 offset:22528
    ds_read_b128 v[88:91], v2 offset:3072
    s_waitcnt lgkmcnt(6)
    v_mfma_f32_16x16x32_bf16 v[128:131], v[64:67], a[0:3], 0
    v_mfma_f32_16x16x32_bf16 v[132:135], v[64:67], a[4:7], 0
    v_mfma_f32_16x16x32_bf16 v[136:139], v[64:67], a[8:11], 0
    v_mfma_f32_16x16x32_bf16 v[140:143], v[64:67], a[12:15], 0
    v_mfma_f32_16x16x32_bf16 v[160:163], v[176:179], v[64:67], 0
    v_mfma_f32_16x16x32_bf16 v[168:171], v[64:67], v[64:67], 0
    ds_read_b128 v[92:95], v2 offset:23552
    s_waitcnt lgkmcnt(6)
    v_mfma_f32_16x16x32_bf16 v[144:147], v[68:71], a[0:3], 0
    v_mfma_f32_16x16x32_bf16 v[148:151], v[68:71], a[4:7], 0
    v_mfma_f32_16x16x32_bf16 v[152:155], v[68:71], a[8:11], 0
    v_mfma_f32_16x16x32_bf16 v[156:159], v[68:71], a[12:15], 0
    v_mfma_f32_16x16x32_bf16 v[164:167], v[176:179], v[68:71], 0
    v_mfma_f32_16x16x32_bf16 v[172:175], v[68:71], v[68:71], 0
    ds_read_b128 v[64:67], v2 offset:4096
    s_waitcnt lgkmcnt(6)
    v_mfma_f32_16x16x32_bf16 v[128:131], v[72:75], a[16:19], v[128:131]
    v_mfma_f32_16x16x32_bf16 v[132:135], v[72:75], a[20:23], v[132:135]
    v_mfma_f32_16x16x32_bf16 v[136:139], v[72:75], a[24:27], v[136:139]
    v_mfma_f32_16x16x32_bf16 v[140:143], v[72:75], a[28:31], v[140:143]
    v_mfma_f32_16x16x32_bf16 v[160:163], v[176:179], v[72:75], v[160:163]
    v_mfma_f32_16x16x32_bf16 v[168:171], v[72:75], v[72:75], v[168:171]
    ds_read_b128 v[68:71], v2 offset:24576
    s_waitcnt lgkmcnt(6)
    v_mfma_f32_16x16x32_bf16 v[144:147], v[76:79], a[16:19], v[144:147]
    v_mfma_f32_16x16x32_bf16 v[148:151], v[76:79], a[20:23], v[148:151]
    v_mfma_f32_16x16x32_bf16 v[152:155], v[76:79], a[24:27], v[152:155]
    v_mfma_f32_16x16x32_bf16 v[156:159], v[76:79], a[28:31], v[156:159]
    v_mfma_f32_16x16x32_bf16 v[164:167], v[176:179], v[76:79], v[164:167]
    v_mfma_f32_16x16x32_bf16 v[172:175], v[76:79], v[76:79], v[172:175]
    ds_read_b128 v[72:75], v3 offset:0
    s_waitcnt lgkmcnt(6)
    v_mfma_f32_16x16x32_bf16 v[128:131], v[80:83], a[32:35], v[128:131]
    v_mfma_f32_16x16x32_bf16 v[132:135], v[80:83], a[36:39], v[132:135]
    v_mfma_f32_16x16x32_bf16 v[136:139], v[80:83], a[40:43], v[136:139]
    v_mfma_f32_16x16x32_bf16 v[140:143], v[80:83], a[44:47], v[140:143]
    v_mfma_f32_16x16x32_bf16 v[160:163], v[176:179], v[80:83], v[160:163]
    v_mfma_f32_16x16x32_bf16 v[168:171], v[80:83], v[80:83], v[168:171]
    ds_read_b128 v[76:79], v3 offset:20480
    s_waitcnt lgkmcnt(6)
    v_mfma_f32_16x16x32_bf16 v[144:147], v[84:87], a[32:35], v[144:147]
    v_mfma_f32_16x16x32_bf16 v[148:151], v[84:87], a[36:39], v[148:151]
    v_mfma_f32_16x16x32_bf16 v[152:155], v[84:87], a[40:43], v[152:155]
    v_mfma_f32_16x16x32_bf16 v[156:159], v[84:87], a[44:47], v[156:159]
    v_mfma_f32_16x16x32_bf16 v[164:167], v[176:179], v[84:87], v[164:167]
    v_mfma_f32_16x16x32_bf16 v[172:175], v[84:87], v[84:87], v[172:175]
    ds_read_b128 v[80:83], v3 offset:1024
    s_waitcnt lgkmcnt(6)
    v_mfma_f32_16x16x32_bf16 v[128:131], v[88:91], a[48:51], v[128:131]
    v_mfma_f32_16x16x32_bf16 v[132:135], v[88:91], a[52:55], v[132:135]
    v_mfma_f32_16x16x32_bf16 v[136:139], v[88:91], a[56:59], v[136:139]
    v_mfma_f32_16x16x32_bf16 v[140:143], v[88:91], a[60:63], v[140:143]
    v_mfma_f32_16x16x32_bf16 v[160:163], v[176:179], v[88:91], v[160:163]
    v_mfma_f32_16x16x32_bf16 v[168:171], v[88:91], v[88:91], v[168:171]
    ds_read_b128 v[84:87], v3 offset:21504
    s_waitcnt lgkmcnt(6)
    v_mfma_f32_16x16x32_bf16 v[144:147], v[92:95], a[48:51], v[144:147]
    v_mfma_f32_16x16x32_bf16 v[148:151], v[92:95], a[52:55], v[148:151]
    v_mfma_f32_16x16x32_bf16 v[152:155], v[92:95], a[56:59], v[152:155]
    v_mfma_f32_16x16x32_bf16 v[156:159], v[92:95], a[60:63], v[156:159]
    v_mfma_f32_16x16x32_bf16 v[164:167], v[176:179], v[92:95], v[164:167]
    v_mfma_f32_16x16x32_bf16 v[172:175], v[92:95], v[92:95], v[172:175]
    ds_read_b128 v[88:91], v3 offset:2048
    s_waitcnt lgkmcnt(6)
    v_mfma_f32_16x16x32_bf16 v[128:131], v[64:67], a[64:67], v[128:131]
    v_mfma_f32_16x16x32_bf16 v[132:135], v[64:67], a[68:71], v[132:135]
    v_mfma_f32_16x16x32_bf16 v[136:139], v[64:67], a[72:75], v[136:139]
    v_mfma_f32_16x16x32_bf16 v[140:143], v[64:67], a[76:79], v[140:143]
    v_mfma_f32_16x16x32_bf16 v[160:163], v[176:179], v[64:67], v[160:163]
    v_mfma_f32_16x16x32_bf16 v[168:171], v[64:67], v[64:67], v[168:171]
    ds_read_b128 v[92:95], v3 offset:22528
    s_waitcnt lgkmcnt(6)
    v_mfma_f32_16x16x32_bf16 v[144:147], v[68:71], a[64:67], v[144:147]
    v_mfma_f32_16x16x32_bf16 v[148:151], v[68:71], a[68:71], v[148:151]
    v_mfma_f32_16x16x32_bf16 v[152:155], v[68:71], a[72:75], v[152:155]
    v_mfma_f32_16x16x32_bf16 v[156:159], v[68:71], a[76:79], v[156:159]
    v_mfma_f32_16x16x32_bf16 v[164:167], v[176:179], v[68:71], v[164:167]
    v_mfma_f32_16x16x32_bf16 v[172:175], v[68:71], v[68:71], v[172:175]
    ds_read_b128 v[64:67], v3 offset:3072
    s_waitcnt lgkmcnt(6)
    v_mfma_f32_16x16x32_bf16 v[128:131], v[72:75], a[80:83], v[128:131]
    v_mfma_f32_16x16x32_bf16 v[132:135], v[72:75], a[84:87], v[132:135]
    v_mfma_f32_16x16x32_bf16 v[136:139], v[72:75], a[88:91], v[136:139]
    v_mfma_f32_16x16x32_bf16 v[140:143], v[72:75], a[92:95], v[140:143]
    ds_read_b128 v[68:71], v3 offset:23552
    s_waitcnt lgkmcnt(6)
    v_mfma_f32_16x16x32_bf16 v[144:147], v[76:79], a[80:83], v[144:147]
    v_mfma_f32_16x16x32_bf16 v[148:151], v[76:79], a[84:87], v[148:151]
    v_mfma_f32_16x16x32_bf16 v[152:155], v[76:79], a[88:91], v[152:155]
    v_mfma_f32_16x16x32_bf16 v[156:159], v[76:79], a[92:95], v[156:159]
    ds_read_b128 v[72:75], v3 offset:4096
    s_waitcnt lgkmcnt(6)
    v_mfma_f32_16x16x32_bf16 v[128:131], v[80:83], a[96:99], v[128:131]
    v_mfma_f32_16x16x32_bf16 v[132:135], v[80:83], a[100:103], v[132:135]
    v_mfma_f32_16x16x32_bf16 v[136:139], v[80:83], a[104:107], v[136:139]
    v_mfma_f32_16x16x32_bf16 v[140:143], v[80:83], a[108:111], v[140:143]
    ds_read_b128 v[76:79], v3 offset:24576
    s_waitcnt lgkmcnt(6)
    v_mfma_f32_16x16x32_bf16 v[144:147], v[84:87], a[96:99], v[144:147]
    v_mfma_f32_16x16x32_bf16 v[148:151], v[84:87], a[100:103], v[148:151]
    v_mfma_f32_16x16x32_bf16 v[152:155], v[84:87], a[104:107], v[152:155]
    v_mfma_f32_16x16x32_bf16 v[156:159], v[84:87], a[108:111], v[156:159]
    ds_read_b128 v[80:83], v4 offset:0
    s_waitcnt lgkmcnt(6)
    v_mfma_f32_16x16x32_bf16 v[128:131], v[88:91], a[112:115], v[128:131]
    v_mfma_f32_16x16x32_bf16 v[132:135], v[88:91], a[116:119], v[132:135]
    v_mfma_f32_16x16x32_bf16 v[136:139], v[88:91], a[120:123], v[136:139]
    v_mfma_f32_16x16x32_bf16 v[140:143], v[88:91], a[124:127], v[140:143]
    ds_read_b128 v[84:87], v4 offset:20480
    s_waitcnt lgkmcnt(6)
    v_mfma_f32_16x16x32_bf16 v[144:147], v[92:95], a[112:115], v[144:147]
    v_mfma_f32_16x16x32_bf16 v[148:151], v[92:95], a[116:119], v[148:151]
    v_mfma_f32_16x16x32_bf16 v[152:155], v[92:95], a[120:123], v[152:155]
    v_mfma_f32_16x16x32_bf16 v[156:159], v[92:95], a[124:127], v[156:159]
    ds_read_b128 v[88:91], v4 offset:1024
    s_waitcnt lgkmcnt(6)
    v_mfma_f32_16x16x32_bf16 v[128:131], v[64:67], a[128:131], v[128:131]
    v_mfma_f32_16x16x32_bf16 v[132:135], v[64:67], a[132:135], v[132:135]
    v_mfma_f32_16x16x32_bf16 v[136:139], v[64:67], a[136:139], v[136:139]
    v_mfma_f32_16x16x32_bf16 v[140:143], v[64:67], a[140:143], v[140:143]
    ds_read_b128 v[92:95], v4 offset:21504
    s_waitcnt lgkmcnt(6)
    v_mfma_f32_16x16x32_bf16 v[144:147], v[68:71], a[128:131], v[144:147]
    v_mfma_f32_16x16x32_bf16 v[148:151], v[68:71], a[132:135], v[148:151]
    v_mfma_f32_16x16x32_bf16 v[152:155], v[68:71], a[136:139], v[152:155]
    v_mfma_f32_16x16x32_bf16 v[156:159], v[68:71], a[140:143], v[156:159]
    ds_read_b128 v[64:67], v4 offset:2048
    s_waitcnt lgkmcnt(6)
    v_mfma_f32_16x16x32_bf16 v[128:131], v[72:75], a[144:147], v[128:131]
    v_mfma_f32_16x16x32_bf16 v[132:135], v[72:75], a[148:151], v[132:135]
    v_mfma_f32_16x16x32_bf16 v[136:139], v[72:75], a[152:155], v[136:139]
    v_mfma_f32_16x16x32_bf16 v[140:143], v[72:75], a[156:159], v[140:143]
    ds_read_b128 v[68:71], v4 offset:22528
    s_waitcnt lgkmcnt(6)
    v_mfma_f32_16x16x32_bf16 v[144:147], v[76:79], a[144:147], v[144:147]
    v_mfma_f32_16x16x32_bf16 v[148:151], v[76:79], a[148:151], v[148:151]
    v_mfma_f32_16x16x32_bf16 v[152:155], v[76:79], a[152:155], v[152:155]
    v_mfma_f32_16x16x32_bf16 v[156:159], v[76:79], a[156:159], v[156:159]
    s_waitcnt vmcnt(0)
    v_readfirstlane_b32 s3, v9
    s_nop 0
    s_mov_b32 s41, 0
    s_cmp_ge_u32 s58, 64
    s_cbranch_scc1 NPF_34
    s_cmp_lt_u32 s3, s37
    s_cbranch_scc1 NPF_34
    s_add_u32 s49, s39, s40
    s_mov_b32 s41, 1
    s_mul_i32 s3, s58, 40960
    s_add_u32 s3, s3, s34
    s_mul_i32 s59, s13, 10240
    s_add_u32 s59, s59, s49
    s_mov_b32 m0, s59
    s_add_u32 s59, s59, 1024
    buffer_load_dwordx4 v6, s[24:27], s3 offen sc1 lds
    s_add_u32 s3, s3, s35
    s_mov_b32 m0, s59
    s_add_u32 s59, s59, 1024
    buffer_load_dwordx4 v6, s[24:27], s3 offen sc1 lds
    s_add_u32 s3, s3, s35
    s_mov_b32 m0, s59
    s_add_u32 s59, s59, 1024
    buffer_load_dwordx4 v6, s[24:27], s3 offen sc1 lds
    s_add_u32 s3, s3, s35
    s_mov_b32 m0, s59
    s_add_u32 s59, s59, 1024
    buffer_load_dwordx4 v6, s[24:27], s3 offen sc1 lds
    s_add_u32 s3, s3, s35
    s_mov_b32 m0, s59
    s_add_u32 s59, s59, 1024
    buffer_load_dwordx4 v6, s[24:27], s3 offen sc1 lds
    s_add_u32 s3, s3, s35
    s_mov_b32 m0, s59
    s_add_u32 s59, s59, 1024
    buffer_load_dwordx4 v6, s[24:27], s3 offen sc1 lds
    s_add_u32 s3, s3, s35
    s_mov_b32 m0, s59
    s_add_u32 s59, s59, 1024
    buffer_load_dwordx4 v6, s[24:27], s3 offen sc1 lds
    s_add_u32 s3, s3, s35
    s_mov_b32 m0, s59
    s_add_u32 s59, s59, 1024
    buffer_load_dwordx4 v6, s[24:27], s3 offen sc1 lds
    s_add_u32 s3, s3, s35
    s_mov_b32 m0, s59
    s_add_u32 s59, s59, 1024
    buffer_load_dwordx4 v6, s[24:27], s3 offen sc1 lds
    s_add_u32 s3, s3, s35
    s_mov_b32 m0, s59
    s_add_u32 s59, s59, 1024
    buffer_load_dwordx4 v6, s[24:27], s3 offen sc1 lds
    s_add_u32 s3, s3, s35
NPF_34:
    ds_read_b128 v[72:75], v4 offset:3072
    s_waitcnt lgkmcnt(6)
    v_mfma_f32_16x16x32_bf16 v[128:131], v[80:83], a[160:163], v[128:131]
    v_mfma_f32_16x16x32_bf16 v[132:135], v[80:83], a[164:167], v[132:135]
    v_mfma_f32_16x16x32_bf16 v[136:139], v[80:83], a[168:171], v[136:139]
    v_mfma_f32_16x16x32_bf16 v[140:143], v[80:83], a[172:175], v[140:143]
    ds_read_b128 v[76:79], v4 offset:23552
    s_waitcnt lgkmcnt(6)
    v_mfma_f32_16x16x32_bf16 v[144:147], v[84:87], a[160:163], v[144:147]
    v_mfma_f32_16x16x32_bf16 v[148:151], v[84:87], a[164:167], v[148:151]
    v_mfma_f32_16x16x32_bf16 v[152:155], v[84:87], a[168:171], v[152:155]
    v_mfma_f32_16x16x32_bf16 v[156:159], v[84:87], a[172:175], v[156:159]
    ds_read_b128 v[80:83], v4 offset:4096
    s_waitcnt lgkmcnt(6)
    v_mfma_f32_16x16x32_bf16 v[128:131], v[88:91], a[176:179], v[128:131]
    v_mfma_f32_16x16x32_bf16 v[132:135], v[88:91], a[180:183], v[132:135]
    v_mfma_f32_16x16x32_bf16 v[136:139], v[88:91], a[184:187], v[136:139]
    v_mfma_f32_16x16x32_bf16 v[140:143], v[88:91], a[188:191], v[140:143]
    ds_read_b128 v[84:87], v4 offset:24576
    s_waitcnt lgkmcnt(6)
    v_mfma_f32_16x16x32_bf16 v[144:147], v[92:95], a[176:179], v[144:147]
    v_mfma_f32_16x16x32_bf16 v[148:151], v[92:95], a[180:183], v[148:151]
    v_mfma_f32_16x16x32_bf16 v[152:155], v[92:95], a[184:187], v[152:155]
    v_mfma_f32_16x16x32_bf16 v[156:159], v[92:95], a[188:191], v[156:159]
    ds_read_b128 v[88:91], v5 offset:0
    s_waitcnt lgkmcnt(6)
    v_mfma_f32_16x16x32_bf16 v[128:131], v[64:67], a[192:195], v[128:131]
    v_mfma_f32_16x16x32_bf16 v[132:135], v[64:67], a[196:199], v[132:135]
    v_mfma_f32_16x16x32_bf16 v[136:139], v[64:67], a[200:203], v[136:139]
    v_mfma_f32_16x16x32_bf16 v[140:143], v[64:67], a[204:207], v[140:143]
    ds_read_b128 v[92:95], v5 offset:20480
    s_waitcnt lgkmcnt(6)
    v_mfma_f32_16x16x32_bf16 v[144:147], v[68:71], a[192:195], v[144:147]
    v_mfma_f32_16x16x32_bf16 v[148:151], v[68:71], a[196:199], v[148:151]
    v_mfma_f32_16x16x32_bf16 v[152:155], v[68:71], a[200:203], v[152:155]
    v_mfma_f32_16x16x32_bf16 v[156:159], v[68:71], a[204:207], v[156:159]
    ds_read_b128 v[64:67], v5 offset:1024
    s_waitcnt lgkmcnt(6)
    v_mfma_f32_16x16x32_bf16 v[128:131], v[72:75], a[208:211], v[128:131]
    v_mfma_f32_16x16x32_bf16 v[132:135], v[72:75], a[212:215], v[132:135]
    v_mfma_f32_16x16x32_bf16 v[136:139], v[72:75], a[216:219], v[136:139]
    v_mfma_f32_16x16x32_bf16 v[140:143], v[72:75], a[220:223], v[140:143]
    ds_read_b128 v[68:71], v5 offset:21504
    s_waitcnt lgkmcnt(6)
    v_mfma_f32_16x16x32_bf16 v[144:147], v[76:79], a[208:211], v[144:147]
    v_mfma_f32_16x16x32_bf16 v[148:151], v[76:79], a[212:215], v[148:151]
    v_mfma_f32_16x16x32_bf16 v[152:155], v[76:79], a[216:219], v[152:155]
    v_mfma_f32_16x16x32_bf16 v[156:159], v[76:79], a[220:223], v[156:159]
    ds_read_b128 v[72:75], v5 offset:2048
    s_waitcnt lgkmcnt(6)
    v_mfma_f32_16x16x32_bf16 v[128:131], v[80:83], a[224:227], v[128:131]
    v_mfma_f32_16x16x32_bf16 v[132:135], v[80:83], a[228:231], v[132:135]
    v_mfma_f32_16x16x32_bf16 v[136:139], v[80:83], a[232:235], v[136:139]
    v_mfma_f32_16x16x32_bf16 v[140:143], v[80:83], a[236:239], v[140:143]
    ds_read_b128 v[76:79], v5 offset:22528
    s_waitcnt lgkmcnt(6)
    v_mfma_f32_16x16x32_bf16 v[144:147], v[84:87], a[224:227], v[144:147]
    v_mfma_f32_16x16x32_bf16 v[148:151], v[84:87], a[228:231], v[148:151]
    v_mfma_f32_16x16x32_bf16 v[152:155], v[84:87], a[232:235], v[152:155]
    v_mfma_f32_16x16x32_bf16 v[156:159], v[84:87], a[236:239], v[156:159]
    ds_read_b128 v[80:83], v5 offset:3072
    s_waitcnt lgkmcnt(6)
    v_mfma_f32_16x16x32_bf16 v[128:131], v[88:91], a[240:243], v[128:131]
    v_mfma_f32_16x16x32_bf16 v[132:135], v[88:91], a[244:247], v[132:135]
    v_mfma_f32_16x16x32_bf16 v[136:139], v[88:91], a[248:251], v[136:139]
    v_mfma_f32_16x16x32_bf16 v[140:143], v[88:91], a[252:255], v[140:143]
    ds_read_b128 v[84:87], v5 offset:23552
    s_waitcnt lgkmcnt(6)
    v_mfma_f32_16x16x32_bf16 v[144:147], v[92:95], a[240:243], v[144:147]
    v_mfma_f32_16x16x32_bf16 v[148:151], v[92:95], a[244:247], v[148:151]
    v_mfma_f32_16x16x32_bf16 v[152:155], v[92:95], a[248:251], v[152:155]
    v_mfma_f32_16x16x32_bf16 v[156:159], v[92:95], a[252:255], v[156:159]
    ds_read_b128 v[88:91], v5 offset:4096
    s_waitcnt lgkmcnt(6)
    v_mfma_f32_16x16x32_bf16 v[128:131], v[64:67], v[192:195], v[128:131]
    v_mfma_f32_16x16x32_bf16 v[132:135], v[64:67], v[196:199], v[132:135]
    v_mfma_f32_16x16x32_bf16 v[136:139], v[64:67], v[200:203], v[136:139]
    v_mfma_f32_16x16x32_bf16 v[140:143], v[64:67], v[204:207], v[140:143]
    ds_read_b128 v[92:95], v5 offset:24576
    s_waitcnt lgkmcnt(6)
    v_mfma_f32_16x16x32_bf16 v[144:147], v[68:71], v[192:195], v[144:147]
    v_mfma_f32_16x16x32_bf16 v[148:151], v[68:71], v[196:199], v[148:151]
    v_mfma_f32_16x16x32_bf16 v[152:155], v[68:71], v[200:203], v[152:155]
    v_mfma_f32_16x16x32_bf16 v[156:159], v[68:71], v[204:207], v[156:159]
    s_waitcnt lgkmcnt(5)
    v_mfma_f32_16x16x32_bf16 v[128:131], v[72:75], v[208:211], v[128:131]
    v_mfma_f32_16x16x32_bf16 v[132:135], v[72:75], v[212:215], v[132:135]
    v_mfma_f32_16x16x32_bf16 v[136:139], v[72:75], v[216:219], v[136:139]
    v_mfma_f32_16x16x32_bf16 v[140:143], v[72:75], v[220:223], v[140:143]
    s_waitcnt lgkmcnt(4)
    v_mfma_f32_16x16x32_bf16 v[144:147], v[76:79], v[208:211], v[144:147]
    v_mfma_f32_16x16x32_bf16 v[148:151], v[76:79], v[212:215], v[148:151]
    v_mfma_f32_16x16x32_bf16 v[152:155], v[76:79], v[216:219], v[152:155]
    v_mfma_f32_16x16x32_bf16 v[156:159], v[76:79], v[220:223], v[156:159]
    s_waitcnt lgkmcnt(3)
    v_mfma_f32_16x16x32_bf16 v[128:131], v[80:83], v[224:227], v[128:131]
    v_mfma_f32_16x16x32_bf16 v[132:135], v[80:83], v[228:231], v[132:135]
    v_mfma_f32_16x16x32_bf16 v[136:139], v[80:83], v[232:235], v[136:139]
    v_mfma_f32_16x16x32_bf16 v[140:143], v[80:83], v[236:239], v[140:143]
    s_waitcnt lgkmcnt(2)
    v_mfma_f32_16x16x32_bf16 v[144:147], v[84:87], v[224:227], v[144:147]
    v_mfma_f32_16x16x32_bf16 v[148:151], v[84:87], v[228:231], v[148:151]
    v_mfma_f32_16x16x32_bf16 v[152:155], v[84:87], v[232:235], v[152:155]
    v_mfma_f32_16x16x32_bf16 v[156:159], v[84:87], v[236:239], v[156:159]
    s_waitcnt lgkmcnt(1)
    v_mfma_f32_16x16x32_bf16 v[128:131], v[88:91], v[240:243], v[128:131]
    v_mfma_f32_16x16x32_bf16 v[132:135], v[88:91], v[244:247], v[132:135]
    v_mfma_f32_16x16x32_bf16 v[136:139], v[88:91], v[248:251], v[136:139]
    v_mfma_f32_16x16x32_bf16 v[140:143], v[88:91], v[252:255], v[140:143]
    s_waitcnt lgkmcnt(0)
    v_mfma_f32_16x16x32_bf16 v[144:147], v[92:95], v[240:243], v[144:147]
    v_mfma_f32_16x16x32_bf16 v[148:151], v[92:95], v[244:247], v[148:151]
    v_mfma_f32_16x16x32_bf16 v[152:155], v[92:95], v[248:251], v[152:155]
    v_mfma_f32_16x16x32_bf16 v[156:159], v[92:95], v[252:255], v[156:159]
    v_cndmask_b32 v168, v168, v169, s[50:51]
    v_cndmask_b32 v168, v168, v170, s[52:53]
    v_cndmask_b32 v168, v168, v171, s[54:55]
    v_mov_b32 v161, v168
    v_cndmask_b32 v172, v172, v173, s[50:51]
    v_cndmask_b32 v172, v172, v174, s[52:53]
    v_cndmask_b32 v172, v172, v175, s[54:55]
    v_mov_b32 v165, v172
    s_mov_b64 exec, s[56:57]
    ds_write_b64 v10, v[160:161] offset:0
    ds_write_b64 v10, v[164:165] offset:128
    s_mov_b64 exec, -1
    s_waitcnt lgkmcnt(0)
    s_barrier
    ds_read_b64 v[20:21], v11 offset:0
    ds_read_b64 v[22:23], v11 offset:256
    ds_read_b64 v[24:25], v11 offset:512
    ds_read_b64 v[26:27], v11 offset:768
    ds_read_b64 v[28:29], v11 offset:128
    ds_read_b64 v[30:31], v11 offset:384
    ds_read_b64 v[32:33], v11 offset:640
    ds_read_b64 v[34:35], v11 offset:896
    s_waitcnt lgkmcnt(0)
    v_pk_add_f32 v[20:21], v[20:21], v[22:23]
    v_pk_add_f32 v[24:25], v[24:25], v[26:27]
    v_pk_add_f32 v[20:21], v[20:21], v[24:25]
    v_mul_f32 v20, 0x3acccccd, v20
    v_mul_f32 v21, 0x3acccccd, v21
    v_fma_f32 v21, -v20, v20, v21
    v_max_f32 v21, 0, v21
    v_cvt_pk_bf16_f32 v16, v20, v20
    v_lshlrev_b32 v16, 16, v16
    v_cvt_pk_bf16_f32 v21, v21, v21
    v_lshlrev_b32 v21, 16, v21
    v_add_f32 v21, 0x3727c5ac, v21
    v_cvt_pk_bf16_f32 v21, v21, v21
    v_lshlrev_b32 v21, 16, v21
    v_sqrt_f32 v21, v21
    s_nop 0
    v_cvt_pk_bf16_f32 v21, v21, v21
    v_lshlrev_b32 v21, 16, v21
    v_rcp_f32 v18, v21
    v_pk_add_f32 v[28:29], v[28:29], v[30:31]
    v_pk_add_f32 v[32:33], v[32:33], v[34:35]
    v_pk_add_f32 v[28:29], v[28:29], v[32:33]
    v_mul_f32 v28, 0x3acccccd, v28
    v_mul_f32 v29, 0x3acccccd, v29
    v_fma_f32 v29, -v28, v28, v29
    v_max_f32 v29, 0, v29
    v_cvt_pk_bf16_f32 v17, v28, v28
    v_lshlrev_b32 v17, 16, v17
    v_cvt_pk_bf16_f32 v29, v29, v29
    v_lshlrev_b32 v29, 16, v29
    v_add_f32 v29, 0x3727c5ac, v29
    v_cvt_pk_bf16_f32 v29, v29, v29
    v_lshlrev_b32 v29, 16, v29
    v_sqrt_f32 v29, v29
    s_nop 0
    v_cvt_pk_bf16_f32 v29, v29, v29
    v_lshlrev_b32 v29, 16, v29
    v_rcp_f32 v19, v29
    v_and_b32 v36, 15, v0
    v_lshlrev_b32 v36, 2, v36
    s_lshl_b32 s3, s13, 8
    s_add_u32 s3, s3, 82944
    v_add_u32 v36, s3, v36
    v_and_b32 v37, 48, v0
    v_add_u32 v37, s3, v37
    ds_write_b32 v36, v16 offset:0
    ds_write_b32 v36, v17 offset:64
    ds_write_b32 v36, v18 offset:128
    ds_write_b32 v36, v19 offset:192
    s_waitcnt lgkmcnt(0)
    ds_read_b128 v[20:23], v37 offset:0
    ds_read_b128 v[24:27], v37 offset:64
    ds_read_b128 v[28:31], v37 offset:128
    ds_read_b128 v[32:35], v37 offset:192
    s_waitcnt lgkmcnt(0)
    v_fma_f32 v128, -v20, v96, v128
    v_mul_f32 v128, v128, v28
    v_fma_f32 v129, -v21, v97, v129
    v_mul_f32 v129, v129, v29
    v_fma_f32 v130, -v22, v98, v130
    v_mul_f32 v130, v130, v30
    v_fma_f32 v131, -v23, v99, v131
    v_mul_f32 v131, v131, v31
    v_fma_f32 v132, -v20, v100, v132
    v_mul_f32 v132, v132, v28
    v_fma_f32 v133, -v21, v101, v133
    v_mul_f32 v133, v133, v29
    v_fma_f32 v134, -v22, v102, v134
    v_mul_f32 v134, v134, v30
    v_fma_f32 v135, -v23, v103, v135
    v_mul_f32 v135, v135, v31
    v_fma_f32 v136, -v20, v104, v136
    v_mul_f32 v136, v136, v28
    v_fma_f32 v137, -v21, v105, v137
    v_mul_f32 v137, v137, v29
    v_fma_f32 v138, -v22, v106, v138
    v_mul_f32 v138, v138, v30
    v_fma_f32 v139, -v23, v107, v139
    v_mul_f32 v139, v139, v31
    v_fma_f32 v140, -v20, v108, v140
    v_mul_f32 v140, v140, v28
    v_fma_f32 v141, -v21, v109, v141
    v_mul_f32 v141, v141, v29
    v_fma_f32 v142, -v22, v110, v142
    v_mul_f32 v142, v142, v30
    v_fma_f32 v143, -v23, v111, v143
    v_mul_f32 v143, v143, v31
    v_fma_f32 v144, -v24, v96, v144
    v_mul_f32 v144, v144, v32
    v_fma_f32 v145, -v25, v97, v145
    v_mul_f32 v145, v145, v33
    v_fma_f32 v146, -v26, v98, v146
    v_mul_f32 v146, v146, v34
    v_fma_f32 v147, -v27, v99, v147
    v_mul_f32 v147, v147, v35
    v_fma_f32 v148, -v24, v100, v148
    v_mul_f32 v148, v148, v32
    v_fma_f32 v149, -v25, v101, v149
    v_mul_f32 v149, v149, v33
    v_fma_f32 v150, -v26, v102, v150
    v_mul_f32 v150, v150, v34
    v_fma_f32 v151, -v27, v103, v151
    v_mul_f32 v151, v151, v35
    v_fma_f32 v152, -v24, v104, v152
    v_mul_f32 v152, v152, v32
    v_fma_f32 v153, -v25, v105, v153
    v_mul_f32 v153, v153, v33
    v_fma_f32 v154, -v26, v106, v154
    v_mul_f32 v154, v154, v34
    v_fma_f32 v155, -v27, v107, v155
    v_mul_f32 v155, v155, v35
    v_fma_f32 v156, -v24, v108, v156
    v_mul_f32 v156, v156, v32
    v_fma_f32 v157, -v25, v109, v157
    v_mul_f32 v157, v157, v33
    v_fma_f32 v158, -v26, v110, v158
    v_mul_f32 v158, v158, v34
    v_fma_f32 v159, -v27, v111, v159
    v_mul_f32 v159, v159, v35
    s_lshl_b32 s49, s32, 19
    s_add_u32 s49, s49, s45
    s_add_u32 s59, s49, 4096
    v_cvt_pk_bf16_f32 v40, v128, v129
    v_cvt_pk_bf16_f32 v41, v130, v131
    v_cvt_pk_bf16_f32 v42, v144, v145
    v_cvt_pk_bf16_f32 v43, v146, v147
    buffer_store_dwordx4 v[40:43], v1, s[8:11], s49 offen offset:2048 sc1
    v_cvt_pk_bf16_f32 v44, v132, v133
    v_cvt_pk_bf16_f32 v45, v134, v135
    v_cvt_pk_bf16_f32 v46, v148, v149
    v_cvt_pk_bf16_f32 v47, v150, v151
    buffer_store_dwordx4 v[44:47], v1, s[8:11], s49 offen offset:3072 sc1
    v_cvt_pk_bf16_f32 v48, v136, v137
    v_cvt_pk_bf16_f32 v49, v138, v139
    v_cvt_pk_bf16_f32 v50, v152, v153
    v_cvt_pk_bf16_f32 v51, v154, v155
    buffer_store_dwordx4 v[48:51], v1, s[8:11], s59 offen offset:2048 sc1
    v_cvt_pk_bf16_f32 v52, v140, v141
    v_cvt_pk_bf16_f32 v53, v142, v143
    v_cvt_pk_bf16_f32 v54, v156, v157
    v_cvt_pk_bf16_f32 v55, v158, v159
    buffer_store_dwordx4 v[52:55], v1, s[8:11], s59 offen offset:3072 sc1
KV_END:
    s_waitcnt vmcnt(0)
    s_barrier
    s_lshl_b32 s49, s32, 2
    s_add_u32 s49, s49, s38
    s_cmp_lg_u32 s13, 0
    s_cbranch_scc1 SIG_35
    v_mov_b32 v8, 0
    v_mov_b32 v9, 1
    s_mov_b64 exec, 1
    buffer_store_dword v9, v8, s[8:11], s49 offen sc1
    s_mov_b64 exec, -1
SIG_35:
    v_add_u32 v2, s40, v2
    v_add_u32 v3, s40, v3
    v_add_u32 v4, s40, v4
    v_add_u32 v5, s40, v5
    s_add_u32 s39, s39, s40
    s_sub_u32 s40, 0, s40
    s_add_u32 s32, s32, s33
    s_branch KV_SEG
KV_NEXTP:
    s_add_u32 s14, s14, 1
    s_cmp_lt_u32 s14, s15
    s_cbranch_scc1 KV_PAIR
    s_endpgm
ROLE_QA:
    s_and_b32 s3, s16, 1
    s_cbranch_scc0 QA_BODY
    s_cmp_lg_u32 s14, 0
    s_cbranch_scc1 QA_BODY
    s_cmp_ge_u32 s12, 30
    s_cbranch_scc1 QA_BODY
    s_add_u32 s19, s12, 66
    s_mov_b32 s47, 2
    s_branch P1_BODY
QA_BODY:
    s_and_b32 s3, s16, 32
    s_cbranch_scc0 EXIT2
    s_barrier
    s_and_b32 s19, s12, 15
    s_lshr_b32 s42, s12, 4
    s_mov_b32 s33, 3
    s_mov_b32 s46, 0
    v_lshlrev_b32 v1, 4, v0
    s_add_u32 s3, s13, 0
    s_and_b32 s3, s3, 3
    s_mul_i32 s3, s3, 5120
    v_add_u32 v2, s3, v1
    s_add_u32 s3, s13, 1
    s_and_b32 s3, s3, 3
    s_mul_i32 s3, s3, 5120
    v_add_u32 v3, s3, v1
    s_add_u32 s3, s13, 2
    s_and_b32 s3, s3, 3
    s_mul_i32 s3, s3, 5120
    v_add_u32 v4, s3, v1
    s_add_u32 s3, s13, 3
    s_and_b32 s3, s3, 3
    s_mul_i32 s3, s3, 5120
    v_add_u32 v5, s3, v1
    v_mov_b32 v176, 0x3f803f80
    v_mov_b32 v177, 0x3f803f80
    v_mov_b32 v178, 0x3f803f80
    v_mov_b32 v179, 0x3f803f80
    v_lshrrev_b32 v16, 4, v0
    v_lshlrev_b32 v16, 10, v16
    v_bfe_u32 v17, v0, 2, 2
    v_lshl_add_u32 v16, v17, 7, v16
    v_and_b32 v17, 3, v0
    v_lshl_add_u32 v16, v17, 4, v16
    s_mul_i32 s48, s13, 40960
    v_add_u32 v13, s48, v16
    v_and_b32 v16, 15, v0
    v_lshlrev_b32 v11, 3, v16
    v_add_u32 v11, 81920, v11
    s_lshl_b32 s3, s13, 8
    v_add_u32 v10, s3, v11
    v_and_b32 v17, 3, v0
    v_cmp_eq_u32 s[50:51], 1, v17
    v_cmp_eq_u32 s[52:53], 2, v17
    v_cmp_eq_u32 s[54:55], 3, v17
    v_lshrrev_b32 v17, 2, v16
    v_lshrrev_b32 v18, 4, v0
    v_cmp_eq_u32 s[56:57], v17, v18
    s_nop 0
    s_load_dwordx2 s[4:5], s[0:1], 56
    s_waitcnt lgkmcnt(0)
    s_mov_b32 s28, s4
    s_mov_b32 s29, s5
    s_mov_b32 s30, 0x500000
    s_mov_b32 s31, 0x20000
    s_lshl_b32 s65, s19, 9
    s_lshl_b32 s3, s13, 7
    s_add_u32 s65, s65, s3
    v_lshrrev_b32 v16, 3, v0
    v_mul_u32_u24 v16, 8192, v16
    v_and_b32 v17, 7, v0
    v_lshl_add_u32 v14, v17, 4, v16
    s_add_u32 s3, s13, 0
    s_and_b32 s3, s3, 3
    s_mul_i32 s3, s3, 1310720
    s_add_u32 s60, s3, s65
    s_add_u32 s3, s13, 1
    s_and_b32 s3, s3, 3
    s_mul_i32 s3, s3, 1310720
    s_add_u32 s61, s3, s65
    s_add_u32 s3, s13, 2
    s_and_b32 s3, s3, 3
    s_mul_i32 s3, s3, 1310720
    s_add_u32 s62, s3, s65
    s_add_u32 s3, s13, 3
    s_and_b32 s3, s3, 3
    s_mul_i32 s3, s3, 1310720
    s_add_u32 s63, s3, s65
    s_add_u32 m0, s48, 0
    s_add_u32 s3, s60, 0x0
    buffer_load_dwordx4 v14, s[28:31], s3 offen lds
    s_add_u32 m0, s48, 1024
    s_add_u32 s3, s60, 0x10000
    buffer_load_dwordx4 v14, s[28:31], s3 offen lds
    s_add_u32 m0, s48, 2048
    s_add_u32 s3, s60, 0x20000
    buffer_load_dwordx4 v14, s[28:31], s3 offen lds
    s_add_u32 m0, s48, 3072
    s_add_u32 s3, s60, 0x30000
    buffer_load_dwordx4 v14, s[28:31], s3 offen lds
    s_add_u32 m0, s48, 4096
    s_add_u32 s3, s60, 0x40000
    buffer_load_dwordx4 v14, s[28:31], s3 offen lds
    s_add_u32 m0, s48, 5120
    s_add_u32 s3, s60, 0x50000
    buffer_load_dwordx4 v14, s[28:31], s3 offen lds
    s_add_u32 m0, s48, 6144
    s_add_u32 s3, s60, 0x60000
    buffer_load_dwordx4 v14, s[28:31], s3 offen lds
    s_add_u32 m0, s48, 7168
    s_add_u32 s3, s60, 0x70000
    buffer_load_dwordx4 v14, s[28:31], s3 offen lds
    s_add_u32 m0, s48, 8192
    s_add_u32 s3, s60, 0x80000
    buffer_load_dwordx4 v14, s[28:31], s3 offen lds
    s_add_u32 m0, s48, 9216
    s_add_u32 s3, s60, 0x90000
    buffer_load_dwordx4 v14, s[28:31], s3 offen lds
    s_add_u32 m0, s48, 10240
    s_add_u32 s3, s60, 0xa0000
    buffer_load_dwordx4 v14, s[28:31], s3 offen lds
    s_add_u32 m0, s48, 11264
    s_add_u32 s3, s60, 0xb0000
    buffer_load_dwordx4 v14, s[28:31], s3 offen lds
    s_add_u32 m0, s48, 12288
    s_add_u32 s3, s60, 0xc0000
    buffer_load_dwordx4 v14, s[28:31], s3 offen lds
    s_add_u32 m0, s48, 13312
    s_add_u32 s3, s60, 0xd0000
    buffer_load_dwordx4 v14, s[28:31], s3 offen lds
    s_add_u32 m0, s48, 14336
    s_add_u32 s3, s60, 0xe0000
    buffer_load_dwordx4 v14, s[28:31], s3 offen lds
    s_add_u32 m0, s48, 15360
    s_add_u32 s3, s60, 0xf0000
    buffer_load_dwordx4 v14, s[28:31], s3 offen lds
    s_add_u32 m0, s48, 16384
    s_add_u32 s3, s60, 0x100000
    buffer_load_dwordx4 v14, s[28:31], s3 offen lds
    s_add_u32 m0, s48, 17408
    s_add_u32 s3, s60, 0x110000
    buffer_load_dwordx4 v14, s[28:31], s3 offen lds
    s_add_u32 m0, s48, 18432
    s_add_u32 s3, s60, 0x120000
    buffer_load_dwordx4 v14, s[28:31], s3 offen lds
    s_add_u32 m0, s48, 19456
    s_add_u32 s3, s60, 0x130000
    buffer_load_dwordx4 v14, s[28:31], s3 offen lds
    s_add_u32 m0, s48, 20480
    s_add_u32 s3, s61, 0x0
    buffer_load_dwordx4 v14, s[28:31], s3 offen lds
    s_add_u32 m0, s48, 21504
    s_add_u32 s3, s61, 0x10000
    buffer_load_dwordx4 v14, s[28:31], s3 offen lds
    s_add_u32 m0, s48, 22528
    s_add_u32 s3, s61, 0x20000
    buffer_load_dwordx4 v14, s[28:31], s3 offen lds
    s_add_u32 m0, s48, 23552
    s_add_u32 s3, s61, 0x30000
    buffer_load_dwordx4 v14, s[28:31], s3 offen lds
    s_add_u32 m0, s48, 24576
    s_add_u32 s3, s61, 0x40000
    buffer_load_dwordx4 v14, s[28:31], s3 offen lds
    s_add_u32 m0, s48, 25600
    s_add_u32 s3, s61, 0x50000
    buffer_load_dwordx4 v14, s[28:31], s3 offen lds
    s_add_u32 m0, s48, 26624
    s_add_u32 s3, s61, 0x60000
    buffer_load_dwordx4 v14, s[28:31], s3 offen lds
    s_add_u32 m0, s48, 27648
    s_add_u32 s3, s61, 0x70000
    buffer_load_dwordx4 v14, s[28:31], s3 offen lds
    s_add_u32 m0, s48, 28672
    s_add_u32 s3, s61, 0x80000
    buffer_load_dwordx4 v14, s[28:31], s3 offen lds
    s_add_u32 m0, s48, 29696
    s_add_u32 s3, s61, 0x90000
    buffer_load_dwordx4 v14, s[28:31], s3 offen lds
    s_add_u32 m0, s48, 30720
    s_add_u32 s3, s61, 0xa0000
    buffer_load_dwordx4 v14, s[28:31], s3 offen lds
    s_add_u32 m0, s48, 31744
    s_add_u32 s3, s61, 0xb0000
    buffer_load_dwordx4 v14, s[28:31], s3 offen lds
    s_add_u32 m0, s48, 32768
    s_add_u32 s3, s61, 0xc0000
    buffer_load_dwordx4 v14, s[28:31], s3 offen lds
    s_add_u32 m0, s48, 33792
    s_add_u32 s3, s61, 0xd0000
    buffer_load_dwordx4 v14, s[28:31], s3 offen lds
    s_add_u32 m0, s48, 34816
    s_add_u32 s3, s61, 0xe0000
    buffer_load_dwordx4 v14, s[28:31], s3 offen lds
    s_add_u32 m0, s48, 35840
    s_add_u32 s3, s61, 0xf0000
    buffer_load_dwordx4 v14, s[28:31], s3 offen lds
    s_add_u32 m0, s48, 36864
    s_add_u32 s3, s61, 0x100000
    buffer_load_dwordx4 v14, s[28:31], s3 offen lds
    s_add_u32 m0, s48, 37888
    s_add_u32 s3, s61, 0x110000
    buffer_load_dwordx4 v14, s[28:31], s3 offen lds
    s_add_u32 m0, s48, 38912
    s_add_u32 s3, s61, 0x120000
    buffer_load_dwordx4 v14, s[28:31], s3 offen lds
    s_add_u32 m0, s48, 39936
    s_add_u32 s3, s61, 0x130000
    buffer_load_dwordx4 v14, s[28:31], s3 offen lds
    s_waitcnt vmcnt(20)
    ds_read_b64_tr_b16 a[0:1], v13 offset:0
    ds_read_b64_tr_b16 a[2:3], v13 offset:512
    ds_read_b64_tr_b16 a[4:5], v13 offset:8
    ds_read_b64_tr_b16 a[6:7], v13 offset:520
    ds_read_b64_tr_b16 a[8:9], v13 offset:64
    ds_read_b64_tr_b16 a[10:11], v13 offset:576
    ds_read_b64_tr_b16 a[12:13], v13 offset:72
    ds_read_b64_tr_b16 a[14:15], v13 offset:584
    ds_read_b64_tr_b16 a[16:17], v13 offset:4096
    ds_read_b64_tr_b16 a[18:19], v13 offset:4608
    ds_read_b64_tr_b16 a[20:21], v13 offset:4104
    ds_read_b64_tr_b16 a[22:23], v13 offset:4616
    ds_read_b64_tr_b16 a[24:25], v13 offset:4160
    ds_read_b64_tr_b16 a[26:27], v13 offset:4672
    ds_read_b64_tr_b16 a[28:29], v13 offset:4168
    ds_read_b64_tr_b16 a[30:31], v13 offset:4680
    ds_read_b64_tr_b16 a[32:33], v13 offset:8192
    ds_read_b64_tr_b16 a[34:35], v13 offset:8704
    ds_read_b64_tr_b16 a[36:37], v13 offset:8200
    ds_read_b64_tr_b16 a[38:39], v13 offset:8712
    ds_read_b64_tr_b16 a[40:41], v13 offset:8256
    ds_read_b64_tr_b16 a[42:43], v13 offset:8768
    ds_read_b64_tr_b16 a[44:45], v13 offset:8264
    ds_read_b64_tr_b16 a[46:47], v13 offset:8776
    ds_read_b64_tr_b16 a[48:49], v13 offset:12288
    ds_read_b64_tr_b16 a[50:51], v13 offset:12800
    ds_read_b64_tr_b16 a[52:53], v13 offset:12296
    ds_read_b64_tr_b16 a[54:55], v13 offset:12808
    ds_read_b64_tr_b16 a[56:57], v13 offset:12352
    ds_read_b64_tr_b16 a[58:59], v13 offset:12864
    ds_read_b64_tr_b16 a[60:61], v13 offset:12360
    ds_read_b64_tr_b16 a[62:63], v13 offset:12872
    ds_read_b64_tr_b16 a[64:65], v13 offset:16384
    ds_read_b64_tr_b16 a[66:67], v13 offset:16896
    ds_read_b64_tr_b16 a[68:69], v13 offset:16392
    ds_read_b64_tr_b16 a[70:71], v13 offset:16904
    ds_read_b64_tr_b16 a[72:73], v13 offset:16448
    ds_read_b64_tr_b16 a[74:75], v13 offset:16960
    ds_read_b64_tr_b16 a[76:77], v13 offset:16456
    ds_read_b64_tr_b16 a[78:79], v13 offset:16968
    s_waitcnt lgkmcnt(0)
    s_add_u32 m0, s48, 0
    s_add_u32 s3, s62, 0x0
    buffer_load_dwordx4 v14, s[28:31], s3 offen lds
    s_add_u32 m0, s48, 1024
    s_add_u32 s3, s62, 0x10000
    buffer_load_dwordx4 v14, s[28:31], s3 offen lds
    s_add_u32 m0, s48, 2048
    s_add_u32 s3, s62, 0x20000
    buffer_load_dwordx4 v14, s[28:31], s3 offen lds
    s_add_u32 m0, s48, 3072
    s_add_u32 s3, s62, 0x30000
    buffer_load_dwordx4 v14, s[28:31], s3 offen lds
    s_add_u32 m0, s48, 4096
    s_add_u32 s3, s62, 0x40000
    buffer_load_dwordx4 v14, s[28:31], s3 offen lds
    s_add_u32 m0, s48, 5120
    s_add_u32 s3, s62, 0x50000
    buffer_load_dwordx4 v14, s[28:31], s3 offen lds
    s_add_u32 m0, s48, 6144
    s_add_u32 s3, s62, 0x60000
    buffer_load_dwordx4 v14, s[28:31], s3 offen lds
    s_add_u32 m0, s48, 7168
    s_add_u32 s3, s62, 0x70000
    buffer_load_dwordx4 v14, s[28:31], s3 offen lds
    s_add_u32 m0, s48, 8192
    s_add_u32 s3, s62, 0x80000
    buffer_load_dwordx4 v14, s[28:31], s3 offen lds
    s_add_u32 m0, s48, 9216
    s_add_u32 s3, s62, 0x90000
    buffer_load_dwordx4 v14, s[28:31], s3 offen lds
    s_add_u32 m0, s48, 10240
    s_add_u32 s3, s62, 0xa0000
    buffer_load_dwordx4 v14, s[28:31], s3 offen lds
    s_add_u32 m0, s48, 11264
    s_add_u32 s3, s62, 0xb0000
    buffer_load_dwordx4 v14, s[28:31], s3 offen lds
    s_add_u32 m0, s48, 12288
    s_add_u32 s3, s62, 0xc0000
    buffer_load_dwordx4 v14, s[28:31], s3 offen lds
    s_add_u32 m0, s48, 13312
    s_add_u32 s3, s62, 0xd0000
    buffer_load_dwordx4 v14, s[28:31], s3 offen lds
    s_add_u32 m0, s48, 14336
    s_add_u32 s3, s62, 0xe0000
    buffer_load_dwordx4 v14, s[28:31], s3 offen lds
    s_add_u32 m0, s48, 15360
    s_add_u32 s3, s62, 0xf0000
    buffer_load_dwordx4 v14, s[28:31], s3 offen lds
    s_add_u32 m0, s48, 16384
    s_add_u32 s3, s62, 0x100000
    buffer_load_dwordx4 v14, s[28:31], s3 offen lds
    s_add_u32 m0, s48, 17408
    s_add_u32 s3, s62, 0x110000
    buffer_load_dwordx4 v14, s[28:31], s3 offen lds
    s_add_u32 m0, s48, 18432
    s_add_u32 s3, s62, 0x120000
    buffer_load_dwordx4 v14, s[28:31], s3 offen lds
    s_add_u32 m0, s48, 19456
    s_add_u32 s3, s62, 0x130000
    buffer_load_dwordx4 v14, s[28:31], s3 offen lds
    s_waitcnt vmcnt(20)
    ds_read_b64_tr_b16 a[80:81], v13 offset:20480
    ds_read_b64_tr_b16 a[82:83], v13 offset:20992
    ds_read_b64_tr_b16 a[84:85], v13 offset:20488
    ds_read_b64_tr_b16 a[86:87], v13 offset:21000
    ds_read_b64_tr_b16 a[88:89], v13 offset:20544
    ds_read_b64_tr_b16 a[90:91], v13 offset:21056
    ds_read_b64_tr_b16 a[92:93], v13 offset:20552
    ds_read_b64_tr_b16 a[94:95], v13 offset:21064
    ds_read_b64_tr_b16 a[96:97], v13 offset:24576
    ds_read_b64_tr_b16 a[98:99], v13 offset:25088
    ds_read_b64_tr_b16 a[100:101], v13 offset:24584
    ds_read_b64_tr_b16 a[102:103], v13 offset:25096
    ds_read_b64_tr_b16 a[104:105], v13 offset:24640
    ds_read_b64_tr_b16 a[106:107], v13 offset:25152
    ds_read_b64_tr_b16 a[108:109], v13 offset:24648
    ds_read_b64_tr_b16 a[110:111], v13 offset:25160
    ds_read_b64_tr_b16 a[112:113], v13 offset:28672
    ds_read_b64_tr_b16 a[114:115], v13 offset:29184
    ds_read_b64_tr_b16 a[116:117], v13 offset:28680
    ds_read_b64_tr_b16 a[118:119], v13 offset:29192
    ds_read_b64_tr_b16 a[120:121], v13 offset:28736
    ds_read_b64_tr_b16 a[122:123], v13 offset:29248
    ds_read_b64_tr_b16 a[124:125], v13 offset:28744
    ds_read_b64_tr_b16 a[126:127], v13 offset:29256
    ds_read_b64_tr_b16 a[128:129], v13 offset:32768
    ds_read_b64_tr_b16 a[130:131], v13 offset:33280
    ds_read_b64_tr_b16 a[132:133], v13 offset:32776
    ds_read_b64_tr_b16 a[134:135], v13 offset:33288
    ds_read_b64_tr_b16 a[136:137], v13 offset:32832
    ds_read_b64_tr_b16 a[138:139], v13 offset:33344
    ds_read_b64_tr_b16 a[140:141], v13 offset:32840
    ds_read_b64_tr_b16 a[142:143], v13 offset:33352
    ds_read_b64_tr_b16 a[144:145], v13 offset:36864
    ds_read_b64_tr_b16 a[146:147], v13 offset:37376
    ds_read_b64_tr_b16 a[148:149], v13 offset:36872
    ds_read_b64_tr_b16 a[150:151], v13 offset:37384
    ds_read_b64_tr_b16 a[152:153], v13 offset:36928
    ds_read_b64_tr_b16 a[154:155], v13 offset:37440
    ds_read_b64_tr_b16 a[156:157], v13 offset:36936
    ds_read_b64_tr_b16 a[158:159], v13 offset:37448
    s_waitcnt lgkmcnt(0)
    s_add_u32 m0, s48, 20480
    s_add_u32 s3, s63, 0x0
    buffer_load_dwordx4 v14, s[28:31], s3 offen lds
    s_add_u32 m0, s48, 21504
    s_add_u32 s3, s63, 0x10000
    buffer_load_dwordx4 v14, s[28:31], s3 offen lds
    s_add_u32 m0, s48, 22528
    s_add_u32 s3, s63, 0x20000
    buffer_load_dwordx4 v14, s[28:31], s3 offen lds
    s_add_u32 m0, s48, 23552
    s_add_u32 s3, s63, 0x30000
    buffer_load_dwordx4 v14, s[28:31], s3 offen lds
    s_add_u32 m0, s48, 24576
    s_add_u32 s3, s63, 0x40000
    buffer_load_dwordx4 v14, s[28:31], s3 offen lds
    s_add_u32 m0, s48, 25600
    s_add_u32 s3, s63, 0x50000
    buffer_load_dwordx4 v14, s[28:31], s3 offen lds
    s_add_u32 m0, s48, 26624
    s_add_u32 s3, s63, 0x60000
    buffer_load_dwordx4 v14, s[28:31], s3 offen lds
    s_add_u32 m0, s48, 27648
    s_add_u32 s3, s63, 0x70000
    buffer_load_dwordx4 v14, s[28:31], s3 offen lds
    s_add_u32 m0, s48, 28672
    s_add_u32 s3, s63, 0x80000
    buffer_load_dwordx4 v14, s[28:31], s3 offen lds
    s_add_u32 m0, s48, 29696
    s_add_u32 s3, s63, 0x90000
    buffer_load_dwordx4 v14, s[28:31], s3 offen lds
    s_add_u32 m0, s48, 30720
    s_add_u32 s3, s63, 0xa0000
    buffer_load_dwordx4 v14, s[28:31], s3 offen lds
    s_add_u32 m0, s48, 31744
    s_add_u32 s3, s63, 0xb0000
    buffer_load_dwordx4 v14, s[28:31], s3 offen lds
    s_add_u32 m0, s48, 32768
    s_add_u32 s3, s63, 0xc0000
    buffer_load_dwordx4 v14, s[28:31], s3 offen lds
    s_add_u32 m0, s48, 33792
    s_add_u32 s3, s63, 0xd0000
    buffer_load_dwordx4 v14, s[28:31], s3 offen lds
    s_add_u32 m0, s48, 34816
    s_add_u32 s3, s63, 0xe0000
    buffer_load_dwordx4 v14, s[28:31], s3 offen lds
    s_add_u32 m0, s48, 35840
    s_add_u32 s3, s63, 0xf0000
    buffer_load_dwordx4 v14, s[28:31], s3 offen lds
    s_add_u32 m0, s48, 36864
    s_add_u32 s3, s63, 0x100000
    buffer_load_dwordx4 v14, s[28:31], s3 offen lds
    s_add_u32 m0, s48, 37888
    s_add_u32 s3, s63, 0x110000
    buffer_load_dwordx4 v14, s[28:31], s3 offen lds
    s_add_u32 m0, s48, 38912
    s_add_u32 s3, s63, 0x120000
    buffer_load_dwordx4 v14, s[28:31], s3 offen lds
    s_add_u32 m0, s48, 39936
    s_add_u32 s3, s63, 0x130000
    buffer_load_dwordx4 v14, s[28:31], s3 offen lds
    s_waitcnt vmcnt(20)
    ds_read_b64_tr_b16 a[160:161], v13 offset:0
    ds_read_b64_tr_b16 a[162:163], v13 offset:512
    ds_read_b64_tr_b16 a[164:165], v13 offset:8
    ds_read_b64_tr_b16 a[166:167], v13 offset:520
    ds_read_b64_tr_b16 a[168:169], v13 offset:64
    ds_read_b64_tr_b16 a[170:171], v13 offset:576
    ds_read_b64_tr_b16 a[172:173], v13 offset:72
    ds_read_b64_tr_b16 a[174:175], v13 offset:584
    ds_read_b64_tr_b16 a[176:177], v13 offset:4096
    ds_read_b64_tr_b16 a[178:179], v13 offset:4608
    ds_read_b64_tr_b16 a[180:181], v13 offset:4104
    ds_read_b64_tr_b16 a[182:183], v13 offset:4616
    ds_read_b64_tr_b16 a[184:185], v13 offset:4160
    ds_read_b64_tr_b16 a[186:187], v13 offset:4672
    ds_read_b64_tr_b16 a[188:189], v13 offset:4168
    ds_read_b64_tr_b16 a[190:191], v13 offset:4680
    ds_read_b64_tr_b16 a[192:193], v13 offset:8192
    ds_read_b64_tr_b16 a[194:195], v13 offset:8704
    ds_read_b64_tr_b16 a[196:197], v13 offset:8200
    ds_read_b64_tr_b16 a[198:199], v13 offset:8712
    ds_read_b64_tr_b16 a[200:201], v13 offset:8256
    ds_read_b64_tr_b16 a[202:203], v13 offset:8768
    ds_read_b64_tr_b16 a[204:205], v13 offset:8264
    ds_read_b64_tr_b16 a[206:207], v13 offset:8776
    ds_read_b64_tr_b16 a[208:209], v13 offset:12288
    ds_read_b64_tr_b16 a[210:211], v13 offset:12800
    ds_read_b64_tr_b16 a[212:213], v13 offset:12296
    ds_read_b64_tr_b16 a[214:215], v13 offset:12808
    ds_read_b64_tr_b16 a[216:217], v13 offset:12352
    ds_read_b64_tr_b16 a[218:219], v13 offset:12864
    ds_read_b64_tr_b16 a[220:221], v13 offset:12360
    ds_read_b64_tr_b16 a[222:223], v13 offset:12872
    ds_read_b64_tr_b16 a[224:225], v13 offset:16384
    ds_read_b64_tr_b16 a[226:227], v13 offset:16896
    ds_read_b64_tr_b16 a[228:229], v13 offset:16392
    ds_read_b64_tr_b16 a[230:231], v13 offset:16904
    ds_read_b64_tr_b16 a[232:233], v13 offset:16448
    ds_read_b64_tr_b16 a[234:235], v13 offset:16960
    ds_read_b64_tr_b16 a[236:237], v13 offset:16456
    ds_read_b64_tr_b16 a[238:239], v13 offset:16968
    s_waitcnt lgkmcnt(0)
    s_waitcnt vmcnt(0)
    ds_read_b64_tr_b16 a[240:241], v13 offset:20480
    ds_read_b64_tr_b16 a[242:243], v13 offset:20992
    ds_read_b64_tr_b16 a[244:245], v13 offset:20488
    ds_read_b64_tr_b16 a[246:247], v13 offset:21000
    ds_read_b64_tr_b16 a[248:249], v13 offset:20544
    ds_read_b64_tr_b16 a[250:251], v13 offset:21056
    ds_read_b64_tr_b16 a[252:253], v13 offset:20552
    ds_read_b64_tr_b16 a[254:255], v13 offset:21064
    ds_read_b64_tr_b16 v[192:193], v13 offset:24576
    ds_read_b64_tr_b16 v[194:195], v13 offset:25088
    ds_read_b64_tr_b16 v[196:197], v13 offset:24584
    ds_read_b64_tr_b16 v[198:199], v13 offset:25096
    ds_read_b64_tr_b16 v[200:201], v13 offset:24640
    ds_read_b64_tr_b16 v[202:203], v13 offset:25152
    ds_read_b64_tr_b16 v[204:205], v13 offset:24648
    ds_read_b64_tr_b16 v[206:207], v13 offset:25160
    ds_read_b64_tr_b16 v[208:209], v13 offset:28672
    ds_read_b64_tr_b16 v[210:211], v13 offset:29184
    ds_read_b64_tr_b16 v[212:213], v13 offset:28680
    ds_read_b64_tr_b16 v[214:215], v13 offset:29192
    ds_read_b64_tr_b16 v[216:217], v13 offset:28736
    ds_read_b64_tr_b16 v[218:219], v13 offset:29248
    ds_read_b64_tr_b16 v[220:221], v13 offset:28744
    ds_read_b64_tr_b16 v[222:223], v13 offset:29256
    ds_read_b64_tr_b16 v[224:225], v13 offset:32768
    ds_read_b64_tr_b16 v[226:227], v13 offset:33280
    ds_read_b64_tr_b16 v[228:229], v13 offset:32776
    ds_read_b64_tr_b16 v[230:231], v13 offset:33288
    ds_read_b64_tr_b16 v[232:233], v13 offset:32832
    ds_read_b64_tr_b16 v[234:235], v13 offset:33344
    ds_read_b64_tr_b16 v[236:237], v13 offset:32840
    ds_read_b64_tr_b16 v[238:239], v13 offset:33352
    ds_read_b64_tr_b16 v[240:241], v13 offset:36864
    ds_read_b64_tr_b16 v[242:243], v13 offset:37376
    ds_read_b64_tr_b16 v[244:245], v13 offset:36872
    ds_read_b64_tr_b16 v[246:247], v13 offset:37384
    ds_read_b64_tr_b16 v[248:249], v13 offset:36928
    ds_read_b64_tr_b16 v[250:251], v13 offset:37440
    ds_read_b64_tr_b16 v[252:253], v13 offset:36936
    ds_read_b64_tr_b16 v[254:255], v13 offset:37448
    s_waitcnt lgkmcnt(0)
    v_mfma_f32_16x16x32_bf16 v[96:99], a[0:3], v[176:179], 0
    v_mfma_f32_16x16x32_bf16 v[100:103], a[4:7], v[176:179], 0
    v_mfma_f32_16x16x32_bf16 v[104:107], a[8:11], v[176:179], 0
    v_mfma_f32_16x16x32_bf16 v[108:111], a[12:15], v[176:179], 0
    v_mfma_f32_16x16x32_bf16 v[96:99], a[16:19], v[176:179], v[96:99]
    v_mfma_f32_16x16x32_bf16 v[100:103], a[20:23], v[176:179], v[100:103]
    v_mfma_f32_16x16x32_bf16 v[104:107], a[24:27], v[176:179], v[104:107]
    v_mfma_f32_16x16x32_bf16 v[108:111], a[28:31], v[176:179], v[108:111]
    v_mfma_f32_16x16x32_bf16 v[96:99], a[32:35], v[176:179], v[96:99]
    v_mfma_f32_16x16x32_bf16 v[100:103], a[36:39], v[176:179], v[100:103]
    v_mfma_f32_16x16x32_bf16 v[104:107], a[40:43], v[176:179], v[104:107]
    v_mfma_f32_16x16x32_bf16 v[108:111], a[44:47], v[176:179], v[108:111]
    v_mfma_f32_16x16x32_bf16 v[96:99], a[48:51], v[176:179], v[96:99]
    v_mfma_f32_16x16x32_bf16 v[100:103], a[52:55], v[176:179], v[100:103]
    v_mfma_f32_16x16x32_bf16 v[104:107], a[56:59], v[176:179], v[104:107]
    v_mfma_f32_16x16x32_bf16 v[108:111], a[60:63], v[176:179], v[108:111]
    v_mfma_f32_16x16x32_bf16 v[96:99], a[64:67], v[176:179], v[96:99]
    v_mfma_f32_16x16x32_bf16 v[100:103], a[68:71], v[176:179], v[100:103]
    v_mfma_f32_16x16x32_bf16 v[104:107], a[72:75], v[176:179], v[104:107]
    v_mfma_f32_16x16x32_bf16 v[108:111], a[76:79], v[176:179], v[108:111]
    v_mfma_f32_16x16x32_bf16 v[96:99], a[80:83], v[176:179], v[96:99]
    v_mfma_f32_16x16x32_bf16 v[100:103], a[84:87], v[176:179], v[100:103]
    v_mfma_f32_16x16x32_bf16 v[104:107], a[88:91], v[176:179], v[104:107]
    v_mfma_f32_16x16x32_bf16 v[108:111], a[92:95], v[176:179], v[108:111]
    v_mfma_f32_16x16x32_bf16 v[96:99], a[96:99], v[176:179], v[96:99]
    v_mfma_f32_16x16x32_bf16 v[100:103], a[100:103], v[176:179], v[100:103]
    v_mfma_f32_16x16x32_bf16 v[104:107], a[104:107], v[176:179], v[104:107]
    v_mfma_f32_16x16x32_bf16 v[108:111], a[108:111], v[176:179], v[108:111]
    v_mfma_f32_16x16x32_bf16 v[96:99], a[112:115], v[176:179], v[96:99]
    v_mfma_f32_16x16x32_bf16 v[100:103], a[116:119], v[176:179], v[100:103]
    v_mfma_f32_16x16x32_bf16 v[104:107], a[120:123], v[176:179], v[104:107]
    v_mfma_f32_16x16x32_bf16 v[108:111], a[124:127], v[176:179], v[108:111]
    v_mfma_f32_16x16x32_bf16 v[96:99], a[128:131], v[176:179], v[96:99]
    v_mfma_f32_16x16x32_bf16 v[100:103], a[132:135], v[176:179], v[100:103]
    v_mfma_f32_16x16x32_bf16 v[104:107], a[136:139], v[176:179], v[104:107]
    v_mfma_f32_16x16x32_bf16 v[108:111], a[140:143], v[176:179], v[108:111]
    v_mfma_f32_16x16x32_bf16 v[96:99], a[144:147], v[176:179], v[96:99]
    v_mfma_f32_16x16x32_bf16 v[100:103], a[148:151], v[176:179], v[100:103]
    v_mfma_f32_16x16x32_bf16 v[104:107], a[152:155], v[176:179], v[104:107]
    v_mfma_f32_16x16x32_bf16 v[108:111], a[156:159], v[176:179], v[108:111]
    v_mfma_f32_16x16x32_bf16 v[96:99], a[160:163], v[176:179], v[96:99]
    v_mfma_f32_16x16x32_bf16 v[100:103], a[164:167], v[176:179], v[100:103]
    v_mfma_f32_16x16x32_bf16 v[104:107], a[168:171], v[176:179], v[104:107]
    v_mfma_f32_16x16x32_bf16 v[108:111], a[172:175], v[176:179], v[108:111]
    v_mfma_f32_16x16x32_bf16 v[96:99], a[176:179], v[176:179], v[96:99]
    v_mfma_f32_16x16x32_bf16 v[100:103], a[180:183], v[176:179], v[100:103]
    v_mfma_f32_16x16x32_bf16 v[104:107], a[184:187], v[176:179], v[104:107]
    v_mfma_f32_16x16x32_bf16 v[108:111], a[188:191], v[176:179], v[108:111]
    v_mfma_f32_16x16x32_bf16 v[96:99], a[192:195], v[176:179], v[96:99]
    v_mfma_f32_16x16x32_bf16 v[100:103], a[196:199], v[176:179], v[100:103]
    v_mfma_f32_16x16x32_bf16 v[104:107], a[200:203], v[176:179], v[104:107]
    v_mfma_f32_16x16x32_bf16 v[108:111], a[204:207], v[176:179], v[108:111]
    v_mfma_f32_16x16x32_bf16 v[96:99], a[208:211], v[176:179], v[96:99]
    v_mfma_f32_16x16x32_bf16 v[100:103], a[212:215], v[176:179], v[100:103]
    v_mfma_f32_16x16x32_bf16 v[104:107], a[216:219], v[176:179], v[104:107]
    v_mfma_f32_16x16x32_bf16 v[108:111], a[220:223], v[176:179], v[108:111]
    v_mfma_f32_16x16x32_bf16 v[96:99], a[224:227], v[176:179], v[96:99]
    v_mfma_f32_16x16x32_bf16 v[100:103], a[228:231], v[176:179], v[100:103]
    v_mfma_f32_16x16x32_bf16 v[104:107], a[232:235], v[176:179], v[104:107]
    v_mfma_f32_16x16x32_bf16 v[108:111], a[236:239], v[176:179], v[108:111]
    v_mfma_f32_16x16x32_bf16 v[96:99], a[240:243], v[176:179], v[96:99]
    v_mfma_f32_16x16x32_bf16 v[100:103], a[244:247], v[176:179], v[100:103]
    v_mfma_f32_16x16x32_bf16 v[104:107], a[248:251], v[176:179], v[104:107]
    v_mfma_f32_16x16x32_bf16 v[108:111], a[252:255], v[176:179], v[108:111]
    v_mfma_f32_16x16x32_bf16 v[96:99], v[192:195], v[176:179], v[96:99]
    v_mfma_f32_16x16x32_bf16 v[100:103], v[196:199], v[176:179], v[100:103]
    v_mfma_f32_16x16x32_bf16 v[104:107], v[200:203], v[176:179], v[104:107]
    v_mfma_f32_16x16x32_bf16 v[108:111], v[204:207], v[176:179], v[108:111]
    v_mfma_f32_16x16x32_bf16 v[96:99], v[208:211], v[176:179], v[96:99]
    v_mfma_f32_16x16x32_bf16 v[100:103], v[212:215], v[176:179], v[100:103]
    v_mfma_f32_16x16x32_bf16 v[104:107], v[216:219], v[176:179], v[104:107]
    v_mfma_f32_16x16x32_bf16 v[108:111], v[220:223], v[176:179], v[108:111]
    v_mfma_f32_16x16x32_bf16 v[96:99], v[224:227], v[176:179], v[96:99]
    v_mfma_f32_16x16x32_bf16 v[100:103], v[228:231], v[176:179], v[100:103]
    v_mfma_f32_16x16x32_bf16 v[104:107], v[232:235], v[176:179], v[104:107]
    v_mfma_f32_16x16x32_bf16 v[108:111], v[236:239], v[176:179], v[108:111]
    v_mfma_f32_16x16x32_bf16 v[96:99], v[240:243], v[176:179], v[96:99]
    v_mfma_f32_16x16x32_bf16 v[100:103], v[244:247], v[176:179], v[100:103]
    v_mfma_f32_16x16x32_bf16 v[104:107], v[248:251], v[176:179], v[104:107]
    v_mfma_f32_16x16x32_bf16 v[108:111], v[252:255], v[176:179], v[108:111]
    s_mov_b32 s24, s8
    s_mov_b32 s25, s9
    s_mov_b32 s26, s10
    s_mov_b32 s27, s11
    v_mov_b32 v6, v1
    s_mov_b32 s35, 1024
    s_mul_i32 s3, s13, 10240
    v_add_u32 v6, s3, v6
    s_lshr_b32 s3, s13, 1
    s_lshl_b32 s64, s19, 1
    s_add_u32 s64, s64, s3
    s_and_b32 s65, s13, 1
    s_lshl_b32 s3, s3, 13
    s_add_u32 s3, s3, 86016
    s_lshl_b32 s59, s65, 11
    s_add_u32 s59, s59, s3
    v_add_u32 v7, s59, v1
    s_lshl_b32 s59, s65, 12
    s_add_u32 s59, s59, s3
    v_add_u32 v12, s59, v1
    v_and_b32 v16, 15, v0
    s_lshl_b32 s3, s65, 4
    v_add_u32 v16, s3, v16
    v_lshrrev_b32 v17, 4, v0
    v_lshlrev_b32 v17, 2, v17
    v_sub_u32 v16, v16, v17
    v_cmp_le_i32 s[66:67], 0, v16
    v_cmp_le_i32 s[68:69], 1, v16
    v_cmp_le_i32 s[70:71], 2, v16
    v_cmp_le_i32 s[72:73], 3, v16
    v_cmp_le_i32 s[74:75], 16, v16
    v_cmp_le_i32 s[76:77], 17, v16
    v_cmp_le_i32 s[78:79], 18, v16
    v_cmp_le_i32 s[80:81], 19, v16
    v_mov_b32 v180, 0xf149f2ca
    v_bfe_u32 v16, v0, 1, 3
    v_and_b32 v17, 48, v0
    v_add_u32 v16, v16, v17
    v_add_u32 v16, 8, v16
    v_lshlrev_b32 v181, 4, v16
    s_mov_b32 s39, 0
    s_mov_b32 s40, 40960
    s_barrier
QA_PAIR:
    s_mul_i32 s17, s14, 0x6000000
    s_add_u32 s17, s17, 0x1000000
    s_lshl_b32 s3, s14, 13
    s_add_u32 s36, s3, 20480
    s_add_u32 s38, s3, 36864
    s_mov_b32 s37, 3
    s_add_u32 s34, s17, 0x700000
    s_lshl_b32 s59, s64, 8
    s_add_u32 s82, s3, s59
    s_lshl_b32 s3, s64, 14
    s_add_u32 s83, s3, s17
    s_add_u32 s83, s83, 0x1000000
    s_lshl_b32 s3, s64, 13
    s_add_u32 s84, s3, s17
    s_add_u32 s84, s84, 0x3000000
    s_lshl_b32 s3, s64, 12
    s_lshl_b32 s59, s65, 17
    s_add_u32 s3, s3, s59
    s_add_u32 s3, s3, s17
    s_add_u32 s45, s3, 0x4000000
    s_mov_b32 s32, s42
    s_mov_b32 s41, 0
QA_SEG:
    s_cmp_ge_u32 s32, 64
    s_cbranch_scc1 QA_NEXTP
    s_cmp_lg_u32 s41, 0
    s_cbranch_scc1 QA_GO
    s_lshl_b32 s49, s32, 7
    s_add_u32 s49, s49, s36
    v_mov_b32 v8, 0
POLL_36:
    buffer_load_dword v9, v8, s[8:11], s49 offen sc1
    s_waitcnt vmcnt(0)
    v_readfirstlane_b32 s58, v9
    s_nop 0
    s_cmp_ge_u32 s58, s37
    s_nop 1
    s_cbranch_scc1 POLLD_37
    s_add_u32 s99, s99, 1
    s_cmp_ge_u32 s99, 0x80000
    s_cbranch_scc1 POLLD_37
    s_sleep 1
    s_branch POLL_36
POLLD_37:
    s_mov_b32 s58, s32
    s_mul_i32 s3, s58, 40960
    s_add_u32 s3, s3, s34
    s_mul_i32 s59, s13, 10240
    s_add_u32 s59, s59, s39
    s_mov_b32 m0, s59
    s_add_u32 s59, s59, 1024
    buffer_load_dwordx4 v6, s[24:27], s3 offen sc1 lds
    s_add_u32 s3, s3, s35
    s_mov_b32 m0, s59
    s_add_u32 s59, s59, 1024
    buffer_load_dwordx4 v6, s[24:27], s3 offen sc1 lds
    s_add_u32 s3, s3, s35
    s_mov_b32 m0, s59
    s_add_u32 s59, s59, 1024
    buffer_load_dwordx4 v6, s[24:27], s3 offen sc1 lds
    s_add_u32 s3, s3, s35
    s_mov_b32 m0, s59
    s_add_u32 s59, s59, 1024
    buffer_load_dwordx4 v6, s[24:27], s3 offen sc1 lds
    s_add_u32 s3, s3, s35
    s_mov_b32 m0, s59
    s_add_u32 s59, s59, 1024
    buffer_load_dwordx4 v6, s[24:27], s3 offen sc1 lds
    s_add_u32 s3, s3, s35
    s_mov_b32 m0, s59
    s_add_u32 s59, s59, 1024
    buffer_load_dwordx4 v6, s[24:27], s3 offen sc1 lds
    s_add_u32 s3, s3, s35
    s_mov_b32 m0, s59
    s_add_u32 s59, s59, 1024
    buffer_load_dwordx4 v6, s[24:27], s3 offen sc1 lds
    s_add_u32 s3, s3, s35
    s_mov_b32 m0, s59
    s_add_u32 s59, s59, 1024
    buffer_load_dwordx4 v6, s[24:27], s3 offen sc1 lds
    s_add_u32 s3, s3, s35
    s_mov_b32 m0, s59
    s_add_u32 s59, s59, 1024
    buffer_load_dwordx4 v6, s[24:27], s3 offen sc1 lds
    s_add_u32 s3, s3, s35
    s_mov_b32 m0, s59
    s_add_u32 s59, s59, 1024
    buffer_load_dwordx4 v6, s[24:27], s3 offen sc1 lds
    s_add_u32 s3, s3, s35
    s_waitcnt vmcnt(0)
QA_GO:
    s_barrier
QA_V0:
    s_add_u32 s58, s32, s33
    s_min_u32 s3, s58, 63
    s_lshl_b32 s3, s3, 7
    s_add_u32 s3, s3, s36
    v_mov_b32 v8, 0
    buffer_load_dword v9, v8, s[8:11], s3 offen sc1
    ds_read_b128 v[64:67], v2 offset:0
    ds_read_b128 v[68:71], v2 offset:20480
    ds_read_b128 v[72:75], v2 offset:1024
    ds_read_b128 v[76:79], v2 offset:21504
    ds_read_b128 v[80:83], v2 offset:2048
    ds_read_b128 v[84:87], v2 offset:22528
    ds_read_b128 v[88:91], v2 offset:3072
    s_waitcnt lgkmcnt(6)
    v_mfma_f32_16x16x32_bf16 v[128:131], a[0:3], v[64:67], 0
    v_mfma_f32_16x16x32_bf16 v[132:135], a[4:7], v[64:67], 0
    v_mfma_f32_16x16x32_bf16 v[136:139], a[8:11], v[64:67], 0
    v_mfma_f32_16x16x32_bf16 v[140:143], a[12:15], v[64:67], 0
    v_mfma_f32_16x16x32_bf16 v[160:163], v[176:179], v[64:67], 0
    v_mfma_f32_16x16x32_bf16 v[168:171], v[64:67], v[64:67], 0
    ds_read_b128 v[92:95], v2 offset:23552
    s_waitcnt lgkmcnt(6)
    v_mfma_f32_16x16x32_bf16 v[144:147], a[0:3], v[68:71], 0
    v_mfma_f32_16x16x32_bf16 v[148:151], a[4:7], v[68:71], 0
    v_mfma_f32_16x16x32_bf16 v[152:155], a[8:11], v[68:71], 0
    v_mfma_f32_16x16x32_bf16 v[156:159], a[12:15], v[68:71], 0
    v_mfma_f32_16x16x32_bf16 v[164:167], v[176:179], v[68:71], 0
    v_mfma_f32_16x16x32_bf16 v[172:175], v[68:71], v[68:71], 0
    ds_read_b128 v[64:67], v2 offset:4096
    s_waitcnt lgkmcnt(6)
    v_mfma_f32_16x16x32_bf16 v[128:131], a[16:19], v[72:75], v[128:131]
    v_mfma_f32_16x16x32_bf16 v[132:135], a[20:23], v[72:75], v[132:135]
    v_mfma_f32_16x16x32_bf16 v[136:139], a[24:27], v[72:75], v[136:139]
    v_mfma_f32_16x16x32_bf16 v[140:143], a[28:31], v[72:75], v[140:143]
    v_mfma_f32_16x16x32_bf16 v[160:163], v[176:179], v[72:75], v[160:163]
    v_mfma_f32_16x16x32_bf16 v[168:171], v[72:75], v[72:75], v[168:171]
    ds_read_b128 v[68:71], v2 offset:24576
    s_waitcnt lgkmcnt(6)
    v_mfma_f32_16x16x32_bf16 v[144:147], a[16:19], v[76:79], v[144:147]
    v_mfma_f32_16x16x32_bf16 v[148:151], a[20:23], v[76:79], v[148:151]
    v_mfma_f32_16x16x32_bf16 v[152:155], a[24:27], v[76:79], v[152:155]
    v_mfma_f32_16x16x32_bf16 v[156:159], a[28:31], v[76:79], v[156:159]
    v_mfma_f32_16x16x32_bf16 v[164:167], v[176:179], v[76:79], v[164:167]
    v_mfma_f32_16x16x32_bf16 v[172:175], v[76:79], v[76:79], v[172:175]
    ds_read_b128 v[72:75], v3 offset:0
    s_waitcnt lgkmcnt(6)
    v_mfma_f32_16x16x32_bf16 v[128:131], a[32:35], v[80:83], v[128:131]
    v_mfma_f32_16x16x32_bf16 v[132:135], a[36:39], v[80:83], v[132:135]
    v_mfma_f32_16x16x32_bf16 v[136:139], a[40:43], v[80:83], v[136:139]
    v_mfma_f32_16x16x32_bf16 v[140:143], a[44:47], v[80:83], v[140:143]
    v_mfma_f32_16x16x32_bf16 v[160:163], v[176:179], v[80:83], v[160:163]
    v_mfma_f32_16x16x32_bf16 v[168:171], v[80:83], v[80:83], v[168:171]
    ds_read_b128 v[76:79], v3 offset:20480
    s_waitcnt lgkmcnt(6)
    v_mfma_f32_16x16x32_bf16 v[144:147], a[32:35], v[84:87], v[144:147]
    v_mfma_f32_16x16x32_bf16 v[148:151], a[36:39], v[84:87], v[148:151]
    v_mfma_f32_16x16x32_bf16 v[152:155], a[40:43], v[84:87], v[152:155]
    v_mfma_f32_16x16x32_bf16 v[156:159], a[44:47], v[84:87], v[156:159]
    v_mfma_f32_16x16x32_bf16 v[164:167], v[176:179], v[84:87], v[164:167]
    v_mfma_f32_16x16x32_bf16 v[172:175], v[84:87], v[84:87], v[172:175]
    ds_read_b128 v[80:83], v3 offset:1024
    s_waitcnt lgkmcnt(6)
    v_mfma_f32_16x16x32_bf16 v[128:131], a[48:51], v[88:91], v[128:131]
    v_mfma_f32_16x16x32_bf16 v[132:135], a[52:55], v[88:91], v[132:135]
    v_mfma_f32_16x16x32_bf16 v[136:139], a[56:59], v[88:91], v[136:139]
    v_mfma_f32_16x16x32_bf16 v[140:143], a[60:63], v[88:91], v[140:143]
    v_mfma_f32_16x16x32_bf16 v[160:163], v[176:179], v[88:91], v[160:163]
    v_mfma_f32_16x16x32_bf16 v[168:171], v[88:91], v[88:91], v[168:171]
    ds_read_b128 v[84:87], v3 offset:21504
    s_waitcnt lgkmcnt(6)
    v_mfma_f32_16x16x32_bf16 v[144:147], a[48:51], v[92:95], v[144:147]
    v_mfma_f32_16x16x32_bf16 v[148:151], a[52:55], v[92:95], v[148:151]
    v_mfma_f32_16x16x32_bf16 v[152:155], a[56:59], v[92:95], v[152:155]
    v_mfma_f32_16x16x32_bf16 v[156:159], a[60:63], v[92:95], v[156:159]
    v_mfma_f32_16x16x32_bf16 v[164:167], v[176:179], v[92:95], v[164:167]
    v_mfma_f32_16x16x32_bf16 v[172:175], v[92:95], v[92:95], v[172:175]
    ds_read_b128 v[88:91], v3 offset:2048
    s_waitcnt lgkmcnt(6)
    v_mfma_f32_16x16x32_bf16 v[128:131], a[64:67], v[64:67], v[128:131]
    v_mfma_f32_16x16x32_bf16 v[132:135], a[68:71], v[64:67], v[132:135]
    v_mfma_f32_16x16x32_bf16 v[136:139], a[72:75], v[64:67], v[136:139]
    v_mfma_f32_16x16x32_bf16 v[140:143], a[76:79], v[64:67], v[140:143]
    v_mfma_f32_16x16x32_bf16 v[160:163], v[176:179], v[64:67], v[160:163]
    v_mfma_f32_16x16x32_bf16 v[168:171], v[64:67], v[64:67], v[168:171]
    ds_read_b128 v[92:95], v3 offset:22528
    s_waitcnt lgkmcnt(6)
    v_mfma_f32_16x16x32_bf16 v[144:147], a[64:67], v[68:71], v[144:147]
    v_mfma_f32_16x16x32_bf16 v[148:151], a[68:71], v[68:71], v[148:151]
    v_mfma_f32_16x16x32_bf16 v[152:155], a[72:75], v[68:71], v[152:155]
    v_mfma_f32_16x16x32_bf16 v[156:159], a[76:79], v[68:71], v[156:159]
    v_mfma_f32_16x16x32_bf16 v[164:167], v[176:179], v[68:71], v[164:167]
    v_mfma_f32_16x16x32_bf16 v[172:175], v[68:71], v[68:71], v[172:175]
    ds_read_b128 v[64:67], v3 offset:3072
    s_waitcnt lgkmcnt(6)
    v_mfma_f32_16x16x32_bf16 v[128:131], a[80:83], v[72:75], v[128:131]
    v_mfma_f32_16x16x32_bf16 v[132:135], a[84:87], v[72:75], v[132:135]
    v_mfma_f32_16x16x32_bf16 v[136:139], a[88:91], v[72:75], v[136:139]
    v_mfma_f32_16x16x32_bf16 v[140:143], a[92:95], v[72:75], v[140:143]
    ds_read_b128 v[68:71], v3 offset:23552
    s_waitcnt lgkmcnt(6)
    v_mfma_f32_16x16x32_bf16 v[144:147], a[80:83], v[76:79], v[144:147]
    v_mfma_f32_16x16x32_bf16 v[148:151], a[84:87], v[76:79], v[148:151]
    v_mfma_f32_16x16x32_bf16 v[152:155], a[88:91], v[76:79], v[152:155]
    v_mfma_f32_16x16x32_bf16 v[156:159], a[92:95], v[76:79], v[156:159]
    ds_read_b128 v[72:75], v3 offset:4096
    s_waitcnt lgkmcnt(6)
    v_mfma_f32_16x16x32_bf16 v[128:131], a[96:99], v[80:83], v[128:131]
    v_mfma_f32_16x16x32_bf16 v[132:135], a[100:103], v[80:83], v[132:135]
    v_mfma_f32_16x16x32_bf16 v[136:139], a[104:107], v[80:83], v[136:139]
    v_mfma_f32_16x16x32_bf16 v[140:143], a[108:111], v[80:83], v[140:143]
    ds_read_b128 v[76:79], v3 offset:24576
    s_waitcnt lgkmcnt(6)
    v_mfma_f32_16x16x32_bf16 v[144:147], a[96:99], v[84:87], v[144:147]
    v_mfma_f32_16x16x32_bf16 v[148:151], a[100:103], v[84:87], v[148:151]
    v_mfma_f32_16x16x32_bf16 v[152:155], a[104:107], v[84:87], v[152:155]
    v_mfma_f32_16x16x32_bf16 v[156:159], a[108:111], v[84:87], v[156:159]
    ds_read_b128 v[80:83], v4 offset:0
    s_waitcnt lgkmcnt(6)
    v_mfma_f32_16x16x32_bf16 v[128:131], a[112:115], v[88:91], v[128:131]
    v_mfma_f32_16x16x32_bf16 v[132:135], a[116:119], v[88:91], v[132:135]
    v_mfma_f32_16x16x32_bf16 v[136:139], a[120:123], v[88:91], v[136:139]
    v_mfma_f32_16x16x32_bf16 v[140:143], a[124:127], v[88:91], v[140:143]
    ds_read_b128 v[84:87], v4 offset:20480
    s_waitcnt lgkmcnt(6)
    v_mfma_f32_16x16x32_bf16 v[144:147], a[112:115], v[92:95], v[144:147]
    v_mfma_f32_16x16x32_bf16 v[148:151], a[116:119], v[92:95], v[148:151]
    v_mfma_f32_16x16x32_bf16 v[152:155], a[120:123], v[92:95], v[152:155]
    v_mfma_f32_16x16x32_bf16 v[156:159], a[124:127], v[92:95], v[156:159]
    ds_read_b128 v[88:91], v4 offset:1024
    s_waitcnt lgkmcnt(6)
    v_mfma_f32_16x16x32_bf16 v[128:131], a[128:131], v[64:67], v[128:131]
    v_mfma_f32_16x16x32_bf16 v[132:135], a[132:135], v[64:67], v[132:135]
    v_mfma_f32_16x16x32_bf16 v[136:139], a[136:139], v[64:67], v[136:139]
    v_mfma_f32_16x16x32_bf16 v[140:143], a[140:143], v[64:67], v[140:143]
    ds_read_b128 v[92:95], v4 offset:21504
    s_waitcnt lgkmcnt(6)
    v_mfma_f32_16x16x32_bf16 v[144:147], a[128:131], v[68:71], v[144:147]
    v_mfma_f32_16x16x32_bf16 v[148:151], a[132:135], v[68:71], v[148:151]
    v_mfma_f32_16x16x32_bf16 v[152:155], a[136:139], v[68:71], v[152:155]
    v_mfma_f32_16x16x32_bf16 v[156:159], a[140:143], v[68:71], v[156:159]
    ds_read_b128 v[64:67], v4 offset:2048
    s_waitcnt lgkmcnt(6)
    v_mfma_f32_16x16x32_bf16 v[128:131], a[144:147], v[72:75], v[128:131]
    v_mfma_f32_16x16x32_bf16 v[132:135], a[148:151], v[72:75], v[132:135]
    v_mfma_f32_16x16x32_bf16 v[136:139], a[152:155], v[72:75], v[136:139]
    v_mfma_f32_16x16x32_bf16 v[140:143], a[156:159], v[72:75], v[140:143]
    ds_read_b128 v[68:71], v4 offset:22528
    s_waitcnt lgkmcnt(6)
    v_mfma_f32_16x16x32_bf16 v[144:147], a[144:147], v[76:79], v[144:147]
    v_mfma_f32_16x16x32_bf16 v[148:151], a[148:151], v[76:79], v[148:151]
    v_mfma_f32_16x16x32_bf16 v[152:155], a[152:155], v[76:79], v[152:155]
    v_mfma_f32_16x16x32_bf16 v[156:159], a[156:159], v[76:79], v[156:159]
    s_waitcnt vmcnt(0)
    v_readfirstlane_b32 s3, v9
    s_nop 0
    s_mov_b32 s41, 0
    s_cmp_ge_u32 s58, 64
    s_cbranch_scc1 NPF_38
    s_cmp_lt_u32 s3, s37
    s_cbranch_scc1 NPF_38
    s_add_u32 s49, s39, s40
    s_mov_b32 s41, 1
    s_mul_i32 s3, s58, 40960
    s_add_u32 s3, s3, s34
    s_mul_i32 s59, s13, 10240
    s_add_u32 s59, s59, s49
    s_mov_b32 m0, s59
    s_add_u32 s59, s59, 1024
    buffer_load_dwordx4 v6, s[24:27], s3 offen sc1 lds
    s_add_u32 s3, s3, s35
    s_mov_b32 m0, s59
    s_add_u32 s59, s59, 1024
    buffer_load_dwordx4 v6, s[24:27], s3 offen sc1 lds
    s_add_u32 s3, s3, s35
    s_mov_b32 m0, s59
    s_add_u32 s59, s59, 1024
    buffer_load_dwordx4 v6, s[24:27], s3 offen sc1 lds
    s_add_u32 s3, s3, s35
    s_mov_b32 m0, s59
    s_add_u32 s59, s59, 1024
    buffer_load_dwordx4 v6, s[24:27], s3 offen sc1 lds
    s_add_u32 s3, s3, s35
    s_mov_b32 m0, s59
    s_add_u32 s59, s59, 1024
    buffer_load_dwordx4 v6, s[24:27], s3 offen sc1 lds
    s_add_u32 s3, s3, s35
    s_mov_b32 m0, s59
    s_add_u32 s59, s59, 1024
    buffer_load_dwordx4 v6, s[24:27], s3 offen sc1 lds
    s_add_u32 s3, s3, s35
    s_mov_b32 m0, s59
    s_add_u32 s59, s59, 1024
    buffer_load_dwordx4 v6, s[24:27], s3 offen sc1 lds
    s_add_u32 s3, s3, s35
    s_mov_b32 m0, s59
    s_add_u32 s59, s59, 1024
    buffer_load_dwordx4 v6, s[24:27], s3 offen sc1 lds
    s_add_u32 s3, s3, s35
    s_mov_b32 m0, s59
    s_add_u32 s59, s59, 1024
    buffer_load_dwordx4 v6, s[24:27], s3 offen sc1 lds
    s_add_u32 s3, s3, s35
    s_mov_b32 m0, s59
    s_add_u32 s59, s59, 1024
    buffer_load_dwordx4 v6, s[24:27], s3 offen sc1 lds
    s_add_u32 s3, s3, s35
NPF_38:
    ds_read_b128 v[72:75], v4 offset:3072
    s_waitcnt lgkmcnt(6)
    v_mfma_f32_16x16x32_bf16 v[128:131], a[160:163], v[80:83], v[128:131]
    v_mfma_f32_16x16x32_bf16 v[132:135], a[164:167], v[80:83], v[132:135]
    v_mfma_f32_16x16x32_bf16 v[136:139], a[168:171], v[80:83], v[136:139]
    v_mfma_f32_16x16x32_bf16 v[140:143], a[172:175], v[80:83], v[140:143]
    ds_read_b128 v[76:79], v4 offset:23552
    s_waitcnt lgkmcnt(6)
    v_mfma_f32_16x16x32_bf16 v[144:147], a[160:163], v[84:87], v[144:147]
    v_mfma_f32_16x16x32_bf16 v[148:151], a[164:167], v[84:87], v[148:151]
    v_mfma_f32_16x16x32_bf16 v[152:155], a[168:171], v[84:87], v[152:155]
    v_mfma_f32_16x16x32_bf16 v[156:159], a[172:175], v[84:87], v[156:159]
    ds_read_b128 v[80:83], v4 offset:4096
    s_waitcnt lgkmcnt(6)
    v_mfma_f32_16x16x32_bf16 v[128:131], a[176:179], v[88:91], v[128:131]
    v_mfma_f32_16x16x32_bf16 v[132:135], a[180:183], v[88:91], v[132:135]
    v_mfma_f32_16x16x32_bf16 v[136:139], a[184:187], v[88:91], v[136:139]
    v_mfma_f32_16x16x32_bf16 v[140:143], a[188:191], v[88:91], v[140:143]
    ds_read_b128 v[84:87], v4 offset:24576
    s_waitcnt lgkmcnt(6)
    v_mfma_f32_16x16x32_bf16 v[144:147], a[176:179], v[92:95], v[144:147]
    v_mfma_f32_16x16x32_bf16 v[148:151], a[180:183], v[92:95], v[148:151]
    v_mfma_f32_16x16x32_bf16 v[152:155], a[184:187], v[92:95], v[152:155]
    v_mfma_f32_16x16x32_bf16 v[156:159], a[188:191], v[92:95], v[156:159]
    ds_read_b128 v[88:91], v5 offset:0
    s_waitcnt lgkmcnt(6)
    v_mfma_f32_16x16x32_bf16 v[128:131], a[192:195], v[64:67], v[128:131]
    v_mfma_f32_16x16x32_bf16 v[132:135], a[196:199], v[64:67], v[132:135]
    v_mfma_f32_16x16x32_bf16 v[136:139], a[200:203], v[64:67], v[136:139]
    v_mfma_f32_16x16x32_bf16 v[140:143], a[204:207], v[64:67], v[140:143]
    ds_read_b128 v[92:95], v5 offset:20480
    s_waitcnt lgkmcnt(6)
    v_mfma_f32_16x16x32_bf16 v[144:147], a[192:195], v[68:71], v[144:147]
    v_mfma_f32_16x16x32_bf16 v[148:151], a[196:199], v[68:71], v[148:151]
    v_mfma_f32_16x16x32_bf16 v[152:155], a[200:203], v[68:71], v[152:155]
    v_mfma_f32_16x16x32_bf16 v[156:159], a[204:207], v[68:71], v[156:159]
    ds_read_b128 v[64:67], v5 offset:1024
    s_waitcnt lgkmcnt(6)
    v_mfma_f32_16x16x32_bf16 v[128:131], a[208:211], v[72:75], v[128:131]
    v_mfma_f32_16x16x32_bf16 v[132:135], a[212:215], v[72:75], v[132:135]
    v_mfma_f32_16x16x32_bf16 v[136:139], a[216:219], v[72:75], v[136:139]
    v_mfma_f32_16x16x32_bf16 v[140:143], a[220:223], v[72:75], v[140:143]
    ds_read_b128 v[68:71], v5 offset:21504
    s_waitcnt lgkmcnt(6)
    v_mfma_f32_16x16x32_bf16 v[144:147], a[208:211], v[76:79], v[144:147]
    v_mfma_f32_16x16x32_bf16 v[148:151], a[212:215], v[76:79], v[148:151]
    v_mfma_f32_16x16x32_bf16 v[152:155], a[216:219], v[76:79], v[152:155]
    v_mfma_f32_16x16x32_bf16 v[156:159], a[220:223], v[76:79], v[156:159]
    ds_read_b128 v[72:75], v5 offset:2048
    s_waitcnt lgkmcnt(6)
    v_mfma_f32_16x16x32_bf16 v[128:131], a[224:227], v[80:83], v[128:131]
    v_mfma_f32_16x16x32_bf16 v[132:135], a[228:231], v[80:83], v[132:135]
    v_mfma_f32_16x16x32_bf16 v[136:139], a[232:235], v[80:83], v[136:139]
    v_mfma_f32_16x16x32_bf16 v[140:143], a[236:239], v[80:83], v[140:143]
    ds_read_b128 v[76:79], v5 offset:22528
    s_waitcnt lgkmcnt(6)
    v_mfma_f32_16x16x32_bf16 v[144:147], a[224:227], v[84:87], v[144:147]
    v_mfma_f32_16x16x32_bf16 v[148:151], a[228:231], v[84:87], v[148:151]
    v_mfma_f32_16x16x32_bf16 v[152:155], a[232:235], v[84:87], v[152:155]
    v_mfma_f32_16x16x32_bf16 v[156:159], a[236:239], v[84:87], v[156:159]
    ds_read_b128 v[80:83], v5 offset:3072
    s_waitcnt lgkmcnt(6)
    v_mfma_f32_16x16x32_bf16 v[128:131], a[240:243], v[88:91], v[128:131]
    v_mfma_f32_16x16x32_bf16 v[132:135], a[244:247], v[88:91], v[132:135]
    v_mfma_f32_16x16x32_bf16 v[136:139], a[248:251], v[88:91], v[136:139]
    v_mfma_f32_16x16x32_bf16 v[140:143], a[252:255], v[88:91], v[140:143]
    ds_read_b128 v[84:87], v5 offset:23552
    s_waitcnt lgkmcnt(6)
    v_mfma_f32_16x16x32_bf16 v[144:147], a[240:243], v[92:95], v[144:147]
    v_mfma_f32_16x16x32_bf16 v[148:151], a[244:247], v[92:95], v[148:151]
    v_mfma_f32_16x16x32_bf16 v[152:155], a[248:251], v[92:95], v[152:155]
    v_mfma_f32_16x16x32_bf16 v[156:159], a[252:255], v[92:95], v[156:159]
    ds_read_b128 v[88:91], v5 offset:4096
    s_waitcnt lgkmcnt(6)
    v_mfma_f32_16x16x32_bf16 v[128:131], v[192:195], v[64:67], v[128:131]
    v_mfma_f32_16x16x32_bf16 v[132:135], v[196:199], v[64:67], v[132:135]
    v_mfma_f32_16x16x32_bf16 v[136:139], v[200:203], v[64:67], v[136:139]
    v_mfma_f32_16x16x32_bf16 v[140:143], v[204:207], v[64:67], v[140:143]
    ds_read_b128 v[92:95], v5 offset:24576
    s_waitcnt lgkmcnt(6)
    v_mfma_f32_16x16x32_bf16 v[144:147], v[192:195], v[68:71], v[144:147]
    v_mfma_f32_16x16x32_bf16 v[148:151], v[196:199], v[68:71], v[148:151]
    v_mfma_f32_16x16x32_bf16 v[152:155], v[200:203], v[68:71], v[152:155]
    v_mfma_f32_16x16x32_bf16 v[156:159], v[204:207], v[68:71], v[156:159]
    s_waitcnt lgkmcnt(5)
    v_mfma_f32_16x16x32_bf16 v[128:131], v[208:211], v[72:75], v[128:131]
    v_mfma_f32_16x16x32_bf16 v[132:135], v[212:215], v[72:75], v[132:135]
    v_mfma_f32_16x16x32_bf16 v[136:139], v[216:219], v[72:75], v[136:139]
    v_mfma_f32_16x16x32_bf16 v[140:143], v[220:223], v[72:75], v[140:143]
    s_waitcnt lgkmcnt(4)
    v_mfma_f32_16x16x32_bf16 v[144:147], v[208:211], v[76:79], v[144:147]
    v_mfma_f32_16x16x32_bf16 v[148:151], v[212:215], v[76:79], v[148:151]
    v_mfma_f32_16x16x32_bf16 v[152:155], v[216:219], v[76:79], v[152:155]
    v_mfma_f32_16x16x32_bf16 v[156:159], v[220:223], v[76:79], v[156:159]
    s_waitcnt lgkmcnt(3)
    v_mfma_f32_16x16x32_bf16 v[128:131], v[224:227], v[80:83], v[128:131]
    v_mfma_f32_16x16x32_bf16 v[132:135], v[228:231], v[80:83], v[132:135]
    v_mfma_f32_16x16x32_bf16 v[136:139], v[232:235], v[80:83], v[136:139]
    v_mfma_f32_16x16x32_bf16 v[140:143], v[236:239], v[80:83], v[140:143]
    s_waitcnt lgkmcnt(2)
    v_mfma_f32_16x16x32_bf16 v[144:147], v[224:227], v[84:87], v[144:147]
    v_mfma_f32_16x16x32_bf16 v[148:151], v[228:231], v[84:87], v[148:151]
    v_mfma_f32_16x16x32_bf16 v[152:155], v[232:235], v[84:87], v[152:155]
    v_mfma_f32_16x16x32_bf16 v[156:159], v[236:239], v[84:87], v[156:159]
    s_waitcnt lgkmcnt(1)
    v_mfma_f32_16x16x32_bf16 v[128:131], v[240:243], v[88:91], v[128:131]
    v_mfma_f32_16x16x32_bf16 v[132:135], v[244:247], v[88:91], v[132:135]
    v_mfma_f32_16x16x32_bf16 v[136:139], v[248:251], v[88:91], v[136:139]
    v_mfma_f32_16x16x32_bf16 v[140:143], v[252:255], v[88:91], v[140:143]
    s_waitcnt lgkmcnt(0)
    v_mfma_f32_16x16x32_bf16 v[144:147], v[240:243], v[92:95], v[144:147]
    v_mfma_f32_16x16x32_bf16 v[148:151], v[244:247], v[92:95], v[148:151]
    v_mfma_f32_16x16x32_bf16 v[152:155], v[248:251], v[92:95], v[152:155]
    v_mfma_f32_16x16x32_bf16 v[156:159], v[252:255], v[92:95], v[156:159]
    v_cndmask_b32 v168, v168, v169, s[50:51]
    v_cndmask_b32 v168, v168, v170, s[52:53]
    v_cndmask_b32 v168, v168, v171, s[54:55]
    v_mov_b32 v161, v168
    v_cndmask_b32 v172, v172, v173, s[50:51]
    v_cndmask_b32 v172, v172, v174, s[52:53]
    v_cndmask_b32 v172, v172, v175, s[54:55]
    v_mov_b32 v165, v172
    s_mov_b64 exec, s[56:57]
    ds_write_b64 v10, v[160:161] offset:0
    ds_write_b64 v10, v[164:165] offset:128
    s_mov_b64 exec, -1
    s_waitcnt lgkmcnt(0)
    s_barrier
    ds_read_b64 v[20:21], v11 offset:0
    ds_read_b64 v[22:23], v11 offset:256
    ds_read_b64 v[24:25], v11 offset:512
    ds_read_b64 v[26:27], v11 offset:768
    ds_read_b64 v[28:29], v11 offset:128
    ds_read_b64 v[30:31], v11 offset:384
    ds_read_b64 v[32:33], v11 offset:640
    ds_read_b64 v[34:35], v11 offset:896
    s_waitcnt lgkmcnt(0)
    v_pk_add_f32 v[20:21], v[20:21], v[22:23]
    v_pk_add_f32 v[24:25], v[24:25], v[26:27]
    v_pk_add_f32 v[20:21], v[20:21], v[24:25]
    v_mul_f32 v20, 0x3acccccd, v20
    v_mul_f32 v21, 0x3acccccd, v21
    v_fma_f32 v21, -v20, v20, v21
    v_max_f32 v21, 0, v21
    v_cvt_pk_bf16_f32 v16, v20, v20
    v_lshlrev_b32 v16, 16, v16
    v_cvt_pk_bf16_f32 v21, v21, v21
    v_lshlrev_b32 v21, 16, v21
    v_add_f32 v21, 0x3727c5ac, v21
    v_cvt_pk_bf16_f32 v21, v21, v21
    v_lshlrev_b32 v21, 16, v21
    v_sqrt_f32 v21, v21
    s_nop 0
    v_cvt_pk_bf16_f32 v21, v21, v21
    v_lshlrev_b32 v21, 16, v21
    v_rcp_f32 v18, v21
    v_pk_add_f32 v[28:29], v[28:29], v[30:31]
    v_pk_add_f32 v[32:33], v[32:33], v[34:35]
    v_pk_add_f32 v[28:29], v[28:29], v[32:33]
    v_mul_f32 v28, 0x3acccccd, v28
    v_mul_f32 v29, 0x3acccccd, v29
    v_fma_f32 v29, -v28, v28, v29
    v_max_f32 v29, 0, v29
    v_cvt_pk_bf16_f32 v17, v28, v28
    v_lshlrev_b32 v17, 16, v17
    v_cvt_pk_bf16_f32 v29, v29, v29
    v_lshlrev_b32 v29, 16, v29
    v_add_f32 v29, 0x3727c5ac, v29
    v_cvt_pk_bf16_f32 v29, v29, v29
    v_lshlrev_b32 v29, 16, v29
    v_sqrt_f32 v29, v29
    s_nop 0
    v_cvt_pk_bf16_f32 v29, v29, v29
    v_lshlrev_b32 v29, 16, v29
    v_rcp_f32 v19, v29
    v_fma_f32 v128, -v16, v96, v128
    v_mul_f32 v128, v128, v18
    v_fma_f32 v129, -v16, v97, v129
    v_mul_f32 v129, v129, v18
    v_fma_f32 v130, -v16, v98, v130
    v_mul_f32 v130, v130, v18
    v_fma_f32 v131, -v16, v99, v131
    v_mul_f32 v131, v131, v18
    v_fma_f32 v132, -v16, v100, v132
    v_mul_f32 v132, v132, v18
    v_fma_f32 v133, -v16, v101, v133
    v_mul_f32 v133, v133, v18
    v_fma_f32 v134, -v16, v102, v134
    v_mul_f32 v134, v134, v18
    v_fma_f32 v135, -v16, v103, v135
    v_mul_f32 v135, v135, v18
    v_fma_f32 v136, -v16, v104, v136
    v_mul_f32 v136, v136, v18
    v_fma_f32 v137, -v16, v105, v137
    v_mul_f32 v137, v137, v18
    v_fma_f32 v138, -v16, v106, v138
    v_mul_f32 v138, v138, v18
    v_fma_f32 v139, -v16, v107, v139
    v_mul_f32 v139, v139, v18
    v_fma_f32 v140, -v16, v108, v140
    v_mul_f32 v140, v140, v18
    v_fma_f32 v141, -v16, v109, v141
    v_mul_f32 v141, v141, v18
    v_fma_f32 v142, -v16, v110, v142
    v_mul_f32 v142, v142, v18
    v_fma_f32 v143, -v16, v111, v143
    v_mul_f32 v143, v143, v18
    v_fma_f32 v144, -v17, v96, v144
    v_mul_f32 v144, v144, v19
    v_fma_f32 v145, -v17, v97, v145
    v_mul_f32 v145, v145, v19
    v_fma_f32 v146, -v17, v98, v146
    v_mul_f32 v146, v146, v19
    v_fma_f32 v147, -v17, v99, v147
    v_mul_f32 v147, v147, v19
    v_fma_f32 v148, -v17, v100, v148
    v_mul_f32 v148, v148, v19
    v_fma_f32 v149, -v17, v101, v149
    v_mul_f32 v149, v149, v19
    v_fma_f32 v150, -v17, v102, v150
    v_mul_f32 v150, v150, v19
    v_fma_f32 v151, -v17, v103, v151
    v_mul_f32 v151, v151, v19
    v_fma_f32 v152, -v17, v104, v152
    v_mul_f32 v152, v152, v19
    v_fma_f32 v153, -v17, v105, v153
    v_mul_f32 v153, v153, v19
    v_fma_f32 v154, -v17, v106, v154
    v_mul_f32 v154, v154, v19
    v_fma_f32 v155, -v17, v107, v155
    v_mul_f32 v155, v155, v19
    v_fma_f32 v156, -v17, v108, v156
    v_mul_f32 v156, v156, v19
    v_fma_f32 v157, -v17, v109, v157
    v_mul_f32 v157, v157, v19
    v_fma_f32 v158, -v17, v110, v158
    v_mul_f32 v158, v158, v19
    v_fma_f32 v159, -v17, v111, v159
    v_mul_f32 v159, v159, v19
    v_cvt_pk_bf16_f32 v20, v128, v129
    v_cvt_pk_bf16_f32 v21, v130, v131
    v_cvt_pk_bf16_f32 v22, v132, v133
    v_cvt_pk_bf16_f32 v23, v134, v135
    ds_write_b128 v7, v[20:23] offset:0
    v_cvt_pk_bf16_f32 v24, v136, v137
    v_cvt_pk_bf16_f32 v25, v138, v139
    v_cvt_pk_bf16_f32 v26, v140, v141
    v_cvt_pk_bf16_f32 v27, v142, v143
    ds_write_b128 v7, v[24:27] offset:1024
    v_cvt_pk_bf16_f32 v28, v144, v145
    v_cvt_pk_bf16_f32 v29, v146, v147
    v_cvt_pk_bf16_f32 v30, v148, v149
    v_cvt_pk_bf16_f32 v31, v150, v151
    ds_write_b128 v7, v[28:31] offset:4096
    v_cvt_pk_bf16_f32 v32, v152, v153
    v_cvt_pk_bf16_f32 v33, v154, v155
    v_cvt_pk_bf16_f32 v34, v156, v157
    v_cvt_pk_bf16_f32 v35, v158, v159
    ds_write_b128 v7, v[32:35] offset:5120
    s_waitcnt lgkmcnt(0)
    s_barrier
    ds_read_b128 v[128:131], v12 offset:0
    ds_read_b128 v[132:135], v12 offset:1024
    ds_read_b128 v[136:139], v12 offset:2048
    ds_read_b128 v[140:143], v12 offset:3072
    s_lshl_b32 s85, s32, 2
    s_add_u32 s85, s85, s82
    s_add_u32 s49, s85, 69632
    v_mov_b32 v8, 0
POLL_39:
    buffer_load_dword v9, v8, s[8:11], s49 offen sc1
    s_waitcnt vmcnt(0)
    v_readfirstlane_b32 s58, v9
    s_nop 0
    s_cmp_ge_u32 s58, 1
    s_nop 1
    s_cbranch_scc1 POLLD_40
    s_add_u32 s99, s99, 1
    s_cmp_ge_u32 s99, 0x80000
    s_cbranch_scc1 POLLD_40
    s_sleep 1
    s_branch POLL_39
POLLD_40:
    s_lshl_b32 s49, s32, 19
    s_add_u32 s49, s49, s83
    buffer_load_dwordx4 v[16:19], v1, s[8:11], s49 offen offset:0 sc1
    buffer_load_dwordx4 v[32:35], v1, s[8:11], s49 offen offset:1024 sc1
    buffer_load_dwordx4 v[64:67], v1, s[8:11], s49 offen offset:2048 sc1
    buffer_load_dwordx4 v[68:71], v1, s[8:11], s49 offen offset:3072 sc1
    s_add_u32 s49, s49, 4096
    buffer_load_dwordx4 v[20:23], v1, s[8:11], s49 offen offset:0 sc1
    buffer_load_dwordx4 v[36:39], v1, s[8:11], s49 offen offset:1024 sc1
    buffer_load_dwordx4 v[72:75], v1, s[8:11], s49 offen offset:2048 sc1
    buffer_load_dwordx4 v[76:79], v1, s[8:11], s49 offen offset:3072 sc1
    s_add_u32 s49, s49, 4096
    buffer_load_dwordx4 v[24:27], v1, s[8:11], s49 offen offset:0 sc1
    buffer_load_dwordx4 v[40:43], v1, s[8:11], s49 offen offset:1024 sc1
    buffer_load_dwordx4 v[80:83], v1, s[8:11], s49 offen offset:2048 sc1
    buffer_load_dwordx4 v[84:87], v1, s[8:11], s49 offen offset:3072 sc1
    s_add_u32 s49, s49, 4096
    buffer_load_dwordx4 v[28:31], v1, s[8:11], s49 offen offset:0 sc1
    buffer_load_dwordx4 v[44:47], v1, s[8:11], s49 offen offset:1024 sc1
    buffer_load_dwordx4 v[88:91], v1, s[8:11], s49 offen offset:2048 sc1
    buffer_load_dwordx4 v[92:95], v1, s[8:11], s49 offen offset:3072 sc1
    s_add_u32 s49, s49, 4096
    s_add_u32 s49, s85, 86016
    v_mov_b32 v8, 0
POLL_41:
    buffer_load_dword v9, v8, s[8:11], s49 offen sc1
    s_waitcnt vmcnt(0)
    v_readfirstlane_b32 s58, v9
    s_nop 0
    s_cmp_ge_u32 s58, 1
    s_nop 1
    s_cbranch_scc1 POLLD_42
    s_add_u32 s99, s99, 1
    s_cmp_ge_u32 s99, 0x80000
    s_cbranch_scc1 POLLD_42
    s_sleep 1
    s_branch POLL_41
POLLD_42:
    s_lshl_b32 s49, s32, 18
    s_add_u32 s49, s49, s84
    s_add_u32 s59, s49, 4096
    buffer_load_dwordx4 v[48:51], v181, s[8:11], s49 offen offset:0 sc1
    buffer_load_dwordx4 v[52:55], v181, s[8:11], s49 offen offset:2048 sc1
    buffer_load_dwordx4 v[56:59], v181, s[8:11], s59 offen offset:0 sc1
    buffer_load_dwordx4 v[60:63], v181, s[8:11], s59 offen offset:2048 sc1
    buffer_load_dwordx4 v[112:115], v1, s[8:11], s49 offen offset:1024 sc1
    buffer_load_dwordx4 v[116:119], v1, s[8:11], s49 offen offset:3072 sc1
    buffer_load_dwordx4 v[120:123], v1, s[8:11], s59 offen offset:1024 sc1
    buffer_load_dwordx4 v[124:127], v1, s[8:11], s59 offen offset:3072 sc1
    s_waitcnt lgkmcnt(0)
    v_mfma_f32_16x16x32_bf16 v[148:151], v[16:19], v[128:131], 0
    v_mfma_f32_16x16x32_bf16 v[152:155], v[32:35], v[128:131], 0
    v_mfma_f32_16x16x32_bf16 v[148:151], v[20:23], v[132:135], v[148:151]
    v_mfma_f32_16x16x32_bf16 v[152:155], v[36:39], v[132:135], v[152:155]
    v_mfma_f32_16x16x32_bf16 v[148:151], v[24:27], v[136:139], v[148:151]
    v_mfma_f32_16x16x32_bf16 v[152:155], v[40:43], v[136:139], v[152:155]
    v_mfma_f32_16x16x32_bf16 v[148:151], v[28:31], v[140:143], v[148:151]
    v_mfma_f32_16x16x32_bf16 v[152:155], v[44:47], v[140:143], v[152:155]
    s_nop 6
    v_cndmask_b32 v148, v180, v148, s[66:67]
    v_cndmask_b32 v149, v180, v149, s[68:69]
    v_cndmask_b32 v150, v180, v150, s[70:71]
    v_cndmask_b32 v151, v180, v151, s[72:73]
    v_cndmask_b32 v152, v180, v152, s[74:75]
    v_cndmask_b32 v153, v180, v153, s[76:77]
    v_cndmask_b32 v154, v180, v154, s[78:79]
    v_cndmask_b32 v155, v180, v155, s[80:81]
    s_waitcnt vmcnt(4)
    v_mfma_f32_16x16x32_bf16 v[144:147], v[48:51], v[128:131], 0
    v_mfma_f32_16x16x32_bf16 v[144:147], v[52:55], v[132:135], v[144:147]
    v_mfma_f32_16x16x32_bf16 v[144:147], v[56:59], v[136:139], v[144:147]
    v_mfma_f32_16x16x32_bf16 v[144:147], v[60:63], v[140:143], v[144:147]
    v_max3_f32 v162, v148, v149, v150
    v_max3_f32 v162, v162, v151, v152
    v_max3_f32 v162, v162, v153, v154
    s_nop 4
    v_mul_f32 v144, 0x3e0293ee, v144
    v_mul_f32 v145, 0x3e0293ee, v145
    v_mul_f32 v146, 0x3e0293ee, v146
    v_mul_f32 v147, 0x3e0293ee, v147
    v_max3_f32 v162, v162, v155, v144
    v_max3_f32 v162, v162, v145, v146
    v_max_f32 v162, v162, v147
    v_mov_b32 v163, v162
    s_nop 1
    v_permlane32_swap_b32 v162, v163
    v_max_f32 v162, v162, v163
    v_mov_b32 v163, v162
    s_nop 1
    v_permlane16_swap_b32 v162, v163
    v_max_f32 v162, v162, v163
    v_sub_f32 v144, v144, v162
    v_sub_f32 v145, v145, v162
    v_sub_f32 v146, v146, v162
    v_sub_f32 v147, v147, v162
    v_sub_f32 v148, v148, v162
    v_sub_f32 v149, v149, v162
    v_sub_f32 v150, v150, v162
    v_sub_f32 v151, v151, v162
    v_sub_f32 v152, v152, v162
    v_sub_f32 v153, v153, v162
    v_sub_f32 v154, v154, v162
    v_sub_f32 v155, v155, v162
    v_exp_f32 v144, v144
    v_exp_f32 v145, v145
    v_exp_f32 v146, v146
    v_exp_f32 v147, v147
    v_exp_f32 v148, v148
    v_exp_f32 v149, v149
    v_exp_f32 v150, v150
    v_exp_f32 v151, v151
    v_exp_f32 v152, v152
    v_exp_f32 v153, v153
    v_exp_f32 v154, v154
    v_exp_f32 v155, v155
    v_add_f32 v162, v144, v145
    v_add_f32 v163, v146, v147
    v_add_f32 v162, v162, v163
    v_mul_f32 v162, 0.5, v162
    v_add_f32 v162, v162, v148
    v_add_f32 v162, v162, v149
    v_add_f32 v162, v162, v150
    v_add_f32 v162, v162, v151
    v_add_f32 v162, v162, v152
    v_add_f32 v162, v162, v153
    v_add_f32 v162, v162, v154
    v_add_f32 v162, v162, v155
    v_mov_b32 v163, v162
    s_nop 1
    v_permlane32_swap_b32 v162, v163
    v_add_f32 v162, v162, v163
    v_mov_b32 v163, v162
    s_nop 1
    v_permlane16_swap_b32 v162, v163
    v_add_f32 v162, v162, v163
    v_rcp_f32 v162, v162
    s_nop 0
    v_mul_f32 v144, v144, v162
    v_mul_f32 v145, v145, v162
    v_mul_f32 v146, v146, v162
    v_mul_f32 v147, v147, v162
    v_mul_f32 v148, v148, v162
    v_mul_f32 v149, v149, v162
    v_mul_f32 v150, v150, v162
    v_mul_f32 v151, v151, v162
    v_mul_f32 v152, v152, v162
    v_mul_f32 v153, v153, v162
    v_mul_f32 v154, v154, v162
    v_mul_f32 v155, v155, v162
    v_cvt_pk_bf16_f32 v160, v144, v145
    v_cvt_pk_bf16_f32 v161, v146, v147
    v_cvt_pk_bf16_f32 v156, v148, v149
    v_cvt_pk_bf16_f32 v157, v150, v151
    v_cvt_pk_bf16_f32 v158, v152, v153
    v_cvt_pk_bf16_f32 v159, v154, v155
    s_waitcnt vmcnt(0)
    s_nop 0
    v_mfma_f32_16x16x32_bf16 v[16:19], v[64:67], v[156:159], 0
    v_mfma_f32_16x16x32_bf16 v[20:23], v[68:71], v[156:159], 0
    v_mfma_f32_16x16x32_bf16 v[24:27], v[72:75], v[156:159], 0
    v_mfma_f32_16x16x32_bf16 v[28:31], v[76:79], v[156:159], 0
    v_mfma_f32_16x16x32_bf16 v[32:35], v[80:83], v[156:159], 0
    v_mfma_f32_16x16x32_bf16 v[36:39], v[84:87], v[156:159], 0
    v_mfma_f32_16x16x32_bf16 v[40:43], v[88:91], v[156:159], 0
    v_mfma_f32_16x16x32_bf16 v[44:47], v[92:95], v[156:159], 0
    v_mfma_f32_16x16x16_bf16 v[16:19], v[112:113], v[160:161], v[16:19]
    v_mfma_f32_16x16x16_bf16 v[20:23], v[114:115], v[160:161], v[20:23]
    v_mfma_f32_16x16x16_bf16 v[24:27], v[116:117], v[160:161], v[24:27]
    v_mfma_f32_16x16x16_bf16 v[28:31], v[118:119], v[160:161], v[28:31]
    v_mfma_f32_16x16x16_bf16 v[32:35], v[120:121], v[160:161], v[32:35]
    v_mfma_f32_16x16x16_bf16 v[36:39], v[122:123], v[160:161], v[36:39]
    v_mfma_f32_16x16x16_bf16 v[40:43], v[124:125], v[160:161], v[40:43]
    v_mfma_f32_16x16x16_bf16 v[44:47], v[126:127], v[160:161], v[44:47]
    s_lshl_b32 s49, s32, 18
    s_add_u32 s49, s49, s45
    v_cvt_pk_bf16_f32 v48, v16, v17
    v_cvt_pk_bf16_f32 v49, v18, v19
    v_cvt_pk_bf16_f32 v50, v20, v21
    v_cvt_pk_bf16_f32 v51, v22, v23
    buffer_store_dwordx4 v[48:51], v1, s[8:11], s49 offen offset:0 sc1
    v_cvt_pk_bf16_f32 v52, v24, v25
    v_cvt_pk_bf16_f32 v53, v26, v27
    v_cvt_pk_bf16_f32 v54, v28, v29
    v_cvt_pk_bf16_f32 v55, v30, v31
    buffer_store_dwordx4 v[52:55], v1, s[8:11], s49 offen offset:1024 sc1
    v_cvt_pk_bf16_f32 v56, v32, v33
    v_cvt_pk_bf16_f32 v57, v34, v35
    v_cvt_pk_bf16_f32 v58, v36, v37
    v_cvt_pk_bf16_f32 v59, v38, v39
    buffer_store_dwordx4 v[56:59], v1, s[8:11], s49 offen offset:2048 sc1
    v_cvt_pk_bf16_f32 v60, v40, v41
    v_cvt_pk_bf16_f32 v61, v42, v43
    v_cvt_pk_bf16_f32 v62, v44, v45
    v_cvt_pk_bf16_f32 v63, v46, v47
    buffer_store_dwordx4 v[60:63], v1, s[8:11], s49 offen offset:3072 sc1
QA_END:
    s_waitcnt vmcnt(0)
    s_barrier
    s_lshl_b32 s49, s32, 7
    s_add_u32 s49, s49, s38
    s_cmp_lg_u32 s13, 0
    s_cbranch_scc1 SIG_43
    v_mov_b32 v8, 0
    v_mov_b32 v9, 1
    s_mov_b64 exec, 1
    buffer_atomic_add v9, v8, s[8:11], s49 offen sc1
    s_mov_b64 exec, -1
SIG_43:
    v_add_u32 v2, s40, v2
    v_add_u32 v3, s40, v3
    v_add_u32 v4, s40, v4
    v_add_u32 v5, s40, v5
    s_add_u32 s39, s39, s40
    s_sub_u32 s40, 0, s40
    s_add_u32 s32, s32, s33
    s_branch QA_SEG
QA_NEXTP:
    s_add_u32 s14, s14, 1
    s_cmp_lt_u32 s14, s15
    s_cbranch_scc1 QA_PAIR
    s_endpgm
ROLE_BO:
    s_mul_i32 s42, s12, 13
    s_lshr_b32 s42, s42, 8
    s_mul_i32 s3, s42, 20
    s_sub_u32 s19, s12, s3
    v_lshlrev_b32 v1, 4, v0
    v_lshrrev_b32 v16, 4, v0
    v_lshlrev_b32 v16, 9, v16
    v_bfe_u32 v17, v0, 2, 2
    v_lshl_add_u32 v16, v17, 6, v16
    v_and_b32 v17, 3, v0
    v_lshl_add_u32 v16, v17, 4, v16
    s_mul_i32 s48, s13, 40960
    v_add_u32 v13, s48, v16
    v_lshrrev_b32 v16, 2, v0
    v_mul_u32_u24 v16, 1280, v16
    v_lshl_add_u32 v14, v17, 4, v16
    s_load_dwordx2 s[4:5], s[0:1], 80
    s_waitcnt lgkmcnt(0)
    s_mov_b32 s28, s4
    s_mov_b32 s29, s5
    s_mov_b32 s30, 0x500000
    s_mov_b32 s31, 0x20000
    s_mul_i32 s60, s13, 1310720
    s_lshl_b32 s3, s19, 6
    s_add_u32 s60, s60, s3
    s_add_u32 m0, s48, 0
    s_add_u32 s3, s60, 0x0
    buffer_load_dwordx4 v14, s[28:31], s3 offen lds
    s_add_u32 m0, s48, 1024
    s_add_u32 s3, s60, 0x5000
    buffer_load_dwordx4 v14, s[28:31], s3 offen lds
    s_add_u32 m0, s48, 2048
    s_add_u32 s3, s60, 0xa000
    buffer_load_dwordx4 v14, s[28:31], s3 offen lds
    s_add_u32 m0, s48, 3072
    s_add_u32 s3, s60, 0xf000
    buffer_load_dwordx4 v14, s[28:31], s3 offen lds
    s_add_u32 m0, s48, 4096
    s_add_u32 s3, s60, 0x14000
    buffer_load_dwordx4 v14, s[28:31], s3 offen lds
    s_add_u32 m0, s48, 5120
    s_add_u32 s3, s60, 0x19000
    buffer_load_dwordx4 v14, s[28:31], s3 offen lds
    s_add_u32 m0, s48, 6144
    s_add_u32 s3, s60, 0x1e000
    buffer_load_dwordx4 v14, s[28:31], s3 offen lds
    s_add_u32 m0, s48, 7168
    s_add_u32 s3, s60, 0x23000
    buffer_load_dwordx4 v14, s[28:31], s3 offen lds
    s_add_u32 m0, s48, 8192
    s_add_u32 s3, s60, 0x28000
    buffer_load_dwordx4 v14, s[28:31], s3 offen lds
    s_add_u32 m0, s48, 9216
    s_add_u32 s3, s60, 0x2d000
    buffer_load_dwordx4 v14, s[28:31], s3 offen lds
    s_add_u32 m0, s48, 10240
    s_add_u32 s3, s60, 0x32000
    buffer_load_dwordx4 v14, s[28:31], s3 offen lds
    s_add_u32 m0, s48, 11264
    s_add_u32 s3, s60, 0x37000
    buffer_load_dwordx4 v14, s[28:31], s3 offen lds
    s_add_u32 m0, s48, 12288
    s_add_u32 s3, s60, 0x3c000
    buffer_load_dwordx4 v14, s[28:31], s3 offen lds
    s_add_u32 m0, s48, 13312
    s_add_u32 s3, s60, 0x41000
    buffer_load_dwordx4 v14, s[28:31], s3 offen lds
    s_add_u32 m0, s48, 14336
    s_add_u32 s3, s60, 0x46000
    buffer_load_dwordx4 v14, s[28:31], s3 offen lds
    s_add_u32 m0, s48, 15360
    s_add_u32 s3, s60, 0x4b000
    buffer_load_dwordx4 v14, s[28:31], s3 offen lds
    s_add_u32 m0, s48, 16384
    s_add_u32 s3, s60, 0x50000
    buffer_load_dwordx4 v14, s[28:31], s3 offen lds
    s_add_u32 m0, s48, 17408
    s_add_u32 s3, s60, 0x55000
    buffer_load_dwordx4 v14, s[28:31], s3 offen lds
    s_add_u32 m0, s48, 18432
    s_add_u32 s3, s60, 0x5a000
    buffer_load_dwordx4 v14, s[28:31], s3 offen lds
    s_add_u32 m0, s48, 19456
    s_add_u32 s3, s60, 0x5f000
    buffer_load_dwordx4 v14, s[28:31], s3 offen lds
    s_add_u32 m0, s48, 20480
    s_add_u32 s3, s60, 0x64000
    buffer_load_dwordx4 v14, s[28:31], s3 offen lds
    s_add_u32 m0, s48, 21504
    s_add_u32 s3, s60, 0x69000
    buffer_load_dwordx4 v14, s[28:31], s3 offen lds
    s_add_u32 m0, s48, 22528
    s_add_u32 s3, s60, 0x6e000
    buffer_load_dwordx4 v14, s[28:31], s3 offen lds
    s_add_u32 m0, s48, 23552
    s_add_u32 s3, s60, 0x73000
    buffer_load_dwordx4 v14, s[28:31], s3 offen lds
    s_add_u32 m0, s48, 24576
    s_add_u32 s3, s60, 0x78000
    buffer_load_dwordx4 v14, s[28:31], s3 offen lds
    s_add_u32 m0, s48, 25600
    s_add_u32 s3, s60, 0x7d000
    buffer_load_dwordx4 v14, s[28:31], s3 offen lds
    s_add_u32 m0, s48, 26624
    s_add_u32 s3, s60, 0x82000
    buffer_load_dwordx4 v14, s[28:31], s3 offen lds
    s_add_u32 m0, s48, 27648
    s_add_u32 s3, s60, 0x87000
    buffer_load_dwordx4 v14, s[28:31], s3 offen lds
    s_add_u32 m0, s48, 28672
    s_add_u32 s3, s60, 0x8c000
    buffer_load_dwordx4 v14, s[28:31], s3 offen lds
    s_add_u32 m0, s48, 29696
    s_add_u32 s3, s60, 0x91000
    buffer_load_dwordx4 v14, s[28:31], s3 offen lds
    s_add_u32 m0, s48, 30720
    s_add_u32 s3, s60, 0x96000
    buffer_load_dwordx4 v14, s[28:31], s3 offen lds
    s_add_u32 m0, s48, 31744
    s_add_u32 s3, s60, 0x9b000
    buffer_load_dwordx4 v14, s[28:31], s3 offen lds
    s_waitcnt vmcnt(16)
    ds_read_b64_tr_b16 a[0:1], v13 offset:0
    ds_read_b64_tr_b16 a[2:3], v13 offset:256
    ds_read_b64_tr_b16 a[4:5], v13 offset:8
    ds_read_b64_tr_b16 a[6:7], v13 offset:264
    ds_read_b64_tr_b16 a[8:9], v13 offset:2048
    ds_read_b64_tr_b16 a[10:11], v13 offset:2304
    ds_read_b64_tr_b16 a[12:13], v13 offset:2056
    ds_read_b64_tr_b16 a[14:15], v13 offset:2312
    ds_read_b64_tr_b16 a[16:17], v13 offset:4096
    ds_read_b64_tr_b16 a[18:19], v13 offset:4352
    ds_read_b64_tr_b16 a[20:21], v13 offset:4104
    ds_read_b64_tr_b16 a[22:23], v13 offset:4360
    ds_read_b64_tr_b16 a[24:25], v13 offset:6144
    ds_read_b64_tr_b16 a[26:27], v13 offset:6400
    ds_read_b64_tr_b16 a[28:29], v13 offset:6152
    ds_read_b64_tr_b16 a[30:31], v13 offset:6408
    ds_read_b64_tr_b16 a[32:33], v13 offset:8192
    ds_read_b64_tr_b16 a[34:35], v13 offset:8448
    ds_read_b64_tr_b16 a[36:37], v13 offset:8200
    ds_read_b64_tr_b16 a[38:39], v13 offset:8456
    ds_read_b64_tr_b16 a[40:41], v13 offset:10240
    ds_read_b64_tr_b16 a[42:43], v13 offset:10496
    ds_read_b64_tr_b16 a[44:45], v13 offset:10248
    ds_read_b64_tr_b16 a[46:47], v13 offset:10504
    ds_read_b64_tr_b16 a[48:49], v13 offset:12288
    ds_read_b64_tr_b16 a[50:51], v13 offset:12544
    ds_read_b64_tr_b16 a[52:53], v13 offset:12296
    ds_read_b64_tr_b16 a[54:55], v13 offset:12552
    ds_read_b64_tr_b16 a[56:57], v13 offset:14336
    ds_read_b64_tr_b16 a[58:59], v13 offset:14592
    ds_read_b64_tr_b16 a[60:61], v13 offset:14344
    ds_read_b64_tr_b16 a[62:63], v13 offset:14600
    s_waitcnt lgkmcnt(0)
    s_add_u32 m0, s48, 0
    s_add_u32 s3, s60, 0xa0000
    buffer_load_dwordx4 v14, s[28:31], s3 offen lds
    s_add_u32 m0, s48, 1024
    s_add_u32 s3, s60, 0xa5000
    buffer_load_dwordx4 v14, s[28:31], s3 offen lds
    s_add_u32 m0, s48, 2048
    s_add_u32 s3, s60, 0xaa000
    buffer_load_dwordx4 v14, s[28:31], s3 offen lds
    s_add_u32 m0, s48, 3072
    s_add_u32 s3, s60, 0xaf000
    buffer_load_dwordx4 v14, s[28:31], s3 offen lds
    s_add_u32 m0, s48, 4096
    s_add_u32 s3, s60, 0xb4000
    buffer_load_dwordx4 v14, s[28:31], s3 offen lds
    s_add_u32 m0, s48, 5120
    s_add_u32 s3, s60, 0xb9000
    buffer_load_dwordx4 v14, s[28:31], s3 offen lds
    s_add_u32 m0, s48, 6144
    s_add_u32 s3, s60, 0xbe000
    buffer_load_dwordx4 v14, s[28:31], s3 offen lds
    s_add_u32 m0, s48, 7168
    s_add_u32 s3, s60, 0xc3000
    buffer_load_dwordx4 v14, s[28:31], s3 offen lds
    s_add_u32 m0, s48, 8192
    s_add_u32 s3, s60, 0xc8000
    buffer_load_dwordx4 v14, s[28:31], s3 offen lds
    s_add_u32 m0, s48, 9216
    s_add_u32 s3, s60, 0xcd000
    buffer_load_dwordx4 v14, s[28:31], s3 offen lds
    s_add_u32 m0, s48, 10240
    s_add_u32 s3, s60, 0xd2000
    buffer_load_dwordx4 v14, s[28:31], s3 offen lds
    s_add_u32 m0, s48, 11264
    s_add_u32 s3, s60, 0xd7000
    buffer_load_dwordx4 v14, s[28:31], s3 offen lds
    s_add_u32 m0, s48, 12288
    s_add_u32 s3, s60, 0xdc000
    buffer_load_dwordx4 v14, s[28:31], s3 offen lds
    s_add_u32 m0, s48, 13312
    s_add_u32 s3, s60, 0xe1000
    buffer_load_dwordx4 v14, s[28:31], s3 offen lds
    s_add_u32 m0, s48, 14336
    s_add_u32 s3, s60, 0xe6000
    buffer_load_dwordx4 v14, s[28:31], s3 offen lds
    s_add_u32 m0, s48, 15360
    s_add_u32 s3, s60, 0xeb000
    buffer_load_dwordx4 v14, s[28:31], s3 offen lds
    s_waitcnt vmcnt(16)
    ds_read_b64_tr_b16 a[64:65], v13 offset:16384
    ds_read_b64_tr_b16 a[66:67], v13 offset:16640
    ds_read_b64_tr_b16 a[68:69], v13 offset:16392
    ds_read_b64_tr_b16 a[70:71], v13 offset:16648
    ds_read_b64_tr_b16 a[72:73], v13 offset:18432
    ds_read_b64_tr_b16 a[74:75], v13 offset:18688
    ds_read_b64_tr_b16 a[76:77], v13 offset:18440
    ds_read_b64_tr_b16 a[78:79], v13 offset:18696
    ds_read_b64_tr_b16 a[80:81], v13 offset:20480
    ds_read_b64_tr_b16 a[82:83], v13 offset:20736
    ds_read_b64_tr_b16 a[84:85], v13 offset:20488
    ds_read_b64_tr_b16 a[86:87], v13 offset:20744
    ds_read_b64_tr_b16 a[88:89], v13 offset:22528
    ds_read_b64_tr_b16 a[90:91], v13 offset:22784
    ds_read_b64_tr_b16 a[92:93], v13 offset:22536
    ds_read_b64_tr_b16 a[94:95], v13 offset:22792
    ds_read_b64_tr_b16 a[96:97], v13 offset:24576
    ds_read_b64_tr_b16 a[98:99], v13 offset:24832
    ds_read_b64_tr_b16 a[100:101], v13 offset:24584
    ds_read_b64_tr_b16 a[102:103], v13 offset:24840
    ds_read_b64_tr_b16 a[104:105], v13 offset:26624
    ds_read_b64_tr_b16 a[106:107], v13 offset:26880
    ds_read_b64_tr_b16 a[108:109], v13 offset:26632
    ds_read_b64_tr_b16 a[110:111], v13 offset:26888
    ds_read_b64_tr_b16 a[112:113], v13 offset:28672
    ds_read_b64_tr_b16 a[114:115], v13 offset:28928
    ds_read_b64_tr_b16 a[116:117], v13 offset:28680
    ds_read_b64_tr_b16 a[118:119], v13 offset:28936
    ds_read_b64_tr_b16 a[120:121], v13 offset:30720
    ds_read_b64_tr_b16 a[122:123], v13 offset:30976
    ds_read_b64_tr_b16 a[124:125], v13 offset:30728
    ds_read_b64_tr_b16 a[126:127], v13 offset:30984
    s_waitcnt lgkmcnt(0)
    s_add_u32 m0, s48, 16384
    s_add_u32 s3, s60, 0xf0000
    buffer_load_dwordx4 v14, s[28:31], s3 offen lds
    s_add_u32 m0, s48, 17408
    s_add_u32 s3, s60, 0xf5000
    buffer_load_dwordx4 v14, s[28:31], s3 offen lds
    s_add_u32 m0, s48, 18432
    s_add_u32 s3, s60, 0xfa000
    buffer_load_dwordx4 v14, s[28:31], s3 offen lds
    s_add_u32 m0, s48, 19456
    s_add_u32 s3, s60, 0xff000
    buffer_load_dwordx4 v14, s[28:31], s3 offen lds
    s_add_u32 m0, s48, 20480
    s_add_u32 s3, s60, 0x104000
    buffer_load_dwordx4 v14, s[28:31], s3 offen lds
    s_add_u32 m0, s48, 21504
    s_add_u32 s3, s60, 0x109000
    buffer_load_dwordx4 v14, s[28:31], s3 offen lds
    s_add_u32 m0, s48, 22528
    s_add_u32 s3, s60, 0x10e000
    buffer_load_dwordx4 v14, s[28:31], s3 offen lds
    s_add_u32 m0, s48, 23552
    s_add_u32 s3, s60, 0x113000
    buffer_load_dwordx4 v14, s[28:31], s3 offen lds
    s_add_u32 m0, s48, 24576
    s_add_u32 s3, s60, 0x118000
    buffer_load_dwordx4 v14, s[28:31], s3 offen lds
    s_add_u32 m0, s48, 25600
    s_add_u32 s3, s60, 0x11d000
    buffer_load_dwordx4 v14, s[28:31], s3 offen lds
    s_add_u32 m0, s48, 26624
    s_add_u32 s3, s60, 0x122000
    buffer_load_dwordx4 v14, s[28:31], s3 offen lds
    s_add_u32 m0, s48, 27648
    s_add_u32 s3, s60, 0x127000
    buffer_load_dwordx4 v14, s[28:31], s3 offen lds
    s_add_u32 m0, s48, 28672
    s_add_u32 s3, s60, 0x12c000
    buffer_load_dwordx4 v14, s[28:31], s3 offen lds
    s_add_u32 m0, s48, 29696
    s_add_u32 s3, s60, 0x131000
    buffer_load_dwordx4 v14, s[28:31], s3 offen lds
    s_add_u32 m0, s48, 30720
    s_add_u32 s3, s60, 0x136000
    buffer_load_dwordx4 v14, s[28:31], s3 offen lds
    s_add_u32 m0, s48, 31744
    s_add_u32 s3, s60, 0x13b000
    buffer_load_dwordx4 v14, s[28:31], s3 offen lds
    s_waitcnt vmcnt(16)
    ds_read_b64_tr_b16 a[128:129], v13 offset:0
    ds_read_b64_tr_b16 a[130:131], v13 offset:256
    ds_read_b64_tr_b16 a[132:133], v13 offset:8
    ds_read_b64_tr_b16 a[134:135], v13 offset:264
    ds_read_b64_tr_b16 a[136:137], v13 offset:2048
    ds_read_b64_tr_b16 a[138:139], v13 offset:2304
    ds_read_b64_tr_b16 a[140:141], v13 offset:2056
    ds_read_b64_tr_b16 a[142:143], v13 offset:2312
    ds_read_b64_tr_b16 a[144:145], v13 offset:4096
    ds_read_b64_tr_b16 a[146:147], v13 offset:4352
    ds_read_b64_tr_b16 a[148:149], v13 offset:4104
    ds_read_b64_tr_b16 a[150:151], v13 offset:4360
    ds_read_b64_tr_b16 a[152:153], v13 offset:6144
    ds_read_b64_tr_b16 a[154:155], v13 offset:6400
    ds_read_b64_tr_b16 a[156:157], v13 offset:6152
    ds_read_b64_tr_b16 a[158:159], v13 offset:6408
    ds_read_b64_tr_b16 a[160:161], v13 offset:8192
    ds_read_b64_tr_b16 a[162:163], v13 offset:8448
    ds_read_b64_tr_b16 a[164:165], v13 offset:8200
    ds_read_b64_tr_b16 a[166:167], v13 offset:8456
    ds_read_b64_tr_b16 a[168:169], v13 offset:10240
    ds_read_b64_tr_b16 a[170:171], v13 offset:10496
    ds_read_b64_tr_b16 a[172:173], v13 offset:10248
    ds_read_b64_tr_b16 a[174:175], v13 offset:10504
    ds_read_b64_tr_b16 a[176:177], v13 offset:12288
    ds_read_b64_tr_b16 a[178:179], v13 offset:12544
    ds_read_b64_tr_b16 a[180:181], v13 offset:12296
    ds_read_b64_tr_b16 a[182:183], v13 offset:12552
    ds_read_b64_tr_b16 a[184:185], v13 offset:14336
    ds_read_b64_tr_b16 a[186:187], v13 offset:14592
    ds_read_b64_tr_b16 a[188:189], v13 offset:14344
    ds_read_b64_tr_b16 a[190:191], v13 offset:14600
    s_waitcnt lgkmcnt(0)
    s_waitcnt vmcnt(0)
    ds_read_b64_tr_b16 a[192:193], v13 offset:16384
    ds_read_b64_tr_b16 a[194:195], v13 offset:16640
    ds_read_b64_tr_b16 a[196:197], v13 offset:16392
    ds_read_b64_tr_b16 a[198:199], v13 offset:16648
    ds_read_b64_tr_b16 a[200:201], v13 offset:18432
    ds_read_b64_tr_b16 a[202:203], v13 offset:18688
    ds_read_b64_tr_b16 a[204:205], v13 offset:18440
    ds_read_b64_tr_b16 a[206:207], v13 offset:18696
    ds_read_b64_tr_b16 a[208:209], v13 offset:20480
    ds_read_b64_tr_b16 a[210:211], v13 offset:20736
    ds_read_b64_tr_b16 a[212:213], v13 offset:20488
    ds_read_b64_tr_b16 a[214:215], v13 offset:20744
    ds_read_b64_tr_b16 a[216:217], v13 offset:22528
    ds_read_b64_tr_b16 a[218:219], v13 offset:22784
    ds_read_b64_tr_b16 a[220:221], v13 offset:22536
    ds_read_b64_tr_b16 a[222:223], v13 offset:22792
    ds_read_b64_tr_b16 a[224:225], v13 offset:24576
    ds_read_b64_tr_b16 a[226:227], v13 offset:24832
    ds_read_b64_tr_b16 a[228:229], v13 offset:24584
    ds_read_b64_tr_b16 a[230:231], v13 offset:24840
    ds_read_b64_tr_b16 a[232:233], v13 offset:26624
    ds_read_b64_tr_b16 a[234:235], v13 offset:26880
    ds_read_b64_tr_b16 a[236:237], v13 offset:26632
    ds_read_b64_tr_b16 a[238:239], v13 offset:26888
    ds_read_b64_tr_b16 a[240:241], v13 offset:28672
    ds_read_b64_tr_b16 a[242:243], v13 offset:28928
    ds_read_b64_tr_b16 a[244:245], v13 offset:28680
    ds_read_b64_tr_b16 a[246:247], v13 offset:28936
    ds_read_b64_tr_b16 a[248:249], v13 offset:30720
    ds_read_b64_tr_b16 a[250:251], v13 offset:30976
    ds_read_b64_tr_b16 a[252:253], v13 offset:30728
    ds_read_b64_tr_b16 a[254:255], v13 offset:30984
    s_waitcnt lgkmcnt(0)
    s_load_dwordx2 s[4:5], s[0:1], 96
    s_waitcnt lgkmcnt(0)
    s_mov_b32 s24, s4
    s_mov_b32 s25, s5
    s_mov_b32 s26, 0x280000
    s_mov_b32 s27, 0x20000
    v_and_b32 v16, 15, v0
    v_mul_u32_u24 v16, 1280, v16
    v_lshrrev_b32 v17, 4, v0
    v_lshl_add_u32 v7, v17, 4, v16
    s_lshl_b32 s3, s13, 12
    v_add_u32 v10, s3, v1
    s_lshl_b32 s3, s13, 11
    v_add_u32 v11, s3, v1
    s_mov_b32 s40, 16384
    s_barrier
BO_PAIR:
    s_mul_i32 s17, s14, 0x6000000
    s_add_u32 s17, s17, 0x1000000
    s_lshl_b32 s3, s14, 13
    s_add_u32 s36, s3, 36864
    s_add_u32 s38, s3, 53248
    s_mov_b32 s32, s42
    s_lshl_b32 s3, s13, 15
    s_add_u32 s34, s3, s17
    s_add_u32 s34, s34, 0x4000000
    s_and_b32 s59, s13, 1
    s_mul_i32 s59, s59, 20480
    s_lshl_b32 s3, s19, 10
    s_add_u32 s3, s3, s59
    s_add_u32 s43, s3, s17
    s_lshl_b32 s3, s19, 6
    s_add_u32 s45, s3, s59
BO_SEG:
    s_lshl_b32 s49, s32, 7
    s_add_u32 s49, s49, s36
    v_mov_b32 v8, 0
POLL_44:
    buffer_load_dword v9, v8, s[8:11], s49 offen sc1
    s_waitcnt vmcnt(0)
    v_readfirstlane_b32 s58, v9
    s_nop 0
    s_cmp_ge_u32 s58, 16
    s_nop 1
    s_cbranch_scc1 POLLD_45
    s_add_u32 s99, s99, 1
    s_cmp_ge_u32 s99, 0x80000
    s_cbranch_scc1 POLLD_45
    s_sleep 1
    s_branch POLL_44
POLLD_45:
    s_mul_i32 s62, s32, 40960
    s_add_u32 s63, s62, s43
    s_add_u32 s3, s63, 0x700000
    buffer_load_dwordx4 v[32:35], v1, s[8:11], s3 offen sc1
    s_lshl_b32 s60, s32, 18
    s_add_u32 s60, s60, s34
    s_add_u32 s61, s60, 0x20000
    buffer_load_dwordx4 v[64:67], v1, s[8:11], s60 offen offset:0 sc1
    buffer_load_dwordx4 v[68:71], v1, s[8:11], s61 offen offset:0 sc1
    buffer_load_dwordx4 v[72:75], v1, s[8:11], s60 offen offset:1024 sc1
    buffer_load_dwordx4 v[76:79], v1, s[8:11], s61 offen offset:1024 sc1
    buffer_load_dwordx4 v[80:83], v1, s[8:11], s60 offen offset:2048 sc1
    buffer_load_dwordx4 v[84:87], v1, s[8:11], s61 offen offset:2048 sc1
    buffer_load_dwordx4 v[88:91], v1, s[8:11], s60 offen offset:3072 sc1
    buffer_load_dwordx4 v[92:95], v1, s[8:11], s61 offen offset:3072 sc1
    s_add_u32 s60, s60, 4096
    buffer_load_dwordx4 v[96:99], v1, s[8:11], s60 offen offset:0 sc1
    s_add_u32 s61, s61, 4096
    buffer_load_dwordx4 v[100:103], v1, s[8:11], s61 offen offset:0 sc1
    buffer_load_dwordx4 v[104:107], v1, s[8:11], s60 offen offset:1024 sc1
    buffer_load_dwordx4 v[108:111], v1, s[8:11], s61 offen offset:1024 sc1
    buffer_load_dwordx4 v[112:115], v1, s[8:11], s60 offen offset:2048 sc1
    buffer_load_dwordx4 v[116:119], v1, s[8:11], s61 offen offset:2048 sc1
    buffer_load_dwordx4 v[120:123], v1, s[8:11], s60 offen offset:3072 sc1
    buffer_load_dwordx4 v[124:127], v1, s[8:11], s61 offen offset:3072 sc1
    s_add_u32 s60, s60, 4096
    buffer_load_dwordx4 v[128:131], v1, s[8:11], s60 offen offset:0 sc1
    s_add_u32 s61, s61, 4096
    buffer_load_dwordx4 v[132:135], v1, s[8:11], s61 offen offset:0 sc1
    buffer_load_dwordx4 v[136:139], v1, s[8:11], s60 offen offset:1024 sc1
    buffer_load_dwordx4 v[140:143], v1, s[8:11], s61 offen offset:1024 sc1
    buffer_load_dwordx4 v[144:147], v1, s[8:11], s60 offen offset:2048 sc1
    buffer_load_dwordx4 v[148:151], v1, s[8:11], s61 offen offset:2048 sc1
    buffer_load_dwordx4 v[152:155], v1, s[8:11], s60 offen offset:3072 sc1
    buffer_load_dwordx4 v[156:159], v1, s[8:11], s61 offen offset:3072 sc1
    s_add_u32 s60, s60, 4096
    buffer_load_dwordx4 v[160:163], v1, s[8:11], s60 offen offset:0 sc1
    s_add_u32 s61, s61, 4096
    buffer_load_dwordx4 v[164:167], v1, s[8:11], s61 offen offset:0 sc1
    buffer_load_dwordx4 v[168:171], v1, s[8:11], s60 offen offset:1024 sc1
    buffer_load_dwordx4 v[172:175], v1, s[8:11], s61 offen offset:1024 sc1
    buffer_load_dwordx4 v[176:179], v1, s[8:11], s60 offen offset:2048 sc1
    buffer_load_dwordx4 v[180:183], v1, s[8:11], s61 offen offset:2048 sc1
    buffer_load_dwordx4 v[184:187], v1, s[8:11], s60 offen offset:3072 sc1
    buffer_load_dwordx4 v[188:191], v1, s[8:11], s61 offen offset:3072 sc1
    s_add_u32 s60, s60, 4096
    buffer_load_dwordx4 v[192:195], v1, s[8:11], s60 offen offset:0 sc1
    s_add_u32 s61, s61, 4096
    buffer_load_dwordx4 v[196:199], v1, s[8:11], s61 offen offset:0 sc1
    buffer_load_dwordx4 v[200:203], v1, s[8:11], s60 offen offset:1024 sc1
    buffer_load_dwordx4 v[204:207], v1, s[8:11], s61 offen offset:1024 sc1
    buffer_load_dwordx4 v[208:211], v1, s[8:11], s60 offen offset:2048 sc1
    buffer_load_dwordx4 v[212:215], v1, s[8:11], s61 offen offset:2048 sc1
    buffer_load_dwordx4 v[216:219], v1, s[8:11], s60 offen offset:3072 sc1
    buffer_load_dwordx4 v[220:223], v1, s[8:11], s61 offen offset:3072 sc1
    s_add_u32 s60, s60, 4096
    buffer_load_dwordx4 v[224:227], v1, s[8:11], s60 offen offset:0 sc1
    s_add_u32 s61, s61, 4096
    buffer_load_dwordx4 v[228:231], v1, s[8:11], s61 offen offset:0 sc1
    buffer_load_dwordx4 v[232:235], v1, s[8:11], s60 offen offset:1024 sc1
    buffer_load_dwordx4 v[236:239], v1, s[8:11], s61 offen offset:1024 sc1
    buffer_load_dwordx4 v[240:243], v1, s[8:11], s60 offen offset:2048 sc1
    buffer_load_dwordx4 v[244:247], v1, s[8:11], s61 offen offset:2048 sc1
    buffer_load_dwordx4 v[248:251], v1, s[8:11], s60 offen offset:3072 sc1
    buffer_load_dwordx4 v[252:255], v1, s[8:11], s61 offen offset:3072 sc1
    s_waitcnt vmcnt(47)
    v_mfma_f32_16x16x32_bf16 v[16:19], a[0:3], v[64:67], 0
    v_mfma_f32_16x16x32_bf16 v[20:23], a[4:7], v[64:67], 0
    s_add_u32 s60, s60, 4096
    buffer_load_dwordx4 v[64:67], v1, s[8:11], s60 offen offset:0 sc1
    s_waitcnt vmcnt(47)
    v_mfma_f32_16x16x32_bf16 v[24:27], a[0:3], v[68:71], 0
    v_mfma_f32_16x16x32_bf16 v[28:31], a[4:7], v[68:71], 0
    s_add_u32 s61, s61, 4096
    buffer_load_dwordx4 v[68:71], v1, s[8:11], s61 offen offset:0 sc1
    s_waitcnt vmcnt(47)
    v_mfma_f32_16x16x32_bf16 v[16:19], a[8:11], v[72:75], v[16:19]
    v_mfma_f32_16x16x32_bf16 v[20:23], a[12:15], v[72:75], v[20:23]
    buffer_load_dwordx4 v[72:75], v1, s[8:11], s60 offen offset:1024 sc1
    s_waitcnt vmcnt(47)
    v_mfma_f32_16x16x32_bf16 v[24:27], a[8:11], v[76:79], v[24:27]
    v_mfma_f32_16x16x32_bf16 v[28:31], a[12:15], v[76:79], v[28:31]
    buffer_load_dwordx4 v[76:79], v1, s[8:11], s61 offen offset:1024 sc1
    s_waitcnt vmcnt(47)
    v_mfma_f32_16x16x32_bf16 v[16:19], a[16:19], v[80:83], v[16:19]
    v_mfma_f32_16x16x32_bf16 v[20:23], a[20:23], v[80:83], v[20:23]
    buffer_load_dwordx4 v[80:83], v1, s[8:11], s60 offen offset:2048 sc1
    s_waitcnt vmcnt(47)
    v_mfma_f32_16x16x32_bf16 v[24:27], a[16:19], v[84:87], v[24:27]
    v_mfma_f32_16x16x32_bf16 v[28:31], a[20:23], v[84:87], v[28:31]
    buffer_load_dwordx4 v[84:87], v1, s[8:11], s61 offen offset:2048 sc1
    s_waitcnt vmcnt(47)
    v_mfma_f32_16x16x32_bf16 v[16:19], a[24:27], v[88:91], v[16:19]
    v_mfma_f32_16x16x32_bf16 v[20:23], a[28:31], v[88:91], v[20:23]
    buffer_load_dwordx4 v[88:91], v1, s[8:11], s60 offen offset:3072 sc1
    s_waitcnt vmcnt(47)
    v_mfma_f32_16x16x32_bf16 v[24:27], a[24:27], v[92:95], v[24:27]
    v_mfma_f32_16x16x32_bf16 v[28:31], a[28:31], v[92:95], v[28:31]
    buffer_load_dwordx4 v[92:95], v1, s[8:11], s61 offen offset:3072 sc1
    s_waitcnt vmcnt(47)
    v_mfma_f32_16x16x32_bf16 v[16:19], a[32:35], v[96:99], v[16:19]
    v_mfma_f32_16x16x32_bf16 v[20:23], a[36:39], v[96:99], v[20:23]
    s_add_u32 s60, s60, 4096
    buffer_load_dwordx4 v[96:99], v1, s[8:11], s60 offen offset:0 sc1
    s_waitcnt vmcnt(47)
    v_mfma_f32_16x16x32_bf16 v[24:27], a[32:35], v[100:103], v[24:27]
    v_mfma_f32_16x16x32_bf16 v[28:31], a[36:39], v[100:103], v[28:31]
    s_add_u32 s61, s61, 4096
    buffer_load_dwordx4 v[100:103], v1, s[8:11], s61 offen offset:0 sc1
    s_waitcnt vmcnt(47)
    v_mfma_f32_16x16x32_bf16 v[16:19], a[40:43], v[104:107], v[16:19]
    v_mfma_f32_16x16x32_bf16 v[20:23], a[44:47], v[104:107], v[20:23]
    buffer_load_dwordx4 v[104:107], v1, s[8:11], s60 offen offset:1024 sc1
    s_waitcnt vmcnt(47)
    v_mfma_f32_16x16x32_bf16 v[24:27], a[40:43], v[108:111], v[24:27]
    v_mfma_f32_16x16x32_bf16 v[28:31], a[44:47], v[108:111], v[28:31]
    buffer_load_dwordx4 v[108:111], v1, s[8:11], s61 offen offset:1024 sc1
    s_waitcnt vmcnt(47)
    v_mfma_f32_16x16x32_bf16 v[16:19], a[48:51], v[112:115], v[16:19]
    v_mfma_f32_16x16x32_bf16 v[20:23], a[52:55], v[112:115], v[20:23]
    buffer_load_dwordx4 v[112:115], v1, s[8:11], s60 offen offset:2048 sc1
    s_waitcnt vmcnt(47)
    v_mfma_f32_16x16x32_bf16 v[24:27], a[48:51], v[116:119], v[24:27]
    v_mfma_f32_16x16x32_bf16 v[28:31], a[52:55], v[116:119], v[28:31]
    buffer_load_dwordx4 v[116:119], v1, s[8:11], s61 offen offset:2048 sc1
    s_waitcnt vmcnt(47)
    v_mfma_f32_16x16x32_bf16 v[16:19], a[56:59], v[120:123], v[16:19]
    v_mfma_f32_16x16x32_bf16 v[20:23], a[60:63], v[120:123], v[20:23]
    buffer_load_dwordx4 v[120:123], v1, s[8:11], s60 offen offset:3072 sc1
    s_waitcnt vmcnt(47)
    v_mfma_f32_16x16x32_bf16 v[24:27], a[56:59], v[124:127], v[24:27]
    v_mfma_f32_16x16x32_bf16 v[28:31], a[60:63], v[124:127], v[28:31]
    buffer_load_dwordx4 v[124:127], v1, s[8:11], s61 offen offset:3072 sc1
    s_waitcnt vmcnt(47)
    v_mfma_f32_16x16x32_bf16 v[16:19], a[64:67], v[128:131], v[16:19]
    v_mfma_f32_16x16x32_bf16 v[20:23], a[68:71], v[128:131], v[20:23]
    s_waitcnt vmcnt(46)
    v_mfma_f32_16x16x32_bf16 v[24:27], a[64:67], v[132:135], v[24:27]
    v_mfma_f32_16x16x32_bf16 v[28:31], a[68:71], v[132:135], v[28:31]
    s_waitcnt vmcnt(45)
    v_mfma_f32_16x16x32_bf16 v[16:19], a[72:75], v[136:139], v[16:19]
    v_mfma_f32_16x16x32_bf16 v[20:23], a[76:79], v[136:139], v[20:23]
    s_waitcnt vmcnt(44)
    v_mfma_f32_16x16x32_bf16 v[24:27], a[72:75], v[140:143], v[24:27]
    v_mfma_f32_16x16x32_bf16 v[28:31], a[76:79], v[140:143], v[28:31]
    s_waitcnt vmcnt(43)
    v_mfma_f32_16x16x32_bf16 v[16:19], a[80:83], v[144:147], v[16:19]
    v_mfma_f32_16x16x32_bf16 v[20:23], a[84:87], v[144:147], v[20:23]
    s_waitcnt vmcnt(42)
    v_mfma_f32_16x16x32_bf16 v[24:27], a[80:83], v[148:151], v[24:27]
    v_mfma_f32_16x16x32_bf16 v[28:31], a[84:87], v[148:151], v[28:31]
    s_waitcnt vmcnt(41)
    v_mfma_f32_16x16x32_bf16 v[16:19], a[88:91], v[152:155], v[16:19]
    v_mfma_f32_16x16x32_bf16 v[20:23], a[92:95], v[152:155], v[20:23]
    s_waitcnt vmcnt(40)
    v_mfma_f32_16x16x32_bf16 v[24:27], a[88:91], v[156:159], v[24:27]
    v_mfma_f32_16x16x32_bf16 v[28:31], a[92:95], v[156:159], v[28:31]
    s_waitcnt vmcnt(39)
    v_mfma_f32_16x16x32_bf16 v[16:19], a[96:99], v[160:163], v[16:19]
    v_mfma_f32_16x16x32_bf16 v[20:23], a[100:103], v[160:163], v[20:23]
    s_waitcnt vmcnt(38)
    v_mfma_f32_16x16x32_bf16 v[24:27], a[96:99], v[164:167], v[24:27]
    v_mfma_f32_16x16x32_bf16 v[28:31], a[100:103], v[164:167], v[28:31]
    s_waitcnt vmcnt(37)
    v_mfma_f32_16x16x32_bf16 v[16:19], a[104:107], v[168:171], v[16:19]
    v_mfma_f32_16x16x32_bf16 v[20:23], a[108:111], v[168:171], v[20:23]
    s_waitcnt vmcnt(36)
    v_mfma_f32_16x16x32_bf16 v[24:27], a[104:107], v[172:175], v[24:27]
    v_mfma_f32_16x16x32_bf16 v[28:31], a[108:111], v[172:175], v[28:31]
    s_waitcnt vmcnt(35)
    v_mfma_f32_16x16x32_bf16 v[16:19], a[112:115], v[176:179], v[16:19]
    v_mfma_f32_16x16x32_bf16 v[20:23], a[116:119], v[176:179], v[20:23]
    s_waitcnt vmcnt(34)
    v_mfma_f32_16x16x32_bf16 v[24:27], a[112:115], v[180:183], v[24:27]
    v_mfma_f32_16x16x32_bf16 v[28:31], a[116:119], v[180:183], v[28:31]
    s_waitcnt vmcnt(33)
    v_mfma_f32_16x16x32_bf16 v[16:19], a[120:123], v[184:187], v[16:19]
    v_mfma_f32_16x16x32_bf16 v[20:23], a[124:127], v[184:187], v[20:23]
    s_waitcnt vmcnt(32)
    v_mfma_f32_16x16x32_bf16 v[24:27], a[120:123], v[188:191], v[24:27]
    v_mfma_f32_16x16x32_bf16 v[28:31], a[124:127], v[188:191], v[28:31]
    s_waitcnt vmcnt(31)
    v_mfma_f32_16x16x32_bf16 v[16:19], a[128:131], v[192:195], v[16:19]
    v_mfma_f32_16x16x32_bf16 v[20:23], a[132:135], v[192:195], v[20:23]
    s_waitcnt vmcnt(30)
    v_mfma_f32_16x16x32_bf16 v[24:27], a[128:131], v[196:199], v[24:27]
    v_mfma_f32_16x16x32_bf16 v[28:31], a[132:135], v[196:199], v[28:31]
    s_waitcnt vmcnt(29)
    v_mfma_f32_16x16x32_bf16 v[16:19], a[136:139], v[200:203], v[16:19]
    v_mfma_f32_16x16x32_bf16 v[20:23], a[140:143], v[200:203], v[20:23]
    s_waitcnt vmcnt(28)
    v_mfma_f32_16x16x32_bf16 v[24:27], a[136:139], v[204:207], v[24:27]
    v_mfma_f32_16x16x32_bf16 v[28:31], a[140:143], v[204:207], v[28:31]
    s_waitcnt vmcnt(27)
    v_mfma_f32_16x16x32_bf16 v[16:19], a[144:147], v[208:211], v[16:19]
    v_mfma_f32_16x16x32_bf16 v[20:23], a[148:151], v[208:211], v[20:23]
    s_waitcnt vmcnt(26)
    v_mfma_f32_16x16x32_bf16 v[24:27], a[144:147], v[212:215], v[24:27]
    v_mfma_f32_16x16x32_bf16 v[28:31], a[148:151], v[212:215], v[28:31]
    s_waitcnt vmcnt(25)
    v_mfma_f32_16x16x32_bf16 v[16:19], a[152:155], v[216:219], v[16:19]
    v_mfma_f32_16x16x32_bf16 v[20:23], a[156:159], v[216:219], v[20:23]
    s_waitcnt vmcnt(24)
    v_mfma_f32_16x16x32_bf16 v[24:27], a[152:155], v[220:223], v[24:27]
    v_mfma_f32_16x16x32_bf16 v[28:31], a[156:159], v[220:223], v[28:31]
    s_waitcnt vmcnt(23)
    v_mfma_f32_16x16x32_bf16 v[16:19], a[160:163], v[224:227], v[16:19]
    v_mfma_f32_16x16x32_bf16 v[20:23], a[164:167], v[224:227], v[20:23]
    s_waitcnt vmcnt(22)
    v_mfma_f32_16x16x32_bf16 v[24:27], a[160:163], v[228:231], v[24:27]
    v_mfma_f32_16x16x32_bf16 v[28:31], a[164:167], v[228:231], v[28:31]
    s_waitcnt vmcnt(21)
    v_mfma_f32_16x16x32_bf16 v[16:19], a[168:171], v[232:235], v[16:19]
    v_mfma_f32_16x16x32_bf16 v[20:23], a[172:175], v[232:235], v[20:23]
    s_waitcnt vmcnt(20)
    v_mfma_f32_16x16x32_bf16 v[24:27], a[168:171], v[236:239], v[24:27]
    v_mfma_f32_16x16x32_bf16 v[28:31], a[172:175], v[236:239], v[28:31]
    s_waitcnt vmcnt(19)
    v_mfma_f32_16x16x32_bf16 v[16:19], a[176:179], v[240:243], v[16:19]
    v_mfma_f32_16x16x32_bf16 v[20:23], a[180:183], v[240:243], v[20:23]
    s_waitcnt vmcnt(18)
    v_mfma_f32_16x16x32_bf16 v[24:27], a[176:179], v[244:247], v[24:27]
    v_mfma_f32_16x16x32_bf16 v[28:31], a[180:183], v[244:247], v[28:31]
    s_waitcnt vmcnt(17)
    v_mfma_f32_16x16x32_bf16 v[16:19], a[184:187], v[248:251], v[16:19]
    v_mfma_f32_16x16x32_bf16 v[20:23], a[188:191], v[248:251], v[20:23]
    s_waitcnt vmcnt(16)
    v_mfma_f32_16x16x32_bf16 v[24:27], a[184:187], v[252:255], v[24:27]
    v_mfma_f32_16x16x32_bf16 v[28:31], a[188:191], v[252:255], v[28:31]
    s_waitcnt vmcnt(15)
    v_mfma_f32_16x16x32_bf16 v[16:19], a[192:195], v[64:67], v[16:19]
    v_mfma_f32_16x16x32_bf16 v[20:23], a[196:199], v[64:67], v[20:23]
    s_waitcnt vmcnt(14)
    v_mfma_f32_16x16x32_bf16 v[24:27], a[192:195], v[68:71], v[24:27]
    v_mfma_f32_16x16x32_bf16 v[28:31], a[196:199], v[68:71], v[28:31]
    s_waitcnt vmcnt(13)
    v_mfma_f32_16x16x32_bf16 v[16:19], a[200:203], v[72:75], v[16:19]
    v_mfma_f32_16x16x32_bf16 v[20:23], a[204:207], v[72:75], v[20:23]
    s_waitcnt vmcnt(12)
    v_mfma_f32_16x16x32_bf16 v[24:27], a[200:203], v[76:79], v[24:27]
    v_mfma_f32_16x16x32_bf16 v[28:31], a[204:207], v[76:79], v[28:31]
    s_waitcnt vmcnt(11)
    v_mfma_f32_16x16x32_bf16 v[16:19], a[208:211], v[80:83], v[16:19]
    v_mfma_f32_16x16x32_bf16 v[20:23], a[212:215], v[80:83], v[20:23]
    s_waitcnt vmcnt(10)
    v_mfma_f32_16x16x32_bf16 v[24:27], a[208:211], v[84:87], v[24:27]
    v_mfma_f32_16x16x32_bf16 v[28:31], a[212:215], v[84:87], v[28:31]
    s_waitcnt vmcnt(9)
    v_mfma_f32_16x16x32_bf16 v[16:19], a[216:219], v[88:91], v[16:19]
    v_mfma_f32_16x16x32_bf16 v[20:23], a[220:223], v[88:91], v[20:23]
    s_waitcnt vmcnt(8)
    v_mfma_f32_16x16x32_bf16 v[24:27], a[216:219], v[92:95], v[24:27]
    v_mfma_f32_16x16x32_bf16 v[28:31], a[220:223], v[92:95], v[28:31]
    s_waitcnt vmcnt(7)
    v_mfma_f32_16x16x32_bf16 v[16:19], a[224:227], v[96:99], v[16:19]
    v_mfma_f32_16x16x32_bf16 v[20:23], a[228:231], v[96:99], v[20:23]
    s_waitcnt vmcnt(6)
    v_mfma_f32_16x16x32_bf16 v[24:27], a[224:227], v[100:103], v[24:27]
    v_mfma_f32_16x16x32_bf16 v[28:31], a[228:231], v[100:103], v[28:31]
    s_waitcnt vmcnt(5)
    v_mfma_f32_16x16x32_bf16 v[16:19], a[232:235], v[104:107], v[16:19]
    v_mfma_f32_16x16x32_bf16 v[20:23], a[236:239], v[104:107], v[20:23]
    s_waitcnt vmcnt(4)
    v_mfma_f32_16x16x32_bf16 v[24:27], a[232:235], v[108:111], v[24:27]
    v_mfma_f32_16x16x32_bf16 v[28:31], a[236:239], v[108:111], v[28:31]
    s_waitcnt vmcnt(3)
    v_mfma_f32_16x16x32_bf16 v[16:19], a[240:243], v[112:115], v[16:19]
    v_mfma_f32_16x16x32_bf16 v[20:23], a[244:247], v[112:115], v[20:23]
    s_waitcnt vmcnt(2)
    v_mfma_f32_16x16x32_bf16 v[24:27], a[240:243], v[116:119], v[24:27]
    v_mfma_f32_16x16x32_bf16 v[28:31], a[244:247], v[116:119], v[28:31]
    s_waitcnt vmcnt(1)
    v_mfma_f32_16x16x32_bf16 v[16:19], a[248:251], v[120:123], v[16:19]
    v_mfma_f32_16x16x32_bf16 v[20:23], a[252:255], v[120:123], v[20:23]
    s_waitcnt vmcnt(0)
    v_mfma_f32_16x16x32_bf16 v[24:27], a[248:251], v[124:127], v[24:27]
    v_mfma_f32_16x16x32_bf16 v[28:31], a[252:255], v[124:127], v[28:31]
    s_nop 3
    ds_write_b128 v10, v[16:19] offset:0
    ds_write_b128 v10, v[20:23] offset:1024
    s_nop 0
    ds_write_b128 v10, v[24:27] offset:2048
    ds_write_b128 v10, v[28:31] offset:3072
    s_waitcnt lgkmcnt(0)
    s_barrier
    s_cmp_ge_u32 s13, 2
    s_cbranch_scc1 BO_NEXT
    ds_read_b128 v[64:67], v11 offset:0
    ds_read_b128 v[68:71], v11 offset:1024
    ds_read_b128 v[72:75], v11 offset:4096
    ds_read_b128 v[76:79], v11 offset:5120
    ds_read_b128 v[80:83], v11 offset:8192
    ds_read_b128 v[84:87], v11 offset:9216
    ds_read_b128 v[88:91], v11 offset:12288
    ds_read_b128 v[92:95], v11 offset:13312
    s_waitcnt lgkmcnt(0)
    v_add_f32 v64, v64, v72
    v_add_f32 v65, v65, v73
    v_add_f32 v66, v66, v74
    v_add_f32 v67, v67, v75
    v_add_f32 v68, v68, v76
    v_add_f32 v69, v69, v77
    v_add_f32 v70, v70, v78
    v_add_f32 v71, v71, v79
    v_add_f32 v64, v64, v80
    v_add_f32 v65, v65, v81
    v_add_f32 v66, v66, v82
    v_add_f32 v67, v67, v83
    v_add_f32 v68, v68, v84
    v_add_f32 v69, v69, v85
    v_add_f32 v70, v70, v86
    v_add_f32 v71, v71, v87
    v_add_f32 v64, v64, v88
    v_add_f32 v65, v65, v89
    v_add_f32 v66, v66, v90
    v_add_f32 v67, v67, v91
    v_add_f32 v68, v68, v92
    v_add_f32 v69, v69, v93
    v_add_f32 v70, v70, v94
    v_add_f32 v71, v71, v95
    v_cvt_pk_bf16_f32 v56, v64, v65
    v_lshlrev_b32 v57, 16, v32
    v_and_b32 v58, 0xffff0000, v32
    v_lshlrev_b32 v59, 16, v56
    v_and_b32 v56, 0xffff0000, v56
    v_add_f32 v57, v57, v59
    v_add_f32 v58, v58, v56
    v_cvt_pk_bf16_f32 v36, v57, v58
    v_cvt_pk_bf16_f32 v56, v66, v67
    v_lshlrev_b32 v57, 16, v33
    v_and_b32 v58, 0xffff0000, v33
    v_lshlrev_b32 v59, 16, v56
    v_and_b32 v56, 0xffff0000, v56
    v_add_f32 v57, v57, v59
    v_add_f32 v58, v58, v56
    v_cvt_pk_bf16_f32 v37, v57, v58
    v_cvt_pk_bf16_f32 v56, v68, v69
    v_lshlrev_b32 v57, 16, v34
    v_and_b32 v58, 0xffff0000, v34
    v_lshlrev_b32 v59, 16, v56
    v_and_b32 v56, 0xffff0000, v56
    v_add_f32 v57, v57, v59
    v_add_f32 v58, v58, v56
    v_cvt_pk_bf16_f32 v38, v57, v58
    v_cvt_pk_bf16_f32 v56, v70, v71
    v_lshlrev_b32 v57, 16, v35
    v_and_b32 v58, 0xffff0000, v35
    v_lshlrev_b32 v59, 16, v56
    v_and_b32 v56, 0xffff0000, v56
    v_add_f32 v57, v57, v59
    v_add_f32 v58, v58, v56
    v_cvt_pk_bf16_f32 v39, v57, v58
    s_cmp_lg_u32 s14, 0
    s_cbranch_scc1 BO_FIN
    s_add_u32 s3, s63, 0xa00000
    buffer_store_dwordx4 v[36:39], v1, s[8:11], s3 offen sc1
    s_lshl_b32 s49, s32, 7
    s_add_u32 s49, s49, s38
    s_mov_b64 exec, 1
    v_mov_b32 v8, 0
    v_mov_b32 v9, 1
    s_waitcnt vmcnt(0)
    buffer_atomic_add v9, v8, s[8:11], s49 offen sc1
    s_mov_b64 exec, -1
    s_branch BO_NEXT
BO_FIN:
    s_add_u32 s3, s62, s45
    buffer_store_dwordx4 v[36:39], v7, s[24:27], s3 offen
BO_NEXT:
    v_add_u32 v10, s40, v10
    v_add_u32 v11, s40, v11
    s_sub_u32 s40, 0, s40
    s_add_u32 s32, s32, 2
    s_cmp_lt_u32 s32, 64
    s_cbranch_scc1 BO_SEG
    s_add_u32 s14, s14, 1
    s_cmp_lt_u32 s14, s15
    s_cbranch_scc1 BO_PAIR
    s_endpgm
ROLE_R:
    s_mov_b32 s32, s12
    s_lshl_b32 s41, s13, 5
    s_add_u32 s41, s41, s32
    v_lshlrev_b32 v1, 4, v0
    v_and_b32 v16, 15, v0
    v_lshrrev_b32 v17, 4, v0
    v_and_b32 v18, 7, v0
    v_bfe_u32 v19, v0, 3, 1
    v_and_b32 v20, 3, v0
    v_bfe_u32 v21, v0, 2, 2
    v_and_b32 v27, 1, v0
    v_mul_u32_u24 v2, 0xaaaa, v27
    v_add_u32 v2, 0x4444, v2
    v_lshrrev_b32 v23, 1, v17
    v_and_b32 v24, 1, v17
    v_mul_u32_u24 v22, 4224, v17
    v_lshl_add_u32 v22, v16, 3, v22
    s_mul_i32 s3, s13, 16896
    s_lshl_b32 s59, s32, 7
    s_add_u32 s3, s3, s59
    v_add_u32 v3, s3, v22
    s_mul_i32 s3, s41, 4224
    v_add_u32 v4, s3, v1
    v_bfe_u32 v22, v0, 2, 1
    v_lshlrev_b32 v22, 8, v22
    v_lshl_add_u32 v22, v24, 5, v22
    v_bfe_u32 v25, v0, 1, 1
    v_lshl_add_u32 v22, v25, 4, v22
    v_lshl_add_u32 v22, v23, 3, v22
    v_lshl_add_u32 v22, v27, 2, v22
    s_lshr_b32 s3, s41, 2
    s_lshl_b32 s3, s3, 9
    s_and_b32 s59, s41, 3
    s_lshl_b32 s59, s59, 6
    s_add_u32 s3, s3, s59
    v_add_u32 v5, s3, v22
    s_lshl_b32 s3, s13, 10
    v_add_u32 v6, s3, v1
    s_and_b32 s55, s13, 1
    s_lshl_b32 s55, s55, 10
    s_add_u32 s55, s55, 8192
    s_xor_b32 s56, s55, 1024
    v_lshlrev_b32 v22, 8, v23
    v_lshl_add_u32 v22, v18, 5, v22
    v_lshl_add_u32 v22, v24, 4, v22
    s_lshl_b32 s3, s13, 9
    v_add_u32 v7, s3, v22
    v_lshl_add_u32 v8, v19, 11, v22
    v_lshlrev_b32 v22, 5, v18
    v_lshl_add_u32 v22, v23, 4, v22
    v_lshl_add_u32 v22, v24, 3, v22
    v_lshl_add_u32 v9, v19, 2, v22
    s_mul_i32 s48, s13, 36864
    s_add_u32 s48, s48, 16384
    v_add_u32 v10, s48, v1
    v_lshlrev_b32 v22, 1, v17
    v_sub_u32 v22, v16, v22
    v_mov_b32 v25, 0x3f803f80
    v_cmp_eq_u32 vcc, 0, v22
    s_nop 1
    v_cndmask_b32 v12, 0, v25, vcc
    v_cmp_eq_u32 vcc, 1, v22
    s_nop 1
    v_cndmask_b32 v13, 0, v25, vcc
    v_cmp_eq_u32 vcc, 8, v22
    s_nop 1
    v_cndmask_b32 v14, 0, v25, vcc
    v_cmp_eq_u32 vcc, 9, v22
    s_nop 1
    v_cndmask_b32 v15, 0, v25, vcc
    v_mov_b32 v25, 0x3f80
    v_mov_b32 v26, 0x3f800000
    v_lshl_add_u32 v22, v20, 2, v21
    v_cmp_eq_u32 vcc, 0, v22
    s_nop 1
    v_cndmask_b32 v100, 0, v25, vcc
    v_cmp_eq_u32 vcc, 1, v22
    s_nop 1
    v_cndmask_b32 v100, v100, v26, vcc
    v_cmp_eq_u32 vcc, 2, v22
    s_nop 1
    v_cndmask_b32 v101, 0, v25, vcc
    v_cmp_eq_u32 vcc, 3, v22
    s_nop 1
    v_cndmask_b32 v101, v101, v26, vcc
    v_cmp_eq_u32 vcc, 4, v22
    s_nop 1
    v_cndmask_b32 v102, 0, v25, vcc
    v_cmp_eq_u32 vcc, 5, v22
    s_nop 1
    v_cndmask_b32 v102, v102, v26, vcc
    v_cmp_eq_u32 vcc, 6, v22
    s_nop 1
    v_cndmask_b32 v103, 0, v25, vcc
    v_cmp_eq_u32 vcc, 7, v22
    s_nop 1
    v_cndmask_b32 v103, v103, v26, vcc
    s_mov_b32 s50, 0x00ff00ff
    s_mov_b32 s51, 0x00ff00ff
    s_mov_b32 s57, 0xff81ff81
    s_cmp_ge_u32 s41, 80
    s_cbranch_scc1 R_NI
    v_mov_b32 v28, s57
    v_mov_b32 v29, s57
    v_mov_b32 v30, s57
    v_mov_b32 v31, s57
    s_mov_b32 s3, 0x100000
    buffer_store_dwordx4 v[28:31], v4, s[8:11], s3 offen sc1
    s_mov_b32 s3, 0x100400
    buffer_store_dwordx4 v[28:31], v4, s[8:11], s3 offen sc1
    s_mov_b32 s3, 0x100800
    buffer_store_dwordx4 v[28:31], v4, s[8:11], s3 offen sc1
    s_mov_b32 s3, 0x100c00
    buffer_store_dwordx4 v[28:31], v4, s[8:11], s3 offen sc1
    s_mov_b32 s3, 0x1c0000
    buffer_store_dword v28, v5, s[8:11], s3 offen sc1
    s_mov_b32 s3, 0x1c2800
    buffer_store_dword v28, v5, s[8:11], s3 offen sc1
    s_mov_b32 s3, 0x1c5000
    buffer_store_dword v28, v5, s[8:11], s3 offen sc1
R_NI:
    s_waitcnt vmcnt(0)
    s_barrier
    s_cmp_lg_u32 s13, 0
    s_cbranch_scc1 R_NT
    s_cmp_eq_u32 s18, 0
    s_cselect_b32 s3, 1, 0x10001
    v_mov_b32 v28, 144
    v_mov_b32 v29, s3
    s_mov_b64 exec, 1
    buffer_atomic_add v29, v28, s[20:23], 0 offen sc1
    s_mov_b64 exec, -1
R_NT:
    s_load_dwordx4 s[4:7], s[0:1], 48
    s_load_dwordx4 s[60:63], s[0:1], 64
    s_waitcnt lgkmcnt(0)
    s_mov_b32 s64, s6
    s_mov_b32 s65, s7
    s_mov_b32 s66, 0x500000
    s_mov_b32 s67, 0x20000
    s_mov_b32 s68, s60
    s_mov_b32 s69, s61
    s_mov_b32 s70, 0x500000
    s_mov_b32 s71, 0x20000
    s_mov_b32 s72, s62
    s_mov_b32 s73, s63
    s_mov_b32 s74, 0x500000
    s_mov_b32 s75, 0x20000
    s_mov_b32 s24, s4
    s_mov_b32 s25, s5
    s_mov_b32 s26, 0x2800
    s_mov_b32 s27, 0x20000
    s_load_dwordx2 s[4:5], s[0:1], 80
    s_waitcnt lgkmcnt(0)
    s_mov_b32 s76, s4
    s_mov_b32 s77, s5
    s_mov_b32 s78, 0x500000
    s_mov_b32 s79, 0x20000
    v_lshrrev_b32 v22, 2, v0
    v_lshlrev_b32 v96, 13, v22
    v_lshl_add_u32 v96, v20, 4, v96
    v_mul_u32_u24 v97, 1280, v22
    v_lshl_add_u32 v97, v20, 4, v97
    v_lshlrev_b32 v22, 4, v23
    v_lshl_add_u32 v22, v24, 2, v22
    v_and_b32 v25, 1, v21
    v_add_u32 v22, v22, v25
    v_lshrrev_b32 v25, 1, v21
    v_lshl_add_u32 v22, v25, 3, v22
    v_lshlrev_b32 v22, 6, v22
    v_lshl_add_u32 v22, v20, 4, v22
    s_mul_i32 s49, s13, 40960
    v_add_u32 v98, s49, v22
    s_lshl_b32 s60, s32, 8
    s_lshl_b32 s3, s13, 6
    s_add_u32 s60, s60, s3
    s_mul_i32 s61, s32, 163840
    s_add_u32 s61, s61, s3
    s_xor_b32 s3, s13, 0
    s_lshl_b32 s3, s3, 19
    s_add_u32 s80, s3, s60
    s_xor_b32 s3, s13, 1
    s_lshl_b32 s3, s3, 19
    s_add_u32 s81, s3, s60
    s_xor_b32 s3, s13, 2
    s_lshl_b32 s3, s3, 19
    s_add_u32 s82, s3, s60
    s_xor_b32 s3, s13, 3
    s_lshl_b32 s3, s3, 19
    s_add_u32 s83, s3, s60
    s_xor_b32 s3, s13, 4
    s_lshl_b32 s3, s3, 19
    s_add_u32 s84, s3, s60
    s_xor_b32 s3, s13, 5
    s_lshl_b32 s3, s3, 19
    s_add_u32 s85, s3, s60
    s_xor_b32 s3, s13, 6
    s_lshl_b32 s3, s3, 19
    s_add_u32 s86, s3, s60
    s_xor_b32 s3, s13, 7
    s_lshl_b32 s3, s3, 19
    s_add_u32 s87, s3, s60
    s_lshl_b32 s3, s55, 9
    s_add_u32 s88, s3, s60
    s_lshl_b32 s3, s56, 9
    s_add_u32 s89, s3, s60
    s_lshl_b32 s3, s32, 2
    s_add_u32 s3, s3, s13
    s_mul_i32 s40, s3, 36864
    s_add_u32 s40, s40, 0x200000
    s_mul_i32 s62, s3, 22528
    s_add_u32 s62, s62, 0x680000
    s_add_u32 m0, s49, 0
    s_add_u32 s3, s80, 0x0
    buffer_load_dwordx4 v96, s[64:67], s3 offen lds
    s_add_u32 m0, s49, 1024
    s_add_u32 s3, s80, 0x20000
    buffer_load_dwordx4 v96, s[64:67], s3 offen lds
    s_add_u32 m0, s49, 2048
    s_add_u32 s3, s80, 0x40000
    buffer_load_dwordx4 v96, s[64:67], s3 offen lds
    s_add_u32 m0, s49, 3072
    s_add_u32 s3, s80, 0x60000
    buffer_load_dwordx4 v96, s[64:67], s3 offen lds
    s_add_u32 m0, s49, 4096
    s_add_u32 s3, s81, 0x0
    buffer_load_dwordx4 v96, s[64:67], s3 offen lds
    s_add_u32 m0, s49, 5120
    s_add_u32 s3, s81, 0x20000
    buffer_load_dwordx4 v96, s[64:67], s3 offen lds
    s_add_u32 m0, s49, 6144
    s_add_u32 s3, s81, 0x40000
    buffer_load_dwordx4 v96, s[64:67], s3 offen lds
    s_add_u32 m0, s49, 7168
    s_add_u32 s3, s81, 0x60000
    buffer_load_dwordx4 v96, s[64:67], s3 offen lds
    s_add_u32 m0, s49, 8192
    s_add_u32 s3, s82, 0x0
    buffer_load_dwordx4 v96, s[64:67], s3 offen lds
    s_add_u32 m0, s49, 9216
    s_add_u32 s3, s82, 0x20000
    buffer_load_dwordx4 v96, s[64:67], s3 offen lds
    s_add_u32 m0, s49, 10240
    s_add_u32 s3, s82, 0x40000
    buffer_load_dwordx4 v96, s[64:67], s3 offen lds
    s_add_u32 m0, s49, 11264
    s_add_u32 s3, s82, 0x60000
    buffer_load_dwordx4 v96, s[64:67], s3 offen lds
    s_add_u32 m0, s49, 12288
    s_add_u32 s3, s83, 0x0
    buffer_load_dwordx4 v96, s[64:67], s3 offen lds
    s_add_u32 m0, s49, 13312
    s_add_u32 s3, s83, 0x20000
    buffer_load_dwordx4 v96, s[64:67], s3 offen lds
    s_add_u32 m0, s49, 14336
    s_add_u32 s3, s83, 0x40000
    buffer_load_dwordx4 v96, s[64:67], s3 offen lds
    s_add_u32 m0, s49, 15360
    s_add_u32 s3, s83, 0x60000
    buffer_load_dwordx4 v96, s[64:67], s3 offen lds
    s_add_u32 m0, s49, 16384
    s_add_u32 s3, s84, 0x0
    buffer_load_dwordx4 v96, s[64:67], s3 offen lds
    s_add_u32 m0, s49, 17408
    s_add_u32 s3, s84, 0x20000
    buffer_load_dwordx4 v96, s[64:67], s3 offen lds
    s_add_u32 m0, s49, 18432
    s_add_u32 s3, s84, 0x40000
    buffer_load_dwordx4 v96, s[64:67], s3 offen lds
    s_add_u32 m0, s49, 19456
    s_add_u32 s3, s84, 0x60000
    buffer_load_dwordx4 v96, s[64:67], s3 offen lds
    s_add_u32 m0, s49, 20480
    s_add_u32 s3, s85, 0x0
    buffer_load_dwordx4 v96, s[64:67], s3 offen lds
    s_add_u32 m0, s49, 21504
    s_add_u32 s3, s85, 0x20000
    buffer_load_dwordx4 v96, s[64:67], s3 offen lds
    s_add_u32 m0, s49, 22528
    s_add_u32 s3, s85, 0x40000
    buffer_load_dwordx4 v96, s[64:67], s3 offen lds
    s_add_u32 m0, s49, 23552
    s_add_u32 s3, s85, 0x60000
    buffer_load_dwordx4 v96, s[64:67], s3 offen lds
    s_add_u32 m0, s49, 24576
    s_add_u32 s3, s86, 0x0
    buffer_load_dwordx4 v96, s[64:67], s3 offen lds
    s_add_u32 m0, s49, 25600
    s_add_u32 s3, s86, 0x20000
    buffer_load_dwordx4 v96, s[64:67], s3 offen lds
    s_add_u32 m0, s49, 26624
    s_add_u32 s3, s86, 0x40000
    buffer_load_dwordx4 v96, s[64:67], s3 offen lds
    s_add_u32 m0, s49, 27648
    s_add_u32 s3, s86, 0x60000
    buffer_load_dwordx4 v96, s[64:67], s3 offen lds
    s_add_u32 m0, s49, 28672
    s_add_u32 s3, s87, 0x0
    buffer_load_dwordx4 v96, s[64:67], s3 offen lds
    s_add_u32 m0, s49, 29696
    s_add_u32 s3, s87, 0x20000
    buffer_load_dwordx4 v96, s[64:67], s3 offen lds
    s_add_u32 m0, s49, 30720
    s_add_u32 s3, s87, 0x40000
    buffer_load_dwordx4 v96, s[64:67], s3 offen lds
    s_add_u32 m0, s49, 31744
    s_add_u32 s3, s87, 0x60000
    buffer_load_dwordx4 v96, s[64:67], s3 offen lds
    s_add_u32 m0, s49, 32768
    s_add_u32 s3, s88, 0x0
    buffer_load_dwordx4 v96, s[64:67], s3 offen lds
    s_add_u32 m0, s49, 33792
    s_add_u32 s3, s88, 0x20000
    buffer_load_dwordx4 v96, s[64:67], s3 offen lds
    s_add_u32 m0, s49, 34816
    s_add_u32 s3, s88, 0x40000
    buffer_load_dwordx4 v96, s[64:67], s3 offen lds
    s_add_u32 m0, s49, 35840
    s_add_u32 s3, s88, 0x60000
    buffer_load_dwordx4 v96, s[64:67], s3 offen lds
    s_add_u32 m0, s49, 36864
    s_add_u32 s3, s89, 0x0
    buffer_load_dwordx4 v96, s[64:67], s3 offen lds
    s_add_u32 m0, s49, 37888
    s_add_u32 s3, s89, 0x20000
    buffer_load_dwordx4 v96, s[64:67], s3 offen lds
    s_add_u32 m0, s49, 38912
    s_add_u32 s3, s89, 0x40000
    buffer_load_dwordx4 v96, s[64:67], s3 offen lds
    s_add_u32 m0, s49, 39936
    s_add_u32 s3, s89, 0x60000
    buffer_load_dwordx4 v96, s[64:67], s3 offen lds
    s_waitcnt vmcnt(20)
    ds_read_b64_tr_b16 v[16:17], v98 offset:0
    ds_read_b64_tr_b16 v[18:19], v98 offset:128
    ds_read_b64_tr_b16 v[20:21], v98 offset:2048
    ds_read_b64_tr_b16 v[22:23], v98 offset:2176
    ds_read_b64_tr_b16 v[24:25], v98 offset:8
    ds_read_b64_tr_b16 v[26:27], v98 offset:136
    ds_read_b64_tr_b16 v[28:29], v98 offset:2056
    ds_read_b64_tr_b16 v[30:31], v98 offset:2184
    ds_read_b64_tr_b16 v[112:113], v98 offset:4096
    ds_read_b64_tr_b16 v[114:115], v98 offset:4224
    ds_read_b64_tr_b16 v[116:117], v98 offset:6144
    ds_read_b64_tr_b16 v[118:119], v98 offset:6272
    ds_read_b64_tr_b16 v[128:129], v98 offset:4104
    ds_read_b64_tr_b16 v[130:131], v98 offset:4232
    ds_read_b64_tr_b16 v[132:133], v98 offset:6152
    ds_read_b64_tr_b16 v[134:135], v98 offset:6280
    ds_read_b64_tr_b16 v[144:145], v98 offset:8192
    ds_read_b64_tr_b16 v[146:147], v98 offset:8320
    ds_read_b64_tr_b16 v[148:149], v98 offset:10240
    ds_read_b64_tr_b16 v[150:151], v98 offset:10368
    ds_read_b64_tr_b16 v[152:153], v98 offset:8200
    ds_read_b64_tr_b16 v[154:155], v98 offset:8328
    ds_read_b64_tr_b16 v[156:157], v98 offset:10248
    ds_read_b64_tr_b16 v[158:159], v98 offset:10376
    ds_read_b64_tr_b16 v[168:169], v98 offset:12288
    ds_read_b64_tr_b16 v[170:171], v98 offset:12416
    ds_read_b64_tr_b16 v[172:173], v98 offset:14336
    ds_read_b64_tr_b16 v[174:175], v98 offset:14464
    ds_read_b64_tr_b16 v[176:177], v98 offset:12296
    ds_read_b64_tr_b16 v[178:179], v98 offset:12424
    ds_read_b64_tr_b16 v[180:181], v98 offset:14344
    ds_read_b64_tr_b16 v[182:183], v98 offset:14472
    ds_read_b64_tr_b16 v[192:193], v98 offset:16384
    ds_read_b64_tr_b16 v[194:195], v98 offset:16512
    ds_read_b64_tr_b16 v[196:197], v98 offset:18432
    ds_read_b64_tr_b16 v[198:199], v98 offset:18560
    ds_read_b64_tr_b16 v[200:201], v98 offset:16392
    ds_read_b64_tr_b16 v[202:203], v98 offset:16520
    ds_read_b64_tr_b16 v[204:205], v98 offset:18440
    ds_read_b64_tr_b16 v[206:207], v98 offset:18568
    s_waitcnt lgkmcnt(0)
    s_add_u32 s3, s62, 0
    buffer_store_dwordx4 v[16:19], v1, s[8:11], s3 offen offset:0
    buffer_store_dwordx4 v[20:23], v1, s[8:11], s3 offen offset:1024
    s_add_u32 s3, s62, 4096
    buffer_store_dwordx4 v[24:27], v1, s[8:11], s3 offen offset:0
    buffer_store_dwordx4 v[28:31], v1, s[8:11], s3 offen offset:1024
    s_add_u32 m0, s49, 0
    s_add_u32 s3, s80, 0x0
    buffer_load_dwordx4 v96, s[68:71], s3 offen lds
    s_add_u32 m0, s49, 1024
    s_add_u32 s3, s80, 0x20000
    buffer_load_dwordx4 v96, s[68:71], s3 offen lds
    s_add_u32 m0, s49, 2048
    s_add_u32 s3, s80, 0x40000
    buffer_load_dwordx4 v96, s[68:71], s3 offen lds
    s_add_u32 m0, s49, 3072
    s_add_u32 s3, s80, 0x60000
    buffer_load_dwordx4 v96, s[68:71], s3 offen lds
    s_add_u32 m0, s49, 4096
    s_add_u32 s3, s81, 0x0
    buffer_load_dwordx4 v96, s[68:71], s3 offen lds
    s_add_u32 m0, s49, 5120
    s_add_u32 s3, s81, 0x20000
    buffer_load_dwordx4 v96, s[68:71], s3 offen lds
    s_add_u32 m0, s49, 6144
    s_add_u32 s3, s81, 0x40000
    buffer_load_dwordx4 v96, s[68:71], s3 offen lds
    s_add_u32 m0, s49, 7168
    s_add_u32 s3, s81, 0x60000
    buffer_load_dwordx4 v96, s[68:71], s3 offen lds
    s_add_u32 m0, s49, 8192
    s_add_u32 s3, s82, 0x0
    buffer_load_dwordx4 v96, s[68:71], s3 offen lds
    s_add_u32 m0, s49, 9216
    s_add_u32 s3, s82, 0x20000
    buffer_load_dwordx4 v96, s[68:71], s3 offen lds
    s_add_u32 m0, s49, 10240
    s_add_u32 s3, s82, 0x40000
    buffer_load_dwordx4 v96, s[68:71], s3 offen lds
    s_add_u32 m0, s49, 11264
    s_add_u32 s3, s82, 0x60000
    buffer_load_dwordx4 v96, s[68:71], s3 offen lds
    s_add_u32 m0, s49, 12288
    s_add_u32 s3, s83, 0x0
    buffer_load_dwordx4 v96, s[68:71], s3 offen lds
    s_add_u32 m0, s49, 13312
    s_add_u32 s3, s83, 0x20000
    buffer_load_dwordx4 v96, s[68:71], s3 offen lds
    s_add_u32 m0, s49, 14336
    s_add_u32 s3, s83, 0x40000
    buffer_load_dwordx4 v96, s[68:71], s3 offen lds
    s_add_u32 m0, s49, 15360
    s_add_u32 s3, s83, 0x60000
    buffer_load_dwordx4 v96, s[68:71], s3 offen lds
    s_add_u32 m0, s49, 16384
    s_add_u32 s3, s84, 0x0
    buffer_load_dwordx4 v96, s[68:71], s3 offen lds
    s_add_u32 m0, s49, 17408
    s_add_u32 s3, s84, 0x20000
    buffer_load_dwordx4 v96, s[68:71], s3 offen lds
    s_add_u32 m0, s49, 18432
    s_add_u32 s3, s84, 0x40000
    buffer_load_dwordx4 v96, s[68:71], s3 offen lds
    s_add_u32 m0, s49, 19456
    s_add_u32 s3, s84, 0x60000
    buffer_load_dwordx4 v96, s[68:71], s3 offen lds
    s_waitcnt vmcnt(24)
    ds_read_b64_tr_b16 v[224:225], v98 offset:20480
    ds_read_b64_tr_b16 v[226:227], v98 offset:20608
    ds_read_b64_tr_b16 v[228:229], v98 offset:22528
    ds_read_b64_tr_b16 v[230:231], v98 offset:22656
    ds_read_b64_tr_b16 v[16:17], v98 offset:20488
    ds_read_b64_tr_b16 v[18:19], v98 offset:20616
    ds_read_b64_tr_b16 v[20:21], v98 offset:22536
    ds_read_b64_tr_b16 v[22:23], v98 offset:22664
    ds_read_b64_tr_b16 v[240:241], v98 offset:24576
    ds_read_b64_tr_b16 v[242:243], v98 offset:24704
    ds_read_b64_tr_b16 v[244:245], v98 offset:26624
    ds_read_b64_tr_b16 v[246:247], v98 offset:26752
    ds_read_b64_tr_b16 v[24:25], v98 offset:24584
    ds_read_b64_tr_b16 v[26:27], v98 offset:24712
    ds_read_b64_tr_b16 v[28:29], v98 offset:26632
    ds_read_b64_tr_b16 v[30:31], v98 offset:26760
    ds_read_b64_tr_b16 a[0:1], v98 offset:28672
    ds_read_b64_tr_b16 a[2:3], v98 offset:28800
    ds_read_b64_tr_b16 a[4:5], v98 offset:30720
    ds_read_b64_tr_b16 a[6:7], v98 offset:30848
    ds_read_b64_tr_b16 a[16:17], v98 offset:28680
    ds_read_b64_tr_b16 a[18:19], v98 offset:28808
    ds_read_b64_tr_b16 a[20:21], v98 offset:30728
    ds_read_b64_tr_b16 a[22:23], v98 offset:30856
    ds_read_b64_tr_b16 a[24:25], v98 offset:32768
    ds_read_b64_tr_b16 a[26:27], v98 offset:32896
    ds_read_b64_tr_b16 a[28:29], v98 offset:34816
    ds_read_b64_tr_b16 a[30:31], v98 offset:34944
    ds_read_b64_tr_b16 a[40:41], v98 offset:32776
    ds_read_b64_tr_b16 a[42:43], v98 offset:32904
    ds_read_b64_tr_b16 a[44:45], v98 offset:34824
    ds_read_b64_tr_b16 a[46:47], v98 offset:34952
    ds_read_b64_tr_b16 a[56:57], v98 offset:36864
    ds_read_b64_tr_b16 a[58:59], v98 offset:36992
    ds_read_b64_tr_b16 a[60:61], v98 offset:38912
    ds_read_b64_tr_b16 a[62:63], v98 offset:39040
    ds_read_b64_tr_b16 v[32:33], v98 offset:36872
    ds_read_b64_tr_b16 v[34:35], v98 offset:37000
    ds_read_b64_tr_b16 v[36:37], v98 offset:38920
    ds_read_b64_tr_b16 v[38:39], v98 offset:39048
    s_waitcnt lgkmcnt(0)
    s_add_u32 s3, s62, 10240
    buffer_store_dwordx4 v[16:19], v1, s[8:11], s3 offen offset:0
    buffer_store_dwordx4 v[20:23], v1, s[8:11], s3 offen offset:1024
    s_add_u32 s3, s62, 12288
    buffer_store_dwordx4 v[24:27], v1, s[8:11], s3 offen offset:0
    buffer_store_dwordx4 v[28:31], v1, s[8:11], s3 offen offset:1024
    s_add_u32 s3, s40, 18432
    buffer_store_dwordx4 v[32:35], v1, s[8:11], s3 offen offset:0
    buffer_store_dwordx4 v[36:39], v1, s[8:11], s3 offen offset:1024
    s_add_u32 m0, s49, 20480
    s_add_u32 s3, s85, 0x0
    buffer_load_dwordx4 v96, s[68:71], s3 offen lds
    s_add_u32 m0, s49, 21504
    s_add_u32 s3, s85, 0x20000
    buffer_load_dwordx4 v96, s[68:71], s3 offen lds
    s_add_u32 m0, s49, 22528
    s_add_u32 s3, s85, 0x40000
    buffer_load_dwordx4 v96, s[68:71], s3 offen lds
    s_add_u32 m0, s49, 23552
    s_add_u32 s3, s85, 0x60000
    buffer_load_dwordx4 v96, s[68:71], s3 offen lds
    s_add_u32 m0, s49, 24576
    s_add_u32 s3, s86, 0x0
    buffer_load_dwordx4 v96, s[68:71], s3 offen lds
    s_add_u32 m0, s49, 25600
    s_add_u32 s3, s86, 0x20000
    buffer_load_dwordx4 v96, s[68:71], s3 offen lds
    s_add_u32 m0, s49, 26624
    s_add_u32 s3, s86, 0x40000
    buffer_load_dwordx4 v96, s[68:71], s3 offen lds
    s_add_u32 m0, s49, 27648
    s_add_u32 s3, s86, 0x60000
    buffer_load_dwordx4 v96, s[68:71], s3 offen lds
    s_add_u32 m0, s49, 28672
    s_add_u32 s3, s87, 0x0
    buffer_load_dwordx4 v96, s[68:71], s3 offen lds
    s_add_u32 m0, s49, 29696
    s_add_u32 s3, s87, 0x20000
    buffer_load_dwordx4 v96, s[68:71], s3 offen lds
    s_add_u32 m0, s49, 30720
    s_add_u32 s3, s87, 0x40000
    buffer_load_dwordx4 v96, s[68:71], s3 offen lds
    s_add_u32 m0, s49, 31744
    s_add_u32 s3, s87, 0x60000
    buffer_load_dwordx4 v96, s[68:71], s3 offen lds
    s_add_u32 m0, s49, 32768
    s_add_u32 s3, s88, 0x0
    buffer_load_dwordx4 v96, s[68:71], s3 offen lds
    s_add_u32 m0, s49, 33792
    s_add_u32 s3, s88, 0x20000
    buffer_load_dwordx4 v96, s[68:71], s3 offen lds
    s_add_u32 m0, s49, 34816
    s_add_u32 s3, s88, 0x40000
    buffer_load_dwordx4 v96, s[68:71], s3 offen lds
    s_add_u32 m0, s49, 35840
    s_add_u32 s3, s88, 0x60000
    buffer_load_dwordx4 v96, s[68:71], s3 offen lds
    s_add_u32 m0, s49, 36864
    s_add_u32 s3, s89, 0x0
    buffer_load_dwordx4 v96, s[68:71], s3 offen lds
    s_add_u32 m0, s49, 37888
    s_add_u32 s3, s89, 0x20000
    buffer_load_dwordx4 v96, s[68:71], s3 offen lds
    s_add_u32 m0, s49, 38912
    s_add_u32 s3, s89, 0x40000
    buffer_load_dwordx4 v96, s[68:71], s3 offen lds
    s_add_u32 m0, s49, 39936
    s_add_u32 s3, s89, 0x60000
    buffer_load_dwordx4 v96, s[68:71], s3 offen lds
    s_waitcnt vmcnt(26)
    ds_read_b64_tr_b16 v[16:17], v98 offset:0
    ds_read_b64_tr_b16 v[18:19], v98 offset:128
    ds_read_b64_tr_b16 v[20:21], v98 offset:2048
    ds_read_b64_tr_b16 v[22:23], v98 offset:2176
    ds_read_b64_tr_b16 v[104:105], v98 offset:8
    ds_read_b64_tr_b16 v[106:107], v98 offset:136
    ds_read_b64_tr_b16 v[108:109], v98 offset:2056
    ds_read_b64_tr_b16 v[110:111], v98 offset:2184
    ds_read_b64_tr_b16 v[120:121], v98 offset:4096
    ds_read_b64_tr_b16 v[122:123], v98 offset:4224
    ds_read_b64_tr_b16 v[124:125], v98 offset:6144
    ds_read_b64_tr_b16 v[126:127], v98 offset:6272
    ds_read_b64_tr_b16 v[136:137], v98 offset:4104
    ds_read_b64_tr_b16 v[138:139], v98 offset:4232
    ds_read_b64_tr_b16 v[140:141], v98 offset:6152
    ds_read_b64_tr_b16 v[142:143], v98 offset:6280
    ds_read_b64_tr_b16 v[24:25], v98 offset:8192
    ds_read_b64_tr_b16 v[26:27], v98 offset:8320
    ds_read_b64_tr_b16 v[28:29], v98 offset:10240
    ds_read_b64_tr_b16 v[30:31], v98 offset:10368
    ds_read_b64_tr_b16 v[160:161], v98 offset:8200
    ds_read_b64_tr_b16 v[162:163], v98 offset:8328
    ds_read_b64_tr_b16 v[164:165], v98 offset:10248
    ds_read_b64_tr_b16 v[166:167], v98 offset:10376
    ds_read_b64_tr_b16 v[32:33], v98 offset:12288
    ds_read_b64_tr_b16 v[34:35], v98 offset:12416
    ds_read_b64_tr_b16 v[36:37], v98 offset:14336
    ds_read_b64_tr_b16 v[38:39], v98 offset:14464
    ds_read_b64_tr_b16 v[184:185], v98 offset:12296
    ds_read_b64_tr_b16 v[186:187], v98 offset:12424
    ds_read_b64_tr_b16 v[188:189], v98 offset:14344
    ds_read_b64_tr_b16 v[190:191], v98 offset:14472
    ds_read_b64_tr_b16 v[40:41], v98 offset:16384
    ds_read_b64_tr_b16 v[42:43], v98 offset:16512
    ds_read_b64_tr_b16 v[44:45], v98 offset:18432
    ds_read_b64_tr_b16 v[46:47], v98 offset:18560
    ds_read_b64_tr_b16 v[208:209], v98 offset:16392
    ds_read_b64_tr_b16 v[210:211], v98 offset:16520
    ds_read_b64_tr_b16 v[212:213], v98 offset:18440
    ds_read_b64_tr_b16 v[214:215], v98 offset:18568
    s_waitcnt lgkmcnt(0)
    s_add_u32 s3, s62, 2048
    buffer_store_dwordx4 v[16:19], v1, s[8:11], s3 offen offset:0
    buffer_store_dwordx4 v[20:23], v1, s[8:11], s3 offen offset:1024
    s_add_u32 s3, s40, 0
    buffer_store_dwordx4 v[24:27], v1, s[8:11], s3 offen offset:0
    buffer_store_dwordx4 v[28:31], v1, s[8:11], s3 offen offset:1024
    s_add_u32 s3, s40, 2048
    buffer_store_dwordx4 v[32:35], v1, s[8:11], s3 offen offset:0
    buffer_store_dwordx4 v[36:39], v1, s[8:11], s3 offen offset:1024
    s_add_u32 s3, s40, 4096
    buffer_store_dwordx4 v[40:43], v1, s[8:11], s3 offen offset:0
    buffer_store_dwordx4 v[44:47], v1, s[8:11], s3 offen offset:1024
    s_add_u32 m0, s49, 0
    s_add_u32 s3, s80, 0x0
    buffer_load_dwordx4 v96, s[72:75], s3 offen lds
    s_add_u32 m0, s49, 1024
    s_add_u32 s3, s80, 0x20000
    buffer_load_dwordx4 v96, s[72:75], s3 offen lds
    s_add_u32 m0, s49, 2048
    s_add_u32 s3, s80, 0x40000
    buffer_load_dwordx4 v96, s[72:75], s3 offen lds
    s_add_u32 m0, s49, 3072
    s_add_u32 s3, s80, 0x60000
    buffer_load_dwordx4 v96, s[72:75], s3 offen lds
    s_add_u32 m0, s49, 4096
    s_add_u32 s3, s81, 0x0
    buffer_load_dwordx4 v96, s[72:75], s3 offen lds
    s_add_u32 m0, s49, 5120
    s_add_u32 s3, s81, 0x20000
    buffer_load_dwordx4 v96, s[72:75], s3 offen lds
    s_add_u32 m0, s49, 6144
    s_add_u32 s3, s81, 0x40000
    buffer_load_dwordx4 v96, s[72:75], s3 offen lds
    s_add_u32 m0, s49, 7168
    s_add_u32 s3, s81, 0x60000
    buffer_load_dwordx4 v96, s[72:75], s3 offen lds
    s_add_u32 m0, s49, 8192
    s_add_u32 s3, s82, 0x0
    buffer_load_dwordx4 v96, s[72:75], s3 offen lds
    s_add_u32 m0, s49, 9216
    s_add_u32 s3, s82, 0x20000
    buffer_load_dwordx4 v96, s[72:75], s3 offen lds
    s_add_u32 m0, s49, 10240
    s_add_u32 s3, s82, 0x40000
    buffer_load_dwordx4 v96, s[72:75], s3 offen lds
    s_add_u32 m0, s49, 11264
    s_add_u32 s3, s82, 0x60000
    buffer_load_dwordx4 v96, s[72:75], s3 offen lds
    s_add_u32 m0, s49, 12288
    s_add_u32 s3, s83, 0x0
    buffer_load_dwordx4 v96, s[72:75], s3 offen lds
    s_add_u32 m0, s49, 13312
    s_add_u32 s3, s83, 0x20000
    buffer_load_dwordx4 v96, s[72:75], s3 offen lds
    s_add_u32 m0, s49, 14336
    s_add_u32 s3, s83, 0x40000
    buffer_load_dwordx4 v96, s[72:75], s3 offen lds
    s_add_u32 m0, s49, 15360
    s_add_u32 s3, s83, 0x60000
    buffer_load_dwordx4 v96, s[72:75], s3 offen lds
    s_add_u32 m0, s49, 16384
    s_add_u32 s3, s84, 0x0
    buffer_load_dwordx4 v96, s[72:75], s3 offen lds
    s_add_u32 m0, s49, 17408
    s_add_u32 s3, s84, 0x20000
    buffer_load_dwordx4 v96, s[72:75], s3 offen lds
    s_add_u32 m0, s49, 18432
    s_add_u32 s3, s84, 0x40000
    buffer_load_dwordx4 v96, s[72:75], s3 offen lds
    s_add_u32 m0, s49, 19456
    s_add_u32 s3, s84, 0x60000
    buffer_load_dwordx4 v96, s[72:75], s3 offen lds
    s_waitcnt vmcnt(28)
    ds_read_b64_tr_b16 v[232:233], v98 offset:20480
    ds_read_b64_tr_b16 v[234:235], v98 offset:20608
    ds_read_b64_tr_b16 v[236:237], v98 offset:22528
    ds_read_b64_tr_b16 v[238:239], v98 offset:22656
    ds_read_b64_tr_b16 v[16:17], v98 offset:20488
    ds_read_b64_tr_b16 v[18:19], v98 offset:20616
    ds_read_b64_tr_b16 v[20:21], v98 offset:22536
    ds_read_b64_tr_b16 v[22:23], v98 offset:22664
    ds_read_b64_tr_b16 v[248:249], v98 offset:24576
    ds_read_b64_tr_b16 v[250:251], v98 offset:24704
    ds_read_b64_tr_b16 v[252:253], v98 offset:26624
    ds_read_b64_tr_b16 v[254:255], v98 offset:26752
    ds_read_b64_tr_b16 v[24:25], v98 offset:24584
    ds_read_b64_tr_b16 v[26:27], v98 offset:24712
    ds_read_b64_tr_b16 v[28:29], v98 offset:26632
    ds_read_b64_tr_b16 v[30:31], v98 offset:26760
    ds_read_b64_tr_b16 a[8:9], v98 offset:28672
    ds_read_b64_tr_b16 a[10:11], v98 offset:28800
    ds_read_b64_tr_b16 a[12:13], v98 offset:30720
    ds_read_b64_tr_b16 a[14:15], v98 offset:30848
    ds_read_b64_tr_b16 v[32:33], v98 offset:28680
    ds_read_b64_tr_b16 v[34:35], v98 offset:28808
    ds_read_b64_tr_b16 v[36:37], v98 offset:30728
    ds_read_b64_tr_b16 v[38:39], v98 offset:30856
    ds_read_b64_tr_b16 a[32:33], v98 offset:32768
    ds_read_b64_tr_b16 a[34:35], v98 offset:32896
    ds_read_b64_tr_b16 a[36:37], v98 offset:34816
    ds_read_b64_tr_b16 a[38:39], v98 offset:34944
    ds_read_b64_tr_b16 v[40:41], v98 offset:32776
    ds_read_b64_tr_b16 v[42:43], v98 offset:32904
    ds_read_b64_tr_b16 v[44:45], v98 offset:34824
    ds_read_b64_tr_b16 v[46:47], v98 offset:34952
    ds_read_b64_tr_b16 a[64:65], v98 offset:36864
    ds_read_b64_tr_b16 a[66:67], v98 offset:36992
    ds_read_b64_tr_b16 a[68:69], v98 offset:38912
    ds_read_b64_tr_b16 a[70:71], v98 offset:39040
    ds_read_b64_tr_b16 a[72:73], v98 offset:36872
    ds_read_b64_tr_b16 a[74:75], v98 offset:37000
    ds_read_b64_tr_b16 a[76:77], v98 offset:38920
    ds_read_b64_tr_b16 a[78:79], v98 offset:39048
    s_waitcnt lgkmcnt(0)
    s_add_u32 s3, s40, 8192
    buffer_store_dwordx4 v[16:19], v1, s[8:11], s3 offen offset:0
    buffer_store_dwordx4 v[20:23], v1, s[8:11], s3 offen offset:1024
    s_add_u32 s3, s40, 10240
    buffer_store_dwordx4 v[24:27], v1, s[8:11], s3 offen offset:0
    buffer_store_dwordx4 v[28:31], v1, s[8:11], s3 offen offset:1024
    s_add_u32 s3, s40, 12288
    buffer_store_dwordx4 v[32:35], v1, s[8:11], s3 offen offset:0
    buffer_store_dwordx4 v[36:39], v1, s[8:11], s3 offen offset:1024
    s_add_u32 s3, s40, 14336
    buffer_store_dwordx4 v[40:43], v1, s[8:11], s3 offen offset:0
    buffer_store_dwordx4 v[44:47], v1, s[8:11], s3 offen offset:1024
    s_add_u32 m0, s49, 20480
    s_add_u32 s3, s85, 0x0
    buffer_load_dwordx4 v96, s[72:75], s3 offen lds
    s_add_u32 m0, s49, 21504
    s_add_u32 s3, s85, 0x20000
    buffer_load_dwordx4 v96, s[72:75], s3 offen lds
    s_add_u32 m0, s49, 22528
    s_add_u32 s3, s85, 0x40000
    buffer_load_dwordx4 v96, s[72:75], s3 offen lds
    s_add_u32 m0, s49, 23552
    s_add_u32 s3, s85, 0x60000
    buffer_load_dwordx4 v96, s[72:75], s3 offen lds
    s_add_u32 m0, s49, 24576
    s_add_u32 s3, s86, 0x0
    buffer_load_dwordx4 v96, s[72:75], s3 offen lds
    s_add_u32 m0, s49, 25600
    s_add_u32 s3, s86, 0x20000
    buffer_load_dwordx4 v96, s[72:75], s3 offen lds
    s_add_u32 m0, s49, 26624
    s_add_u32 s3, s86, 0x40000
    buffer_load_dwordx4 v96, s[72:75], s3 offen lds
    s_add_u32 m0, s49, 27648
    s_add_u32 s3, s86, 0x60000
    buffer_load_dwordx4 v96, s[72:75], s3 offen lds
    s_add_u32 m0, s49, 28672
    s_add_u32 s3, s87, 0x0
    buffer_load_dwordx4 v96, s[72:75], s3 offen lds
    s_add_u32 m0, s49, 29696
    s_add_u32 s3, s87, 0x20000
    buffer_load_dwordx4 v96, s[72:75], s3 offen lds
    s_add_u32 m0, s49, 30720
    s_add_u32 s3, s87, 0x40000
    buffer_load_dwordx4 v96, s[72:75], s3 offen lds
    s_add_u32 m0, s49, 31744
    s_add_u32 s3, s87, 0x60000
    buffer_load_dwordx4 v96, s[72:75], s3 offen lds
    s_add_u32 m0, s49, 32768
    s_add_u32 s3, s88, 0x0
    buffer_load_dwordx4 v96, s[72:75], s3 offen lds
    s_add_u32 m0, s49, 33792
    s_add_u32 s3, s88, 0x20000
    buffer_load_dwordx4 v96, s[72:75], s3 offen lds
    s_add_u32 m0, s49, 34816
    s_add_u32 s3, s88, 0x40000
    buffer_load_dwordx4 v96, s[72:75], s3 offen lds
    s_add_u32 m0, s49, 35840
    s_add_u32 s3, s88, 0x60000
    buffer_load_dwordx4 v96, s[72:75], s3 offen lds
    s_add_u32 m0, s49, 36864
    s_add_u32 s3, s89, 0x0
    buffer_load_dwordx4 v96, s[72:75], s3 offen lds
    s_add_u32 m0, s49, 37888
    s_add_u32 s3, s89, 0x20000
    buffer_load_dwordx4 v96, s[72:75], s3 offen lds
    s_add_u32 m0, s49, 38912
    s_add_u32 s3, s89, 0x40000
    buffer_load_dwordx4 v96, s[72:75], s3 offen lds
    s_add_u32 m0, s49, 39936
    s_add_u32 s3, s89, 0x60000
    buffer_load_dwordx4 v96, s[72:75], s3 offen lds
    s_waitcnt vmcnt(28)
    ds_read_b64_tr_b16 v[16:17], v98 offset:0
    ds_read_b64_tr_b16 v[18:19], v98 offset:128
    ds_read_b64_tr_b16 v[20:21], v98 offset:2048
    ds_read_b64_tr_b16 v[22:23], v98 offset:2176
    ds_read_b64_tr_b16 v[24:25], v98 offset:8
    ds_read_b64_tr_b16 v[26:27], v98 offset:136
    ds_read_b64_tr_b16 v[28:29], v98 offset:2056
    ds_read_b64_tr_b16 v[30:31], v98 offset:2184
    ds_read_b64_tr_b16 v[32:33], v98 offset:4096
    ds_read_b64_tr_b16 v[34:35], v98 offset:4224
    ds_read_b64_tr_b16 v[36:37], v98 offset:6144
    ds_read_b64_tr_b16 v[38:39], v98 offset:6272
    ds_read_b64_tr_b16 v[40:41], v98 offset:4104
    ds_read_b64_tr_b16 v[42:43], v98 offset:4232
    ds_read_b64_tr_b16 v[44:45], v98 offset:6152
    ds_read_b64_tr_b16 v[46:47], v98 offset:6280
    ds_read_b64_tr_b16 a[96:97], v98 offset:8192
    ds_read_b64_tr_b16 a[98:99], v98 offset:8320
    ds_read_b64_tr_b16 a[100:101], v98 offset:10240
    ds_read_b64_tr_b16 a[102:103], v98 offset:10368
    ds_read_b64_tr_b16 a[104:105], v98 offset:8200
    ds_read_b64_tr_b16 a[106:107], v98 offset:8328
    ds_read_b64_tr_b16 a[108:109], v98 offset:10248
    ds_read_b64_tr_b16 a[110:111], v98 offset:10376
    ds_read_b64_tr_b16 a[112:113], v98 offset:12288
    ds_read_b64_tr_b16 a[114:115], v98 offset:12416
    ds_read_b64_tr_b16 a[116:117], v98 offset:14336
    ds_read_b64_tr_b16 a[118:119], v98 offset:14464
    ds_read_b64_tr_b16 a[120:121], v98 offset:12296
    ds_read_b64_tr_b16 a[122:123], v98 offset:12424
    ds_read_b64_tr_b16 a[124:125], v98 offset:14344
    ds_read_b64_tr_b16 a[126:127], v98 offset:14472
    ds_read_b64_tr_b16 v[216:217], v98 offset:16384
    ds_read_b64_tr_b16 v[218:219], v98 offset:16512
    ds_read_b64_tr_b16 v[220:221], v98 offset:18432
    ds_read_b64_tr_b16 v[222:223], v98 offset:18560
    ds_read_b64_tr_b16 v[48:49], v98 offset:16392
    ds_read_b64_tr_b16 v[50:51], v98 offset:16520
    ds_read_b64_tr_b16 v[52:53], v98 offset:18440
    ds_read_b64_tr_b16 v[54:55], v98 offset:18568
    s_waitcnt lgkmcnt(0)
    s_add_u32 s3, s62, 6144
    buffer_store_dwordx4 v[16:19], v1, s[8:11], s3 offen offset:0
    buffer_store_dwordx4 v[20:23], v1, s[8:11], s3 offen offset:1024
    s_add_u32 s3, s62, 8192
    buffer_store_dwordx4 v[24:27], v1, s[8:11], s3 offen offset:0
    buffer_store_dwordx4 v[28:31], v1, s[8:11], s3 offen offset:1024
    s_add_u32 s3, s62, 14336
    buffer_store_dwordx4 v[32:35], v1, s[8:11], s3 offen offset:0
    buffer_store_dwordx4 v[36:39], v1, s[8:11], s3 offen offset:1024
    s_add_u32 s3, s62, 16384
    buffer_store_dwordx4 v[40:43], v1, s[8:11], s3 offen offset:0
    buffer_store_dwordx4 v[44:47], v1, s[8:11], s3 offen offset:1024
    s_add_u32 s3, s40, 6144
    buffer_store_dwordx4 v[48:51], v1, s[8:11], s3 offen offset:0
    buffer_store_dwordx4 v[52:55], v1, s[8:11], s3 offen offset:1024
    s_add_u32 m0, s49, 0
    s_add_u32 s3, s61, 0x0
    buffer_load_dwordx4 v97, s[76:79], s3 offen lds
    s_add_u32 m0, s49, 1024
    s_add_u32 s3, s61, 0x5000
    buffer_load_dwordx4 v97, s[76:79], s3 offen lds
    s_add_u32 m0, s49, 2048
    s_add_u32 s3, s61, 0xa000
    buffer_load_dwordx4 v97, s[76:79], s3 offen lds
    s_add_u32 m0, s49, 3072
    s_add_u32 s3, s61, 0xf000
    buffer_load_dwordx4 v97, s[76:79], s3 offen lds
    s_add_u32 m0, s49, 4096
    s_add_u32 s3, s61, 0x14000
    buffer_load_dwordx4 v97, s[76:79], s3 offen lds
    s_add_u32 m0, s49, 5120
    s_add_u32 s3, s61, 0x19000
    buffer_load_dwordx4 v97, s[76:79], s3 offen lds
    s_add_u32 m0, s49, 6144
    s_add_u32 s3, s61, 0x1e000
    buffer_load_dwordx4 v97, s[76:79], s3 offen lds
    s_add_u32 m0, s49, 7168
    s_add_u32 s3, s61, 0x23000
    buffer_load_dwordx4 v97, s[76:79], s3 offen lds
    s_add_u32 m0, s49, 8192
    s_add_u32 s3, s61, 0x100
    buffer_load_dwordx4 v97, s[76:79], s3 offen lds
    s_add_u32 m0, s49, 9216
    s_add_u32 s3, s61, 0x5100
    buffer_load_dwordx4 v97, s[76:79], s3 offen lds
    s_add_u32 m0, s49, 10240
    s_add_u32 s3, s61, 0xa100
    buffer_load_dwordx4 v97, s[76:79], s3 offen lds
    s_add_u32 m0, s49, 11264
    s_add_u32 s3, s61, 0xf100
    buffer_load_dwordx4 v97, s[76:79], s3 offen lds
    s_add_u32 m0, s49, 12288
    s_add_u32 s3, s61, 0x14100
    buffer_load_dwordx4 v97, s[76:79], s3 offen lds
    s_add_u32 m0, s49, 13312
    s_add_u32 s3, s61, 0x19100
    buffer_load_dwordx4 v97, s[76:79], s3 offen lds
    s_add_u32 m0, s49, 14336
    s_add_u32 s3, s61, 0x1e100
    buffer_load_dwordx4 v97, s[76:79], s3 offen lds
    s_add_u32 m0, s49, 15360
    s_add_u32 s3, s61, 0x23100
    buffer_load_dwordx4 v97, s[76:79], s3 offen lds
    s_waitcnt vmcnt(26)
    ds_read_b64_tr_b16 a[128:129], v98 offset:20480
    ds_read_b64_tr_b16 a[130:131], v98 offset:20608
    ds_read_b64_tr_b16 a[132:133], v98 offset:22528
    ds_read_b64_tr_b16 a[134:135], v98 offset:22656
    ds_read_b64_tr_b16 a[136:137], v98 offset:20488
    ds_read_b64_tr_b16 a[138:139], v98 offset:20616
    ds_read_b64_tr_b16 a[140:141], v98 offset:22536
    ds_read_b64_tr_b16 a[142:143], v98 offset:22664
    ds_read_b64_tr_b16 a[144:145], v98 offset:24576
    ds_read_b64_tr_b16 a[146:147], v98 offset:24704
    ds_read_b64_tr_b16 a[148:149], v98 offset:26624
    ds_read_b64_tr_b16 a[150:151], v98 offset:26752
    ds_read_b64_tr_b16 a[152:153], v98 offset:24584
    ds_read_b64_tr_b16 a[154:155], v98 offset:24712
    ds_read_b64_tr_b16 a[156:157], v98 offset:26632
    ds_read_b64_tr_b16 a[158:159], v98 offset:26760
    ds_read_b64_tr_b16 a[160:161], v98 offset:28672
    ds_read_b64_tr_b16 a[162:163], v98 offset:28800
    ds_read_b64_tr_b16 a[164:165], v98 offset:30720
    ds_read_b64_tr_b16 a[166:167], v98 offset:30848
    ds_read_b64_tr_b16 a[168:169], v98 offset:28680
    ds_read_b64_tr_b16 a[170:171], v98 offset:28808
    ds_read_b64_tr_b16 a[172:173], v98 offset:30728
    ds_read_b64_tr_b16 a[174:175], v98 offset:30856
    ds_read_b64_tr_b16 a[48:49], v98 offset:32768
    ds_read_b64_tr_b16 a[50:51], v98 offset:32896
    ds_read_b64_tr_b16 a[52:53], v98 offset:34816
    ds_read_b64_tr_b16 a[54:55], v98 offset:34944
    ds_read_b64_tr_b16 v[16:17], v98 offset:32776
    ds_read_b64_tr_b16 v[18:19], v98 offset:32904
    ds_read_b64_tr_b16 v[20:21], v98 offset:34824
    ds_read_b64_tr_b16 v[22:23], v98 offset:34952
    ds_read_b64_tr_b16 a[80:81], v98 offset:36864
    ds_read_b64_tr_b16 a[82:83], v98 offset:36992
    ds_read_b64_tr_b16 a[84:85], v98 offset:38912
    ds_read_b64_tr_b16 a[86:87], v98 offset:39040
    ds_read_b64_tr_b16 a[88:89], v98 offset:36872
    ds_read_b64_tr_b16 a[90:91], v98 offset:37000
    ds_read_b64_tr_b16 a[92:93], v98 offset:38920
    ds_read_b64_tr_b16 a[94:95], v98 offset:39048
    s_waitcnt lgkmcnt(0)
    s_add_u32 s3, s40, 16384
    buffer_store_dwordx4 v[16:19], v1, s[8:11], s3 offen offset:0
    buffer_store_dwordx4 v[20:23], v1, s[8:11], s3 offen offset:1024
    s_add_u32 m0, s49, 20480
    s_add_u32 s3, s61, 0x200
    buffer_load_dwordx4 v97, s[76:79], s3 offen lds
    s_add_u32 m0, s49, 21504
    s_add_u32 s3, s61, 0x5200
    buffer_load_dwordx4 v97, s[76:79], s3 offen lds
    s_add_u32 m0, s49, 22528
    s_add_u32 s3, s61, 0xa200
    buffer_load_dwordx4 v97, s[76:79], s3 offen lds
    s_add_u32 m0, s49, 23552
    s_add_u32 s3, s61, 0xf200
    buffer_load_dwordx4 v97, s[76:79], s3 offen lds
    s_add_u32 m0, s49, 24576
    s_add_u32 s3, s61, 0x14200
    buffer_load_dwordx4 v97, s[76:79], s3 offen lds
    s_add_u32 m0, s49, 25600
    s_add_u32 s3, s61, 0x19200
    buffer_load_dwordx4 v97, s[76:79], s3 offen lds
    s_add_u32 m0, s49, 26624
    s_add_u32 s3, s61, 0x1e200
    buffer_load_dwordx4 v97, s[76:79], s3 offen lds
    s_add_u32 m0, s49, 27648
    s_add_u32 s3, s61, 0x23200
    buffer_load_dwordx4 v97, s[76:79], s3 offen lds
    s_add_u32 m0, s49, 28672
    s_add_u32 s3, s61, 0x300
    buffer_load_dwordx4 v97, s[76:79], s3 offen lds
    s_add_u32 m0, s49, 29696
    s_add_u32 s3, s61, 0x5300
    buffer_load_dwordx4 v97, s[76:79], s3 offen lds
    s_add_u32 m0, s49, 30720
    s_add_u32 s3, s61, 0xa300
    buffer_load_dwordx4 v97, s[76:79], s3 offen lds
    s_add_u32 m0, s49, 31744
    s_add_u32 s3, s61, 0xf300
    buffer_load_dwordx4 v97, s[76:79], s3 offen lds
    s_add_u32 m0, s49, 32768
    s_add_u32 s3, s61, 0x14300
    buffer_load_dwordx4 v97, s[76:79], s3 offen lds
    s_add_u32 m0, s49, 33792
    s_add_u32 s3, s61, 0x19300
    buffer_load_dwordx4 v97, s[76:79], s3 offen lds
    s_add_u32 m0, s49, 34816
    s_add_u32 s3, s61, 0x1e300
    buffer_load_dwordx4 v97, s[76:79], s3 offen lds
    s_add_u32 m0, s49, 35840
    s_add_u32 s3, s61, 0x23300
    buffer_load_dwordx4 v97, s[76:79], s3 offen lds
    s_waitcnt vmcnt(18)
    ds_read_b64_tr_b16 v[16:17], v98 offset:0
    ds_read_b64_tr_b16 v[18:19], v98 offset:128
    ds_read_b64_tr_b16 v[20:21], v98 offset:2048
    ds_read_b64_tr_b16 v[22:23], v98 offset:2176
    ds_read_b64_tr_b16 v[24:25], v98 offset:8
    ds_read_b64_tr_b16 v[26:27], v98 offset:136
    ds_read_b64_tr_b16 v[28:29], v98 offset:2056
    ds_read_b64_tr_b16 v[30:31], v98 offset:2184
    ds_read_b64_tr_b16 v[32:33], v98 offset:4096
    ds_read_b64_tr_b16 v[34:35], v98 offset:4224
    ds_read_b64_tr_b16 v[36:37], v98 offset:6144
    ds_read_b64_tr_b16 v[38:39], v98 offset:6272
    ds_read_b64_tr_b16 v[40:41], v98 offset:4104
    ds_read_b64_tr_b16 v[42:43], v98 offset:4232
    ds_read_b64_tr_b16 v[44:45], v98 offset:6152
    ds_read_b64_tr_b16 v[46:47], v98 offset:6280
    ds_read_b64_tr_b16 a[176:177], v98 offset:8192
    ds_read_b64_tr_b16 a[178:179], v98 offset:8320
    ds_read_b64_tr_b16 a[180:181], v98 offset:10240
    ds_read_b64_tr_b16 a[182:183], v98 offset:10368
    ds_read_b64_tr_b16 a[184:185], v98 offset:8200
    ds_read_b64_tr_b16 a[186:187], v98 offset:8328
    ds_read_b64_tr_b16 a[188:189], v98 offset:10248
    ds_read_b64_tr_b16 a[190:191], v98 offset:10376
    ds_read_b64_tr_b16 v[48:49], v98 offset:12288
    ds_read_b64_tr_b16 v[50:51], v98 offset:12416
    ds_read_b64_tr_b16 v[52:53], v98 offset:14336
    ds_read_b64_tr_b16 v[54:55], v98 offset:14464
    ds_read_b64_tr_b16 v[56:57], v98 offset:12296
    ds_read_b64_tr_b16 v[58:59], v98 offset:12424
    ds_read_b64_tr_b16 v[60:61], v98 offset:14344
    ds_read_b64_tr_b16 v[62:63], v98 offset:14472
    s_waitcnt lgkmcnt(0)
    s_add_u32 s3, s62, 18432
    buffer_store_dwordx4 v[16:19], v1, s[8:11], s3 offen offset:0
    buffer_store_dwordx4 v[20:23], v1, s[8:11], s3 offen offset:1024
    s_add_u32 s3, s62, 20480
    buffer_store_dwordx4 v[24:27], v1, s[8:11], s3 offen offset:0
    buffer_store_dwordx4 v[28:31], v1, s[8:11], s3 offen offset:1024
    s_add_u32 s3, s40, 20480
    buffer_store_dwordx4 v[32:35], v1, s[8:11], s3 offen offset:0
    buffer_store_dwordx4 v[36:39], v1, s[8:11], s3 offen offset:1024
    s_add_u32 s3, s40, 22528
    buffer_store_dwordx4 v[40:43], v1, s[8:11], s3 offen offset:0
    buffer_store_dwordx4 v[44:47], v1, s[8:11], s3 offen offset:1024
    s_add_u32 s3, s40, 24576
    buffer_store_dwordx4 v[48:51], v1, s[8:11], s3 offen offset:0
    buffer_store_dwordx4 v[52:55], v1, s[8:11], s3 offen offset:1024
    s_add_u32 s3, s40, 26624
    buffer_store_dwordx4 v[56:59], v1, s[8:11], s3 offen offset:0
    buffer_store_dwordx4 v[60:63], v1, s[8:11], s3 offen offset:1024
    s_add_u32 m0, s49, 0
    s_add_u32 s3, s61, 0x400
    buffer_load_dwordx4 v97, s[76:79], s3 offen lds
    s_add_u32 m0, s49, 1024
    s_add_u32 s3, s61, 0x5400
    buffer_load_dwordx4 v97, s[76:79], s3 offen lds
    s_add_u32 m0, s49, 2048
    s_add_u32 s3, s61, 0xa400
    buffer_load_dwordx4 v97, s[76:79], s3 offen lds
    s_add_u32 m0, s49, 3072
    s_add_u32 s3, s61, 0xf400
    buffer_load_dwordx4 v97, s[76:79], s3 offen lds
    s_add_u32 m0, s49, 4096
    s_add_u32 s3, s61, 0x14400
    buffer_load_dwordx4 v97, s[76:79], s3 offen lds
    s_add_u32 m0, s49, 5120
    s_add_u32 s3, s61, 0x19400
    buffer_load_dwordx4 v97, s[76:79], s3 offen lds
    s_add_u32 m0, s49, 6144
    s_add_u32 s3, s61, 0x1e400
    buffer_load_dwordx4 v97, s[76:79], s3 offen lds
    s_add_u32 m0, s49, 7168
    s_add_u32 s3, s61, 0x23400
    buffer_load_dwordx4 v97, s[76:79], s3 offen lds
    s_waitcnt vmcnt(20)
    ds_read_b64_tr_b16 a[192:193], v98 offset:20480
    ds_read_b64_tr_b16 a[194:195], v98 offset:20608
    ds_read_b64_tr_b16 a[196:197], v98 offset:22528
    ds_read_b64_tr_b16 a[198:199], v98 offset:22656
    ds_read_b64_tr_b16 a[200:201], v98 offset:20488
    ds_read_b64_tr_b16 a[202:203], v98 offset:20616
    ds_read_b64_tr_b16 a[204:205], v98 offset:22536
    ds_read_b64_tr_b16 a[206:207], v98 offset:22664
    ds_read_b64_tr_b16 v[16:17], v98 offset:24576
    ds_read_b64_tr_b16 v[18:19], v98 offset:24704
    ds_read_b64_tr_b16 v[20:21], v98 offset:26624
    ds_read_b64_tr_b16 v[22:23], v98 offset:26752
    ds_read_b64_tr_b16 v[24:25], v98 offset:24584
    ds_read_b64_tr_b16 v[26:27], v98 offset:24712
    ds_read_b64_tr_b16 v[28:29], v98 offset:26632
    ds_read_b64_tr_b16 v[30:31], v98 offset:26760
    ds_read_b64_tr_b16 a[208:209], v98 offset:28672
    ds_read_b64_tr_b16 a[210:211], v98 offset:28800
    ds_read_b64_tr_b16 a[212:213], v98 offset:30720
    ds_read_b64_tr_b16 a[214:215], v98 offset:30848
    ds_read_b64_tr_b16 a[216:217], v98 offset:28680
    ds_read_b64_tr_b16 a[218:219], v98 offset:28808
    ds_read_b64_tr_b16 a[220:221], v98 offset:30728
    ds_read_b64_tr_b16 a[222:223], v98 offset:30856
    ds_read_b64_tr_b16 v[32:33], v98 offset:32768
    ds_read_b64_tr_b16 v[34:35], v98 offset:32896
    ds_read_b64_tr_b16 v[36:37], v98 offset:34816
    ds_read_b64_tr_b16 v[38:39], v98 offset:34944
    ds_read_b64_tr_b16 v[40:41], v98 offset:32776
    ds_read_b64_tr_b16 v[42:43], v98 offset:32904
    ds_read_b64_tr_b16 v[44:45], v98 offset:34824
    ds_read_b64_tr_b16 v[46:47], v98 offset:34952
    s_waitcnt lgkmcnt(0)
    s_add_u32 s3, s40, 28672
    buffer_store_dwordx4 v[16:19], v1, s[8:11], s3 offen offset:0
    buffer_store_dwordx4 v[20:23], v1, s[8:11], s3 offen offset:1024
    s_add_u32 s3, s40, 30720
    buffer_store_dwordx4 v[24:27], v1, s[8:11], s3 offen offset:0
    buffer_store_dwordx4 v[28:31], v1, s[8:11], s3 offen offset:1024
    s_add_u32 s3, s40, 32768
    buffer_store_dwordx4 v[32:35], v1, s[8:11], s3 offen offset:0
    buffer_store_dwordx4 v[36:39], v1, s[8:11], s3 offen offset:1024
    s_add_u32 s3, s40, 34816
    buffer_store_dwordx4 v[40:43], v1, s[8:11], s3 offen offset:0
    buffer_store_dwordx4 v[44:47], v1, s[8:11], s3 offen offset:1024
    s_waitcnt vmcnt(8)
    ds_read_b64_tr_b16 a[224:225], v98 offset:0
    ds_read_b64_tr_b16 a[226:227], v98 offset:128
    ds_read_b64_tr_b16 a[228:229], v98 offset:2048
    ds_read_b64_tr_b16 a[230:231], v98 offset:2176
    ds_read_b64_tr_b16 a[232:233], v98 offset:8
    ds_read_b64_tr_b16 a[234:235], v98 offset:136
    ds_read_b64_tr_b16 a[236:237], v98 offset:2056
    ds_read_b64_tr_b16 a[238:239], v98 offset:2184
    ds_read_b64_tr_b16 a[240:241], v98 offset:4096
    ds_read_b64_tr_b16 a[242:243], v98 offset:4224
    ds_read_b64_tr_b16 a[244:245], v98 offset:6144
    ds_read_b64_tr_b16 a[246:247], v98 offset:6272
    ds_read_b64_tr_b16 a[248:249], v98 offset:4104
    ds_read_b64_tr_b16 a[250:251], v98 offset:4232
    ds_read_b64_tr_b16 a[252:253], v98 offset:6152
    ds_read_b64_tr_b16 a[254:255], v98 offset:6280
    s_waitcnt lgkmcnt(0)
    s_waitcnt vmcnt(0)
    s_barrier
    s_add_u32 m0, s48, 0
    s_add_u32 s3, s40, 0
    buffer_load_dwordx4 v1, s[8:11], s3 offen lds
    s_add_u32 m0, s48, 1024
    s_add_u32 s3, s40, 1024
    buffer_load_dwordx4 v1, s[8:11], s3 offen lds
    s_add_u32 m0, s48, 2048
    s_add_u32 s3, s40, 2048
    buffer_load_dwordx4 v1, s[8:11], s3 offen lds
    s_add_u32 m0, s48, 3072
    s_add_u32 s3, s40, 3072
    buffer_load_dwordx4 v1, s[8:11], s3 offen lds
    s_add_u32 m0, s48, 4096
    s_add_u32 s3, s40, 4096
    buffer_load_dwordx4 v1, s[8:11], s3 offen lds
    s_add_u32 m0, s48, 5120
    s_add_u32 s3, s40, 5120
    buffer_load_dwordx4 v1, s[8:11], s3 offen lds
    s_add_u32 m0, s48, 6144
    s_add_u32 s3, s40, 6144
    buffer_load_dwordx4 v1, s[8:11], s3 offen lds
    s_add_u32 m0, s48, 7168
    s_add_u32 s3, s40, 7168
    buffer_load_dwordx4 v1, s[8:11], s3 offen lds
    s_add_u32 m0, s48, 8192
    s_add_u32 s3, s40, 8192
    buffer_load_dwordx4 v1, s[8:11], s3 offen lds
    s_add_u32 m0, s48, 9216
    s_add_u32 s3, s40, 9216
    buffer_load_dwordx4 v1, s[8:11], s3 offen lds
    s_add_u32 m0, s48, 10240
    s_add_u32 s3, s40, 10240
    buffer_load_dwordx4 v1, s[8:11], s3 offen lds
    s_add_u32 m0, s48, 11264
    s_add_u32 s3, s40, 11264
    buffer_load_dwordx4 v1, s[8:11], s3 offen lds
    s_add_u32 m0, s48, 12288
    s_add_u32 s3, s40, 12288
    buffer_load_dwordx4 v1, s[8:11], s3 offen lds
    s_add_u32 m0, s48, 13312
    s_add_u32 s3, s40, 13312
    buffer_load_dwordx4 v1, s[8:11], s3 offen lds
    s_add_u32 m0, s48, 14336
    s_add_u32 s3, s40, 14336
    buffer_load_dwordx4 v1, s[8:11], s3 offen lds
    s_add_u32 m0, s48, 15360
    s_add_u32 s3, s40, 15360
    buffer_load_dwordx4 v1, s[8:11], s3 offen lds
    s_add_u32 m0, s48, 16384
    s_add_u32 s3, s40, 16384
    buffer_load_dwordx4 v1, s[8:11], s3 offen lds
    s_add_u32 m0, s48, 17408
    s_add_u32 s3, s40, 17408
    buffer_load_dwordx4 v1, s[8:11], s3 offen lds
    s_add_u32 m0, s48, 18432
    s_add_u32 s3, s40, 18432
    buffer_load_dwordx4 v1, s[8:11], s3 offen lds
    s_add_u32 m0, s48, 19456
    s_add_u32 s3, s40, 19456
    buffer_load_dwordx4 v1, s[8:11], s3 offen lds
    s_add_u32 m0, s48, 20480
    s_add_u32 s3, s40, 20480
    buffer_load_dwordx4 v1, s[8:11], s3 offen lds
    s_add_u32 m0, s48, 21504
    s_add_u32 s3, s40, 21504
    buffer_load_dwordx4 v1, s[8:11], s3 offen lds
    s_add_u32 m0, s48, 22528
    s_add_u32 s3, s40, 22528
    buffer_load_dwordx4 v1, s[8:11], s3 offen lds
    s_add_u32 m0, s48, 23552
    s_add_u32 s3, s40, 23552
    buffer_load_dwordx4 v1, s[8:11], s3 offen lds
    s_add_u32 m0, s48, 24576
    s_add_u32 s3, s40, 24576
    buffer_load_dwordx4 v1, s[8:11], s3 offen lds
    s_add_u32 m0, s48, 25600
    s_add_u32 s3, s40, 25600
    buffer_load_dwordx4 v1, s[8:11], s3 offen lds
    s_add_u32 m0, s48, 26624
    s_add_u32 s3, s40, 26624
    buffer_load_dwordx4 v1, s[8:11], s3 offen lds
    s_add_u32 m0, s48, 27648
    s_add_u32 s3, s40, 27648
    buffer_load_dwordx4 v1, s[8:11], s3 offen lds
    s_add_u32 m0, s48, 28672
    s_add_u32 s3, s40, 28672
    buffer_load_dwordx4 v1, s[8:11], s3 offen lds
    s_add_u32 m0, s48, 29696
    s_add_u32 s3, s40, 29696
    buffer_load_dwordx4 v1, s[8:11], s3 offen lds
    s_add_u32 m0, s48, 30720
    s_add_u32 s3, s40, 30720
    buffer_load_dwordx4 v1, s[8:11], s3 offen lds
    s_add_u32 m0, s48, 31744
    s_add_u32 s3, s40, 31744
    buffer_load_dwordx4 v1, s[8:11], s3 offen lds
    s_add_u32 m0, s48, 32768
    s_add_u32 s3, s40, 32768
    buffer_load_dwordx4 v1, s[8:11], s3 offen lds
    s_add_u32 m0, s48, 33792
    s_add_u32 s3, s40, 33792
    buffer_load_dwordx4 v1, s[8:11], s3 offen lds
    s_add_u32 m0, s48, 34816
    s_add_u32 s3, s40, 34816
    buffer_load_dwordx4 v1, s[8:11], s3 offen lds
    s_add_u32 m0, s48, 35840
    s_add_u32 s3, s40, 35840
    buffer_load_dwordx4 v1, s[8:11], s3 offen lds
    s_add_u32 s64, s62, 0
    s_add_u32 s65, s62, 4096
    s_add_u32 s66, s62, 8192
    s_add_u32 s67, s62, 12288
    s_add_u32 s68, s62, 16384
    s_add_u32 s69, s62, 20480
    v_mov_b32 v28, 144
R_TW:
    buffer_load_dword v29, v28, s[20:23], 0 offen sc1
    s_waitcnt vmcnt(0)
    v_readfirstlane_b32 s59, v29
    s_nop 0
    s_and_b32 s3, s59, 0xffff
    s_add_u32 s99, s99, 1
    s_cmp_ge_u32 s99, 0x80000
    s_cbranch_scc1 R_TD
    s_cmp_lt_u32 s3, 32
    s_cbranch_scc1 R_TW
R_TD:
    s_mov_b32 s34, 0x100000
    s_mov_b32 s35, 0x1c0000
    s_mov_b32 s36, 0x1c5000
    s_mov_b32 s70, 0x3e0293ee
    s_mov_b32 s60, 0x17800000
    s_mov_b32 s61, 0x67800000
    s_mov_b32 s63, 0xff810000
    s_mov_b32 s28, 0
    s_mov_b32 s73, 0x110800
    s_mov_b32 s74, 0x121000
    s_mov_b32 s75, 0x131800
    s_mov_b32 s76, 0x142000
    s_cmp_eq_u32 s59, 32
    s_cbranch_scc0 RS_PAIR
RF_PAIR:
    s_mul_i32 s17, s14, 0x6000000
    s_add_u32 s17, s17, 0x1000000
    s_lshl_b32 s3, s32, 14
    s_add_u32 s54, s3, s17
    s_add_u32 s54, s54, 0x1000000
    s_lshl_b32 s59, s13, 12
    s_add_u32 s37, s54, s59
    s_add_u32 s3, s3, s59
    s_lshr_b32 s3, s3, 1
    s_add_u32 s38, s3, s17
    s_add_u32 s38, s38, 0x3000000
    s_lshl_b32 s3, s14, 13
    s_lshl_b32 s59, s32, 8
    s_add_u32 s39, s3, s59
    s_add_u32 s71, s39, 69632
    s_add_u32 s39, s39, 86016
    s_mov_b32 s33, 0
    s_sub_u32 s31, s39, 4
    s_cmp_eq_u32 s13, 3
    s_cselect_b32 s31, s31, 0x10000000
    v_bfe_u32 v16, v1, 5, 3
    v_mul_u32_u24 v16, 1280, v16
    v_lshrrev_b32 v17, 8, v1
    v_lshl_add_u32 v16, v17, 5, v16
    v_and_b32 v17, 16, v1
    v_add_u32 v16, v16, v17
    s_lshl_b32 s3, s13, 7
    s_lshr_b32 s59, s55, 3
    buffer_load_dwordx4 v[40:43], v16, s[24:27], s3 offen
    buffer_load_dwordx4 v[44:47], v16, s[24:27], s3 offen offset:512
    buffer_load_dwordx4 v[48:51], v16, s[24:27], s59 offen
    buffer_load_dwordx4 v[68:71], v1, s[8:11], s64 offen offset:0 sc1
    buffer_load_dwordx4 v[72:75], v1, s[8:11], s64 offen offset:1024 sc1
    buffer_load_dwordx4 v[76:79], v1, s[8:11], s64 offen offset:2048 sc1
    buffer_load_dwordx4 v[80:83], v1, s[8:11], s64 offen offset:3072 sc1
    buffer_load_dwordx4 v[60:63], v1, s[8:11], s65 offen offset:0 sc1
    buffer_load_dwordx4 v[64:67], v1, s[8:11], s65 offen offset:1024 sc1
    buffer_load_dwordx4 v[84:87], v1, s[8:11], s65 offen offset:2048 sc1
    buffer_load_dwordx4 v[88:91], v1, s[8:11], s65 offen offset:3072 sc1
    buffer_load_dwordx4 v[92:95], v1, s[8:11], s66 offen offset:0 sc1
    buffer_load_dwordx4 v[96:99], v1, s[8:11], s66 offen offset:1024 sc1
    v_mov_b32 v16, 0
POLL_46:
    buffer_load_dword v17, v16, s[8:11], s71 offen sc1
    s_waitcnt vmcnt(0)
    v_readfirstlane_b32 s3, v17
    s_nop 0
    s_cmp_ge_u32 s3, 1
    s_nop 1
    s_cbranch_scc1 POLLD_47
    s_add_u32 s99, s99, 1
    s_cmp_ge_u32 s99, 0x80000
    s_cbranch_scc1 POLLD_47
    s_branch POLL_46
POLLD_47:
    v_mov_b64 v[16:17], 0
    v_mov_b64 v[18:19], 0
    v_mov_b64 v[20:21], 0
    v_mov_b64 v[22:23], 0
    v_mov_b64 v[24:25], 0
    v_mov_b64 v[26:27], 0
    v_mov_b64 v[28:29], 0
    v_mov_b64 v[30:31], 0
    v_mov_b64 v[32:33], 0
    v_mov_b64 v[34:35], 0
    v_mov_b64 v[36:37], 0
    v_mov_b64 v[38:39], 0
    buffer_load_dwordx4 v[52:55], v1, s[8:11], s37 offen offset:0 nt
    buffer_load_dwordx4 v[56:59], v1, s[8:11], s37 offen offset:1024 nt
    s_add_u32 s7, s36, 4096
    s_add_u32 s59, s36, s55
    s_add_u32 s62, s36, s56
    buffer_store_dwordx4 v[44:47], v6, s[8:11], s7 offen
    buffer_store_dwordx4 v[48:51], v1, s[8:11], s59 offen
    v_mov_b32 v11, 0
    s_waitcnt vmcnt(0) lgkmcnt(0)
    s_barrier
RF_STEP:
    ds_write_b128 v6, v[40:43] offset:0
    v_smfmac_f32_16x16x64_bf16 v[16:19], v[40:43], v[68:75], v2
    v_smfmac_f32_16x16x64_bf16 v[20:23], v[40:43], v[76:83], v2
    buffer_load_dwordx4 v[48:51], v6, s[8:11], s7 offen sc1
    v_smfmac_f32_16x16x64_bf16 v[24:27], v[40:43], v[60:67], v2
    s_waitcnt lgkmcnt(0)
    s_barrier
    v_xor_b32 v0, 1024, v6
    ds_read_b128 v[44:47], v0 offset:0
    v_xor_b32 v0, 2048, v6
    ds_read_b128 v[100:103], v0 offset:0
    v_cmp_ne_u32 s[48:49], 0, v11
    s_nop 0
    s_lshl_b32 s72, s33, 19
    s_add_u32 s72, s72, s37
    v_smfmac_f32_16x16x64_bf16 v[28:31], v[40:43], v[104:111], v2
    v_smfmac_f32_16x16x64_bf16 v[32:35], v[40:43], v[84:91], v2
    ds_read_b128 v[84:87], v10 offset:0
    ds_read_b128 v[88:91], v10 offset:1024
    v_smfmac_f32_16x16x64_bf16 v[36:39], v[40:43], v[92:99], v2
    buffer_load_dwordx4 v[68:71], v1, s[8:11], s66 offen offset:2048 sc1
    ds_read_b128 v[92:95], v10 offset:2048
    ds_read_b128 v[96:99], v10 offset:3072
    v_xor_b32 v0, 3072, v6
    ds_read_b128 v[40:43], v0 offset:0
    s_waitcnt lgkmcnt(6)
    v_smfmac_f32_16x16x64_bf16 v[16:19], v[44:47], v[112:119], v2
    v_smfmac_f32_16x16x64_bf16 v[20:23], v[44:47], v[120:127], v2
    v_smfmac_f32_16x16x64_bf16 v[24:27], v[44:47], v[128:135], v2
    buffer_load_dwordx4 v[72:75], v1, s[8:11], s66 offen offset:3072 sc1
    v_smfmac_f32_16x16x64_bf16 v[28:31], v[44:47], v[136:143], v2
    s_waitcnt lgkmcnt(5)
    v_smfmac_f32_16x16x64_bf16 v[16:19], v[100:103], v[144:151], v2
    s_waitcnt lgkmcnt(3)
    v_smfmac_f32_16x16x64_bf16 v[20:23], v[100:103], v[84:91], v2
    ds_read_b128 v[84:87], v10 offset:4096
    ds_read_b128 v[88:91], v10 offset:5120
    buffer_load_dwordx4 v[76:79], v1, s[8:11], s67 offen offset:0 sc1
    v_smfmac_f32_16x16x64_bf16 v[24:27], v[100:103], v[152:159], v2
    s_lshl_b32 s5, s33, 2
    s_add_u32 s5, s5, s31
    v_smfmac_f32_16x16x64_bf16 v[28:31], v[100:103], v[160:167], v2
    s_waitcnt lgkmcnt(2)
    v_smfmac_f32_16x16x64_bf16 v[16:19], v[40:43], v[168:175], v2
    buffer_load_dwordx4 v[80:83], v1, s[8:11], s67 offen offset:1024 sc1
    v_smfmac_f32_16x16x64_bf16 v[20:23], v[40:43], v[92:99], v2
    ds_read_b128 v[92:95], v10 offset:6144
    ds_read_b128 v[96:99], v10 offset:7168
    v_smfmac_f32_16x16x64_bf16 v[24:27], v[40:43], v[176:183], v2
    buffer_load_dwordx4 v[44:47], v1, s[8:11], s59 offen sc1
    v_smfmac_f32_16x16x64_bf16 v[28:31], v[40:43], v[184:191], v2
    s_cmp_eq_u32 s33, 0
    s_cselect_b32 s5, 0x10000000, s5
    s_waitcnt vmcnt(5)
RF_BC1:
    v_max3_u32 v0, v48, v49, v50
    v_max_u32 v0, v0, v51
    v_cmp_le_u32 vcc, s63, v0
    s_nop 0
    s_cbranch_vccnz RF_BR1
RF_BOK1:
    ds_write_b128 v6, v[48:51] offset:4096
    v_smfmac_f32_16x16x64_bf16 v[16:19], v[48:51], v[192:199], v2
    s_waitcnt lgkmcnt(3)
    v_smfmac_f32_16x16x64_bf16 v[20:23], v[48:51], v[84:91], v2
    ds_read_b128 v[84:87], v10 offset:8192
    ds_read_b128 v[88:91], v10 offset:9216
    v_smfmac_f32_16x16x64_bf16 v[24:27], v[48:51], v[200:207], v2
    s_waitcnt lgkmcnt(2)
    s_barrier
    v_xor_b32 v0, 1024, v6
    ds_read_b128 v[100:103], v0 offset:4096
    v_xor_b32 v0, 2048, v6
    ds_read_b128 v[40:43], v0 offset:4096
    v_smfmac_f32_16x16x64_bf16 v[28:31], v[48:51], v[208:215], v2
    s_lshl_b32 s6, s33, 18
    s_add_u32 s6, s6, s38
    v_smfmac_f32_16x16x64_bf16 v[32:35], v[48:51], v[216:223], v2
    v_smfmac_f32_16x16x64_bf16 v[36:39], v[48:51], v[92:99], v2
    ds_read_b128 v[92:95], v10 offset:10240
    ds_read_b128 v[96:99], v10 offset:11264
    v_xor_b32 v0, 3072, v6
    ds_read_b128 v[48:51], v0 offset:4096
    s_waitcnt lgkmcnt(4)
    v_smfmac_f32_16x16x64_bf16 v[16:19], v[100:103], v[224:231], v2
    v_smfmac_f32_16x16x64_bf16 v[20:23], v[100:103], v[232:239], v2
    s_waitcnt vmcnt(3)
    v_smfmac_f32_16x16x64_bf16 v[24:27], v[100:103], v[68:75], v2
    v_smfmac_f32_16x16x64_bf16 v[28:31], v[100:103], v[84:91], v2
    ds_read_b128 v[84:87], v10 offset:12288
    ds_read_b128 v[88:91], v10 offset:13312
    buffer_load_dwordx4 v[100:103], v1, s[8:11], s62 offen sc1
    s_waitcnt lgkmcnt(5)
    v_smfmac_f32_16x16x64_bf16 v[16:19], v[40:43], v[240:247], v2
    buffer_load_dwordx4 v[68:71], v1, s[8:11], s67 offen offset:2048 sc1
    v_smfmac_f32_16x16x64_bf16 v[20:23], v[40:43], v[248:255], v2
    s_waitcnt vmcnt(3)
    v_smfmac_f32_16x16x64_bf16 v[24:27], v[40:43], v[76:83], v2
    buffer_load_dwordx4 v[72:75], v1, s[8:11], s67 offen offset:3072 sc1
    s_waitcnt lgkmcnt(3)
    v_smfmac_f32_16x16x64_bf16 v[28:31], v[40:43], v[92:99], v2
    ds_read_b128 v[92:95], v10 offset:14336
    ds_read_b128 v[96:99], v10 offset:15360
    s_waitcnt lgkmcnt(4)
    v_smfmac_f32_16x16x64_bf16 v[16:19], v[48:51], a[0:7], v2
    buffer_load_dwordx4 v[76:79], v1, s[8:11], s68 offen offset:0 sc1
    v_xor_b32 v0, 1024, v6
    ds_read_b128 v[40:43], v0 offset:0
    v_smfmac_f32_16x16x64_bf16 v[20:23], v[48:51], a[8:15], v2
    v_smfmac_f32_16x16x64_bf16 v[24:27], v[48:51], a[16:23], v2
    buffer_load_dwordx4 v[80:83], v1, s[8:11], s68 offen offset:1024 sc1
    s_waitcnt lgkmcnt(3)
    v_smfmac_f32_16x16x64_bf16 v[28:31], v[48:51], v[84:91], v2
    ds_read_b128 v[84:87], v10 offset:16384
    ds_read_b128 v[88:91], v10 offset:17408
    s_waitcnt vmcnt(5)
RF_BC2:
    v_max3_u32 v0, v44, v45, v46
    v_max_u32 v0, v0, v47
    v_cmp_le_u32 vcc, s63, v0
    s_nop 0
    s_cbranch_vccnz RF_BR2
RF_BOK2:
    v_smfmac_f32_16x16x64_bf16 v[16:19], v[44:47], a[24:31], v2
    v_xor_b32 v0, 2048, v6
    ds_read_b128 v[48:51], v0 offset:0
    v_smfmac_f32_16x16x64_bf16 v[20:23], v[44:47], a[32:39], v2
    buffer_load_dwordx4 v[60:63], v1, s[8:11], s72 offen offset:2048 nt
    v_smfmac_f32_16x16x64_bf16 v[24:27], v[44:47], a[40:47], v2
    s_waitcnt lgkmcnt(4)
    v_smfmac_f32_16x16x64_bf16 v[28:31], v[44:47], v[92:99], v2
    ds_read_b128 v[92:95], v10 offset:18432
    ds_read_b128 v[96:99], v10 offset:19456
    v_smfmac_f32_16x16x64_bf16 v[32:35], v[44:47], a[48:55], v2
    buffer_load_dwordx4 v[64:67], v1, s[8:11], s72 offen offset:3072 nt
    s_waitcnt lgkmcnt(3)
    v_smfmac_f32_16x16x64_bf16 v[36:39], v[44:47], v[84:91], v2
    s_waitcnt vmcnt(6)
RF_BC3:
    v_max3_u32 v0, v100, v101, v102
    v_max_u32 v0, v0, v103
    v_cmp_le_u32 vcc, s63, v0
    s_nop 0
    s_cbranch_vccnz RF_BR3
RF_BOK3:
    v_smfmac_f32_16x16x64_bf16 v[16:19], v[100:103], a[56:63], v2
    s_mov_b64 exec, 1
    buffer_store_dword v2, v1, s[8:11], s5 offen sc1
    s_mov_b64 exec, -1
    v_smfmac_f32_16x16x64_bf16 v[20:23], v[100:103], a[64:71], v2
    s_add_u32 s4, s33, 1
    s_min_u32 s4, s4, 63
    s_waitcnt lgkmcnt(0)
    v_smfmac_f32_16x16x64_bf16 v[24:27], v[100:103], v[92:99], v2
    v_smfmac_f32_16x16x64_bf16 v[28:31], v[100:103], a[72:79], v2
    s_bitcmp1_b64 s[48:49], s4
    s_cbranch_scc0 RF_WKV
RF_KVOK:
    v_smfmac_f32_16x16x64_bf16 v[32:35], v[100:103], a[80:87], v2
    s_lshl_b32 s4, s4, 19
    s_add_u32 s4, s4, s37
    v_smfmac_f32_16x16x64_bf16 v[36:39], v[100:103], a[88:95], v2
    s_add_u32 s7, s35, 4096
    s_add_u32 s59, s35, s55
    s_add_u32 s62, s35, s56
    s_mov_b32 s58, 0
    v_xor_b32 v0, 3072, v6
    ds_read_b128 v[44:47], v0 offset:0
    v_cvt_pk_bf16_f32 v16, v16, v17
    v_cvt_pk_bf16_f32 v17, v18, v19
    v_cvt_pk_bf16_f32 v18, v20, v21
    v_cvt_pk_bf16_f32 v19, v22, v23
    s_nop 1
    v_mfma_f32_16x16x32_bf16 v[20:23], v[16:19], v[12:15], 0
    v_cvt_pk_bf16_f32 v24, v24, v25
    v_cvt_pk_bf16_f32 v25, v26, v27
    v_cvt_pk_bf16_f32 v26, v28, v29
    v_cvt_pk_bf16_f32 v27, v30, v31
    s_nop 1
    v_mfma_f32_16x16x32_bf16 v[28:31], v[24:27], v[12:15], 0
    s_waitcnt vmcnt(5)
    v_smfmac_f32_16x16x64_bf16 v[32:35], v[40:43], v[68:75], v2
    buffer_load_dwordx4 v[68:71], v1, s[8:11], s68 offen offset:2048 sc1
    buffer_load_dwordx4 v[72:75], v1, s[8:11], s68 offen offset:3072 sc1
    s_waitcnt vmcnt(5)
    v_smfmac_f32_16x16x64_bf16 v[36:39], v[40:43], v[76:83], v2
    buffer_load_dwordx4 v[76:79], v1, s[8:11], s69 offen offset:0 sc1
    buffer_load_dwordx4 v[80:83], v1, s[8:11], s69 offen offset:1024 sc1
    v_xor_b32 v0, 1024, v6
    ds_read_b128 v[100:103], v0 offset:4096
    v_cvt_pk_bf16_f32 v16, v20, v21
    v_cvt_pk_bf16_f32 v17, v22, v23
    v_cvt_pk_bf16_f32 v18, v28, v29
    v_cvt_pk_bf16_f32 v19, v30, v31
    s_nop 1
    v_mfma_f32_16x16x32_bf16 v[84:87], v[52:55], v[16:19], 0
    v_mfma_f32_16x16x32_bf16 v[88:91], v[56:59], v[16:19], 0
    v_mfma_f32_16x16x32_bf16 v[24:27], v[16:19], v[16:19], 0
    v_smfmac_f32_16x16x64_bf16 v[32:35], v[48:51], a[96:103], v2
    buffer_load_dwordx4 v[52:55], v1, s[8:11], s4 offen offset:0 nt
    v_smfmac_f32_16x16x64_bf16 v[36:39], v[48:51], a[104:111], v2
    buffer_load_dwordx4 v[56:59], v1, s[8:11], s4 offen offset:1024 nt
    v_xor_b32 v0, 2048, v6
    ds_read_b128 v[40:43], v0 offset:4096
    s_mov_b64 exec, s[50:51]
    ds_write_b128 v7, v[84:87] offset:10240
    ds_write_b128 v7, v[88:91] offset:12288
    ds_write_b128 v7, v[24:27] offset:14336
    s_mov_b64 exec, -1
    s_waitcnt lgkmcnt(5)
    v_smfmac_f32_16x16x64_bf16 v[32:35], v[44:47], a[112:119], v2
    v_smfmac_f32_16x16x64_bf16 v[36:39], v[44:47], a[120:127], v2
    v_xor_b32 v0, 3072, v6
    ds_read_b128 v[48:51], v0 offset:4096
    s_not_b64 exec, s[50:51]
    buffer_store_dwordx4 v[16:19], v1, s[8:11], s6 offen sc1
    s_mov_b64 exec, -1
    s_waitcnt lgkmcnt(1)
    s_barrier
    ds_read_b128 v[84:87], v8 offset:10240
    ds_read_b128 v[88:91], v8 offset:10752
    ds_read_b128 v[92:95], v8 offset:11264
    ds_read_b128 v[96:99], v8 offset:11776
    ds_read_b32 v20, v9 offset:14592
    ds_read_b32 v21, v9 offset:15104
    ds_read_b32 v22, v9 offset:15616
    ds_read_b32 v23, v9 offset:16128
    v_smfmac_f32_16x16x64_bf16 v[32:35], v[100:103], a[128:135], v2
    v_smfmac_f32_16x16x64_bf16 v[36:39], v[100:103], a[136:143], v2
    v_lshrrev_b32 v0, 2, v1
    buffer_load_dword v11, v0, s[8:11], s71 offen sc1
    v_smfmac_f32_16x16x64_bf16 v[32:35], v[40:43], a[144:151], v2
    v_smfmac_f32_16x16x64_bf16 v[36:39], v[40:43], a[152:159], v2
    s_waitcnt lgkmcnt(8)
    v_smfmac_f32_16x16x64_bf16 v[32:35], v[48:51], a[160:167], v2
    v_smfmac_f32_16x16x64_bf16 v[36:39], v[48:51], a[168:175], v2
    s_waitcnt lgkmcnt(6)
    v_add_f32 v84, v84, v88
    v_add_f32 v85, v85, v89
    v_add_f32 v86, v86, v90
    v_add_f32 v87, v87, v91
    s_waitcnt lgkmcnt(4)
    v_add_f32 v92, v92, v96
    v_add_f32 v93, v93, v97
    v_add_f32 v94, v94, v98
    v_add_f32 v95, v95, v99
    s_waitcnt lgkmcnt(0)
    v_add_f32 v20, v20, v21
    v_add_f32 v22, v22, v23
    v_add_f32 v84, v84, v92
    v_add_f32 v85, v85, v93
    v_add_f32 v86, v86, v94
    v_add_f32 v87, v87, v95
    v_add_f32 v20, v20, v22
    v_mul_f32 v20, s70, v20
    v_cvt_pk_bf16_f32 v32, v32, v33
    v_cvt_pk_bf16_f32 v33, v34, v35
    v_cvt_pk_bf16_f32 v34, v36, v37
    v_cvt_pk_bf16_f32 v35, v38, v39
    buffer_store_dwordx4 v[32:35], v1, s[8:11], s6 offen offset:1024 sc1
    s_waitcnt vmcnt(10)
RF_EXP:
    v_exp_f32 v28, v84
    v_exp_f32 v29, v85
    v_exp_f32 v30, v86
    v_exp_f32 v31, v87
    v_exp_f32 v21, v20
    v_cvt_pk_bf16_f32 v92, v28, v29
    v_cvt_pk_bf16_f32 v93, v30, v31
    v_cvt_pk_bf16_f32 v96, v21, v21
    v_add_f32 v24, v28, v29
    v_mov_b32_dpp v94, v92 row_ror:8 row_mask:0xf bank_mask:0xf
    v_mov_b32_dpp v95, v93 row_ror:8 row_mask:0xf bank_mask:0xf
    v_mov_b32_dpp v97, v96 row_ror:8 row_mask:0xf bank_mask:0xf
    v_add_f32 v25, v30, v31
    v_add_f32 v24, v24, v21
    v_mfma_f32_16x16x32_bf16 v[40:43], v[60:63], v[92:95], 0
    v_mfma_f32_16x16x32_bf16 v[44:47], v[64:67], v[92:95], 0
    v_add_f32 v24, v24, v25
    v_mfma_f32_16x16x16_bf16 v[40:43], v[32:33], v[96:97], v[40:43]
    v_mfma_f32_16x16x16_bf16 v[44:47], v[34:35], v[96:97], v[44:47]
    v_add_f32_dpp v24, v24, v24 row_ror:8 row_mask:0xf bank_mask:0xf
    v_mov_b32 v25, v24
    s_nop 1
    v_permlane32_swap_b32 v24, v25
    v_add_f32 v24, v24, v25
    v_mov_b32 v25, v24
    s_nop 1
    v_permlane16_swap_b32 v24, v25
    v_add_f32 v24, v24, v25
    v_mov_b32 v25, s61
    v_rcp_f32 v26, v24
    v_med3_f32 v25, v24, s60, v25
    v_cmp_neq_f32 vcc, v24, v25
    v_pk_mul_f32 v[40:41], v[40:41], v[26:27] op_sel_hi:[1,0]
    v_pk_mul_f32 v[42:43], v[42:43], v[26:27] op_sel_hi:[1,0]
    v_pk_mul_f32 v[44:45], v[44:45], v[26:27] op_sel_hi:[1,0]
    v_pk_mul_f32 v[46:47], v[46:47], v[26:27] op_sel_hi:[1,0]
    s_cbranch_vccnz RF_FB
RF_OK:
    buffer_load_dwordx4 v[60:63], v1, s[8:11], s65 offen offset:0 sc1
    v_cvt_pk_bf16_f32 v48, v40, v41
    v_cvt_pk_bf16_f32 v49, v42, v43
    v_cvt_pk_bf16_f32 v50, v44, v45
    v_cvt_pk_bf16_f32 v51, v46, v47
    s_mov_b64 exec, s[50:51]
    ds_write_b128 v7, v[48:51] offset:8192
    s_mov_b64 exec, -1
    ds_read_b128 v[84:87], v10 offset:20480
    ds_read_b128 v[88:91], v10 offset:21504
    ds_read_b128 v[92:95], v10 offset:22528
    ds_read_b128 v[96:99], v10 offset:23552
    buffer_load_dwordx4 v[64:67], v1, s[8:11], s65 offen offset:1024 sc1
    s_cmp_eq_u32 s33, 63
    s_cbranch_scc1 RF_LAST
    s_waitcnt lgkmcnt(4)
    s_barrier
    ds_read_b128 v[40:43], v1 offset:8192
    ds_read_b128 v[44:47], v1 offset:9216
    v_mov_b64 v[16:17], 0
    v_mov_b64 v[18:19], 0
    v_mov_b64 v[20:21], 0
    v_mov_b64 v[22:23], 0
    v_mov_b64 v[24:25], 0
    v_mov_b64 v[26:27], 0
    v_mov_b64 v[28:29], 0
    v_mov_b64 v[30:31], 0
    v_mov_b64 v[32:33], 0
    v_mov_b64 v[34:35], 0
    v_mov_b64 v[36:37], 0
    v_mov_b64 v[38:39], 0
    s_waitcnt lgkmcnt(1)
    s_waitcnt vmcnt(9)
    v_smfmac_f32_16x16x64_bf16 v[16:19], v[40:43], v[68:75], v2
    buffer_load_dwordx4 v[68:71], v1, s[8:11], s64 offen offset:0 sc1
    buffer_load_dwordx4 v[72:75], v1, s[8:11], s64 offen offset:1024 sc1
    s_waitcnt vmcnt(9)
    v_smfmac_f32_16x16x64_bf16 v[20:23], v[40:43], v[76:83], v2
    buffer_load_dwordx4 v[76:79], v1, s[8:11], s64 offen offset:2048 sc1
    buffer_load_dwordx4 v[80:83], v1, s[8:11], s64 offen offset:3072 sc1
    s_waitcnt lgkmcnt(0)
    v_smfmac_f32_16x16x64_bf16 v[16:19], v[44:47], v[84:91], v2
    ds_read_b128 v[84:87], v10 offset:24576
    ds_read_b128 v[88:91], v10 offset:25600
    v_smfmac_f32_16x16x64_bf16 v[20:23], v[44:47], v[92:99], v2
    ds_read_b128 v[92:95], v10 offset:26624
    ds_read_b128 v[96:99], v10 offset:27648
    v_smfmac_f32_16x16x64_bf16 v[24:27], v[40:43], a[176:183], v2
    v_smfmac_f32_16x16x64_bf16 v[28:31], v[40:43], a[184:191], v2
    s_nop 0
    v_add_f32 v16, v16, v17
    v_add_f32 v18, v18, v19
    s_nop 0
    v_add_f32 v20, v20, v21
    s_waitcnt lgkmcnt(2)
    v_smfmac_f32_16x16x64_bf16 v[24:27], v[44:47], v[84:91], v2
    ds_read_b128 v[84:87], v10 offset:28672
    ds_read_b128 v[88:91], v10 offset:29696
    v_add_f32 v22, v22, v23
    v_cvt_pk_bf16_f32 v48, v16, v18
    v_cvt_pk_bf16_f32 v49, v20, v22
    s_waitcnt lgkmcnt(2)
    v_smfmac_f32_16x16x64_bf16 v[28:31], v[44:47], v[92:99], v2
    ds_read_b128 v[92:95], v10 offset:30720
    ds_read_b128 v[96:99], v10 offset:31744
    v_and_or_b32 v48, v48, -2, s28
    buffer_store_dwordx2 v[48:49], v3, s[8:11], s34 offen
    v_mov_b64 v[16:17], 0
    v_smfmac_f32_16x16x64_bf16 v[32:35], v[40:43], a[192:199], v2
    v_mov_b64 v[18:19], 0
    v_mov_b64 v[20:21], 0
    v_mov_b64 v[22:23], 0
    v_smfmac_f32_16x16x64_bf16 v[36:39], v[40:43], a[200:207], v2
    v_add_f32 v24, v24, v25
    v_add_f32 v26, v26, v27
    v_add_f32 v28, v28, v29
    s_waitcnt lgkmcnt(2)
    v_smfmac_f32_16x16x64_bf16 v[32:35], v[44:47], v[84:91], v2
    ds_read_b128 v[84:87], v10 offset:32768
    ds_read_b128 v[88:91], v10 offset:33792
    v_add_f32 v30, v30, v31
    v_cvt_pk_bf16_f32 v50, v24, v26
    v_cvt_pk_bf16_f32 v51, v28, v30
    s_waitcnt lgkmcnt(2)
    v_smfmac_f32_16x16x64_bf16 v[36:39], v[44:47], v[92:99], v2
    ds_read_b128 v[92:95], v10 offset:34816
    ds_read_b128 v[96:99], v10 offset:35840
    v_and_or_b32 v50, v50, -2, s28
    buffer_store_dwordx2 v[50:51], v3, s[8:11], s73 offen
    v_mov_b64 v[24:25], 0
    v_smfmac_f32_16x16x64_bf16 v[16:19], v[40:43], a[208:215], v2
    v_mov_b64 v[26:27], 0
    v_mov_b64 v[28:29], 0
    v_mov_b64 v[30:31], 0
    v_smfmac_f32_16x16x64_bf16 v[20:23], v[40:43], a[216:223], v2
    v_add_f32 v32, v32, v33
    v_add_f32 v34, v34, v35
    v_add_f32 v36, v36, v37
    s_waitcnt lgkmcnt(2)
    v_smfmac_f32_16x16x64_bf16 v[16:19], v[44:47], v[84:91], v2
    v_add_f32 v38, v38, v39
    v_cvt_pk_bf16_f32 v48, v32, v34
    v_cvt_pk_bf16_f32 v49, v36, v38
    s_waitcnt lgkmcnt(0)
    v_smfmac_f32_16x16x64_bf16 v[20:23], v[44:47], v[92:99], v2
    v_and_or_b32 v48, v48, -2, s28
    buffer_store_dwordx2 v[48:49], v3, s[8:11], s74 offen
    v_smfmac_f32_16x16x64_bf16 v[24:27], v[40:43], a[224:231], v2
    v_smfmac_f32_16x16x64_bf16 v[28:31], v[40:43], a[232:239], v2
    v_add_f32 v16, v16, v17
    v_add_f32 v18, v18, v19
    s_nop 1
    v_add_f32 v20, v20, v21
    v_smfmac_f32_16x16x64_bf16 v[24:27], v[44:47], a[240:247], v2
    v_add_f32 v22, v22, v23
    v_cvt_pk_bf16_f32 v50, v16, v18
    v_cvt_pk_bf16_f32 v51, v20, v22
    v_smfmac_f32_16x16x64_bf16 v[28:31], v[44:47], a[248:255], v2
    v_and_or_b32 v50, v50, -2, s28
    buffer_store_dwordx2 v[50:51], v3, s[8:11], s75 offen
    s_nop 1
    v_add_f32 v24, v24, v25
    v_add_f32 v26, v26, v27
    s_nop 1
    v_add_f32 v28, v28, v29
    v_add_f32 v30, v30, v31
    v_cvt_pk_bf16_f32 v48, v24, v26
    v_cvt_pk_bf16_f32 v49, v28, v30
    v_and_or_b32 v48, v48, -2, s28
    buffer_store_dwordx2 v[48:49], v3, s[8:11], s76 offen
    s_cmp_ge_u32 s41, 80
    s_cbranch_scc1 RF_NR
    v_lshrrev_b32 v0, 2, v1
    v_and_b32 v0, 16, v0
    s_movk_i32 s3, 0x3f80
    v_lshlrev_b32_e64 v0, v0, s3
    s_mov_b32 vcc_lo, 0x110011
    s_mov_b32 vcc_hi, 0x110011
    v_cndmask_b32 v100, 0, v0, vcc
    s_mov_b32 vcc_lo, 0x11001100
    s_mov_b32 vcc_hi, 0x11001100
    v_cndmask_b32 v101, 0, v0, vcc
    s_mov_b32 vcc_lo, 0x220022
    s_mov_b32 vcc_hi, 0x220022
    v_cndmask_b32 v102, 0, v0, vcc
    s_mov_b32 vcc_lo, 0x22002200
    s_mov_b32 vcc_hi, 0x22002200
    v_cndmask_b32 v103, 0, v0, vcc
    s_sleep 1
    s_cmp_lg_u32 s13, 0
    s_cbranch_scc1 RF_C1
RF_C0:
    buffer_load_dwordx4 v[16:19], v4, s[8:11], s34 offen offset:0 sc1
    buffer_load_dwordx4 v[20:23], v4, s[8:11], s34 offen offset:1024 sc1
    buffer_load_dwordx4 v[24:27], v4, s[8:11], s34 offen offset:2048 sc1
    buffer_load_dwordx4 v[28:31], v4, s[8:11], s34 offen offset:3072 sc1
    buffer_load_dwordx4 v[84:87], v1, s[8:11], s65 offen offset:2048 sc1
    buffer_load_dwordx4 v[88:91], v1, s[8:11], s65 offen offset:3072 sc1
    buffer_load_dwordx4 v[92:95], v1, s[8:11], s66 offen offset:0 sc1
    buffer_load_dwordx4 v[96:99], v1, s[8:11], s66 offen offset:1024 sc1
    s_waitcnt vmcnt(4)
RF_CK:
    v_mfma_f32_16x16x32_bf16 v[48:51], v[100:103], v[16:19], 0
    v_mfma_f32_16x16x32_bf16 v[48:51], v[100:103], v[20:23], v[48:51]
    v_mfma_f32_16x16x32_bf16 v[48:51], v[100:103], v[24:27], v[48:51]
    v_mfma_f32_16x16x32_bf16 v[48:51], v[100:103], v[28:31], v[48:51]
    v_bitop3_b32 v44, v16, v18, s28 bitop3:0x7e
    v_bitop3_b32 v45, v20, v22, s28 bitop3:0x7e
    v_bitop3_b32 v46, v24, v26, s28 bitop3:0x7e
    v_bitop3_b32 v47, v28, v30, s28 bitop3:0x7e
    v_or3_b32 v0, v44, v45, v46
    v_bitop3_b32 v0, v0, v47, 1 bitop3:0xa8
    v_cmp_ne_u32 vcc, 0, v0
    s_nop 0
    s_cbranch_vccnz RF_PB
RF_PA1:
    buffer_load_dwordx4 v[40:43], v6, s[8:11], s35 offen sc1
    v_mov_b32 v44, s57
    v_add_f32_dpp v48, v48, v48 row_ror:8 row_mask:0xf bank_mask:0xf
    v_add_f32_dpp v49, v49, v49 row_ror:8 row_mask:0xf bank_mask:0xf
    s_mov_b64 exec, s[50:51]
    v_cvt_pk_bf16_f32 v48, v48, v49
    buffer_store_dword v48, v5, s[8:11], s35 offen
    buffer_store_dword v44, v5, s[8:11], s36 offen
    s_mov_b64 exec, -1
    v_mov_b64 v[16:17], 0
    v_mov_b64 v[18:19], 0
    v_mov_b64 v[20:21], 0
    v_mov_b64 v[22:23], 0
    v_mov_b64 v[24:25], 0
    v_mov_b64 v[26:27], 0
    v_mov_b64 v[28:29], 0
    v_mov_b64 v[30:31], 0
    v_mov_b64 v[32:33], 0
    v_mov_b64 v[34:35], 0
    v_mov_b64 v[36:37], 0
    v_mov_b64 v[38:39], 0
    s_waitcnt vmcnt(2)
RF_BL:
    v_max3_u32 v0, v40, v41, v42
    v_max_u32 v0, v0, v43
    v_cmp_le_u32 vcc, s63, v0
    s_nop 0
    s_cbranch_vccnz RF_BX
RF_BOK0:
    s_xor_b32 s28, s28, 1
    s_mov_b32 s36, s35
    s_add_u32 s35, s35, 10240
    s_cmp_eq_u32 s35, 0x1c7800
    s_cselect_b32 s35, 0x1c0000, s35
    s_add_u32 s33, s33, 1
    s_branch RF_STEP
RF_C1:
    s_sleep 1
    s_cmp_lt_u32 s41, 64
    s_cbranch_scc1 RF_C2
    s_sleep 3
    s_branch RF_C0
RF_C2:
    buffer_load_dwordx4 v[84:87], v1, s[8:11], s65 offen offset:2048 sc1
    buffer_load_dwordx4 v[88:91], v1, s[8:11], s65 offen offset:3072 sc1
    buffer_load_dwordx4 v[92:95], v1, s[8:11], s66 offen offset:0 sc1
    buffer_load_dwordx4 v[96:99], v1, s[8:11], s66 offen offset:1024 sc1
    s_cmp_lt_u32 s41, 64
    s_cbranch_scc1 RF_PAR2
    s_sleep 1
RF_PAR2:
    buffer_load_dwordx4 v[16:19], v4, s[8:11], s34 offen offset:0 sc1
    buffer_load_dwordx4 v[20:23], v4, s[8:11], s34 offen offset:1024 sc1
    buffer_load_dwordx4 v[24:27], v4, s[8:11], s34 offen offset:2048 sc1
    buffer_load_dwordx4 v[28:31], v4, s[8:11], s34 offen offset:3072 sc1
    s_waitcnt vmcnt(0)
    s_branch RF_CK
RF_NR:
    v_mov_b64 v[16:17], 0
    v_mov_b64 v[18:19], 0
    v_mov_b64 v[20:21], 0
    v_mov_b64 v[22:23], 0
    v_mov_b64 v[24:25], 0
    v_mov_b64 v[26:27], 0
    v_mov_b64 v[28:29], 0
    v_mov_b64 v[30:31], 0
    v_mov_b64 v[32:33], 0
    v_mov_b64 v[34:35], 0
    v_mov_b64 v[36:37], 0
    v_mov_b64 v[38:39], 0
    s_sleep 2
    buffer_load_dwordx4 v[84:87], v1, s[8:11], s65 offen offset:2048 sc1
    buffer_load_dwordx4 v[88:91], v1, s[8:11], s65 offen offset:3072 sc1
    buffer_load_dwordx4 v[92:95], v1, s[8:11], s66 offen offset:0 sc1
    buffer_load_dwordx4 v[96:99], v1, s[8:11], s66 offen offset:1024 sc1
    s_sleep 6
RF_BX:
    buffer_load_dwordx4 v[40:43], v6, s[8:11], s35 offen sc1
    s_add_u32 s99, s99, 1
    s_and_b32 s3, s99, 63
    s_waitcnt vmcnt(0)
    s_cbranch_scc1 RF_BL
    s_mov_b64 s[96:97], 0
    v_cmp_eq_u32 vcc, s57, v40
    s_nop 0
    s_or_b64 s[96:97], s[96:97], vcc
    v_cmp_eq_u32 vcc, s57, v41
    s_nop 0
    s_or_b64 s[96:97], s[96:97], vcc
    v_cmp_eq_u32 vcc, s57, v42
    s_nop 0
    s_or_b64 s[96:97], s[96:97], vcc
    v_cmp_eq_u32 vcc, s57, v43
    s_nop 0
    s_or_b64 s[96:97], s[96:97], vcc
    s_cmp_eq_u64 s[96:97], 0
    s_cbranch_scc1 RF_BOK0
    s_cmp_ge_u32 s99, 0x80000
    s_cbranch_scc1 RF_BOK0
    s_branch RF_BL
RF_PB:
    s_add_u32 s99, s99, 1
    s_cmp_lt_u32 s99, 0x80000
    s_cbranch_scc1 RF_PAR2
    s_branch RF_PA1
RF_BR1:
    v_cmp_eq_u32 vcc, s57, v0
    s_nop 0
    s_cbranch_vccnz RF_BS1
    s_mov_b64 s[96:97], 0
    v_cmp_eq_u32 vcc, s57, v48
    s_nop 0
    s_or_b64 s[96:97], s[96:97], vcc
    v_cmp_eq_u32 vcc, s57, v49
    s_nop 0
    s_or_b64 s[96:97], s[96:97], vcc
    v_cmp_eq_u32 vcc, s57, v50
    s_nop 0
    s_or_b64 s[96:97], s[96:97], vcc
    v_cmp_eq_u32 vcc, s57, v51
    s_nop 0
    s_or_b64 s[96:97], s[96:97], vcc
    s_cmp_eq_u64 s[96:97], 0
    s_cbranch_scc1 RF_BOK1
RF_BS1:
    s_add_u32 s99, s99, 1
    s_cmp_ge_u32 s99, 0x80000
    s_cbranch_scc1 RF_BOK1
    buffer_load_dwordx4 v[48:51], v6, s[8:11], s7 offen sc1
    s_waitcnt vmcnt(0)
    s_branch RF_BC1
RF_BR2:
    v_cmp_eq_u32 vcc, s57, v0
    s_nop 0
    s_cbranch_vccnz RF_BS2
    s_mov_b64 s[96:97], 0
    v_cmp_eq_u32 vcc, s57, v44
    s_nop 0
    s_or_b64 s[96:97], s[96:97], vcc
    v_cmp_eq_u32 vcc, s57, v45
    s_nop 0
    s_or_b64 s[96:97], s[96:97], vcc
    v_cmp_eq_u32 vcc, s57, v46
    s_nop 0
    s_or_b64 s[96:97], s[96:97], vcc
    v_cmp_eq_u32 vcc, s57, v47
    s_nop 0
    s_or_b64 s[96:97], s[96:97], vcc
    s_cmp_eq_u64 s[96:97], 0
    s_cbranch_scc1 RF_BOK2
RF_BS2:
    s_add_u32 s99, s99, 1
    s_cmp_ge_u32 s99, 0x80000
    s_cbranch_scc1 RF_BOK2
    buffer_load_dwordx4 v[44:47], v1, s[8:11], s59 offen sc1
    s_waitcnt vmcnt(0)
    s_branch RF_BC2
RF_BR3:
    v_cmp_eq_u32 vcc, s57, v0
    s_nop 0
    s_cbranch_vccnz RF_BS3
    s_mov_b64 s[96:97], 0
    v_cmp_eq_u32 vcc, s57, v100
    s_nop 0
    s_or_b64 s[96:97], s[96:97], vcc
    v_cmp_eq_u32 vcc, s57, v101
    s_nop 0
    s_or_b64 s[96:97], s[96:97], vcc
    v_cmp_eq_u32 vcc, s57, v102
    s_nop 0
    s_or_b64 s[96:97], s[96:97], vcc
    v_cmp_eq_u32 vcc, s57, v103
    s_nop 0
    s_or_b64 s[96:97], s[96:97], vcc
    s_cmp_eq_u64 s[96:97], 0
    s_cbranch_scc1 RF_BOK3
RF_BS3:
    s_add_u32 s99, s99, 1
    s_cmp_ge_u32 s99, 0x80000
    s_cbranch_scc1 RF_BOK3
    buffer_load_dwordx4 v[100:103], v1, s[8:11], s62 offen sc1
    s_waitcnt vmcnt(0)
    s_branch RF_BC3
RF_WKV:
    v_lshrrev_b32 v0, 2, v1
    buffer_load_dword v11, v0, s[8:11], s71 offen sc1
    s_waitcnt vmcnt(0)
    v_cmp_ne_u32 s[48:49], 0, v11
    s_nop 0
    s_bitcmp1_b64 s[48:49], s4
    s_nop 1
    s_cbranch_scc1 RF_KVOK
    s_add_u32 s99, s99, 1
    s_cmp_lt_u32 s99, 0x80000
    s_cbranch_scc1 RF_WKV
    s_branch RF_KVOK
RF_FB:
    s_cmp_lg_u32 s58, 0
    s_cbranch_scc1 RF_OK
    s_mov_b32 s58, 1
    v_max3_f32 v24, v84, v85, v86
    v_max3_f32 v24, v24, v87, v20
    s_nop 1
    v_max_f32_dpp v24, v24, v24 row_ror:8 row_mask:0xf bank_mask:0xf
    v_mov_b32 v25, v24
    s_nop 1
    v_permlane32_swap_b32 v24, v25
    v_max_f32 v24, v24, v25
    v_mov_b32 v25, v24
    s_nop 1
    v_permlane16_swap_b32 v24, v25
    v_max_f32 v24, v24, v25
    v_sub_f32 v84, v84, v24
    v_sub_f32 v85, v85, v24
    v_sub_f32 v86, v86, v24
    v_sub_f32 v87, v87, v24
    v_sub_f32 v20, v20, v24
    s_nop 0
    s_branch RF_EXP
RF_LAST:
    s_waitcnt vmcnt(0) lgkmcnt(0)
    s_barrier
    s_add_u32 s49, s39, 252
    s_cmp_lg_u32 s13, 0
    s_cbranch_scc1 SIG_48
    v_mov_b32 v16, 0
    v_mov_b32 v17, 1
    s_mov_b64 exec, 1
    buffer_store_dword v17, v16, s[8:11], s49 offen sc1
    s_mov_b64 exec, -1
SIG_48:
    s_nop 7
    s_nop 7
    s_add_u32 s14, s14, 1
    s_cmp_lt_u32 s14, s15
    s_cbranch_scc1 RF_PAIR
    s_endpgm
RS_PAIR:
    s_mul_i32 s17, s14, 0x6000000
    s_add_u32 s17, s17, 0x1000000
    s_lshl_b32 s3, s32, 14
    s_add_u32 s54, s3, s17
    s_add_u32 s54, s54, 0x1000000
    s_lshl_b32 s59, s13, 12
    s_add_u32 s37, s54, s59
    s_add_u32 s3, s3, s59
    s_lshr_b32 s3, s3, 1
    s_add_u32 s38, s3, s17
    s_add_u32 s38, s38, 0x3000000
    s_lshl_b32 s3, s14, 13
    s_lshl_b32 s59, s32, 8
    s_add_u32 s39, s3, s59
    s_add_u32 s71, s39, 69632
    s_add_u32 s39, s39, 86016
    s_mov_b32 s33, 0
    s_sub_u32 s31, s39, 4
    s_cmp_eq_u32 s13, 3
    s_cselect_b32 s31, s31, 0x10000000
    v_bfe_u32 v16, v1, 5, 3
    v_mul_u32_u24 v16, 1280, v16
    v_lshrrev_b32 v17, 8, v1
    v_lshl_add_u32 v16, v17, 5, v16
    v_and_b32 v17, 16, v1
    v_add_u32 v16, v16, v17
    s_lshl_b32 s3, s13, 7
    s_lshr_b32 s59, s55, 3
    buffer_load_dwordx4 v[40:43], v16, s[24:27], s3 offen
    buffer_load_dwordx4 v[44:47], v16, s[24:27], s3 offen offset:512
    buffer_load_dwordx4 v[48:51], v16, s[24:27], s59 offen
    buffer_load_dwordx4 v[68:71], v1, s[8:11], s64 offen offset:0 sc1
    buffer_load_dwordx4 v[72:75], v1, s[8:11], s64 offen offset:1024 sc1
    buffer_load_dwordx4 v[76:79], v1, s[8:11], s64 offen offset:2048 sc1
    buffer_load_dwordx4 v[80:83], v1, s[8:11], s64 offen offset:3072 sc1
    buffer_load_dwordx4 v[60:63], v1, s[8:11], s65 offen offset:0 sc1
    buffer_load_dwordx4 v[64:67], v1, s[8:11], s65 offen offset:1024 sc1
    buffer_load_dwordx4 v[84:87], v1, s[8:11], s65 offen offset:2048 sc1
    buffer_load_dwordx4 v[88:91], v1, s[8:11], s65 offen offset:3072 sc1
    buffer_load_dwordx4 v[92:95], v1, s[8:11], s66 offen offset:0 sc1
    buffer_load_dwordx4 v[96:99], v1, s[8:11], s66 offen offset:1024 sc1
    v_mov_b32 v16, 0
POLL_49:
    buffer_load_dword v17, v16, s[8:11], s71 offen sc1
    s_waitcnt vmcnt(0)
    v_readfirstlane_b32 s3, v17
    s_nop 0
    s_cmp_ge_u32 s3, 1
    s_nop 1
    s_cbranch_scc1 POLLD_50
    s_add_u32 s99, s99, 1
    s_cmp_ge_u32 s99, 0x80000
    s_cbranch_scc1 POLLD_50
    s_branch POLL_49
POLLD_50:
    v_mov_b64 v[16:17], 0
    v_mov_b64 v[18:19], 0
    v_mov_b64 v[20:21], 0
    v_mov_b64 v[22:23], 0
    v_mov_b64 v[24:25], 0
    v_mov_b64 v[26:27], 0
    v_mov_b64 v[28:29], 0
    v_mov_b64 v[30:31], 0
    v_mov_b64 v[32:33], 0
    v_mov_b64 v[34:35], 0
    v_mov_b64 v[36:37], 0
    v_mov_b64 v[38:39], 0
    buffer_load_dwordx4 v[52:55], v1, s[8:11], s37 offen offset:0 nt
    buffer_load_dwordx4 v[56:59], v1, s[8:11], s37 offen offset:1024 nt
    s_add_u32 s7, s36, 4096
    s_add_u32 s59, s36, s55
    s_add_u32 s62, s36, s56
    buffer_store_dwordx4 v[44:47], v6, s[8:11], s7 offen sc1
    buffer_store_dwordx4 v[48:51], v1, s[8:11], s59 offen sc1
    v_mov_b32 v11, 0
    s_waitcnt vmcnt(0) lgkmcnt(0)
    s_barrier
RS_STEP:
    ds_write_b128 v6, v[40:43] offset:0
    v_smfmac_f32_16x16x64_bf16 v[16:19], v[40:43], v[68:75], v2
    v_smfmac_f32_16x16x64_bf16 v[20:23], v[40:43], v[76:83], v2
    buffer_load_dwordx4 v[48:51], v6, s[8:11], s7 offen sc1
    v_smfmac_f32_16x16x64_bf16 v[24:27], v[40:43], v[60:67], v2
    s_waitcnt lgkmcnt(0)
    s_barrier
    v_xor_b32 v0, 1024, v6
    ds_read_b128 v[44:47], v0 offset:0
    v_xor_b32 v0, 2048, v6
    ds_read_b128 v[100:103], v0 offset:0
    v_cmp_ne_u32 s[48:49], 0, v11
    s_nop 0
    s_lshl_b32 s72, s33, 19
    s_add_u32 s72, s72, s37
    v_smfmac_f32_16x16x64_bf16 v[28:31], v[40:43], v[104:111], v2
    v_smfmac_f32_16x16x64_bf16 v[32:35], v[40:43], v[84:91], v2
    ds_read_b128 v[84:87], v10 offset:0
    ds_read_b128 v[88:91], v10 offset:1024
    v_smfmac_f32_16x16x64_bf16 v[36:39], v[40:43], v[92:99], v2
    buffer_load_dwordx4 v[68:71], v1, s[8:11], s66 offen offset:2048 sc1
    ds_read_b128 v[92:95], v10 offset:2048
    ds_read_b128 v[96:99], v10 offset:3072
    v_xor_b32 v0, 3072, v6
    ds_read_b128 v[40:43], v0 offset:0
    s_waitcnt lgkmcnt(6)
    v_smfmac_f32_16x16x64_bf16 v[16:19], v[44:47], v[112:119], v2
    v_smfmac_f32_16x16x64_bf16 v[20:23], v[44:47], v[120:127], v2
    v_smfmac_f32_16x16x64_bf16 v[24:27], v[44:47], v[128:135], v2
    buffer_load_dwordx4 v[72:75], v1, s[8:11], s66 offen offset:3072 sc1
    v_smfmac_f32_16x16x64_bf16 v[28:31], v[44:47], v[136:143], v2
    s_waitcnt lgkmcnt(5)
    v_smfmac_f32_16x16x64_bf16 v[16:19], v[100:103], v[144:151], v2
    s_waitcnt lgkmcnt(3)
    v_smfmac_f32_16x16x64_bf16 v[20:23], v[100:103], v[84:91], v2
    ds_read_b128 v[84:87], v10 offset:4096
    ds_read_b128 v[88:91], v10 offset:5120
    buffer_load_dwordx4 v[76:79], v1, s[8:11], s67 offen offset:0 sc1
    v_smfmac_f32_16x16x64_bf16 v[24:27], v[100:103], v[152:159], v2
    s_lshl_b32 s5, s33, 2
    s_add_u32 s5, s5, s31
    v_smfmac_f32_16x16x64_bf16 v[28:31], v[100:103], v[160:167], v2
    s_waitcnt lgkmcnt(2)
    v_smfmac_f32_16x16x64_bf16 v[16:19], v[40:43], v[168:175], v2
    buffer_load_dwordx4 v[80:83], v1, s[8:11], s67 offen offset:1024 sc1
    v_smfmac_f32_16x16x64_bf16 v[20:23], v[40:43], v[92:99], v2
    ds_read_b128 v[92:95], v10 offset:6144
    ds_read_b128 v[96:99], v10 offset:7168
    v_smfmac_f32_16x16x64_bf16 v[24:27], v[40:43], v[176:183], v2
    buffer_load_dwordx4 v[44:47], v1, s[8:11], s59 offen sc1
    v_smfmac_f32_16x16x64_bf16 v[28:31], v[40:43], v[184:191], v2
    s_cmp_eq_u32 s33, 0
    s_cselect_b32 s5, 0x10000000, s5
    s_waitcnt vmcnt(5)
RS_BC1:
    v_max3_u32 v0, v48, v49, v50
    v_max_u32 v0, v0, v51
    v_cmp_le_u32 vcc, s63, v0
    s_nop 0
    s_cbranch_vccnz RS_BR1
RS_BOK1:
    ds_write_b128 v6, v[48:51] offset:4096
    v_smfmac_f32_16x16x64_bf16 v[16:19], v[48:51], v[192:199], v2
    s_waitcnt lgkmcnt(3)
    v_smfmac_f32_16x16x64_bf16 v[20:23], v[48:51], v[84:91], v2
    ds_read_b128 v[84:87], v10 offset:8192
    ds_read_b128 v[88:91], v10 offset:9216
    v_smfmac_f32_16x16x64_bf16 v[24:27], v[48:51], v[200:207], v2
    s_waitcnt lgkmcnt(2)
    s_barrier
    v_xor_b32 v0, 1024, v6
    ds_read_b128 v[100:103], v0 offset:4096
    v_xor_b32 v0, 2048, v6
    ds_read_b128 v[40:43], v0 offset:4096
    v_smfmac_f32_16x16x64_bf16 v[28:31], v[48:51], v[208:215], v2
    s_lshl_b32 s6, s33, 18
    s_add_u32 s6, s6, s38
    v_smfmac_f32_16x16x64_bf16 v[32:35], v[48:51], v[216:223], v2
    v_smfmac_f32_16x16x64_bf16 v[36:39], v[48:51], v[92:99], v2
    ds_read_b128 v[92:95], v10 offset:10240
    ds_read_b128 v[96:99], v10 offset:11264
    v_xor_b32 v0, 3072, v6
    ds_read_b128 v[48:51], v0 offset:4096
    s_waitcnt lgkmcnt(4)
    v_smfmac_f32_16x16x64_bf16 v[16:19], v[100:103], v[224:231], v2
    v_smfmac_f32_16x16x64_bf16 v[20:23], v[100:103], v[232:239], v2
    s_waitcnt vmcnt(3)
    v_smfmac_f32_16x16x64_bf16 v[24:27], v[100:103], v[68:75], v2
    v_smfmac_f32_16x16x64_bf16 v[28:31], v[100:103], v[84:91], v2
    ds_read_b128 v[84:87], v10 offset:12288
    ds_read_b128 v[88:91], v10 offset:13312
    buffer_load_dwordx4 v[100:103], v1, s[8:11], s62 offen sc1
    s_waitcnt lgkmcnt(5)
    v_smfmac_f32_16x16x64_bf16 v[16:19], v[40:43], v[240:247], v2
    buffer_load_dwordx4 v[68:71], v1, s[8:11], s67 offen offset:2048 sc1
    v_smfmac_f32_16x16x64_bf16 v[20:23], v[40:43], v[248:255], v2
    s_waitcnt vmcnt(3)
    v_smfmac_f32_16x16x64_bf16 v[24:27], v[40:43], v[76:83], v2
    buffer_load_dwordx4 v[72:75], v1, s[8:11], s67 offen offset:3072 sc1
    s_waitcnt lgkmcnt(3)
    v_smfmac_f32_16x16x64_bf16 v[28:31], v[40:43], v[92:99], v2
    ds_read_b128 v[92:95], v10 offset:14336
    ds_read_b128 v[96:99], v10 offset:15360
    s_waitcnt lgkmcnt(4)
    v_smfmac_f32_16x16x64_bf16 v[16:19], v[48:51], a[0:7], v2
    buffer_load_dwordx4 v[76:79], v1, s[8:11], s68 offen offset:0 sc1
    v_xor_b32 v0, 1024, v6
    ds_read_b128 v[40:43], v0 offset:0
    v_smfmac_f32_16x16x64_bf16 v[20:23], v[48:51], a[8:15], v2
    v_smfmac_f32_16x16x64_bf16 v[24:27], v[48:51], a[16:23], v2
    buffer_load_dwordx4 v[80:83], v1, s[8:11], s68 offen offset:1024 sc1
    s_waitcnt lgkmcnt(3)
    v_smfmac_f32_16x16x64_bf16 v[28:31], v[48:51], v[84:91], v2
    ds_read_b128 v[84:87], v10 offset:16384
    ds_read_b128 v[88:91], v10 offset:17408
    s_waitcnt vmcnt(5)
RS_BC2:
    v_max3_u32 v0, v44, v45, v46
    v_max_u32 v0, v0, v47
    v_cmp_le_u32 vcc, s63, v0
    s_nop 0
    s_cbranch_vccnz RS_BR2
RS_BOK2:
    v_smfmac_f32_16x16x64_bf16 v[16:19], v[44:47], a[24:31], v2
    v_xor_b32 v0, 2048, v6
    ds_read_b128 v[48:51], v0 offset:0
    v_smfmac_f32_16x16x64_bf16 v[20:23], v[44:47], a[32:39], v2
    buffer_load_dwordx4 v[60:63], v1, s[8:11], s72 offen offset:2048 nt
    v_smfmac_f32_16x16x64_bf16 v[24:27], v[44:47], a[40:47], v2
    s_waitcnt lgkmcnt(4)
    v_smfmac_f32_16x16x64_bf16 v[28:31], v[44:47], v[92:99], v2
    ds_read_b128 v[92:95], v10 offset:18432
    ds_read_b128 v[96:99], v10 offset:19456
    v_smfmac_f32_16x16x64_bf16 v[32:35], v[44:47], a[48:55], v2
    buffer_load_dwordx4 v[64:67], v1, s[8:11], s72 offen offset:3072 nt
    s_waitcnt lgkmcnt(3)
    v_smfmac_f32_16x16x64_bf16 v[36:39], v[44:47], v[84:91], v2
    s_waitcnt vmcnt(6)
RS_BC3:
    v_max3_u32 v0, v100, v101, v102
    v_max_u32 v0, v0, v103
    v_cmp_le_u32 vcc, s63, v0
    s_nop 0
    s_cbranch_vccnz RS_BR3
RS_BOK3:
    v_smfmac_f32_16x16x64_bf16 v[16:19], v[100:103], a[56:63], v2
    s_mov_b64 exec, 1
    buffer_store_dword v2, v1, s[8:11], s5 offen sc1
    s_mov_b64 exec, -1
    v_smfmac_f32_16x16x64_bf16 v[20:23], v[100:103], a[64:71], v2
    s_add_u32 s4, s33, 1
    s_min_u32 s4, s4, 63
    s_waitcnt lgkmcnt(0)
    v_smfmac_f32_16x16x64_bf16 v[24:27], v[100:103], v[92:99], v2
    v_smfmac_f32_16x16x64_bf16 v[28:31], v[100:103], a[72:79], v2
    s_bitcmp1_b64 s[48:49], s4
    s_cbranch_scc0 RS_WKV
RS_KVOK:
    v_smfmac_f32_16x16x64_bf16 v[32:35], v[100:103], a[80:87], v2
    s_lshl_b32 s4, s4, 19
    s_add_u32 s4, s4, s37
    v_smfmac_f32_16x16x64_bf16 v[36:39], v[100:103], a[88:95], v2
    s_add_u32 s7, s35, 4096
    s_add_u32 s59, s35, s55
    s_add_u32 s62, s35, s56
    s_mov_b32 s58, 0
    v_xor_b32 v0, 3072, v6
    ds_read_b128 v[44:47], v0 offset:0
    v_cvt_pk_bf16_f32 v16, v16, v17
    v_cvt_pk_bf16_f32 v17, v18, v19
    v_cvt_pk_bf16_f32 v18, v20, v21
    v_cvt_pk_bf16_f32 v19, v22, v23
    s_nop 1
    v_mfma_f32_16x16x32_bf16 v[20:23], v[16:19], v[12:15], 0
    v_cvt_pk_bf16_f32 v24, v24, v25
    v_cvt_pk_bf16_f32 v25, v26, v27
    v_cvt_pk_bf16_f32 v26, v28, v29
    v_cvt_pk_bf16_f32 v27, v30, v31
    s_nop 1
    v_mfma_f32_16x16x32_bf16 v[28:31], v[24:27], v[12:15], 0
    s_waitcnt vmcnt(5)
    v_smfmac_f32_16x16x64_bf16 v[32:35], v[40:43], v[68:75], v2
    buffer_load_dwordx4 v[68:71], v1, s[8:11], s68 offen offset:2048 sc1
    buffer_load_dwordx4 v[72:75], v1, s[8:11], s68 offen offset:3072 sc1
    s_waitcnt vmcnt(5)
    v_smfmac_f32_16x16x64_bf16 v[36:39], v[40:43], v[76:83], v2
    buffer_load_dwordx4 v[76:79], v1, s[8:11], s69 offen offset:0 sc1
    buffer_load_dwordx4 v[80:83], v1, s[8:11], s69 offen offset:1024 sc1
    v_xor_b32 v0, 1024, v6
    ds_read_b128 v[100:103], v0 offset:4096
    v_cvt_pk_bf16_f32 v16, v20, v21
    v_cvt_pk_bf16_f32 v17, v22, v23
    v_cvt_pk_bf16_f32 v18, v28, v29
    v_cvt_pk_bf16_f32 v19, v30, v31
    s_nop 1
    v_mfma_f32_16x16x32_bf16 v[84:87], v[52:55], v[16:19], 0
    v_mfma_f32_16x16x32_bf16 v[88:91], v[56:59], v[16:19], 0
    v_mfma_f32_16x16x32_bf16 v[24:27], v[16:19], v[16:19], 0
    v_smfmac_f32_16x16x64_bf16 v[32:35], v[48:51], a[96:103], v2
    buffer_load_dwordx4 v[52:55], v1, s[8:11], s4 offen offset:0 nt
    v_smfmac_f32_16x16x64_bf16 v[36:39], v[48:51], a[104:111], v2
    buffer_load_dwordx4 v[56:59], v1, s[8:11], s4 offen offset:1024 nt
    v_xor_b32 v0, 2048, v6
    ds_read_b128 v[40:43], v0 offset:4096
    s_mov_b64 exec, s[50:51]
    ds_write_b128 v7, v[84:87] offset:10240
    ds_write_b128 v7, v[88:91] offset:12288
    ds_write_b128 v7, v[24:27] offset:14336
    s_mov_b64 exec, -1
    s_waitcnt lgkmcnt(5)
    v_smfmac_f32_16x16x64_bf16 v[32:35], v[44:47], a[112:119], v2
    v_smfmac_f32_16x16x64_bf16 v[36:39], v[44:47], a[120:127], v2
    v_xor_b32 v0, 3072, v6
    ds_read_b128 v[48:51], v0 offset:4096
    s_not_b64 exec, s[50:51]
    buffer_store_dwordx4 v[16:19], v1, s[8:11], s6 offen sc1
    s_mov_b64 exec, -1
    s_waitcnt lgkmcnt(1)
    s_barrier
    ds_read_b128 v[84:87], v8 offset:10240
    ds_read_b128 v[88:91], v8 offset:10752
    ds_read_b128 v[92:95], v8 offset:11264
    ds_read_b128 v[96:99], v8 offset:11776
    ds_read_b32 v20, v9 offset:14592
    ds_read_b32 v21, v9 offset:15104
    ds_read_b32 v22, v9 offset:15616
    ds_read_b32 v23, v9 offset:16128
    v_smfmac_f32_16x16x64_bf16 v[32:35], v[100:103], a[128:135], v2
    v_smfmac_f32_16x16x64_bf16 v[36:39], v[100:103], a[136:143], v2
    v_lshrrev_b32 v0, 2, v1
    buffer_load_dword v11, v0, s[8:11], s71 offen sc1
    v_smfmac_f32_16x16x64_bf16 v[32:35], v[40:43], a[144:151], v2
    v_smfmac_f32_16x16x64_bf16 v[36:39], v[40:43], a[152:159], v2
    s_waitcnt lgkmcnt(8)
    v_smfmac_f32_16x16x64_bf16 v[32:35], v[48:51], a[160:167], v2
    v_smfmac_f32_16x16x64_bf16 v[36:39], v[48:51], a[168:175], v2
    s_waitcnt lgkmcnt(6)
    v_add_f32 v84, v84, v88
    v_add_f32 v85, v85, v89
    v_add_f32 v86, v86, v90
    v_add_f32 v87, v87, v91
    s_waitcnt lgkmcnt(4)
    v_add_f32 v92, v92, v96
    v_add_f32 v93, v93, v97
    v_add_f32 v94, v94, v98
    v_add_f32 v95, v95, v99
    s_waitcnt lgkmcnt(0)
    v_add_f32 v20, v20, v21
    v_add_f32 v22, v22, v23
    v_add_f32 v84, v84, v92
    v_add_f32 v85, v85, v93
    v_add_f32 v86, v86, v94
    v_add_f32 v87, v87, v95
    v_add_f32 v20, v20, v22
    v_mul_f32 v20, s70, v20
    v_cvt_pk_bf16_f32 v32, v32, v33
    v_cvt_pk_bf16_f32 v33, v34, v35
    v_cvt_pk_bf16_f32 v34, v36, v37
    v_cvt_pk_bf16_f32 v35, v38, v39
    buffer_store_dwordx4 v[32:35], v1, s[8:11], s6 offen offset:1024 sc1
    s_waitcnt vmcnt(10)
RS_EXP:
    v_exp_f32 v28, v84
    v_exp_f32 v29, v85
    v_exp_f32 v30, v86
    v_exp_f32 v31, v87
    v_exp_f32 v21, v20
    v_cvt_pk_bf16_f32 v92, v28, v29
    v_cvt_pk_bf16_f32 v93, v30, v31
    v_cvt_pk_bf16_f32 v96, v21, v21
    v_add_f32 v24, v28, v29
    v_mov_b32_dpp v94, v92 row_ror:8 row_mask:0xf bank_mask:0xf
    v_mov_b32_dpp v95, v93 row_ror:8 row_mask:0xf bank_mask:0xf
    v_mov_b32_dpp v97, v96 row_ror:8 row_mask:0xf bank_mask:0xf
    v_add_f32 v25, v30, v31
    v_add_f32 v24, v24, v21
    v_mfma_f32_16x16x32_bf16 v[40:43], v[60:63], v[92:95], 0
    v_mfma_f32_16x16x32_bf16 v[44:47], v[64:67], v[92:95], 0
    v_add_f32 v24, v24, v25
    v_mfma_f32_16x16x16_bf16 v[40:43], v[32:33], v[96:97], v[40:43]
    v_mfma_f32_16x16x16_bf16 v[44:47], v[34:35], v[96:97], v[44:47]
    v_add_f32_dpp v24, v24, v24 row_ror:8 row_mask:0xf bank_mask:0xf
    v_mov_b32 v25, v24
    s_nop 1
    v_permlane32_swap_b32 v24, v25
    v_add_f32 v24, v24, v25
    v_mov_b32 v25, v24
    s_nop 1
    v_permlane16_swap_b32 v24, v25
    v_add_f32 v24, v24, v25
    v_mov_b32 v25, s61
    v_rcp_f32 v26, v24
    v_med3_f32 v25, v24, s60, v25
    v_cmp_neq_f32 vcc, v24, v25
    v_pk_mul_f32 v[40:41], v[40:41], v[26:27] op_sel_hi:[1,0]
    v_pk_mul_f32 v[42:43], v[42:43], v[26:27] op_sel_hi:[1,0]
    v_pk_mul_f32 v[44:45], v[44:45], v[26:27] op_sel_hi:[1,0]
    v_pk_mul_f32 v[46:47], v[46:47], v[26:27] op_sel_hi:[1,0]
    s_cbranch_vccnz RS_FB
RS_OK:
    buffer_load_dwordx4 v[60:63], v1, s[8:11], s65 offen offset:0 sc1
    v_cvt_pk_bf16_f32 v48, v40, v41
    v_cvt_pk_bf16_f32 v49, v42, v43
    v_cvt_pk_bf16_f32 v50, v44, v45
    v_cvt_pk_bf16_f32 v51, v46, v47
    s_mov_b64 exec, s[50:51]
    ds_write_b128 v7, v[48:51] offset:8192
    s_mov_b64 exec, -1
    ds_read_b128 v[84:87], v10 offset:20480
    ds_read_b128 v[88:91], v10 offset:21504
    ds_read_b128 v[92:95], v10 offset:22528
    ds_read_b128 v[96:99], v10 offset:23552
    buffer_load_dwordx4 v[64:67], v1, s[8:11], s65 offen offset:1024 sc1
    s_cmp_eq_u32 s33, 63
    s_cbranch_scc1 RS_LAST
    s_waitcnt lgkmcnt(4)
    s_barrier
    ds_read_b128 v[40:43], v1 offset:8192
    ds_read_b128 v[44:47], v1 offset:9216
    v_mov_b64 v[16:17], 0
    v_mov_b64 v[18:19], 0
    v_mov_b64 v[20:21], 0
    v_mov_b64 v[22:23], 0
    v_mov_b64 v[24:25], 0
    v_mov_b64 v[26:27], 0
    v_mov_b64 v[28:29], 0
    v_mov_b64 v[30:31], 0
    v_mov_b64 v[32:33], 0
    v_mov_b64 v[34:35], 0
    v_mov_b64 v[36:37], 0
    v_mov_b64 v[38:39], 0
    s_waitcnt lgkmcnt(1)
    s_waitcnt vmcnt(9)
    v_smfmac_f32_16x16x64_bf16 v[16:19], v[40:43], v[68:75], v2
    buffer_load_dwordx4 v[68:71], v1, s[8:11], s64 offen offset:0 sc1
    buffer_load_dwordx4 v[72:75], v1, s[8:11], s64 offen offset:1024 sc1
    s_waitcnt vmcnt(9)
    v_smfmac_f32_16x16x64_bf16 v[20:23], v[40:43], v[76:83], v2
    buffer_load_dwordx4 v[76:79], v1, s[8:11], s64 offen offset:2048 sc1
    buffer_load_dwordx4 v[80:83], v1, s[8:11], s64 offen offset:3072 sc1
    s_waitcnt lgkmcnt(0)
    v_smfmac_f32_16x16x64_bf16 v[16:19], v[44:47], v[84:91], v2
    ds_read_b128 v[84:87], v10 offset:24576
    ds_read_b128 v[88:91], v10 offset:25600
    v_smfmac_f32_16x16x64_bf16 v[20:23], v[44:47], v[92:99], v2
    ds_read_b128 v[92:95], v10 offset:26624
    ds_read_b128 v[96:99], v10 offset:27648
    v_smfmac_f32_16x16x64_bf16 v[24:27], v[40:43], a[176:183], v2
    v_smfmac_f32_16x16x64_bf16 v[28:31], v[40:43], a[184:191], v2
    s_nop 0
    v_add_f32 v16, v16, v17
    v_add_f32 v18, v18, v19
    s_nop 0
    v_add_f32 v20, v20, v21
    s_waitcnt lgkmcnt(2)
    v_smfmac_f32_16x16x64_bf16 v[24:27], v[44:47], v[84:91], v2
    ds_read_b128 v[84:87], v10 offset:28672
    ds_read_b128 v[88:91], v10 offset:29696
    v_add_f32 v22, v22, v23
    v_cvt_pk_bf16_f32 v48, v16, v18
    v_cvt_pk_bf16_f32 v49, v20, v22
    s_waitcnt lgkmcnt(2)
    v_smfmac_f32_16x16x64_bf16 v[28:31], v[44:47], v[92:99], v2
    ds_read_b128 v[92:95], v10 offset:30720
    ds_read_b128 v[96:99], v10 offset:31744
    v_and_or_b32 v48, v48, -2, s28
    buffer_store_dwordx2 v[48:49], v3, s[8:11], s34 offen sc1
    v_mov_b64 v[16:17], 0
    v_smfmac_f32_16x16x64_bf16 v[32:35], v[40:43], a[192:199], v2
    v_mov_b64 v[18:19], 0
    v_mov_b64 v[20:21], 0
    v_mov_b64 v[22:23], 0
    v_smfmac_f32_16x16x64_bf16 v[36:39], v[40:43], a[200:207], v2
    v_add_f32 v24, v24, v25
    v_add_f32 v26, v26, v27
    v_add_f32 v28, v28, v29
    s_waitcnt lgkmcnt(2)
    v_smfmac_f32_16x16x64_bf16 v[32:35], v[44:47], v[84:91], v2
    ds_read_b128 v[84:87], v10 offset:32768
    ds_read_b128 v[88:91], v10 offset:33792
    v_add_f32 v30, v30, v31
    v_cvt_pk_bf16_f32 v50, v24, v26
    v_cvt_pk_bf16_f32 v51, v28, v30
    s_waitcnt lgkmcnt(2)
    v_smfmac_f32_16x16x64_bf16 v[36:39], v[44:47], v[92:99], v2
    ds_read_b128 v[92:95], v10 offset:34816
    ds_read_b128 v[96:99], v10 offset:35840
    v_and_or_b32 v50, v50, -2, s28
    buffer_store_dwordx2 v[50:51], v3, s[8:11], s73 offen sc1
    v_mov_b64 v[24:25], 0
    v_smfmac_f32_16x16x64_bf16 v[16:19], v[40:43], a[208:215], v2
    v_mov_b64 v[26:27], 0
    v_mov_b64 v[28:29], 0
    v_mov_b64 v[30:31], 0
    v_smfmac_f32_16x16x64_bf16 v[20:23], v[40:43], a[216:223], v2
    v_add_f32 v32, v32, v33
    v_add_f32 v34, v34, v35
    v_add_f32 v36, v36, v37
    s_waitcnt lgkmcnt(2)
    v_smfmac_f32_16x16x64_bf16 v[16:19], v[44:47], v[84:91], v2
    v_add_f32 v38, v38, v39
    v_cvt_pk_bf16_f32 v48, v32, v34
    v_cvt_pk_bf16_f32 v49, v36, v38
    s_waitcnt lgkmcnt(0)
    v_smfmac_f32_16x16x64_bf16 v[20:23], v[44:47], v[92:99], v2
    v_and_or_b32 v48, v48, -2, s28
    buffer_store_dwordx2 v[48:49], v3, s[8:11], s74 offen sc1
    v_smfmac_f32_16x16x64_bf16 v[24:27], v[40:43], a[224:231], v2
    v_smfmac_f32_16x16x64_bf16 v[28:31], v[40:43], a[232:239], v2
    v_add_f32 v16, v16, v17
    v_add_f32 v18, v18, v19
    s_nop 1
    v_add_f32 v20, v20, v21
    v_smfmac_f32_16x16x64_bf16 v[24:27], v[44:47], a[240:247], v2
    v_add_f32 v22, v22, v23
    v_cvt_pk_bf16_f32 v50, v16, v18
    v_cvt_pk_bf16_f32 v51, v20, v22
    v_smfmac_f32_16x16x64_bf16 v[28:31], v[44:47], a[248:255], v2
    v_and_or_b32 v50, v50, -2, s28
    buffer_store_dwordx2 v[50:51], v3, s[8:11], s75 offen sc1
    s_nop 1
    v_add_f32 v24, v24, v25
    v_add_f32 v26, v26, v27
    s_nop 1
    v_add_f32 v28, v28, v29
    v_add_f32 v30, v30, v31
    v_cvt_pk_bf16_f32 v48, v24, v26
    v_cvt_pk_bf16_f32 v49, v28, v30
    v_and_or_b32 v48, v48, -2, s28
    buffer_store_dwordx2 v[48:49], v3, s[8:11], s76 offen sc1
    s_cmp_ge_u32 s41, 80
    s_cbranch_scc1 RS_NR
    v_lshrrev_b32 v0, 2, v1
    v_and_b32 v0, 16, v0
    s_movk_i32 s3, 0x3f80
    v_lshlrev_b32_e64 v0, v0, s3
    s_mov_b32 vcc_lo, 0x110011
    s_mov_b32 vcc_hi, 0x110011
    v_cndmask_b32 v100, 0, v0, vcc
    s_mov_b32 vcc_lo, 0x11001100
    s_mov_b32 vcc_hi, 0x11001100
    v_cndmask_b32 v101, 0, v0, vcc
    s_mov_b32 vcc_lo, 0x220022
    s_mov_b32 vcc_hi, 0x220022
    v_cndmask_b32 v102, 0, v0, vcc
    s_mov_b32 vcc_lo, 0x22002200
    s_mov_b32 vcc_hi, 0x22002200
    v_cndmask_b32 v103, 0, v0, vcc
    s_sleep 1
    s_cmp_lg_u32 s13, 0
    s_cbranch_scc1 RS_C1
RS_C0:
    buffer_load_dwordx4 v[16:19], v4, s[8:11], s34 offen offset:0 sc1
    buffer_load_dwordx4 v[20:23], v4, s[8:11], s34 offen offset:1024 sc1
    buffer_load_dwordx4 v[24:27], v4, s[8:11], s34 offen offset:2048 sc1
    buffer_load_dwordx4 v[28:31], v4, s[8:11], s34 offen offset:3072 sc1
    buffer_load_dwordx4 v[84:87], v1, s[8:11], s65 offen offset:2048 sc1
    buffer_load_dwordx4 v[88:91], v1, s[8:11], s65 offen offset:3072 sc1
    buffer_load_dwordx4 v[92:95], v1, s[8:11], s66 offen offset:0 sc1
    buffer_load_dwordx4 v[96:99], v1, s[8:11], s66 offen offset:1024 sc1
    s_waitcnt vmcnt(4)
RS_CK:
    v_mfma_f32_16x16x32_bf16 v[48:51], v[100:103], v[16:19], 0
    v_mfma_f32_16x16x32_bf16 v[48:51], v[100:103], v[20:23], v[48:51]
    v_mfma_f32_16x16x32_bf16 v[48:51], v[100:103], v[24:27], v[48:51]
    v_mfma_f32_16x16x32_bf16 v[48:51], v[100:103], v[28:31], v[48:51]
    v_bitop3_b32 v44, v16, v18, s28 bitop3:0x7e
    v_bitop3_b32 v45, v20, v22, s28 bitop3:0x7e
    v_bitop3_b32 v46, v24, v26, s28 bitop3:0x7e
    v_bitop3_b32 v47, v28, v30, s28 bitop3:0x7e
    v_or3_b32 v0, v44, v45, v46
    v_bitop3_b32 v0, v0, v47, 1 bitop3:0xa8
    v_cmp_ne_u32 vcc, 0, v0
    s_nop 0
    s_cbranch_vccnz RS_PB
RS_PA1:
    buffer_load_dwordx4 v[40:43], v6, s[8:11], s35 offen sc1
    v_mov_b32 v44, s57
    v_add_f32_dpp v48, v48, v48 row_ror:8 row_mask:0xf bank_mask:0xf
    v_add_f32_dpp v49, v49, v49 row_ror:8 row_mask:0xf bank_mask:0xf
    s_mov_b64 exec, s[50:51]
    v_cvt_pk_bf16_f32 v48, v48, v49
    buffer_store_dword v48, v5, s[8:11], s35 offen sc1
    buffer_store_dword v44, v5, s[8:11], s36 offen sc1
    s_mov_b64 exec, -1
    v_mov_b64 v[16:17], 0
    v_mov_b64 v[18:19], 0
    v_mov_b64 v[20:21], 0
    v_mov_b64 v[22:23], 0
    v_mov_b64 v[24:25], 0
    v_mov_b64 v[26:27], 0
    v_mov_b64 v[28:29], 0
    v_mov_b64 v[30:31], 0
    v_mov_b64 v[32:33], 0
    v_mov_b64 v[34:35], 0
    v_mov_b64 v[36:37], 0
    v_mov_b64 v[38:39], 0
    s_waitcnt vmcnt(2)
RS_BL:
    v_max3_u32 v0, v40, v41, v42
    v_max_u32 v0, v0, v43
    v_cmp_le_u32 vcc, s63, v0
    s_nop 0
    s_cbranch_vccnz RS_BX
RS_BOK0:
    s_xor_b32 s28, s28, 1
    s_mov_b32 s36, s35
    s_add_u32 s35, s35, 10240
    s_cmp_eq_u32 s35, 0x1c7800
    s_cselect_b32 s35, 0x1c0000, s35
    s_add_u32 s33, s33, 1
    s_branch RS_STEP
RS_C1:
    s_sleep 1
    s_cmp_lt_u32 s41, 64
    s_cbranch_scc1 RS_C2
    s_sleep 3
    s_branch RS_C0
RS_C2:
    buffer_load_dwordx4 v[84:87], v1, s[8:11], s65 offen offset:2048 sc1
    buffer_load_dwordx4 v[88:91], v1, s[8:11], s65 offen offset:3072 sc1
    buffer_load_dwordx4 v[92:95], v1, s[8:11], s66 offen offset:0 sc1
    buffer_load_dwordx4 v[96:99], v1, s[8:11], s66 offen offset:1024 sc1
    s_cmp_lt_u32 s41, 64
    s_cbranch_scc1 RS_PAR2
    s_sleep 1
RS_PAR2:
    buffer_load_dwordx4 v[16:19], v4, s[8:11], s34 offen offset:0 sc1
    buffer_load_dwordx4 v[20:23], v4, s[8:11], s34 offen offset:1024 sc1
    buffer_load_dwordx4 v[24:27], v4, s[8:11], s34 offen offset:2048 sc1
    buffer_load_dwordx4 v[28:31], v4, s[8:11], s34 offen offset:3072 sc1
    s_waitcnt vmcnt(0)
    s_branch RS_CK
RS_NR:
    v_mov_b64 v[16:17], 0
    v_mov_b64 v[18:19], 0
    v_mov_b64 v[20:21], 0
    v_mov_b64 v[22:23], 0
    v_mov_b64 v[24:25], 0
    v_mov_b64 v[26:27], 0
    v_mov_b64 v[28:29], 0
    v_mov_b64 v[30:31], 0
    v_mov_b64 v[32:33], 0
    v_mov_b64 v[34:35], 0
    v_mov_b64 v[36:37], 0
    v_mov_b64 v[38:39], 0
    s_sleep 2
    buffer_load_dwordx4 v[84:87], v1, s[8:11], s65 offen offset:2048 sc1
    buffer_load_dwordx4 v[88:91], v1, s[8:11], s65 offen offset:3072 sc1
    buffer_load_dwordx4 v[92:95], v1, s[8:11], s66 offen offset:0 sc1
    buffer_load_dwordx4 v[96:99], v1, s[8:11], s66 offen offset:1024 sc1
    s_sleep 6
RS_BX:
    buffer_load_dwordx4 v[40:43], v6, s[8:11], s35 offen sc1
    s_add_u32 s99, s99, 1
    s_and_b32 s3, s99, 63
    s_waitcnt vmcnt(0)
    s_cbranch_scc1 RS_BL
    s_mov_b64 s[96:97], 0
    v_cmp_eq_u32 vcc, s57, v40
    s_nop 0
    s_or_b64 s[96:97], s[96:97], vcc
    v_cmp_eq_u32 vcc, s57, v41
    s_nop 0
    s_or_b64 s[96:97], s[96:97], vcc
    v_cmp_eq_u32 vcc, s57, v42
    s_nop 0
    s_or_b64 s[96:97], s[96:97], vcc
    v_cmp_eq_u32 vcc, s57, v43
    s_nop 0
    s_or_b64 s[96:97], s[96:97], vcc
    s_cmp_eq_u64 s[96:97], 0
    s_cbranch_scc1 RS_BOK0
    s_cmp_ge_u32 s99, 0x80000
    s_cbranch_scc1 RS_BOK0
    s_branch RS_BL
RS_PB:
    s_add_u32 s99, s99, 1
    s_cmp_lt_u32 s99, 0x80000
    s_cbranch_scc1 RS_PAR2
    s_branch RS_PA1
RS_BR1:
    v_cmp_eq_u32 vcc, s57, v0
    s_nop 0
    s_cbranch_vccnz RS_BS1
    s_mov_b64 s[96:97], 0
    v_cmp_eq_u32 vcc, s57, v48
    s_nop 0
    s_or_b64 s[96:97], s[96:97], vcc
    v_cmp_eq_u32 vcc, s57, v49
    s_nop 0
    s_or_b64 s[96:97], s[96:97], vcc
    v_cmp_eq_u32 vcc, s57, v50
    s_nop 0
    s_or_b64 s[96:97], s[96:97], vcc
    v_cmp_eq_u32 vcc, s57, v51
    s_nop 0
    s_or_b64 s[96:97], s[96:97], vcc
    s_cmp_eq_u64 s[96:97], 0
    s_cbranch_scc1 RS_BOK1
RS_BS1:
    s_add_u32 s99, s99, 1
    s_cmp_ge_u32 s99, 0x80000
    s_cbranch_scc1 RS_BOK1
    buffer_load_dwordx4 v[48:51], v6, s[8:11], s7 offen sc1
    s_waitcnt vmcnt(0)
    s_branch RS_BC1
RS_BR2:
    v_cmp_eq_u32 vcc, s57, v0
    s_nop 0
    s_cbranch_vccnz RS_BS2
    s_mov_b64 s[96:97], 0
    v_cmp_eq_u32 vcc, s57, v44
    s_nop 0
    s_or_b64 s[96:97], s[96:97], vcc
    v_cmp_eq_u32 vcc, s57, v45
    s_nop 0
    s_or_b64 s[96:97], s[96:97], vcc
    v_cmp_eq_u32 vcc, s57, v46
    s_nop 0
    s_or_b64 s[96:97], s[96:97], vcc
    v_cmp_eq_u32 vcc, s57, v47
    s_nop 0
    s_or_b64 s[96:97], s[96:97], vcc
    s_cmp_eq_u64 s[96:97], 0
    s_cbranch_scc1 RS_BOK2
RS_BS2:
    s_add_u32 s99, s99, 1
    s_cmp_ge_u32 s99, 0x80000
    s_cbranch_scc1 RS_BOK2
    buffer_load_dwordx4 v[44:47], v1, s[8:11], s59 offen sc1
    s_waitcnt vmcnt(0)
    s_branch RS_BC2
RS_BR3:
    v_cmp_eq_u32 vcc, s57, v0
    s_nop 0
    s_cbranch_vccnz RS_BS3
    s_mov_b64 s[96:97], 0
    v_cmp_eq_u32 vcc, s57, v100
    s_nop 0
    s_or_b64 s[96:97], s[96:97], vcc
    v_cmp_eq_u32 vcc, s57, v101
    s_nop 0
    s_or_b64 s[96:97], s[96:97], vcc
    v_cmp_eq_u32 vcc, s57, v102
    s_nop 0
    s_or_b64 s[96:97], s[96:97], vcc
    v_cmp_eq_u32 vcc, s57, v103
    s_nop 0
    s_or_b64 s[96:97], s[96:97], vcc
    s_cmp_eq_u64 s[96:97], 0
    s_cbranch_scc1 RS_BOK3
RS_BS3:
    s_add_u32 s99, s99, 1
    s_cmp_ge_u32 s99, 0x80000
    s_cbranch_scc1 RS_BOK3
    buffer_load_dwordx4 v[100:103], v1, s[8:11], s62 offen sc1
    s_waitcnt vmcnt(0)
    s_branch RS_BC3
RS_WKV:
    v_lshrrev_b32 v0, 2, v1
    buffer_load_dword v11, v0, s[8:11], s71 offen sc1
    s_waitcnt vmcnt(0)
    v_cmp_ne_u32 s[48:49], 0, v11
    s_nop 0
    s_bitcmp1_b64 s[48:49], s4
    s_nop 1
    s_cbranch_scc1 RS_KVOK
    s_add_u32 s99, s99, 1
    s_cmp_lt_u32 s99, 0x80000
    s_cbranch_scc1 RS_WKV
    s_branch RS_KVOK
RS_FB:
    s_cmp_lg_u32 s58, 0
    s_cbranch_scc1 RS_OK
    s_mov_b32 s58, 1
    v_max3_f32 v24, v84, v85, v86
    v_max3_f32 v24, v24, v87, v20
    s_nop 1
    v_max_f32_dpp v24, v24, v24 row_ror:8 row_mask:0xf bank_mask:0xf
    v_mov_b32 v25, v24
    s_nop 1
    v_permlane32_swap_b32 v24, v25
    v_max_f32 v24, v24, v25
    v_mov_b32 v25, v24
    s_nop 1
    v_permlane16_swap_b32 v24, v25
    v_max_f32 v24, v24, v25
    v_sub_f32 v84, v84, v24
    v_sub_f32 v85, v85, v24
    v_sub_f32 v86, v86, v24
    v_sub_f32 v87, v87, v24
    v_sub_f32 v20, v20, v24
    s_nop 0
    s_branch RS_EXP
RS_LAST:
    s_waitcnt vmcnt(0) lgkmcnt(0)
    s_barrier
    s_add_u32 s49, s39, 252
    s_cmp_lg_u32 s13, 0
    s_cbranch_scc1 SIG_51
    v_mov_b32 v16, 0
    v_mov_b32 v17, 1
    s_mov_b64 exec, 1
    buffer_store_dword v17, v16, s[8:11], s49 offen sc1
    s_mov_b64 exec, -1
SIG_51:
    s_nop 7
    s_nop 7
    s_add_u32 s14, s14, 1
    s_cmp_lt_u32 s14, s15
    s_cbranch_scc1 RS_PAIR
    s_endpgm
.section .rodata,"a"
.p2align 6
.amdhsa_kernel init_kernel
  .amdhsa_next_free_vgpr 8
  .amdhsa_next_free_sgpr 16
  .amdhsa_accum_offset 8
  .amdhsa_group_segment_fixed_size 0
  .amdhsa_kernarg_size 120
  .amdhsa_user_sgpr_count 2
  .amdhsa_user_sgpr_kernarg_segment_ptr 1
  .amdhsa_system_sgpr_workgroup_id_x 1
.end_amdhsa_kernel
.p2align 6
.amdhsa_kernel m0_kernel
  .amdhsa_next_free_vgpr 512
  .amdhsa_next_free_sgpr 102
  .amdhsa_accum_offset 256
  .amdhsa_group_segment_fixed_size 0
  .amdhsa_kernarg_size 120
  .amdhsa_user_sgpr_count 2
  .amdhsa_user_sgpr_kernarg_segment_ptr 1
  .amdhsa_system_sgpr_workgroup_id_x 1
.end_amdhsa_kernel
```
